```python
import torch

def _softmax(x, axis=-1):
    return torch.softmax(x, dim=axis)
def _gelu(x):
    return torch.nn.functional.gelu(x, approximate="tanh")
def _silu(x):
    return torch.nn.functional.silu(x)
def _sigmoid(x):
    return torch.sigmoid(x)
def _layernorm(x, axis=-1, eps=1e-5):
    m = x.mean(dim=axis, keepdim=True)
    v = x.var(dim=axis, keepdim=True, unbiased=False)
    return (x - m) / torch.sqrt(v + eps)
def _scatter_add(tgt, idx, src, axis=0):
    return tgt.clone().index_add_(axis, idx, src)
def _segment_sum(src, seg, n):
    out = torch.zeros((n,) + src.shape[1:], dtype=src.dtype)
    return out.index_add_(0, seg, src)
def _pad(x, pw):
    flat = tuple(v for pair in reversed(pw) for v in pair)
    return torch.nn.functional.pad(x, flat)

kernel_name = 'parallel_sum__compressed_kv_cla__geglu_ffn__prompt'

def setup_inputs():

    _w = (lambda a: (lambda t: t.to(torch.bfloat16) if t.is_floating_point() else t)(torch.as_tensor(a)))
    def _A_setup():
        B, H, Sq, Sk, D, M = 1, 32, 2048, 2048, 128, 512
        Dc = 4 * D
        return {
            "x": _w((lambda *s: torch.randn(*s, dtype=torch.bfloat16) * 0.05)(B, Sq, M)),
            "c_kv": _w((lambda *s: torch.randn(*s, dtype=torch.bfloat16) * 1.6)(B, Sk, Dc)),
            "w_q": _w((lambda *s: torch.randn(*s, dtype=torch.bfloat16) * 0.8)(M, H, D) * (M ** -0.5)),
            "w_uk": _w((lambda *s: torch.randn(*s, dtype=torch.bfloat16) * 0.8)(Dc, H, D) * (Dc ** -0.5)),
            "w_uv": _w((lambda *s: torch.randn(*s, dtype=torch.bfloat16) * 1.6)(Dc, H, D) * (Dc ** -0.5)),
            "w_o": _w((lambda *s: torch.randn(*s, dtype=torch.bfloat16) * 1.6)(H, D, M) * ((H * D) ** -0.5)),
        }
    _A_in = _A_setup()

    def _B_setup():
        B, S, D, F = 1, 2048, 512, 1376
        return {
            "x": _w((lambda *s: torch.randn(*s, dtype=torch.bfloat16) * 0.05)(B, S, D)),
            "w_gate": _w((lambda *s: torch.randn(*s, dtype=torch.bfloat16) * 0.05)(D, F)),
            "w_up": _w((lambda *s: torch.randn(*s, dtype=torch.bfloat16) * 0.05)(D, F)),
            "w_down": _w((lambda *s: torch.randn(*s, dtype=torch.bfloat16) * 0.05)(F, D)),
        }
    _B_in = _B_setup()

    return {
        "A_x": _A_in["x"],
        "A_c_kv": _A_in["c_kv"],
        "A_w_q": _A_in["w_q"],
        "A_w_uk": _A_in["w_uk"],
        "A_w_uv": _A_in["w_uv"],
        "A_w_o": _A_in["w_o"],
        "B_x": _B_in["x"],
        "B_w_gate": _B_in["w_gate"],
        "B_w_up": _B_in["w_up"],
        "B_w_down": _B_in["w_down"],
    }

def reference(A_x, A_c_kv, A_w_q, A_w_uk, A_w_uv, A_w_o, B_x, B_w_gate, B_w_up, B_w_down):
    def _A_ref(x, c_kv, w_q, w_uk, w_uv, w_o):
        B, Sq, M = x.shape[0], x.shape[1], x.shape[2]
        Sk = c_kv.shape[1]
        H, D = w_q.shape[1], w_q.shape[2]
        q = torch.einsum("bqm,mhd->bhqd", x, w_q)
        k = torch.einsum("bkc,chd->bhkd", c_kv, w_uk)
        v = torch.einsum("bkc,chd->bhkd", c_kv, w_uv)
        scores = torch.einsum("bhqd,bhkd->bhqk", q, k) * (D ** -0.5)
        off = Sk - Sq
        qi = torch.arange(Sq)[:, None]
        kj = torch.arange(Sk)[None, :]
        cmask = kj <= (qi + off)
        scores = torch.where(cmask[None, None], scores, -1e9)
        p = _softmax(scores, axis=-1)
        ctx = torch.einsum("bhqk,bhkd->bhqd", p, v)
        return torch.einsum("bhqd,hdm->bqm", ctx, w_o)

    def _B_ref(x, w_gate, w_up, w_down):
        return (_gelu(x @ w_gate) * (x @ w_up)) @ w_down

    x = A_x
    xn = _layernorm(x, axis=-1)
    return x + _A_ref(xn, A_c_kv, A_w_q, A_w_uk, A_w_uv, A_w_o) + _B_ref(xn, B_w_gate, B_w_up, B_w_down)
```

```asm
; @launch grid=(256,1,1) block=(256,1,1) lds=163840
.amdgcn_target "amdgcn-amd-amdhsa--gfx950"
.text
.globl parallel_sum__compressed_kv_cla__geglu_ffn__prompt_kernel
.p2align 8
.type parallel_sum__compressed_kv_cla__geglu_ffn__prompt_kernel,@function
parallel_sum__compressed_kv_cla__geglu_ffn__prompt_kernel:
    s_cmp_ge_u32 s2, 256
    s_cbranch_scc1 L_exit
    s_load_dwordx2 s[8:9], s[0:1], 8
    s_load_dwordx2 s[16:17], s[0:1], 24
    s_load_dwordx2 s[4:5], s[0:1], 0
    s_load_dwordx2 s[48:49], s[0:1], 96
    s_load_dwordx2 s[44:45], s[0:1], 88
    s_load_dwordx2 s[20:21], s[0:1], 32
    s_load_dwordx2 s[12:13], s[0:1], 16
    s_load_dwordx2 s[24:25], s[0:1], 40
    s_load_dwordx2 s[28:29], s[0:1], 56
    s_load_dwordx2 s[32:33], s[0:1], 64
    s_load_dwordx2 s[36:37], s[0:1], 72
    s_load_dwordx2 s[40:41], s[0:1], 80
    v_and_b32 v255, 63, v0
    v_lshrrev_b32 v1, 6, v0
    s_mov_b32 s55, s2
    v_readfirstlane_b32 s52, v1
    s_getpc_b64 s[76:77]
L_pc_1:
    s_sub_u32 s76, s76, L_pc_1-parallel_sum__compressed_kv_cla__geglu_ffn__prompt_kernel
    s_subb_u32 s77, s77, 0
    s_lshr_b32 s73, s55, 3
    s_lshl_b32 s73, s73, 2
    s_add_u32 s73, s73, s52
    s_lshl_b32 s73, s73, 10
    v_lshlrev_b32 v22, 4, v255
    v_add_u32 v22, s73, v22
    v_min_u32 v22, L_exit-parallel_sum__compressed_kv_cla__geglu_ffn__prompt_kernel-16, v22
    v_mov_b32 v23, s77
    v_add_co_u32 v22, vcc, s76, v22
    s_nop 1
    v_addc_co_u32 v23, vcc, 0, v23, vcc
    global_load_dwordx4 v[172:175], v[22:23], off
    s_mov_b32 s10, 2097152
    s_mov_b32 s11, 0x20000
    s_mov_b32 s18, 4194304
    s_mov_b32 s19, 0x20000
    s_mov_b32 s6, 2097152
    s_mov_b32 s7, 0x20000
    s_mov_b32 s50, 75497472
    s_mov_b32 s51, 0x20000
    s_mov_b32 s46, 256
    s_mov_b32 s47, 0x20000
    s_mov_b32 s22, 4194304
    s_mov_b32 s23, 0x20000
    s_mov_b32 s14, 4194304
    s_mov_b32 s15, 0x20000
    s_mov_b32 s26, 4194304
    s_mov_b32 s27, 0x20000
    s_mov_b32 s30, 1409024
    s_mov_b32 s31, 0x20000
    s_mov_b32 s34, 1409024
    s_mov_b32 s35, 0x20000
    s_mov_b32 s38, 1409024
    s_mov_b32 s39, 0x20000
    s_mov_b32 s42, 2097152
    s_mov_b32 s43, 0x20000
    s_and_b32 s56, s55, 7
    s_lshl_b32 s56, s56, 2
    s_bfe_u32 s73, s55, 0x20003
    s_add_u32 s53, s56, s73
    s_lshr_b32 s54, s55, 5
    s_lshl_b32 s57, s52, 11
    s_mul_i32 s58, s52, 24576
    s_add_u32 s58, s58, 65536
    s_add_u32 s56, s53, s54
    s_mul_i32 s73, s56, 86
    s_lshr_b32 s73, s73, 8
    s_mul_i32 s73, s73, 3
    s_sub_u32 s56, s56, s73
    s_mov_b32 s80, 0
    s_add_u32 s73, s56, 0
    s_sub_u32 s74, s73, 3
    s_min_u32 s73, s73, s74
    s_add_u32 s73, s73, 1
    s_lshl_b32 s81, s73, 8
    s_add_u32 s73, s56, 1
    s_sub_u32 s74, s73, 3
    s_min_u32 s73, s73, s74
    s_add_u32 s73, s73, 1
    s_lshl_b32 s82, s73, 8
    s_add_u32 s73, s56, 2
    s_sub_u32 s74, s73, 3
    s_min_u32 s73, s73, s74
    s_add_u32 s73, s73, 1
    s_lshl_b32 s85, s73, 8
    v_lshrrev_b32 v1, 3, v255
    v_lshrrev_b32 v2, 4, v255
    v_and_b32 v3, 7, v255
    s_lshl_b32 s56, s54, 2
    s_add_u32 s56, s56, s52
    s_lshl_b32 s56, s56, 16
    v_xor_b32 v4, v3, v2
    v_lshlrev_b32 v5, 10, v1
    v_lshl_add_u32 v6, v4, 4, v5
    v_add_u32 v128, s56, v6
    v_xor_b32 v7, 64, v128
    v_add_u32 v129, 7168, v7
    v_add_u32 v130, 14336, v128
    v_add_u32 v131, 21504, v7
    v_add_u32 v132, 32768, v128
    v_add_u32 v133, 39936, v7
    v_add_u32 v134, 47104, v128
    v_add_u32 v135, 54272, v7
    v_lshrrev_b32 v8, 5, v255
    v_and_b32 v9, 3, v1
    v_lshl_add_u32 v9, v8, 3, v9
    s_lshr_b32 s56, s52, 1
    s_lshl_b32 s56, s56, 5
    s_and_b32 s73, s52, 1
    s_lshl_b32 s73, s73, 2
    s_add_u32 s56, s56, s73
    v_add_u32 v9, s56, v9
    v_lshlrev_b32 v10, 1, v2
    v_xor_b32 v10, v3, v10
    v_lshlrev_b32 v10, 4, v10
    s_lshl_b32 s56, s53, 8
    v_lshl_add_u32 v11, v9, 13, v10
    v_add_u32 v239, s56, v11
    v_add_u32 v240, 130048, v239
    v_mov_b32 v253, 0
    v_mov_b32 v254, 1
    s_waitcnt lgkmcnt(0)
    s_add_u32 s56, s80, 0
    s_add_u32 m0, s58, 0
    s_nop 0
    buffer_load_dwordx4 v128, s[8:11], s56 offen offset:0 sc1 lds
    buffer_load_dwordx4 v129, s[8:11], s56 offen offset:1024 sc1 lds
    buffer_load_dwordx4 v130, s[8:11], s56 offen offset:2048 sc1 lds
    buffer_load_dwordx4 v131, s[8:11], s56 offen offset:3072 sc1 lds
    s_add_u32 m0, s58, 4096
    s_nop 0
    buffer_load_dwordx4 v132, s[8:11], s56 offen offset:0 sc1 lds
    buffer_load_dwordx4 v133, s[8:11], s56 offen offset:1024 sc1 lds
    buffer_load_dwordx4 v134, s[8:11], s56 offen offset:2048 sc1 lds
    buffer_load_dwordx4 v135, s[8:11], s56 offen offset:3072 sc1 lds
    s_mul_i32 s56, s80, 4096
    s_add_u32 m0, s57, 0
    s_nop 0
    buffer_load_dwordx4 v239, s[16:19], s56 offen offset:0 sc1 lds
    buffer_load_dwordx4 v240, s[16:19], s56 offen offset:1024 sc1 lds
    s_mul_i32 s56, s80, 4096
    s_add_u32 s56, s56, 128
    s_add_u32 m0, s57, 8192
    s_nop 0
    buffer_load_dwordx4 v239, s[16:19], s56 offen offset:0 sc1 lds
    buffer_load_dwordx4 v240, s[16:19], s56 offen offset:1024 sc1 lds
    s_lshl_b32 s56, s55, 2
    s_add_u32 s56, s56, s52
    s_lshl_b32 s56, s56, 11
    v_and_b32 v12, 31, v255
    v_lshlrev_b32 v13, 10, v8
    v_lshl_add_u32 v13, v12, 4, v13
    v_add_u32 v168, s56, v13
    buffer_load_dwordx4 v[136:139], v168, s[4:7], 0 offen
    buffer_load_dwordx4 v[140:143], v168, s[4:7], 0 offen offset:512
    v_mov_b32 v14, 2147483392
    v_cmp_eq_u32 vcc, 0, v0
    v_lshlrev_b32 v250, 2, v12
    v_lshlrev_b32 v251, 2, v3
    v_cndmask_b32 v249, v14, v253, vcc
    s_lshr_b32 s56, s55, 4
    s_sub_u32 s73, 15, s56
    s_min_u32 s73, s56, s73
    s_lshl_b32 s73, s73, 7
    s_lshr_b32 s56, s55, 7
    s_lshl_b32 s56, s56, 4
    s_and_b32 s74, s55, 15
    s_add_u32 s56, s56, s74
    s_lshl_b32 s56, s56, 2
    s_add_u32 s94, s56, s73
    s_add_u32 s94, s94, 58720256
    s_lshl_b32 s56, s53, 7
    s_lshl_b32 s73, s54, 2
    s_add_u32 s95, s56, s73
    s_add_u32 s95, s95, 58721280
    s_lshl_b32 s56, s54, 7
    s_lshl_b32 s73, s53, 2
    s_add_u32 s56, s56, s73
    s_add_u32 s96, s56, 58725376
    s_add_u32 s97, s56, 58726400
    v_lshrrev_b32 v16, 1, v255
    v_and_b32 v17, 1, v255
    s_lshl_b32 s73, s54, 2
    s_add_u32 s73, s73, s52
    s_lshl_b32 s74, s73, 17
    s_lshl_b32 s75, s53, 8
    s_add_u32 s74, s74, s75
    v_lshlrev_b32 v16, 13, v16
    v_lshl_add_u32 v16, v17, 7, v16
    v_add_u32 v16, s74, v16
    v_mov_b32 v18, 2147483392
    v_cmp_gt_u32 vcc, 32, v255
    s_lshl_b32 s73, s73, 16
    s_and_b32 s75, s53, 3
    v_cndmask_b32 v226, v18, v16, vcc
    s_lshl_b32 s75, s75, 14
    s_add_u32 s73, s73, s75
    s_add_u32 s73, s73, 384
    v_and_b32 v16, 15, v255
    v_lshrrev_b32 v17, 4, v255
    v_lshlrev_b32 v16, 10, v16
    v_lshl_add_u32 v16, v17, 7, v16
    v_add_u32 v227, s73, v16
    v_lshrrev_b32 v160, 4, v255
    v_and_b32 v161, 15, v255
    v_lshrrev_b32 v162, 2, v161
    v_lshl_add_u32 v162, v160, 2, v162
    v_and_b32 v163, 3, v161
    v_lshlrev_b32 v163, 3, v163
    v_bfe_u32 v164, v162, 1, 2
    v_lshlrev_b32 v164, 5, v164
    v_lshl_add_u32 v165, v162, 7, v163
    v_add_u32 v232, v165, v164
    v_xor_b32 v233, 32, v232
    v_xor_b32 v234, 64, v232
    v_xor_b32 v235, 96, v232
    v_and_b32 v164, 1, v160
    v_lshlrev_b32 v164, 5, v164
    v_lshl_add_u32 v165, v162, 6, v163
    v_add_u32 v236, v165, v164
    v_xor_b32 v237, 32, v236
    v_lshl_add_u32 v238, v162, 5, v163
    v_lshrrev_b32 v164, 1, v161
    v_xor_b32 v164, v160, v164
    v_lshlrev_b32 v164, 4, v164
    v_lshl_add_u32 v164, v161, 7, v164
    v_add_u32 v241, s58, v164
    v_xor_b32 v242, 64, v241
    v_lshlrev_b32 v245, 4, v255
    v_add_u32 v246, 4096, v245
    v_add_u32 v247, 8192, v245
    v_add_u32 v248, 12288, v245
    s_add_u32 s56, s80, 128
    s_add_u32 m0, s58, 8192
    s_nop 0
    buffer_load_dwordx4 v128, s[8:11], s56 offen offset:0 sc1 lds
    buffer_load_dwordx4 v129, s[8:11], s56 offen offset:1024 sc1 lds
    buffer_load_dwordx4 v130, s[8:11], s56 offen offset:2048 sc1 lds
    buffer_load_dwordx4 v131, s[8:11], s56 offen offset:3072 sc1 lds
    s_add_u32 m0, s58, 12288
    s_nop 0
    buffer_load_dwordx4 v132, s[8:11], s56 offen offset:0 sc1 lds
    buffer_load_dwordx4 v133, s[8:11], s56 offen offset:1024 sc1 lds
    buffer_load_dwordx4 v134, s[8:11], s56 offen offset:2048 sc1 lds
    buffer_load_dwordx4 v135, s[8:11], s56 offen offset:3072 sc1 lds
    s_mul_i32 s56, s80, 4096
    s_add_u32 s56, s56, 524288
    s_add_u32 m0, s57, 16384
    s_nop 0
    buffer_load_dwordx4 v239, s[16:19], s56 offen offset:0 sc1 lds
    buffer_load_dwordx4 v240, s[16:19], s56 offen offset:1024 sc1 lds
    s_mul_i32 s56, s80, 4096
    s_add_u32 s56, s56, 524416
    s_add_u32 m0, s57, 24576
    s_nop 0
    buffer_load_dwordx4 v239, s[16:19], s56 offen offset:0 sc1 lds
    buffer_load_dwordx4 v240, s[16:19], s56 offen offset:1024 sc1 lds
    s_mul_i32 s73, s52, 3072
    s_add_u32 s73, s73, 58720256
    s_cmp_eq_u32 s55, 0
    s_cselect_b32 s73, s73, 2147483392
    v_lshlrev_b32 v20, 4, v255
    v_mov_b32 v24, 0
    v_mov_b32 v25, 0
    v_mov_b32 v26, 0
    v_mov_b32 v27, 0
    buffer_store_dwordx4 v[24:27], v20, s[48:51], s73 offen offset:0 sc1
    buffer_store_dwordx4 v[24:27], v20, s[48:51], s73 offen offset:1024 sc1
    buffer_store_dwordx4 v[24:27], v20, s[48:51], s73 offen offset:2048 sc1
    s_waitcnt vmcnt(21)
    ds_read_b128 a[0:3], v241 offset:0
    ds_read_b128 a[4:7], v241 offset:2048
    ds_read_b128 a[8:11], v241 offset:4096
    ds_read_b128 a[12:15], v241 offset:6144
    ds_read_b128 a[16:19], v242 offset:0
    ds_read_b128 a[20:23], v242 offset:2048
    ds_read_b128 a[24:27], v242 offset:4096
    ds_read_b128 a[28:31], v242 offset:6144
    s_waitcnt vmcnt(17) lgkmcnt(0)
    s_barrier
    ds_read_b64_tr_b16 v[192:193], v232 offset:0
    ds_read_b64_tr_b16 v[194:195], v232 offset:2048
    ds_read_b64_tr_b16 v[196:197], v232 offset:4096
    ds_read_b64_tr_b16 v[198:199], v232 offset:6144
    ds_read_b64_tr_b16 v[200:201], v233 offset:0
    ds_read_b64_tr_b16 v[202:203], v233 offset:2048
    ds_read_b64_tr_b16 v[204:205], v233 offset:4096
    ds_read_b64_tr_b16 v[206:207], v233 offset:6144
    s_waitcnt lgkmcnt(4)
    v_mfma_f32_16x16x32_bf16 v[0:3], v[192:195], a[0:3], 0
    s_mul_i32 s56, s81, 4096
    ds_read_b64_tr_b16 v[208:209], v234 offset:0
    v_mfma_f32_16x16x32_bf16 v[0:3], v[196:199], a[16:19], v[0:3]
    s_add_u32 m0, s57, 32768
    ds_read_b64_tr_b16 v[210:211], v234 offset:2048
    v_mfma_f32_16x16x32_bf16 v[4:7], v[192:195], a[4:7], 0
    buffer_load_dwordx4 v239, s[16:19], s56 offen offset:0 sc1 lds
    v_mfma_f32_16x16x32_bf16 v[4:7], v[196:199], a[20:23], v[4:7]
    ds_read_b64_tr_b16 v[212:213], v234 offset:4096
    v_mfma_f32_16x16x32_bf16 v[8:11], v[192:195], a[8:11], 0
    ds_read_b64_tr_b16 v[214:215], v234 offset:6144
    v_mfma_f32_16x16x32_bf16 v[8:11], v[196:199], a[24:27], v[8:11]
    v_mfma_f32_16x16x32_bf16 v[12:15], v[192:195], a[12:15], 0
    buffer_load_dwordx4 v240, s[16:19], s56 offen offset:1024 sc1 lds
    v_mfma_f32_16x16x32_bf16 v[12:15], v[196:199], a[28:31], v[12:15]
    s_waitcnt lgkmcnt(4)
    s_add_u32 s56, s81, 0
    ds_read_b64_tr_b16 v[192:193], v235 offset:0
    v_mfma_f32_16x16x32_bf16 v[16:19], v[200:203], a[0:3], 0
    s_add_u32 m0, s58, 16384
    ds_read_b64_tr_b16 v[194:195], v235 offset:2048
    v_mfma_f32_16x16x32_bf16 v[16:19], v[204:207], a[16:19], v[16:19]
    v_mfma_f32_16x16x32_bf16 v[20:23], v[200:203], a[4:7], 0
    buffer_load_dwordx4 v128, s[8:11], s56 offen offset:0 sc1 lds
    v_mfma_f32_16x16x32_bf16 v[20:23], v[204:207], a[20:23], v[20:23]
    ds_read_b64_tr_b16 v[196:197], v235 offset:4096
    v_mfma_f32_16x16x32_bf16 v[24:27], v[200:203], a[8:11], 0
    ds_read_b64_tr_b16 v[198:199], v235 offset:6144
    v_mfma_f32_16x16x32_bf16 v[24:27], v[204:207], a[24:27], v[24:27]
    v_mfma_f32_16x16x32_bf16 v[28:31], v[200:203], a[12:15], 0
    buffer_load_dwordx4 v129, s[8:11], s56 offen offset:1024 sc1 lds
    v_mfma_f32_16x16x32_bf16 v[28:31], v[204:207], a[28:31], v[28:31]
    s_waitcnt lgkmcnt(4)
    v_mfma_f32_16x16x32_bf16 v[32:35], v[208:211], a[0:3], 0
    v_mfma_f32_16x16x32_bf16 v[32:35], v[212:215], a[16:19], v[32:35]
    ds_read_b64_tr_b16 v[200:201], v232 offset:8192
    ds_read_b64_tr_b16 v[202:203], v232 offset:10240
    v_mfma_f32_16x16x32_bf16 v[36:39], v[208:211], a[4:7], 0
    buffer_load_dwordx4 v130, s[8:11], s56 offen offset:2048 sc1 lds
    v_mfma_f32_16x16x32_bf16 v[36:39], v[212:215], a[20:23], v[36:39]
    s_waitcnt vmcnt(21)
    ds_read_b64_tr_b16 v[204:205], v232 offset:12288
    v_lshlrev_b32 v144, 16, v136
    v_mfma_f32_16x16x32_bf16 v[40:43], v[208:211], a[8:11], 0
    v_and_b32 v145, 0xffff0000, v136
    v_mfma_f32_16x16x32_bf16 v[40:43], v[212:215], a[24:27], v[40:43]
    ds_read_b64_tr_b16 v[206:207], v232 offset:14336
    v_lshlrev_b32 v146, 16, v137
    v_mfma_f32_16x16x32_bf16 v[44:47], v[208:211], a[12:15], 0
    buffer_load_dwordx4 v131, s[8:11], s56 offen offset:3072 sc1 lds
    v_mfma_f32_16x16x32_bf16 v[44:47], v[212:215], a[28:31], v[44:47]
    s_waitcnt lgkmcnt(4)
    s_add_u32 s56, s81, 0
    ds_read_b64_tr_b16 v[208:209], v233 offset:8192
    v_mfma_f32_16x16x32_bf16 v[48:51], v[192:195], a[0:3], 0
    s_add_u32 m0, s58, 20480
    v_and_b32 v147, 0xffff0000, v137
    v_mfma_f32_16x16x32_bf16 v[48:51], v[196:199], a[16:19], v[48:51]
    ds_read_b64_tr_b16 v[210:211], v233 offset:10240
    v_lshlrev_b32 v148, 16, v138
    v_mfma_f32_16x16x32_bf16 v[52:55], v[192:195], a[4:7], 0
    buffer_load_dwordx4 v132, s[8:11], s56 offen offset:0 sc1 lds
    v_mfma_f32_16x16x32_bf16 v[52:55], v[196:199], a[20:23], v[52:55]
    s_waitcnt vmcnt(14)
    ds_read_b64_tr_b16 v[212:213], v233 offset:12288
    v_and_b32 v149, 0xffff0000, v138
    v_mfma_f32_16x16x32_bf16 v[56:59], v[192:195], a[8:11], 0
    v_lshlrev_b32 v150, 16, v139
    v_mfma_f32_16x16x32_bf16 v[56:59], v[196:199], a[24:27], v[56:59]
    ds_read_b64_tr_b16 v[214:215], v233 offset:14336
    ds_read_b128 a[32:35], v241 offset:8192
    v_mfma_f32_16x16x32_bf16 v[60:63], v[192:195], a[12:15], 0
    buffer_load_dwordx4 v133, s[8:11], s56 offen offset:1024 sc1 lds
    v_mfma_f32_16x16x32_bf16 v[60:63], v[196:199], a[28:31], v[60:63]
    s_waitcnt lgkmcnt(5)
    ds_read_b64_tr_b16 v[192:193], v234 offset:8192
    v_mfma_f32_16x16x32_bf16 v[64:67], v[200:203], a[0:3], 0
    ds_read_b128 a[36:39], v241 offset:10240
    v_and_b32 v151, 0xffff0000, v139
    v_mfma_f32_16x16x32_bf16 v[64:67], v[204:207], a[16:19], v[64:67]
    ds_read_b64_tr_b16 v[194:195], v234 offset:10240
    ds_read_b128 a[40:43], v241 offset:12288
    v_mfma_f32_16x16x32_bf16 v[68:71], v[200:203], a[4:7], 0
    buffer_load_dwordx4 v134, s[8:11], s56 offen offset:2048 sc1 lds
    v_mfma_f32_16x16x32_bf16 v[68:71], v[204:207], a[20:23], v[68:71]
    ds_read_b64_tr_b16 v[196:197], v234 offset:12288
    ds_read_b128 a[44:47], v241 offset:14336
    v_mfma_f32_16x16x32_bf16 v[72:75], v[200:203], a[8:11], 0
    v_lshlrev_b32 v152, 16, v140
    v_mfma_f32_16x16x32_bf16 v[72:75], v[204:207], a[24:27], v[72:75]
    ds_read_b64_tr_b16 v[198:199], v234 offset:14336
    ds_read_b128 a[48:51], v242 offset:8192
    v_mfma_f32_16x16x32_bf16 v[76:79], v[200:203], a[12:15], 0
    ds_read_b128 a[52:55], v242 offset:10240
    buffer_load_dwordx4 v135, s[8:11], s56 offen offset:3072 sc1 lds
    v_mfma_f32_16x16x32_bf16 v[76:79], v[204:207], a[28:31], v[76:79]
    s_waitcnt lgkmcnt(10)
    ds_read_b64_tr_b16 v[200:201], v235 offset:8192
    ds_read_b64_tr_b16 v[202:203], v235 offset:10240
    v_mfma_f32_16x16x32_bf16 v[80:83], v[208:211], a[0:3], 0
    s_add_u32 s56, s81, 128
    ds_read_b64_tr_b16 v[204:205], v235 offset:12288
    ds_read_b64_tr_b16 v[206:207], v235 offset:14336
    v_mfma_f32_16x16x32_bf16 v[80:83], v[212:215], a[16:19], v[80:83]
    s_add_u32 m0, s58, 0
    ds_read_b128 a[56:59], v242 offset:12288
    v_and_b32 v153, 0xffff0000, v140
    v_mfma_f32_16x16x32_bf16 v[84:87], v[208:211], a[4:7], 0
    buffer_load_dwordx4 v128, s[8:11], s56 offen offset:0 sc1 lds
    v_mfma_f32_16x16x32_bf16 v[84:87], v[212:215], a[20:23], v[84:87]
    ds_read_b128 a[60:63], v242 offset:14336
    v_lshlrev_b32 v154, 16, v141
    v_mfma_f32_16x16x32_bf16 v[88:91], v[208:211], a[8:11], 0
    v_and_b32 v155, 0xffff0000, v141
    v_mfma_f32_16x16x32_bf16 v[88:91], v[212:215], a[24:27], v[88:91]
    v_lshlrev_b32 v156, 16, v142
    v_mfma_f32_16x16x32_bf16 v[92:95], v[208:211], a[12:15], 0
    buffer_load_dwordx4 v129, s[8:11], s56 offen offset:1024 sc1 lds
    v_mfma_f32_16x16x32_bf16 v[92:95], v[212:215], a[28:31], v[92:95]
    s_waitcnt lgkmcnt(8)
    v_and_b32 v157, 0xffff0000, v142
    v_mfma_f32_16x16x32_bf16 v[96:99], v[192:195], a[0:3], 0
    v_lshlrev_b32 v158, 16, v143
    v_mfma_f32_16x16x32_bf16 v[96:99], v[196:199], a[16:19], v[96:99]
    buffer_load_dwordx4 v130, s[8:11], s56 offen offset:2048 sc1 lds
    v_mfma_f32_16x16x32_bf16 v[100:103], v[192:195], a[4:7], 0
    s_waitcnt vmcnt(13) lgkmcnt(0)
    s_barrier
    v_and_b32 v159, 0xffff0000, v143
    v_mfma_f32_16x16x32_bf16 v[100:103], v[196:199], a[20:23], v[100:103]
    ds_read_b64_tr_b16 v[208:209], v232 offset:16384
    ds_read_b64_tr_b16 v[210:211], v232 offset:18432
    v_mfma_f32_16x16x32_bf16 v[104:107], v[192:195], a[8:11], 0
    ds_read_b64_tr_b16 v[212:213], v232 offset:20480
    ds_read_b64_tr_b16 v[214:215], v232 offset:22528
    v_mfma_f32_16x16x32_bf16 v[104:107], v[196:199], a[24:27], v[104:107]
    buffer_load_dwordx4 v131, s[8:11], s56 offen offset:3072 sc1 lds
    v_mfma_f32_16x16x32_bf16 v[108:111], v[192:195], a[12:15], 0
    s_mul_i32 s56, s81, 4096
    s_add_u32 s56, s56, 128
    s_add_u32 m0, s57, 0
    v_mfma_f32_16x16x32_bf16 v[108:111], v[196:199], a[28:31], v[108:111]
    ds_read_b64_tr_b16 v[192:193], v233 offset:16384
    v_add_f32 v160, v144, v145
    v_mfma_f32_16x16x32_bf16 v[112:115], v[200:203], a[0:3], 0
    s_cmp_eq_u32 s55, 0
    s_cselect_b32 s100, 0, 2147483392
    v_add_f32 v161, v146, v147
    v_mfma_f32_16x16x32_bf16 v[112:115], v[204:207], a[16:19], v[112:115]
    buffer_store_dword v254, v249, s[44:47], s100 offen sc1
    v_mfma_f32_16x16x32_bf16 v[116:119], v[200:203], a[4:7], 0
    buffer_load_dwordx4 v239, s[16:19], s56 offen offset:0 sc1 lds
    v_mfma_f32_16x16x32_bf16 v[116:119], v[204:207], a[20:23], v[116:119]
    ds_read_b64_tr_b16 v[194:195], v233 offset:18432
    ds_read_b64_tr_b16 v[196:197], v233 offset:20480
    v_add_f32 v160, v160, v148
    v_mfma_f32_16x16x32_bf16 v[120:123], v[200:203], a[8:11], 0
    v_add_f32 v161, v161, v149
    v_mfma_f32_16x16x32_bf16 v[120:123], v[204:207], a[24:27], v[120:123]
    ds_read_b64_tr_b16 v[198:199], v233 offset:22528
    v_add_f32 v160, v160, v150
    v_mfma_f32_16x16x32_bf16 v[124:127], v[200:203], a[12:15], 0
    buffer_load_dwordx4 v240, s[16:19], s56 offen offset:1024 sc1 lds
    v_mfma_f32_16x16x32_bf16 v[124:127], v[204:207], a[28:31], v[124:127]
    s_waitcnt lgkmcnt(4)
    s_add_u32 s56, s81, 128
    v_mfma_f32_16x16x32_bf16 v[0:3], v[208:211], a[32:35], v[0:3]
    ds_read_b64_tr_b16 v[200:201], v234 offset:16384
    v_add_f32 v161, v161, v151
    v_mfma_f32_16x16x32_bf16 v[0:3], v[212:215], a[48:51], v[0:3]
    s_add_u32 m0, s58, 4096
    ds_read_b64_tr_b16 v[202:203], v234 offset:18432
    v_add_f32 v160, v160, v152
    v_mfma_f32_16x16x32_bf16 v[4:7], v[208:211], a[36:39], v[4:7]
    buffer_load_dwordx4 v132, s[8:11], s56 offen offset:0 sc1 lds
    v_mfma_f32_16x16x32_bf16 v[4:7], v[212:215], a[52:55], v[4:7]
    ds_read_b64_tr_b16 v[204:205], v234 offset:20480
    v_add_f32 v161, v161, v153
    v_mfma_f32_16x16x32_bf16 v[8:11], v[208:211], a[40:43], v[8:11]
    ds_read_b64_tr_b16 v[206:207], v234 offset:22528
    v_add_f32 v160, v160, v154
    v_mfma_f32_16x16x32_bf16 v[8:11], v[212:215], a[56:59], v[8:11]
    v_add_f32 v161, v161, v155
    v_mfma_f32_16x16x32_bf16 v[12:15], v[208:211], a[44:47], v[12:15]
    buffer_load_dwordx4 v133, s[8:11], s56 offen offset:1024 sc1 lds
    v_mfma_f32_16x16x32_bf16 v[12:15], v[212:215], a[60:63], v[12:15]
    s_waitcnt lgkmcnt(4)
    ds_read_b64_tr_b16 v[208:209], v235 offset:16384
    v_add_f32 v160, v160, v156
    v_mfma_f32_16x16x32_bf16 v[16:19], v[192:195], a[32:35], v[16:19]
    v_add_f32 v161, v161, v157
    v_mfma_f32_16x16x32_bf16 v[16:19], v[196:199], a[48:51], v[16:19]
    ds_read_b64_tr_b16 v[210:211], v235 offset:18432
    v_add_f32 v160, v160, v158
    v_mfma_f32_16x16x32_bf16 v[20:23], v[192:195], a[36:39], v[20:23]
    buffer_load_dwordx4 v134, s[8:11], s56 offen offset:2048 sc1 lds
    v_mfma_f32_16x16x32_bf16 v[20:23], v[196:199], a[52:55], v[20:23]
    ds_read_b64_tr_b16 v[212:213], v235 offset:20480
    v_add_f32 v161, v161, v159
    v_mfma_f32_16x16x32_bf16 v[24:27], v[192:195], a[40:43], v[24:27]
    v_add_f32 v160, v160, v161
    v_mfma_f32_16x16x32_bf16 v[24:27], v[196:199], a[56:59], v[24:27]
    ds_read_b64_tr_b16 v[214:215], v235 offset:22528
    v_add_f32_dpp v160, v160, v160 row_ror:8 row_mask:0xf bank_mask:0xf
    v_mfma_f32_16x16x32_bf16 v[28:31], v[192:195], a[44:47], v[28:31]
    buffer_load_dwordx4 v135, s[8:11], s56 offen offset:3072 sc1 lds
    v_mfma_f32_16x16x32_bf16 v[28:31], v[196:199], a[60:63], v[28:31]
    s_waitcnt lgkmcnt(4)
    s_mul_i32 s56, s81, 4096
    ds_read_b64_tr_b16 v[192:193], v232 offset:24576
    v_mfma_f32_16x16x32_bf16 v[32:35], v[200:203], a[32:35], v[32:35]
    s_add_u32 s56, s56, 524288
    s_add_u32 m0, s57, 8192
    v_add_f32_dpp v160, v160, v160 row_ror:4 row_mask:0xf bank_mask:0xf
    v_mfma_f32_16x16x32_bf16 v[32:35], v[204:207], a[48:51], v[32:35]
    ds_read_b64_tr_b16 v[194:195], v232 offset:26624
    v_add_f32_dpp v160, v160, v160 row_ror:2 row_mask:0xf bank_mask:0xf
    v_mfma_f32_16x16x32_bf16 v[36:39], v[200:203], a[36:39], v[36:39]
    buffer_load_dwordx4 v239, s[16:19], s56 offen offset:0 sc1 lds
    v_mfma_f32_16x16x32_bf16 v[36:39], v[204:207], a[52:55], v[36:39]
    ds_read_b64_tr_b16 v[196:197], v232 offset:28672
    v_add_f32_dpp v160, v160, v160 row_ror:1 row_mask:0xf bank_mask:0xf
    v_mfma_f32_16x16x32_bf16 v[40:43], v[200:203], a[40:43], v[40:43]
    v_mov_b32 v167, v160
    v_mfma_f32_16x16x32_bf16 v[40:43], v[204:207], a[56:59], v[40:43]
    s_waitcnt vmcnt(12)
    ds_read_b64_tr_b16 v[198:199], v232 offset:30720
    v_permlane16_swap_b32 v160, v167
    v_mfma_f32_16x16x32_bf16 v[44:47], v[200:203], a[44:47], v[44:47]
    buffer_load_dwordx4 v240, s[16:19], s56 offen offset:1024 sc1 lds
    v_mfma_f32_16x16x32_bf16 v[44:47], v[204:207], a[60:63], v[44:47]
    s_waitcnt lgkmcnt(4)
    ds_read_b64_tr_b16 v[200:201], v233 offset:24576
    ds_read_b128 a[64:67], v241 offset:16384
    v_mfma_f32_16x16x32_bf16 v[48:51], v[208:211], a[32:35], v[48:51]
    ds_read_b128 a[68:71], v241 offset:18432
    v_add_f32 v160, v160, v167
    v_mfma_f32_16x16x32_bf16 v[48:51], v[212:215], a[48:51], v[48:51]
    ds_read_b128 a[72:75], v241 offset:20480
    v_mfma_f32_16x16x32_bf16 v[52:55], v[208:211], a[36:39], v[52:55]
    ds_read_b64_tr_b16 v[202:203], v233 offset:26624
    v_mul_f32 v160, 0x3b000000, v160
    v_mfma_f32_16x16x32_bf16 v[52:55], v[212:215], a[52:55], v[52:55]
    ds_read_b64_tr_b16 v[204:205], v233 offset:28672
    v_mfma_f32_16x16x32_bf16 v[56:59], v[208:211], a[40:43], v[56:59]
    s_add_u32 s56, s82, 0
    v_sub_f32 v144, v144, v160
    v_mfma_f32_16x16x32_bf16 v[56:59], v[212:215], a[56:59], v[56:59]
    s_add_u32 m0, s58, 8192
    ds_read_b64_tr_b16 v[206:207], v233 offset:30720
    v_sub_f32 v145, v145, v160
    v_mfma_f32_16x16x32_bf16 v[60:63], v[208:211], a[44:47], v[60:63]
    ds_read_b128 a[76:79], v241 offset:22528
    v_sub_f32 v146, v146, v160
    v_mfma_f32_16x16x32_bf16 v[60:63], v[212:215], a[60:63], v[60:63]
    s_waitcnt lgkmcnt(8)
    ds_read_b64_tr_b16 v[208:209], v234 offset:24576
    v_sub_f32 v147, v147, v160
    v_mfma_f32_16x16x32_bf16 v[64:67], v[192:195], a[32:35], v[64:67]
    ds_read_b128 a[80:83], v242 offset:16384
    v_sub_f32 v148, v148, v160
    v_mfma_f32_16x16x32_bf16 v[64:67], v[196:199], a[48:51], v[64:67]
    ds_read_b64_tr_b16 v[210:211], v234 offset:26624
    v_sub_f32 v149, v149, v160
    v_mfma_f32_16x16x32_bf16 v[68:71], v[192:195], a[36:39], v[68:71]
    buffer_load_dwordx4 v128, s[8:11], s56 offen offset:0 sc1 lds
    v_mfma_f32_16x16x32_bf16 v[68:71], v[196:199], a[52:55], v[68:71]
    ds_read_b64_tr_b16 v[212:213], v234 offset:28672
    ds_read_b128 a[84:87], v242 offset:18432
    v_mfma_f32_16x16x32_bf16 v[72:75], v[192:195], a[40:43], v[72:75]
    v_sub_f32 v150, v150, v160
    v_mfma_f32_16x16x32_bf16 v[72:75], v[196:199], a[56:59], v[72:75]
    ds_read_b64_tr_b16 v[214:215], v234 offset:30720
    ds_read_b128 a[88:91], v242 offset:20480
    v_mfma_f32_16x16x32_bf16 v[76:79], v[192:195], a[44:47], v[76:79]
    buffer_load_dwordx4 v129, s[8:11], s56 offen offset:1024 sc1 lds
    v_mfma_f32_16x16x32_bf16 v[76:79], v[196:199], a[60:63], v[76:79]
    s_waitcnt lgkmcnt(8)
    ds_read_b64_tr_b16 v[192:193], v235 offset:24576
    ds_read_b64_tr_b16 v[194:195], v235 offset:26624
    ds_read_b64_tr_b16 v[196:197], v235 offset:28672
    ds_read_b64_tr_b16 v[198:199], v235 offset:30720
    v_mfma_f32_16x16x32_bf16 v[80:83], v[200:203], a[32:35], v[80:83]
    buffer_load_dwordx4 v130, s[8:11], s56 offen offset:2048 sc1 lds
    v_mfma_f32_16x16x32_bf16 v[80:83], v[204:207], a[48:51], v[80:83]
    ds_read_b128 a[92:95], v242 offset:22528
    v_sub_f32 v151, v151, v160
    v_mfma_f32_16x16x32_bf16 v[84:87], v[200:203], a[36:39], v[84:87]
    buffer_load_dwordx4 v131, s[8:11], s56 offen offset:3072 sc1 lds
    v_mfma_f32_16x16x32_bf16 v[84:87], v[204:207], a[52:55], v[84:87]
    s_mul_i32 s56, s81, 4096
    s_add_u32 s56, s56, 524416
    v_mfma_f32_16x16x32_bf16 v[88:91], v[200:203], a[40:43], v[88:91]
    s_add_u32 m0, s57, 40960
    v_sub_f32 v152, v152, v160
    v_mfma_f32_16x16x32_bf16 v[88:91], v[204:207], a[56:59], v[88:91]
    v_sub_f32 v153, v153, v160
    v_sub_f32 v154, v154, v160
    v_mfma_f32_16x16x32_bf16 v[92:95], v[200:203], a[44:47], v[92:95]
    buffer_load_dwordx4 v239, s[16:19], s56 offen offset:0 sc1 lds
    v_mfma_f32_16x16x32_bf16 v[92:95], v[204:207], a[60:63], v[92:95]
    s_waitcnt lgkmcnt(6)
    v_sub_f32 v155, v155, v160
    v_sub_f32 v156, v156, v160
    v_sub_f32 v157, v157, v160
    v_mfma_f32_16x16x32_bf16 v[96:99], v[208:211], a[32:35], v[96:99]
    s_lshl_b32 s73, s52, 5
    s_add_u32 s73, s73, 57344
    v_sub_f32 v158, v158, v160
    v_sub_f32 v159, v159, v160
    v_mul_f32 v161, v144, v144
    v_mul_f32 v162, v145, v145
    v_fmac_f32 v161, v146, v146
    v_fmac_f32 v162, v147, v147
    v_fmac_f32 v161, v148, v148
    v_fmac_f32 v162, v149, v149
    v_fmac_f32 v161, v150, v150
    v_fmac_f32 v162, v151, v151
    v_fmac_f32 v161, v152, v152
    v_fmac_f32 v162, v153, v153
    v_fmac_f32 v161, v154, v154
    v_fmac_f32 v162, v155, v155
    v_fmac_f32 v161, v156, v156
    v_fmac_f32 v162, v157, v157
    v_fmac_f32 v161, v158, v158
    v_fmac_f32 v162, v159, v159
    v_add_f32 v161, v161, v162
    s_nop 1
    v_add_f32_dpp v161, v161, v161 row_ror:8 row_mask:0xf bank_mask:0xf
    s_nop 1
    v_add_f32_dpp v161, v161, v161 row_ror:4 row_mask:0xf bank_mask:0xf
    s_nop 1
    v_add_f32_dpp v161, v161, v161 row_ror:2 row_mask:0xf bank_mask:0xf
    s_nop 1
    v_add_f32_dpp v161, v161, v161 row_ror:1 row_mask:0xf bank_mask:0xf
    v_mov_b32 v167, v161
    s_nop 1
    v_permlane16_swap_b32 v161, v167
    v_add_f32 v161, v161, v167
    v_mul_f32 v161, 0x3b000000, v161
    v_cvt_pk_bf16_f32 v162, v160, v161
    v_and_b32 v163, 0xffff0000, v162
    v_lshlrev_b32 v162, 16, v162
    v_add_f32 v163, 0x3727c5ac, v163
    v_cvt_pk_bf16_f32 v163, v163, v163
    v_and_b32 v163, 0xffff0000, v163
    v_sub_f32 v162, v160, v162
    v_and_b32 v164, 31, v255
    v_lshrrev_b32 v165, 5, v255
    v_lshl_add_u32 v164, v164, 3, v165
    v_lshl_add_u32 v164, v164, 4, s73
    v_sqrt_f32 v163, v163
    s_nop 0
    v_cvt_pk_bf16_f32 v163, v163, v163
    v_and_b32 v163, 0xffff0000, v163
    v_rcp_f32 v163, v163
    s_nop 0
    v_mul_f32 v162, v162, v163
    v_fma_f32 v144, v144, v163, v162
    v_fma_f32 v145, v145, v163, v162
    v_fma_f32 v146, v146, v163, v162
    v_fma_f32 v147, v147, v163, v162
    v_fma_f32 v148, v148, v163, v162
    v_fma_f32 v149, v149, v163, v162
    v_fma_f32 v150, v150, v163, v162
    v_fma_f32 v151, v151, v163, v162
    v_fma_f32 v152, v152, v163, v162
    v_fma_f32 v153, v153, v163, v162
    v_fma_f32 v154, v154, v163, v162
    v_fma_f32 v155, v155, v163, v162
    v_fma_f32 v156, v156, v163, v162
    v_fma_f32 v157, v157, v163, v162
    v_fma_f32 v158, v158, v163, v162
    v_fma_f32 v159, v159, v163, v162
    v_cvt_pk_bf16_f32 v136, v144, v145
    v_cvt_pk_bf16_f32 v137, v146, v147
    v_cvt_pk_bf16_f32 v138, v148, v149
    v_cvt_pk_bf16_f32 v139, v150, v151
    ds_write_b128 v164, v[136:139]
    v_cvt_pk_bf16_f32 v140, v152, v153
    v_cvt_pk_bf16_f32 v141, v154, v155
    v_cvt_pk_bf16_f32 v142, v156, v157
    v_cvt_pk_bf16_f32 v143, v158, v159
    ds_write_b128 v164, v[140:143] offset:4096
    v_mfma_f32_16x16x32_bf16 v[96:99], v[212:215], a[48:51], v[96:99]
    buffer_load_dwordx4 v240, s[16:19], s56 offen offset:1024 sc1 lds
    v_mfma_f32_16x16x32_bf16 v[100:103], v[208:211], a[36:39], v[100:103]
    s_waitcnt vmcnt(12) lgkmcnt(0)
    s_barrier
    s_add_u32 s56, s82, 0
    v_mfma_f32_16x16x32_bf16 v[100:103], v[212:215], a[52:55], v[100:103]
    s_add_u32 m0, s58, 12288
    ds_read_b64_tr_b16 v[200:201], v232 offset:32768
    ds_read_b64_tr_b16 v[202:203], v232 offset:34816
    v_mfma_f32_16x16x32_bf16 v[104:107], v[208:211], a[40:43], v[104:107]
    s_lshl_b32 s73, s52, 11
    ds_read_b64_tr_b16 v[204:205], v232 offset:36864
    v_mfma_f32_16x16x32_bf16 v[104:107], v[212:215], a[56:59], v[104:107]
    buffer_load_dwordx4 v132, s[8:11], s56 offen offset:0 sc1 lds
    v_mfma_f32_16x16x32_bf16 v[108:111], v[208:211], a[44:47], v[108:111]
    s_add_u32 s73, s73, 57344
    ds_read_b64_tr_b16 v[206:207], v232 offset:38912
    v_add_u32 v160, s73, v245
    v_mfma_f32_16x16x32_bf16 v[108:111], v[212:215], a[60:63], v[108:111]
    ds_read_b64_tr_b16 v[208:209], v233 offset:32768
    v_mfma_f32_16x16x32_bf16 v[112:115], v[192:195], a[32:35], v[112:115]
    ds_read_b128 v[136:139], v160
    v_mfma_f32_16x16x32_bf16 v[112:115], v[196:199], a[48:51], v[112:115]
    ds_read_b64_tr_b16 v[210:211], v233 offset:34816
    ds_read_b128 v[140:143], v160 offset:1024
    v_mfma_f32_16x16x32_bf16 v[116:119], v[192:195], a[36:39], v[116:119]
    buffer_load_dwordx4 v133, s[8:11], s56 offen offset:1024 sc1 lds
    v_mfma_f32_16x16x32_bf16 v[116:119], v[196:199], a[52:55], v[116:119]
    ds_read_b64_tr_b16 v[212:213], v233 offset:36864
    v_lshrrev_b32 v161, 3, v255
    v_mfma_f32_16x16x32_bf16 v[120:123], v[192:195], a[40:43], v[120:123]
    v_mfma_f32_16x16x32_bf16 v[120:123], v[196:199], a[56:59], v[120:123]
    ds_read_b64_tr_b16 v[214:215], v233 offset:38912
    v_and_b32 v162, 7, v255
    v_mfma_f32_16x16x32_bf16 v[124:127], v[192:195], a[44:47], v[124:127]
    buffer_load_dwordx4 v134, s[8:11], s56 offen offset:2048 sc1 lds
    v_mfma_f32_16x16x32_bf16 v[124:127], v[196:199], a[60:63], v[124:127]
    s_waitcnt lgkmcnt(6)
    ds_read_b64_tr_b16 v[192:193], v234 offset:32768
    buffer_load_dwordx4 v135, s[8:11], s56 offen offset:3072 sc1 lds
    v_mfma_f32_16x16x32_bf16 v[0:3], v[200:203], a[64:67], v[0:3]
    s_mul_i32 s56, s82, 4096
    s_add_u32 m0, s57, 16384
    v_lshlrev_b32 v162, 4, v162
    v_mfma_f32_16x16x32_bf16 v[0:3], v[204:207], a[80:83], v[0:3]
    ds_read_b64_tr_b16 v[194:195], v234 offset:34816
    v_lshl_add_u32 v161, v161, 8, v162
    v_mfma_f32_16x16x32_bf16 v[4:7], v[200:203], a[68:71], v[4:7]
    buffer_load_dwordx4 v239, s[16:19], s56 offen offset:0 sc1 lds
    v_mfma_f32_16x16x32_bf16 v[4:7], v[204:207], a[84:87], v[4:7]
    s_lshr_b32 s73, s55, 1
    s_lshl_b32 s73, s73, 14
    ds_read_b64_tr_b16 v[196:197], v234 offset:36864
    v_mfma_f32_16x16x32_bf16 v[8:11], v[200:203], a[72:75], v[8:11]
    s_and_b32 s74, s55, 1
    v_mfma_f32_16x16x32_bf16 v[8:11], v[204:207], a[88:91], v[8:11]
    ds_read_b64_tr_b16 v[198:199], v234 offset:38912
    v_mfma_f32_16x16x32_bf16 v[12:15], v[200:203], a[76:79], v[12:15]
    buffer_load_dwordx4 v240, s[16:19], s56 offen offset:1024 sc1 lds
    v_mfma_f32_16x16x32_bf16 v[12:15], v[204:207], a[92:95], v[12:15]
    s_waitcnt lgkmcnt(4)
    s_lshl_b32 s74, s74, 7
    s_add_u32 s73, s73, s74
    v_mfma_f32_16x16x32_bf16 v[16:19], v[208:211], a[64:67], v[16:19]
    buffer_load_dword v228, v226, s[20:23], 0 offen
    v_mfma_f32_16x16x32_bf16 v[16:19], v[212:215], a[80:83], v[16:19]
    s_lshl_b32 s74, s52, 12
    ds_read_b64_tr_b16 v[200:201], v235 offset:32768
    ds_read_b64_tr_b16 v[202:203], v235 offset:34816
    v_mfma_f32_16x16x32_bf16 v[20:23], v[208:211], a[68:71], v[20:23]
    v_mfma_f32_16x16x32_bf16 v[20:23], v[212:215], a[84:87], v[20:23]
    s_add_u32 s73, s73, s74
    ds_read_b64_tr_b16 v[204:205], v235 offset:36864
    v_add_u32 v161, s73, v161
    v_mfma_f32_16x16x32_bf16 v[24:27], v[208:211], a[72:75], v[24:27]
    buffer_store_dwordx4 v[136:139], v161, s[48:51], 0 offen sc1
    v_mfma_f32_16x16x32_bf16 v[24:27], v[212:215], a[88:91], v[24:27]
    ds_read_b64_tr_b16 v[206:207], v235 offset:38912
    v_mfma_f32_16x16x32_bf16 v[28:31], v[208:211], a[76:79], v[28:31]
    v_mfma_f32_16x16x32_bf16 v[28:31], v[212:215], a[92:95], v[28:31]
    s_waitcnt lgkmcnt(4)
    v_mfma_f32_16x16x32_bf16 v[32:35], v[192:195], a[64:67], v[32:35]
    buffer_store_dwordx4 v[140:143], v161, s[48:51], 0 offen offset:2048 sc1
    v_mfma_f32_16x16x32_bf16 v[32:35], v[196:199], a[80:83], v[32:35]
    s_mul_i32 s56, s82, 4096
    ds_read_b64_tr_b16 v[208:209], v232 offset:0
    ds_read_b64_tr_b16 v[210:211], v232 offset:2048
    v_mfma_f32_16x16x32_bf16 v[36:39], v[192:195], a[68:71], v[36:39]
    s_add_u32 s56, s56, 128
    s_add_u32 m0, s57, 24576
    v_mfma_f32_16x16x32_bf16 v[36:39], v[196:199], a[84:87], v[36:39]
    ds_read_b64_tr_b16 v[212:213], v232 offset:4096
    v_mfma_f32_16x16x32_bf16 v[40:43], v[192:195], a[72:75], v[40:43]
    buffer_load_dwordx4 v239, s[16:19], s56 offen offset:0 sc1 lds
    v_mfma_f32_16x16x32_bf16 v[40:43], v[196:199], a[88:91], v[40:43]
    s_waitcnt vmcnt(18)
    ds_read_b64_tr_b16 v[214:215], v232 offset:6144
    ds_read_b128 a[96:99], v241 offset:0
    v_mfma_f32_16x16x32_bf16 v[44:47], v[192:195], a[76:79], v[44:47]
    buffer_load_dword v231, v253, s[44:47], 0 offen sc1
    v_mfma_f32_16x16x32_bf16 v[44:47], v[196:199], a[92:95], v[44:47]
    s_waitcnt lgkmcnt(5)
    ds_read_b64_tr_b16 v[192:193], v233 offset:0
    v_mfma_f32_16x16x32_bf16 v[48:51], v[200:203], a[64:67], v[48:51]
    buffer_load_dwordx4 v240, s[16:19], s56 offen offset:1024 sc1 lds
    v_mfma_f32_16x16x32_bf16 v[48:51], v[204:207], a[80:83], v[48:51]
    ds_read_b64_tr_b16 v[194:195], v233 offset:2048
    ds_read_b128 a[100:103], v241 offset:2048
    v_mfma_f32_16x16x32_bf16 v[52:55], v[200:203], a[68:71], v[52:55]
    s_add_u32 s56, s82, 128
    s_add_u32 m0, s58, 16384
    s_lshl_b32 s73, s53, 6
    v_mfma_f32_16x16x32_bf16 v[52:55], v[204:207], a[84:87], v[52:55]
    s_lshl_b32 s74, s54, 3
    s_add_u32 s73, s73, s74
    ds_read_b64_tr_b16 v[196:197], v233 offset:4096
    v_mfma_f32_16x16x32_bf16 v[56:59], v[200:203], a[72:75], v[56:59]
    ds_read_b128 a[104:107], v241 offset:4096
    buffer_load_dwordx4 v128, s[8:11], s56 offen offset:0 sc1 lds
    v_mfma_f32_16x16x32_bf16 v[56:59], v[204:207], a[88:91], v[56:59]
    s_lshl_b32 s74, s52, 1
    s_add_u32 s73, s73, s74
    ds_read_b64_tr_b16 v[198:199], v233 offset:6144
    v_mfma_f32_16x16x32_bf16 v[60:63], v[200:203], a[76:79], v[60:63]
    s_lshl_b32 s73, s73, 13
    s_add_u32 s59, s73, 2097152
    ds_read_b128 a[108:111], v241 offset:6144
    v_mfma_f32_16x16x32_bf16 v[60:63], v[204:207], a[92:95], v[60:63]
    s_waitcnt lgkmcnt(8)
    s_add_u32 s60, s73, 18874368
    ds_read_b64_tr_b16 v[200:201], v234 offset:0
    v_mfma_f32_16x16x32_bf16 v[64:67], v[208:211], a[64:67], v[64:67]
    s_sub_u32 s73, 15, s54
    s_lshl_b32 s73, s73, 3
    ds_read_b128 a[112:115], v242 offset:0
    v_mfma_f32_16x16x32_bf16 v[64:67], v[212:215], a[80:83], v[64:67]
    s_lshl_b32 s74, s54, 3
    s_sub_u32 s75, 7, s52
    ds_read_b64_tr_b16 v[202:203], v234 offset:2048
    v_mfma_f32_16x16x32_bf16 v[68:71], v[208:211], a[68:71], v[68:71]
    buffer_load_dwordx4 v129, s[8:11], s56 offen offset:1024 sc1 lds
    v_mfma_f32_16x16x32_bf16 v[68:71], v[212:215], a[84:87], v[68:71]
    s_add_u32 s90, s73, s75
    ds_read_b64_tr_b16 v[204:205], v234 offset:4096
    ds_read_b128 a[116:119], v242 offset:2048
    v_mfma_f32_16x16x32_bf16 v[72:75], v[208:211], a[72:75], v[72:75]
    s_add_u32 s91, s73, s52
    s_add_u32 s92, s74, s75
    s_add_u32 s93, s74, s52
    v_mfma_f32_16x16x32_bf16 v[72:75], v[212:215], a[88:91], v[72:75]
    s_lshl_b32 s61, s90, 14
    ds_read_b64_tr_b16 v[206:207], v234 offset:6144
    ds_read_b128 a[120:123], v242 offset:4096
    v_mfma_f32_16x16x32_bf16 v[76:79], v[208:211], a[76:79], v[76:79]
    buffer_load_dwordx4 v130, s[8:11], s56 offen offset:2048 sc1 lds
    v_mfma_f32_16x16x32_bf16 v[76:79], v[212:215], a[92:95], v[76:79]
    s_waitcnt lgkmcnt(8)
    ds_read_b64_tr_b16 v[208:209], v235 offset:0
    ds_read_b64_tr_b16 v[210:211], v235 offset:2048
    ds_read_b64_tr_b16 v[212:213], v235 offset:4096
    v_mfma_f32_16x16x32_bf16 v[80:83], v[192:195], a[64:67], v[80:83]
    buffer_load_dwordx4 v131, s[8:11], s56 offen offset:3072 sc1 lds
    s_add_u32 s56, s82, 128
    v_mfma_f32_16x16x32_bf16 v[80:83], v[196:199], a[80:83], v[80:83]
    s_add_u32 m0, s58, 20480
    s_lshr_b32 s73, s90, 2
    ds_read_b128 a[124:127], v242 offset:6144
    v_mfma_f32_16x16x32_bf16 v[84:87], v[192:195], a[68:71], v[84:87]
    s_and_b32 s74, s90, 3
    s_lshl_b32 s74, s74, 10
    s_mul_i32 s65, s73, 176128
    ds_read_b64_tr_b16 v[214:215], v235 offset:6144
    v_mfma_f32_16x16x32_bf16 v[84:87], v[196:199], a[84:87], v[84:87]
    s_add_u32 s65, s65, s74
    s_lshl_b32 s75, s53, 12
    s_add_u32 s65, s65, s75
    v_mfma_f32_16x16x32_bf16 v[88:91], v[192:195], a[72:75], v[88:91]
    buffer_load_dwordx4 v132, s[8:11], s56 offen offset:0 sc1 lds
    v_mfma_f32_16x16x32_bf16 v[88:91], v[196:199], a[88:91], v[88:91]
    s_add_u32 s65, s65, 52428800
    s_lshl_b32 s69, s73, 19
    s_add_u32 s69, s69, s74
    v_mfma_f32_16x16x32_bf16 v[92:95], v[192:195], a[76:79], v[92:95]
    s_lshl_b32 s75, s53, 14
    s_add_u32 s69, s69, s75
    s_add_u32 s69, s69, 35651584
    v_mfma_f32_16x16x32_bf16 v[92:95], v[196:199], a[92:95], v[92:95]
    s_waitcnt lgkmcnt(6)
    s_lshl_b32 s62, s91, 14
    s_lshr_b32 s73, s91, 2
    v_mfma_f32_16x16x32_bf16 v[96:99], v[200:203], a[64:67], v[96:99]
    buffer_load_dwordx4 v133, s[8:11], s56 offen offset:1024 sc1 lds
    v_mfma_f32_16x16x32_bf16 v[96:99], v[204:207], a[80:83], v[96:99]
    s_and_b32 s74, s91, 3
    s_lshl_b32 s74, s74, 10
    v_mfma_f32_16x16x32_bf16 v[100:103], v[200:203], a[68:71], v[100:103]
    s_waitcnt vmcnt(18) lgkmcnt(0)
    s_barrier
    s_mul_i32 s66, s73, 176128
    v_mfma_f32_16x16x32_bf16 v[100:103], v[204:207], a[84:87], v[100:103]
    s_add_u32 s66, s66, s74
    ds_read_b64_tr_b16 v[192:193], v232 offset:8192
    ds_read_b64_tr_b16 v[194:195], v232 offset:10240
    v_mfma_f32_16x16x32_bf16 v[104:107], v[200:203], a[72:75], v[104:107]
    s_lshl_b32 s75, s53, 12
    ds_read_b64_tr_b16 v[196:197], v232 offset:12288
    ds_read_b64_tr_b16 v[198:199], v232 offset:14336
    v_mfma_f32_16x16x32_bf16 v[104:107], v[204:207], a[88:91], v[104:107]
    buffer_load_dwordx4 v134, s[8:11], s56 offen offset:2048 sc1 lds
    v_mfma_f32_16x16x32_bf16 v[108:111], v[200:203], a[76:79], v[108:111]
    buffer_load_dwordx4 v135, s[8:11], s56 offen offset:3072 sc1 lds
    v_mfma_f32_16x16x32_bf16 v[108:111], v[204:207], a[92:95], v[108:111]
    s_mul_i32 s56, s82, 4096
    ds_read_b64_tr_b16 v[200:201], v233 offset:8192
    v_mfma_f32_16x16x32_bf16 v[112:115], v[208:211], a[64:67], v[112:115]
    s_add_u32 s56, s56, 524288
    s_add_u32 m0, s57, 0
    s_add_u32 s66, s66, s75
    v_mfma_f32_16x16x32_bf16 v[112:115], v[212:215], a[80:83], v[112:115]
    s_add_u32 s66, s66, 52428800
    s_lshl_b32 s70, s73, 19
    ds_read_b64_tr_b16 v[202:203], v233 offset:10240
    v_mfma_f32_16x16x32_bf16 v[116:119], v[208:211], a[68:71], v[116:119]
    buffer_load_dwordx4 v239, s[16:19], s56 offen offset:0 sc1 lds
    v_mfma_f32_16x16x32_bf16 v[116:119], v[212:215], a[84:87], v[116:119]
    s_add_u32 s70, s70, s74
    s_lshl_b32 s75, s53, 14
    ds_read_b64_tr_b16 v[204:205], v233 offset:12288
    v_mfma_f32_16x16x32_bf16 v[120:123], v[208:211], a[72:75], v[120:123]
    s_add_u32 s70, s70, s75
    s_add_u32 s70, s70, 35651584
    s_lshl_b32 s63, s92, 14
    v_mfma_f32_16x16x32_bf16 v[120:123], v[212:215], a[88:91], v[120:123]
    s_lshr_b32 s73, s92, 2
    s_and_b32 s74, s92, 3
    ds_read_b64_tr_b16 v[206:207], v233 offset:14336
    v_mfma_f32_16x16x32_bf16 v[124:127], v[208:211], a[76:79], v[124:127]
    buffer_load_dwordx4 v240, s[16:19], s56 offen offset:1024 sc1 lds
    v_mfma_f32_16x16x32_bf16 v[124:127], v[212:215], a[92:95], v[124:127]
    s_waitcnt lgkmcnt(4)
    s_lshl_b32 s74, s74, 10
    ds_read_b64_tr_b16 v[208:209], v234 offset:8192
    v_mfma_f32_16x16x32_bf16 v[0:3], v[192:195], a[96:99], v[0:3]
    s_mul_i32 s67, s73, 176128
    s_add_u32 s67, s67, s74
    s_lshl_b32 s75, s53, 12
    v_mfma_f32_16x16x32_bf16 v[0:3], v[196:199], a[112:115], v[0:3]
    s_add_u32 s67, s67, s75
    s_add_u32 s67, s67, 52428800
    ds_read_b64_tr_b16 v[210:211], v234 offset:10240
    v_mfma_f32_16x16x32_bf16 v[4:7], v[192:195], a[100:103], v[4:7]
    s_lshl_b32 s71, s73, 19
    s_add_u32 s71, s71, s74
    s_lshl_b32 s75, s53, 14
    v_mfma_f32_16x16x32_bf16 v[4:7], v[196:199], a[116:119], v[4:7]
    s_add_u32 s71, s71, s75
    v_mfma_f32_16x16x32_bf16 v[8:11], v[192:195], a[104:107], v[8:11]
    s_add_u32 s71, s71, 35651584
    v_mfma_f32_16x16x32_bf16 v[8:11], v[196:199], a[120:123], v[8:11]
    s_lshl_b32 s64, s93, 14
    s_lshr_b32 s73, s93, 2
    v_mfma_f32_16x16x32_bf16 v[12:15], v[192:195], a[108:111], v[12:15]
    s_and_b32 s74, s93, 3
    ds_read_b64_tr_b16 v[212:213], v234 offset:12288
    ds_read_b64_tr_b16 v[214:215], v234 offset:14336
    v_mfma_f32_16x16x32_bf16 v[12:15], v[196:199], a[124:127], v[12:15]
    s_waitcnt lgkmcnt(4)
    s_lshl_b32 s74, s74, 10
    ds_read_b64_tr_b16 v[192:193], v235 offset:8192
    v_mfma_f32_16x16x32_bf16 v[16:19], v[200:203], a[96:99], v[16:19]
    s_mul_i32 s68, s73, 176128
    s_add_u32 s68, s68, s74
    v_mfma_f32_16x16x32_bf16 v[16:19], v[204:207], a[112:115], v[16:19]
    s_lshl_b32 s75, s53, 12
    ds_read_b64_tr_b16 v[194:195], v235 offset:10240
    v_mfma_f32_16x16x32_bf16 v[20:23], v[200:203], a[100:103], v[20:23]
    s_add_u32 s68, s68, s75
    v_mfma_f32_16x16x32_bf16 v[20:23], v[204:207], a[116:119], v[20:23]
    s_add_u32 s68, s68, 52428800
    v_mfma_f32_16x16x32_bf16 v[24:27], v[200:203], a[104:107], v[24:27]
    s_lshl_b32 s72, s73, 19
    s_add_u32 s72, s72, s74
    ds_read_b64_tr_b16 v[196:197], v235 offset:12288
    v_mfma_f32_16x16x32_bf16 v[24:27], v[204:207], a[120:123], v[24:27]
    s_mul_i32 s56, s82, 4096
    s_add_u32 s56, s56, 524416
    ds_read_b64_tr_b16 v[198:199], v235 offset:14336
    v_mfma_f32_16x16x32_bf16 v[28:31], v[200:203], a[108:111], v[28:31]
    s_add_u32 m0, s57, 32768
    s_lshl_b32 s75, s53, 14
    s_add_u32 s72, s72, s75
    v_mfma_f32_16x16x32_bf16 v[28:31], v[204:207], a[124:127], v[28:31]
    s_waitcnt lgkmcnt(4)
    s_add_u32 s72, s72, 35651584
    ds_read_b64_tr_b16 v[200:201], v232 offset:40960
    v_mfma_f32_16x16x32_bf16 v[32:35], v[208:211], a[96:99], v[32:35]
    buffer_load_dwordx4 v239, s[16:19], s56 offen offset:0 sc1 lds
    v_mfma_f32_16x16x32_bf16 v[32:35], v[212:215], a[112:115], v[32:35]
    s_lshr_b32 s73, s53, 1
    s_add_u32 s73, s73, 32
    s_sub_u32 s73, s73, s53
    v_mfma_f32_16x16x32_bf16 v[36:39], v[208:211], a[100:103], v[36:39]
    s_lshl_b32 s99, s73, 12
    ds_read_b64_tr_b16 v[202:203], v232 offset:43008
    v_mfma_f32_16x16x32_bf16 v[36:39], v[212:215], a[116:119], v[36:39]
    s_lshl_b32 s73, s80, 4
    ds_read_b64_tr_b16 v[204:205], v232 offset:45056
    v_mov_b32 v230, 0xbdd2d3e8
    v_mfma_f32_16x16x32_bf16 v[40:43], v[208:211], a[104:107], v[40:43]
    buffer_load_dwordx4 v240, s[16:19], s56 offen offset:1024 sc1 lds
    v_mfma_f32_16x16x32_bf16 v[40:43], v[212:215], a[120:123], v[40:43]
    s_waitcnt vmcnt(20)
    ds_read_b64_tr_b16 v[206:207], v232 offset:47104
    v_add_u32 v216, s73, v245
    v_mfma_f32_16x16x32_bf16 v[44:47], v[208:211], a[108:111], v[44:47]
    s_lshl_b32 s73, s81, 4
    v_add_u32 v217, s73, v245
    v_mfma_f32_16x16x32_bf16 v[44:47], v[212:215], a[124:127], v[44:47]
    s_waitcnt lgkmcnt(4)
    ds_read_b64_tr_b16 v[208:209], v233 offset:40960
    ds_read_b128 a[128:131], v241 offset:8192
    v_mfma_f32_16x16x32_bf16 v[48:51], v[192:195], a[96:99], v[48:51]
    s_lshl_b32 s73, s82, 4
    v_add_u32 v218, s73, v245
    s_lshl_b32 s73, s85, 4
    v_mfma_f32_16x16x32_bf16 v[48:51], v[196:199], a[112:115], v[48:51]
    ds_read_b64_tr_b16 v[210:211], v233 offset:43008
    v_add_u32 v219, s73, v245
    v_mfma_f32_16x16x32_bf16 v[52:55], v[192:195], a[100:103], v[52:55]
    s_add_u32 s56, s85, 0
    s_add_u32 m0, s58, 0
    ds_read_b128 a[132:135], v241 offset:10240
    v_mfma_f32_16x16x32_bf16 v[52:55], v[196:199], a[116:119], v[52:55]
    buffer_load_dwordx4 v128, s[8:11], s56 offen offset:0 sc1 lds
    v_mfma_f32_16x16x32_bf16 v[56:59], v[192:195], a[104:107], v[56:59]
    ds_read_b64_tr_b16 v[212:213], v233 offset:45056
    ds_read_b128 a[136:139], v241 offset:12288
    v_mfma_f32_16x16x32_bf16 v[56:59], v[196:199], a[120:123], v[56:59]
    ds_read_b64_tr_b16 v[214:215], v233 offset:47104
    v_mfma_f32_16x16x32_bf16 v[60:63], v[192:195], a[108:111], v[60:63]
    s_waitcnt vmcnt(14)
    ds_read_b128 a[140:143], v241 offset:14336
    v_cmp_ne_u32 vcc, 1, v231
    v_mfma_f32_16x16x32_bf16 v[60:63], v[196:199], a[124:127], v[60:63]
    s_waitcnt lgkmcnt(8)
    ds_read_b64_tr_b16 v[192:193], v234 offset:40960
    v_mfma_f32_16x16x32_bf16 v[64:67], v[200:203], a[96:99], v[64:67]
    buffer_load_dwordx4 v129, s[8:11], s56 offen offset:1024 sc1 lds
    v_mfma_f32_16x16x32_bf16 v[64:67], v[204:207], a[112:115], v[64:67]
    ds_read_b64_tr_b16 v[194:195], v234 offset:43008
    ds_read_b128 a[144:147], v242 offset:8192
    v_mfma_f32_16x16x32_bf16 v[68:71], v[200:203], a[100:103], v[68:71]
    ds_read_b64_tr_b16 v[196:197], v234 offset:45056
    v_mfma_f32_16x16x32_bf16 v[68:71], v[204:207], a[116:119], v[68:71]
    s_cbranch_vccnz L_spin_2
L_back_3:
    ds_read_b128 a[148:151], v242 offset:10240
    v_mfma_f32_16x16x32_bf16 v[72:75], v[200:203], a[104:107], v[72:75]
    buffer_load_dwordx4 v130, s[8:11], s56 offen offset:2048 sc1 lds
    v_mfma_f32_16x16x32_bf16 v[72:75], v[204:207], a[120:123], v[72:75]
    ds_read_b64_tr_b16 v[198:199], v234 offset:47104
    ds_read_b128 a[152:155], v242 offset:12288
    v_mfma_f32_16x16x32_bf16 v[76:79], v[200:203], a[108:111], v[76:79]
    ds_read_b128 a[156:159], v242 offset:14336
    v_mfma_f32_16x16x32_bf16 v[76:79], v[204:207], a[124:127], v[76:79]
    s_waitcnt lgkmcnt(9)
    ds_read_b64_tr_b16 v[200:201], v235 offset:40960
    ds_read_b64_tr_b16 v[202:203], v235 offset:43008
    v_mfma_f32_16x16x32_bf16 v[80:83], v[208:211], a[96:99], v[80:83]
    buffer_load_dwordx4 v131, s[8:11], s56 offen offset:3072 sc1 lds
    v_mfma_f32_16x16x32_bf16 v[80:83], v[212:215], a[112:115], v[80:83]
    ds_read_b64_tr_b16 v[204:205], v235 offset:45056
    ds_read_b64_tr_b16 v[206:207], v235 offset:47104
    v_mfma_f32_16x16x32_bf16 v[84:87], v[208:211], a[100:103], v[84:87]
    v_mfma_f32_16x16x32_bf16 v[84:87], v[212:215], a[116:119], v[84:87]
    v_mfma_f32_16x16x32_bf16 v[88:91], v[208:211], a[104:107], v[88:91]
    v_mfma_f32_16x16x32_bf16 v[88:91], v[212:215], a[120:123], v[88:91]
    v_mfma_f32_16x16x32_bf16 v[92:95], v[208:211], a[108:111], v[92:95]
    v_mfma_f32_16x16x32_bf16 v[92:95], v[212:215], a[124:127], v[92:95]
    s_waitcnt lgkmcnt(6)
    v_mfma_f32_16x16x32_bf16 v[96:99], v[192:195], a[96:99], v[96:99]
    v_mfma_f32_16x16x32_bf16 v[96:99], v[196:199], a[112:115], v[96:99]
    s_add_u32 s56, s85, 0
    s_add_u32 m0, s58, 4096
    v_mfma_f32_16x16x32_bf16 v[100:103], v[192:195], a[100:103], v[100:103]
    s_waitcnt vmcnt(16) lgkmcnt(0)
    s_barrier
    buffer_load_dwordx4 v132, s[8:11], s56 offen offset:0 sc1 lds
    v_mfma_f32_16x16x32_bf16 v[100:103], v[196:199], a[116:119], v[100:103]
    ds_read_b64_tr_b16 v[208:209], v232 offset:16384
    ds_read_b64_tr_b16 v[210:211], v232 offset:18432
    v_mfma_f32_16x16x32_bf16 v[104:107], v[192:195], a[104:107], v[104:107]
    ds_read_b64_tr_b16 v[212:213], v232 offset:20480
    ds_read_b64_tr_b16 v[214:215], v232 offset:22528
    v_mfma_f32_16x16x32_bf16 v[104:107], v[196:199], a[120:123], v[104:107]
    v_mfma_f32_16x16x32_bf16 v[108:111], v[192:195], a[108:111], v[108:111]
    buffer_store_dword v254, v249, s[48:51], s94 offen sc1
    v_mfma_f32_16x16x32_bf16 v[108:111], v[196:199], a[124:127], v[108:111]
    ds_read_b64_tr_b16 v[192:193], v233 offset:16384
    v_mfma_f32_16x16x32_bf16 v[112:115], v[200:203], a[96:99], v[112:115]
    v_mfma_f32_16x16x32_bf16 v[112:115], v[204:207], a[112:115], v[112:115]
    ds_read_b64_tr_b16 v[194:195], v233 offset:18432
    v_mfma_f32_16x16x32_bf16 v[116:119], v[200:203], a[100:103], v[116:119]
    buffer_load_dwordx4 v133, s[8:11], s56 offen offset:1024 sc1 lds
    v_mfma_f32_16x16x32_bf16 v[116:119], v[204:207], a[116:119], v[116:119]
    ds_read_b64_tr_b16 v[196:197], v233 offset:20480
    v_mfma_f32_16x16x32_bf16 v[120:123], v[200:203], a[104:107], v[120:123]
    ds_read_b64_tr_b16 v[198:199], v233 offset:22528
    v_mfma_f32_16x16x32_bf16 v[120:123], v[204:207], a[120:123], v[120:123]
    v_mfma_f32_16x16x32_bf16 v[124:127], v[200:203], a[108:111], v[124:127]
    buffer_load_dwordx4 v134, s[8:11], s56 offen offset:2048 sc1 lds
    v_mfma_f32_16x16x32_bf16 v[124:127], v[204:207], a[124:127], v[124:127]
    s_waitcnt lgkmcnt(4)
    ds_read_b64_tr_b16 v[200:201], v234 offset:16384
    v_mfma_f32_16x16x32_bf16 v[0:3], v[208:211], a[128:131], v[0:3]
    buffer_load_dwordx4 v135, s[8:11], s56 offen offset:3072 sc1 lds
    v_mfma_f32_16x16x32_bf16 v[0:3], v[212:215], a[144:147], v[0:3]
    s_mul_i32 s56, s85, 4096
    v_mfma_f32_16x16x32_bf16 v[4:7], v[208:211], a[132:135], v[4:7]
    ds_read_b64_tr_b16 v[202:203], v234 offset:18432
    v_mfma_f32_16x16x32_bf16 v[4:7], v[212:215], a[148:151], v[4:7]
    s_add_u32 m0, s57, 8192
    ds_read_b64_tr_b16 v[204:205], v234 offset:20480
    v_mfma_f32_16x16x32_bf16 v[8:11], v[208:211], a[136:139], v[8:11]
    buffer_load_dwordx4 v239, s[16:19], s56 offen offset:0 sc1 lds
    v_mfma_f32_16x16x32_bf16 v[8:11], v[212:215], a[152:155], v[8:11]
    ds_read_b64_tr_b16 v[206:207], v234 offset:22528
    v_mfma_f32_16x16x32_bf16 v[12:15], v[208:211], a[140:143], v[12:15]
    v_mfma_f32_16x16x32_bf16 v[12:15], v[212:215], a[156:159], v[12:15]
    s_waitcnt lgkmcnt(4)
    v_mfma_f32_16x16x32_bf16 v[16:19], v[192:195], a[128:131], v[16:19]
    buffer_load_dwordx4 v240, s[16:19], s56 offen offset:1024 sc1 lds
    v_mfma_f32_16x16x32_bf16 v[16:19], v[196:199], a[144:147], v[16:19]
    ds_read_b64_tr_b16 v[208:209], v235 offset:16384
    ds_read_b64_tr_b16 v[210:211], v235 offset:18432
    v_mfma_f32_16x16x32_bf16 v[20:23], v[192:195], a[132:135], v[20:23]
    v_mfma_f32_16x16x32_bf16 v[20:23], v[196:199], a[148:151], v[20:23]
    ds_read_b64_tr_b16 v[212:213], v235 offset:20480
    v_mfma_f32_16x16x32_bf16 v[24:27], v[192:195], a[136:139], v[24:27]
    ds_read_b64_tr_b16 v[214:215], v235 offset:22528
    v_mfma_f32_16x16x32_bf16 v[24:27], v[196:199], a[152:155], v[24:27]
    s_mul_i32 s56, s85, 4096
    s_add_u32 s56, s56, 128
    v_mfma_f32_16x16x32_bf16 v[28:31], v[192:195], a[140:143], v[28:31]
    v_mfma_f32_16x16x32_bf16 v[28:31], v[196:199], a[156:159], v[28:31]
    s_waitcnt lgkmcnt(4)
    s_add_u32 m0, s57, 40960
    v_mfma_f32_16x16x32_bf16 v[32:35], v[200:203], a[128:131], v[32:35]
    buffer_load_dwordx4 v239, s[16:19], s56 offen offset:0 sc1 lds
    v_mfma_f32_16x16x32_bf16 v[32:35], v[204:207], a[144:147], v[32:35]
    ds_read_b64_tr_b16 v[192:193], v232 offset:24576
    ds_read_b64_tr_b16 v[194:195], v232 offset:26624
    v_mfma_f32_16x16x32_bf16 v[36:39], v[200:203], a[132:135], v[36:39]
    v_mfma_f32_16x16x32_bf16 v[36:39], v[204:207], a[148:151], v[36:39]
    ds_read_b64_tr_b16 v[196:197], v232 offset:28672
    v_mfma_f32_16x16x32_bf16 v[40:43], v[200:203], a[136:139], v[40:43]
    buffer_load_dwordx4 v240, s[16:19], s56 offen offset:1024 sc1 lds
    v_mfma_f32_16x16x32_bf16 v[40:43], v[204:207], a[152:155], v[40:43]
    s_waitcnt vmcnt(17)
    ds_read_b64_tr_b16 v[198:199], v232 offset:30720
    v_mfma_f32_16x16x32_bf16 v[44:47], v[200:203], a[140:143], v[44:47]
    v_mfma_f32_16x16x32_bf16 v[44:47], v[204:207], a[156:159], v[44:47]
    s_waitcnt lgkmcnt(4)
    v_mfma_f32_16x16x32_bf16 v[48:51], v[208:211], a[128:131], v[48:51]
    ds_read_b64_tr_b16 v[200:201], v233 offset:24576
    ds_read_b128 a[160:163], v241 offset:16384
    v_mfma_f32_16x16x32_bf16 v[48:51], v[212:215], a[144:147], v[48:51]
    s_add_u32 s56, s85, 128
    ds_read_b64_tr_b16 v[202:203], v233 offset:26624
    v_mfma_f32_16x16x32_bf16 v[52:55], v[208:211], a[132:135], v[52:55]
    s_add_u32 m0, s58, 8192
    ds_read_b64_tr_b16 v[204:205], v233 offset:28672
    v_mfma_f32_16x16x32_bf16 v[52:55], v[212:215], a[148:151], v[52:55]
    buffer_load_dwordx4 v128, s[8:11], s56 offen offset:0 sc1 lds
    v_mfma_f32_16x16x32_bf16 v[56:59], v[208:211], a[136:139], v[56:59]
    ds_read_b128 a[164:167], v241 offset:18432
    ds_read_b128 a[168:171], v241 offset:20480
    v_mfma_f32_16x16x32_bf16 v[56:59], v[212:215], a[152:155], v[56:59]
    ds_read_b64_tr_b16 v[206:207], v233 offset:30720
    ds_read_b128 a[172:175], v241 offset:22528
    v_mfma_f32_16x16x32_bf16 v[60:63], v[208:211], a[140:143], v[60:63]
    v_mfma_f32_16x16x32_bf16 v[60:63], v[212:215], a[156:159], v[60:63]
    s_waitcnt lgkmcnt(8)
    ds_read_b64_tr_b16 v[208:209], v234 offset:24576
    v_mfma_f32_16x16x32_bf16 v[64:67], v[192:195], a[128:131], v[64:67]
    buffer_load_dwordx4 v129, s[8:11], s56 offen offset:1024 sc1 lds
    v_mfma_f32_16x16x32_bf16 v[64:67], v[196:199], a[144:147], v[64:67]
    ds_read_b64_tr_b16 v[210:211], v234 offset:26624
    v_mfma_f32_16x16x32_bf16 v[68:71], v[192:195], a[132:135], v[68:71]
    ds_read_b128 a[176:179], v242 offset:16384
    v_mfma_f32_16x16x32_bf16 v[68:71], v[196:199], a[148:151], v[68:71]
    ds_read_b64_tr_b16 v[212:213], v234 offset:28672
    ds_read_b128 a[180:183], v242 offset:18432
    v_mfma_f32_16x16x32_bf16 v[72:75], v[192:195], a[136:139], v[72:75]
    buffer_load_dwordx4 v130, s[8:11], s56 offen offset:2048 sc1 lds
    v_mfma_f32_16x16x32_bf16 v[72:75], v[196:199], a[152:155], v[72:75]
    ds_read_b64_tr_b16 v[214:215], v234 offset:30720
    v_mfma_f32_16x16x32_bf16 v[76:79], v[192:195], a[140:143], v[76:79]
    ds_read_b128 a[184:187], v242 offset:20480
    ds_read_b128 a[188:191], v242 offset:22528
    v_mfma_f32_16x16x32_bf16 v[76:79], v[196:199], a[156:159], v[76:79]
    s_waitcnt lgkmcnt(9)
    ds_read_b64_tr_b16 v[192:193], v235 offset:24576
    ds_read_b64_tr_b16 v[194:195], v235 offset:26624
    v_mfma_f32_16x16x32_bf16 v[80:83], v[200:203], a[128:131], v[80:83]
    buffer_load_dwordx4 v131, s[8:11], s56 offen offset:3072 sc1 lds
    v_mfma_f32_16x16x32_bf16 v[80:83], v[204:207], a[144:147], v[80:83]
    ds_read_b64_tr_b16 v[196:197], v235 offset:28672
    v_mfma_f32_16x16x32_bf16 v[84:87], v[200:203], a[132:135], v[84:87]
    ds_read_b64_tr_b16 v[198:199], v235 offset:30720
    v_mfma_f32_16x16x32_bf16 v[84:87], v[204:207], a[148:151], v[84:87]
    v_mfma_f32_16x16x32_bf16 v[88:91], v[200:203], a[136:139], v[88:91]
    v_mfma_f32_16x16x32_bf16 v[88:91], v[204:207], a[152:155], v[88:91]
    v_mfma_f32_16x16x32_bf16 v[92:95], v[200:203], a[140:143], v[92:95]
    buffer_load_dword v228, v226, s[12:15], 0 offen
    v_mfma_f32_16x16x32_bf16 v[92:95], v[204:207], a[156:159], v[92:95]
    s_waitcnt lgkmcnt(6)
    v_mfma_f32_16x16x32_bf16 v[96:99], v[208:211], a[128:131], v[96:99]
    v_mfma_f32_16x16x32_bf16 v[96:99], v[212:215], a[144:147], v[96:99]
    v_mfma_f32_16x16x32_bf16 v[100:103], v[208:211], a[132:135], v[100:103]
    s_waitcnt vmcnt(18) lgkmcnt(0)
    s_barrier
    v_mfma_f32_16x16x32_bf16 v[100:103], v[212:215], a[148:151], v[100:103]
    ds_read_b64_tr_b16 v[200:201], v232 offset:0
    ds_read_b64_tr_b16 v[202:203], v232 offset:2048
    v_mfma_f32_16x16x32_bf16 v[104:107], v[208:211], a[136:139], v[104:107]
    s_add_u32 s56, s85, 128
    s_add_u32 m0, s58, 12288
    v_mfma_f32_16x16x32_bf16 v[104:107], v[212:215], a[152:155], v[104:107]
    buffer_load_dwordx4 v132, s[8:11], s56 offen offset:0 sc1 lds
    v_mfma_f32_16x16x32_bf16 v[108:111], v[208:211], a[140:143], v[108:111]
    ds_read_b64_tr_b16 v[204:205], v232 offset:4096
    ds_read_b64_tr_b16 v[206:207], v232 offset:6144
    v_mfma_f32_16x16x32_bf16 v[108:111], v[212:215], a[156:159], v[108:111]
    v_mfma_f32_16x16x32_bf16 v[112:115], v[192:195], a[128:131], v[112:115]
    v_mfma_f32_16x16x32_bf16 v[112:115], v[196:199], a[144:147], v[112:115]
    ds_read_b64_tr_b16 v[208:209], v233 offset:0
    ds_read_b64_tr_b16 v[210:211], v233 offset:2048
    v_mfma_f32_16x16x32_bf16 v[116:119], v[192:195], a[132:135], v[116:119]
    buffer_load_dwordx4 v133, s[8:11], s56 offen offset:1024 sc1 lds
    v_mfma_f32_16x16x32_bf16 v[116:119], v[196:199], a[148:151], v[116:119]
    ds_read_b64_tr_b16 v[212:213], v233 offset:4096
    ds_read_b64_tr_b16 v[214:215], v233 offset:6144
    v_mfma_f32_16x16x32_bf16 v[120:123], v[192:195], a[136:139], v[120:123]
    v_mfma_f32_16x16x32_bf16 v[120:123], v[196:199], a[152:155], v[120:123]
    v_mfma_f32_16x16x32_bf16 v[124:127], v[192:195], a[140:143], v[124:127]
    buffer_load_dwordx4 v134, s[8:11], s56 offen offset:2048 sc1 lds
    v_mfma_f32_16x16x32_bf16 v[124:127], v[196:199], a[156:159], v[124:127]
    s_waitcnt lgkmcnt(4)
    v_mfma_f32_16x16x32_bf16 v[0:3], v[200:203], a[160:163], v[0:3]
    v_mfma_f32_16x16x32_bf16 v[0:3], v[204:207], a[176:179], v[0:3]
    ds_read_b64_tr_b16 v[192:193], v234 offset:0
    ds_read_b64_tr_b16 v[194:195], v234 offset:2048
    v_mfma_f32_16x16x32_bf16 v[4:7], v[200:203], a[164:167], v[4:7]
    buffer_load_dwordx4 v135, s[8:11], s56 offen offset:3072 sc1 lds
    v_mfma_f32_16x16x32_bf16 v[4:7], v[204:207], a[180:183], v[4:7]
    s_mul_i32 s56, s85, 4096
    s_add_u32 s56, s56, 524288
    ds_read_b64_tr_b16 v[196:197], v234 offset:4096
    v_mfma_f32_16x16x32_bf16 v[8:11], v[200:203], a[168:171], v[8:11]
    s_add_u32 m0, s57, 16384
    v_mfma_f32_16x16x32_bf16 v[8:11], v[204:207], a[184:187], v[8:11]
    ds_read_b64_tr_b16 v[198:199], v234 offset:6144
    v_mfma_f32_16x16x32_bf16 v[12:15], v[200:203], a[172:175], v[12:15]
    buffer_load_dwordx4 v239, s[16:19], s56 offen offset:0 sc1 lds
    v_mfma_f32_16x16x32_bf16 v[12:15], v[204:207], a[188:191], v[12:15]
    s_waitcnt lgkmcnt(4)
    ds_read_b64_tr_b16 v[200:201], v235 offset:0
    v_mfma_f32_16x16x32_bf16 v[16:19], v[208:211], a[160:163], v[16:19]
    v_mfma_f32_16x16x32_bf16 v[16:19], v[212:215], a[176:179], v[16:19]
    ds_read_b64_tr_b16 v[202:203], v235 offset:2048
    v_mfma_f32_16x16x32_bf16 v[20:23], v[208:211], a[164:167], v[20:23]
    buffer_load_dwordx4 v240, s[16:19], s56 offen offset:1024 sc1 lds
    v_mfma_f32_16x16x32_bf16 v[20:23], v[212:215], a[180:183], v[20:23]
    s_mul_i32 s56, s85, 4096
    s_add_u32 s56, s56, 524416
    ds_read_b64_tr_b16 v[204:205], v235 offset:4096
    v_mfma_f32_16x16x32_bf16 v[24:27], v[208:211], a[168:171], v[24:27]
    s_add_u32 m0, s57, 24576
    v_mfma_f32_16x16x32_bf16 v[24:27], v[212:215], a[184:187], v[24:27]
    ds_read_b64_tr_b16 v[206:207], v235 offset:6144
    v_mfma_f32_16x16x32_bf16 v[28:31], v[208:211], a[172:175], v[28:31]
    buffer_load_dwordx4 v239, s[16:19], s56 offen offset:0 sc1 lds
    v_mfma_f32_16x16x32_bf16 v[28:31], v[212:215], a[188:191], v[28:31]
    s_waitcnt lgkmcnt(4)
    v_mfma_f32_16x16x32_bf16 v[32:35], v[192:195], a[160:163], v[32:35]
    ds_read_b64_tr_b16 v[208:209], v232 offset:32768
    v_mfma_f32_16x16x32_bf16 v[32:35], v[196:199], a[176:179], v[32:35]
    ds_read_b64_tr_b16 v[210:211], v232 offset:34816
    v_mfma_f32_16x16x32_bf16 v[36:39], v[192:195], a[164:167], v[36:39]
    buffer_load_dwordx4 v240, s[16:19], s56 offen offset:1024 sc1 lds
    v_mfma_f32_16x16x32_bf16 v[36:39], v[196:199], a[180:183], v[36:39]
    ds_read_b64_tr_b16 v[212:213], v232 offset:36864
    v_mfma_f32_16x16x32_bf16 v[40:43], v[192:195], a[168:171], v[40:43]
    v_mfma_f32_16x16x32_bf16 v[40:43], v[196:199], a[184:187], v[40:43]
    s_waitcnt vmcnt(17)
    ds_read_b64_tr_b16 v[214:215], v232 offset:38912
    v_mfma_f32_16x16x32_bf16 v[44:47], v[192:195], a[172:175], v[44:47]
    s_lshr_b32 s86, s55, 3
    s_lshl_b32 s86, s86, 2
    v_mfma_f32_16x16x32_bf16 v[44:47], v[196:199], a[188:191], v[44:47]
    s_waitcnt lgkmcnt(4)
    ds_read_b64_tr_b16 v[192:193], v233 offset:32768
    ds_read_b128 a[192:195], v241 offset:0
    v_mfma_f32_16x16x32_bf16 v[48:51], v[200:203], a[160:163], v[48:51]
    s_add_u32 s86, s86, s52
    v_mfma_f32_16x16x32_bf16 v[48:51], v[204:207], a[176:179], v[48:51]
    s_lshl_b32 s86, s86, 2
    ds_read_b64_tr_b16 v[194:195], v233 offset:34816
    ds_read_b128 a[196:199], v241 offset:2048
    v_mfma_f32_16x16x32_bf16 v[52:55], v[200:203], a[164:167], v[52:55]
    v_lshrrev_b32 v220, 3, v255
    v_mfma_f32_16x16x32_bf16 v[52:55], v[204:207], a[180:183], v[52:55]
    ds_read_b64_tr_b16 v[196:197], v233 offset:36864
    v_add_u32 v220, s86, v220
    v_mfma_f32_16x16x32_bf16 v[56:59], v[200:203], a[168:171], v[56:59]
    ds_read_b128 a[200:203], v241 offset:4096
    v_mfma_f32_16x16x32_bf16 v[56:59], v[204:207], a[184:187], v[56:59]
    ds_read_b64_tr_b16 v[198:199], v233 offset:38912
    v_mul_u32_u24 v220, 2752, v220
    v_mfma_f32_16x16x32_bf16 v[60:63], v[200:203], a[172:175], v[60:63]
    s_and_b32 s87, s55, 7
    v_mfma_f32_16x16x32_bf16 v[60:63], v[204:207], a[188:191], v[60:63]
    s_waitcnt lgkmcnt(7)
    s_lshl_b32 s88, s87, 8
    ds_read_b128 a[204:207], v241 offset:6144
    v_mfma_f32_16x16x32_bf16 v[64:67], v[208:211], a[160:163], v[64:67]
    s_lshl_b32 s87, s87, 7
    ds_read_b128 a[208:211], v242 offset:0
    v_mfma_f32_16x16x32_bf16 v[64:67], v[212:215], a[176:179], v[64:67]
    s_add_u32 s87, s87, 1676
    ds_read_b64_tr_b16 v[200:201], v234 offset:32768
    v_mfma_f32_16x16x32_bf16 v[68:71], v[208:211], a[164:167], v[68:71]
    ds_read_b64_tr_b16 v[202:203], v234 offset:34816
    v_and_b32 v221, 7, v255
    v_mfma_f32_16x16x32_bf16 v[68:71], v[212:215], a[180:183], v[68:71]
    ds_read_b128 a[212:215], v242 offset:2048
    v_mfma_f32_16x16x32_bf16 v[72:75], v[208:211], a[168:171], v[72:75]
    ds_read_b64_tr_b16 v[204:205], v234 offset:36864
    v_mul_u32_u24 v222, 124, v221
    v_mfma_f32_16x16x32_bf16 v[72:75], v[212:215], a[184:187], v[72:75]
    ds_read_b64_tr_b16 v[206:207], v234 offset:38912
    ds_read_b128 a[216:219], v242 offset:4096
    v_mfma_f32_16x16x32_bf16 v[76:79], v[208:211], a[172:175], v[76:79]
    ds_read_b128 a[220:223], v242 offset:6144
    v_mov_b32 v223, s88
    v_mfma_f32_16x16x32_bf16 v[76:79], v[212:215], a[188:191], v[76:79]
    s_waitcnt lgkmcnt(9)
    ds_read_b64_tr_b16 v[208:209], v235 offset:32768
    ds_read_b64_tr_b16 v[210:211], v235 offset:34816
    v_mfma_f32_16x16x32_bf16 v[80:83], v[192:195], a[160:163], v[80:83]
    s_mul_i32 s56, s80, 4096
    ds_read_b64_tr_b16 v[212:213], v235 offset:36864
    v_mov_b32 v224, s87
    v_mfma_f32_16x16x32_bf16 v[80:83], v[196:199], a[176:179], v[80:83]
    s_add_u32 m0, s57, 49152
    ds_read_b64_tr_b16 v[214:215], v235 offset:38912
    v_mfma_f32_16x16x32_bf16 v[84:87], v[192:195], a[164:167], v[84:87]
    buffer_load_dwordx4 v239, s[20:23], s56 offen offset:0 sc1 lds
    v_mfma_f32_16x16x32_bf16 v[84:87], v[196:199], a[180:183], v[84:87]
    v_cmp_gt_u32 vcc, 3, v221
    v_mfma_f32_16x16x32_bf16 v[88:91], v[192:195], a[168:171], v[88:91]
    s_nop 0
    v_cndmask_b32 v223, v224, v223, vcc
    v_mfma_f32_16x16x32_bf16 v[88:91], v[196:199], a[184:187], v[88:91]
    v_add3_u32 v220, v220, v222, v223
    v_mfma_f32_16x16x32_bf16 v[92:95], v[192:195], a[172:175], v[92:95]
    buffer_load_dwordx4 v240, s[20:23], s56 offen offset:1024 sc1 lds
    v_mfma_f32_16x16x32_bf16 v[92:95], v[196:199], a[188:191], v[92:95]
    s_waitcnt lgkmcnt(6)
    v_lshrrev_b32 v222, 5, v255
    v_lshlrev_b32 v222, 3, v222
    v_mfma_f32_16x16x32_bf16 v[96:99], v[200:203], a[160:163], v[96:99]
    v_add_u32 v221, v221, v222
    v_mov_b32 v222, 2147483392
    v_mfma_f32_16x16x32_bf16 v[96:99], v[204:207], a[176:179], v[96:99]
    v_cmp_gt_u32 vcc, 5, v221
    s_nop 1
    v_cndmask_b32 v220, v222, v220, vcc
    v_mfma_f32_16x16x32_bf16 v[100:103], v[200:203], a[164:167], v[100:103]
    s_waitcnt vmcnt(15) lgkmcnt(0)
    s_barrier
    buffer_load_dword v228, v220, s[28:31], 0 offen
    v_mfma_f32_16x16x32_bf16 v[100:103], v[204:207], a[180:183], v[100:103]
    ds_read_b64_tr_b16 v[192:193], v232 offset:8192
    ds_read_b64_tr_b16 v[194:195], v232 offset:10240
    buffer_load_dword v228, v220, s[32:35], 0 offen
    v_mfma_f32_16x16x32_bf16 v[104:107], v[200:203], a[168:171], v[104:107]
    ds_read_b64_tr_b16 v[196:197], v232 offset:12288
    ds_read_b64_tr_b16 v[198:199], v232 offset:14336
    v_mfma_f32_16x16x32_bf16 v[104:107], v[204:207], a[184:187], v[104:107]
    s_mul_i32 s56, s80, 4096
    s_add_u32 s56, s56, 128
    s_add_u32 m0, s57, 0
    v_mfma_f32_16x16x32_bf16 v[108:111], v[200:203], a[172:175], v[108:111]
    buffer_load_dwordx4 v239, s[20:23], s56 offen offset:0 sc1 lds
    v_mfma_f32_16x16x32_bf16 v[108:111], v[204:207], a[188:191], v[108:111]
    ds_read_b64_tr_b16 v[200:201], v233 offset:8192
    ds_read_b64_tr_b16 v[202:203], v233 offset:10240
    v_mfma_f32_16x16x32_bf16 v[112:115], v[208:211], a[160:163], v[112:115]
    v_mfma_f32_16x16x32_bf16 v[112:115], v[212:215], a[176:179], v[112:115]
    ds_read_b64_tr_b16 v[204:205], v233 offset:12288
    v_mfma_f32_16x16x32_bf16 v[116:119], v[208:211], a[164:167], v[116:119]
    buffer_load_dwordx4 v240, s[20:23], s56 offen offset:1024 sc1 lds
    v_mfma_f32_16x16x32_bf16 v[116:119], v[212:215], a[180:183], v[116:119]
    v_mfma_f32_16x16x32_bf16 v[120:123], v[208:211], a[168:171], v[120:123]
    v_mfma_f32_16x16x32_bf16 v[120:123], v[212:215], a[184:187], v[120:123]
    v_mfma_f32_16x16x32_bf16 v[124:127], v[208:211], a[172:175], v[124:127]
    ds_read_b64_tr_b16 v[206:207], v233 offset:14336
    v_mfma_f32_16x16x32_bf16 v[124:127], v[212:215], a[188:191], v[124:127]
    s_waitcnt lgkmcnt(4)
    v_mfma_f32_16x16x32_bf16 v[0:3], v[192:195], a[192:195], v[0:3]
    v_mfma_f32_16x16x32_bf16 v[0:3], v[196:199], a[208:211], v[0:3]
    ds_read_b64_tr_b16 v[208:209], v234 offset:8192
    ds_read_b64_tr_b16 v[210:211], v234 offset:10240
    v_mfma_f32_16x16x32_bf16 v[4:7], v[192:195], a[196:199], v[4:7]
    v_mfma_f32_16x16x32_bf16 v[4:7], v[196:199], a[212:215], v[4:7]
    s_mul_i32 s56, s80, 4096
    s_add_u32 s56, s56, 524288
    ds_read_b64_tr_b16 v[212:213], v234 offset:12288
    v_mfma_f32_16x16x32_bf16 v[8:11], v[192:195], a[200:203], v[8:11]
    s_add_u32 m0, s57, 32768
    v_mfma_f32_16x16x32_bf16 v[8:11], v[196:199], a[216:219], v[8:11]
    ds_read_b64_tr_b16 v[214:215], v234 offset:14336
    v_mfma_f32_16x16x32_bf16 v[12:15], v[192:195], a[204:207], v[12:15]
    buffer_load_dwordx4 v239, s[20:23], s56 offen offset:0 sc1 lds
    v_mfma_f32_16x16x32_bf16 v[12:15], v[196:199], a[220:223], v[12:15]
    s_waitcnt lgkmcnt(4)
    ds_read_b64_tr_b16 v[192:193], v235 offset:8192
    v_mfma_f32_16x16x32_bf16 v[16:19], v[200:203], a[192:195], v[16:19]
    ds_read_b64_tr_b16 v[194:195], v235 offset:10240
    v_mfma_f32_16x16x32_bf16 v[16:19], v[204:207], a[208:211], v[16:19]
    v_mfma_f32_16x16x32_bf16 v[20:23], v[200:203], a[196:199], v[20:23]
    v_mfma_f32_16x16x32_bf16 v[20:23], v[204:207], a[212:215], v[20:23]
    v_mfma_f32_16x16x32_bf16 v[24:27], v[200:203], a[200:203], v[24:27]
    ds_read_b64_tr_b16 v[196:197], v235 offset:12288
    v_mfma_f32_16x16x32_bf16 v[24:27], v[204:207], a[216:219], v[24:27]
    buffer_load_dwordx4 v240, s[20:23], s56 offen offset:1024 sc1 lds
    v_mfma_f32_16x16x32_bf16 v[28:31], v[200:203], a[204:207], v[28:31]
    ds_read_b64_tr_b16 v[198:199], v235 offset:14336
    v_mfma_f32_16x16x32_bf16 v[28:31], v[204:207], a[220:223], v[28:31]
    s_waitcnt lgkmcnt(4)
    v_mfma_f32_16x16x32_bf16 v[32:35], v[208:211], a[192:195], v[32:35]
    v_mfma_f32_16x16x32_bf16 v[32:35], v[212:215], a[208:211], v[32:35]
    ds_read_b64_tr_b16 v[200:201], v232 offset:40960
    ds_read_b64_tr_b16 v[202:203], v232 offset:43008
    v_mfma_f32_16x16x32_bf16 v[36:39], v[208:211], a[196:199], v[36:39]
    v_mfma_f32_16x16x32_bf16 v[36:39], v[212:215], a[212:215], v[36:39]
    s_waitcnt vmcnt(12)
    v_mfma_f32_16x16x32_bf16 v[40:43], v[208:211], a[200:203], v[40:43]
    ds_read_b64_tr_b16 v[204:205], v232 offset:45056
    v_mfma_f32_16x16x32_bf16 v[40:43], v[212:215], a[216:219], v[40:43]
    ds_read_b64_tr_b16 v[206:207], v232 offset:47104
    v_mfma_f32_16x16x32_bf16 v[44:47], v[208:211], a[204:207], v[44:47]
    ds_read_b128 a[224:227], v241 offset:8192
    v_mfma_f32_16x16x32_bf16 v[44:47], v[212:215], a[220:223], v[44:47]
    s_waitcnt lgkmcnt(5)
    ds_read_b64_tr_b16 v[208:209], v233 offset:40960
    v_mfma_f32_16x16x32_bf16 v[48:51], v[192:195], a[192:195], v[48:51]
    ds_read_b64_tr_b16 v[210:211], v233 offset:43008
    ds_read_b128 a[228:231], v241 offset:10240
    v_mfma_f32_16x16x32_bf16 v[48:51], v[196:199], a[208:211], v[48:51]
    v_mfma_f32_16x16x32_bf16 v[52:55], v[192:195], a[196:199], v[52:55]
    ds_read_b64_tr_b16 v[212:213], v233 offset:45056
    ds_read_b128 a[232:235], v241 offset:12288
    v_mfma_f32_16x16x32_bf16 v[52:55], v[196:199], a[212:215], v[52:55]
    ds_read_b128 a[236:239], v241 offset:14336
    v_mfma_f32_16x16x32_bf16 v[56:59], v[192:195], a[200:203], v[56:59]
    v_mfma_f32_16x16x32_bf16 v[56:59], v[196:199], a[216:219], v[56:59]
    ds_read_b64_tr_b16 v[214:215], v233 offset:47104
    v_mfma_f32_16x16x32_bf16 v[60:63], v[192:195], a[204:207], v[60:63]
    v_mfma_f32_16x16x32_bf16 v[60:63], v[196:199], a[220:223], v[60:63]
    s_waitcnt lgkmcnt(8)
    ds_read_b64_tr_b16 v[192:193], v234 offset:40960
    ds_read_b128 a[240:243], v242 offset:8192
    v_mfma_f32_16x16x32_bf16 v[64:67], v[200:203], a[192:195], v[64:67]
    v_mfma_f32_16x16x32_bf16 v[64:67], v[204:207], a[208:211], v[64:67]
    ds_read_b64_tr_b16 v[194:195], v234 offset:43008
    v_mfma_f32_16x16x32_bf16 v[68:71], v[200:203], a[196:199], v[68:71]
    ds_read_b128 a[244:247], v242 offset:10240
    v_mfma_f32_16x16x32_bf16 v[68:71], v[204:207], a[212:215], v[68:71]
    ds_read_b64_tr_b16 v[196:197], v234 offset:45056
    ds_read_b128 a[248:251], v242 offset:12288
    v_mfma_f32_16x16x32_bf16 v[72:75], v[200:203], a[200:203], v[72:75]
    ds_read_b128 a[252:255], v242 offset:14336
    v_mfma_f32_16x16x32_bf16 v[72:75], v[204:207], a[216:219], v[72:75]
    ds_read_b64_tr_b16 v[198:199], v234 offset:47104
    v_mfma_f32_16x16x32_bf16 v[76:79], v[200:203], a[204:207], v[76:79]
    v_mfma_f32_16x16x32_bf16 v[76:79], v[204:207], a[220:223], v[76:79]
    s_waitcnt lgkmcnt(8)
    ds_read_b64_tr_b16 v[200:201], v235 offset:40960
    ds_read_b64_tr_b16 v[202:203], v235 offset:43008
    v_mfma_f32_16x16x32_bf16 v[80:83], v[208:211], a[192:195], v[80:83]
    ds_read_b64_tr_b16 v[204:205], v235 offset:45056
    ds_read_b64_tr_b16 v[206:207], v235 offset:47104
    v_mfma_f32_16x16x32_bf16 v[80:83], v[212:215], a[208:211], v[80:83]
    v_mfma_f32_16x16x32_bf16 v[84:87], v[208:211], a[196:199], v[84:87]
    v_mfma_f32_16x16x32_bf16 v[84:87], v[212:215], a[212:215], v[84:87]
    v_mfma_f32_16x16x32_bf16 v[88:91], v[208:211], a[200:203], v[88:91]
    v_mfma_f32_16x16x32_bf16 v[88:91], v[212:215], a[216:219], v[88:91]
    v_mfma_f32_16x16x32_bf16 v[92:95], v[208:211], a[204:207], v[92:95]
    v_mfma_f32_16x16x32_bf16 v[92:95], v[212:215], a[220:223], v[92:95]
    s_waitcnt lgkmcnt(4)
    v_mfma_f32_16x16x32_bf16 v[96:99], v[192:195], a[192:195], v[96:99]
    v_mfma_f32_16x16x32_bf16 v[96:99], v[196:199], a[208:211], v[96:99]
    v_mfma_f32_16x16x32_bf16 v[100:103], v[192:195], a[196:199], v[100:103]
    s_waitcnt vmcnt(8) lgkmcnt(0)
    s_barrier
    v_mfma_f32_16x16x32_bf16 v[100:103], v[196:199], a[212:215], v[100:103]
    s_mul_i32 s56, s80, 4096
    ds_read_b64_tr_b16 v[208:209], v232 offset:16384
    v_mfma_f32_16x16x32_bf16 v[104:107], v[192:195], a[200:203], v[104:107]
    ds_read_b64_tr_b16 v[210:211], v232 offset:18432
    ds_read_b64_tr_b16 v[212:213], v232 offset:20480
    v_mfma_f32_16x16x32_bf16 v[104:107], v[196:199], a[216:219], v[104:107]
    s_add_u32 s56, s56, 524416
    s_add_u32 m0, s57, 8192
    ds_read_b64_tr_b16 v[214:215], v232 offset:22528
    v_mfma_f32_16x16x32_bf16 v[108:111], v[192:195], a[204:207], v[108:111]
    buffer_load_dwordx4 v239, s[20:23], s56 offen offset:0 sc1 lds
    v_mfma_f32_16x16x32_bf16 v[108:111], v[196:199], a[220:223], v[108:111]
    ds_read_b64_tr_b16 v[192:193], v233 offset:16384
    v_mfma_f32_16x16x32_bf16 v[112:115], v[200:203], a[192:195], v[112:115]
    ds_read_b64_tr_b16 v[194:195], v233 offset:18432
    v_mfma_f32_16x16x32_bf16 v[112:115], v[204:207], a[208:211], v[112:115]
    v_mfma_f32_16x16x32_bf16 v[116:119], v[200:203], a[196:199], v[116:119]
    buffer_load_dwordx4 v240, s[20:23], s56 offen offset:1024 sc1 lds
    v_mfma_f32_16x16x32_bf16 v[116:119], v[204:207], a[212:215], v[116:119]
    s_mul_i32 s56, s81, 4096
    ds_read_b64_tr_b16 v[196:197], v233 offset:20480
    v_mfma_f32_16x16x32_bf16 v[120:123], v[200:203], a[200:203], v[120:123]
    v_mfma_f32_16x16x32_bf16 v[120:123], v[204:207], a[216:219], v[120:123]
    s_add_u32 m0, s57, 40960
    ds_read_b64_tr_b16 v[198:199], v233 offset:22528
    v_mfma_f32_16x16x32_bf16 v[124:127], v[200:203], a[204:207], v[124:127]
    buffer_load_dwordx4 v239, s[20:23], s56 offen offset:0 sc1 lds
    v_mfma_f32_16x16x32_bf16 v[124:127], v[204:207], a[220:223], v[124:127]
    s_waitcnt lgkmcnt(4)
    ds_read_b64_tr_b16 v[200:201], v234 offset:16384
    v_mfma_f32_16x16x32_bf16 v[0:3], v[208:211], a[224:227], v[0:3]
    ds_read_b64_tr_b16 v[202:203], v234 offset:18432
    v_mfma_f32_16x16x32_bf16 v[0:3], v[212:215], a[240:243], v[0:3]
    ds_read_b64_tr_b16 v[204:205], v234 offset:20480
    v_mfma_f32_16x16x32_bf16 v[4:7], v[208:211], a[228:231], v[4:7]
    buffer_load_dwordx4 v240, s[20:23], s56 offen offset:1024 sc1 lds
    v_mfma_f32_16x16x32_bf16 v[4:7], v[212:215], a[244:247], v[4:7]
    s_mul_i32 s56, s81, 4096
    s_add_u32 s56, s56, 128
    v_mfma_f32_16x16x32_bf16 v[8:11], v[208:211], a[232:235], v[8:11]
    s_add_u32 m0, s57, 57344
    v_mfma_f32_16x16x32_bf16 v[8:11], v[212:215], a[248:251], v[8:11]
    ds_read_b64_tr_b16 v[206:207], v234 offset:22528
    v_mfma_f32_16x16x32_bf16 v[12:15], v[208:211], a[236:239], v[12:15]
    buffer_load_dwordx4 v239, s[20:23], s56 offen offset:0 sc1 lds
    v_mfma_f32_16x16x32_bf16 v[12:15], v[212:215], a[252:255], v[12:15]
    s_waitcnt lgkmcnt(4)
    ds_read_b64_tr_b16 v[208:209], v235 offset:16384
    ds_read_b64_tr_b16 v[210:211], v235 offset:18432
    v_mfma_f32_16x16x32_bf16 v[16:19], v[192:195], a[224:227], v[16:19]
    v_mfma_f32_16x16x32_bf16 v[16:19], v[196:199], a[240:243], v[16:19]
    v_mfma_f32_16x16x32_bf16 v[20:23], v[192:195], a[228:231], v[20:23]
    buffer_load_dwordx4 v240, s[20:23], s56 offen offset:1024 sc1 lds
    v_mfma_f32_16x16x32_bf16 v[20:23], v[196:199], a[244:247], v[20:23]
    s_mul_i32 s56, s81, 4096
    s_add_u32 s56, s56, 524288
    ds_read_b64_tr_b16 v[212:213], v235 offset:20480
    v_mfma_f32_16x16x32_bf16 v[24:27], v[192:195], a[232:235], v[24:27]
    s_add_u32 m0, s57, 65536
    v_mfma_f32_16x16x32_bf16 v[24:27], v[196:199], a[248:251], v[24:27]
    ds_read_b64_tr_b16 v[214:215], v235 offset:22528
    v_mfma_f32_16x16x32_bf16 v[28:31], v[192:195], a[236:239], v[28:31]
    buffer_load_dwordx4 v239, s[20:23], s56 offen offset:0 sc1 lds
    v_mfma_f32_16x16x32_bf16 v[28:31], v[196:199], a[252:255], v[28:31]
    s_waitcnt lgkmcnt(4)
    ds_read_b64_tr_b16 v[192:193], v232 offset:24576
    ds_read_b64_tr_b16 v[194:195], v232 offset:26624
    v_mfma_f32_16x16x32_bf16 v[32:35], v[200:203], a[224:227], v[32:35]
    ds_read_b64_tr_b16 v[196:197], v232 offset:28672
    v_mfma_f32_16x16x32_bf16 v[32:35], v[204:207], a[240:243], v[32:35]
    v_mfma_f32_16x16x32_bf16 v[36:39], v[200:203], a[228:231], v[36:39]
    buffer_load_dwordx4 v240, s[20:23], s56 offen offset:1024 sc1 lds
    v_mfma_f32_16x16x32_bf16 v[36:39], v[204:207], a[244:247], v[36:39]
    s_mul_i32 s56, s81, 4096
    s_add_u32 s56, s56, 524416
    ds_read_b64_tr_b16 v[198:199], v232 offset:30720
    v_mfma_f32_16x16x32_bf16 v[40:43], v[200:203], a[232:235], v[40:43]
    s_add_u32 m0, s57, 73728
    v_mfma_f32_16x16x32_bf16 v[40:43], v[204:207], a[248:251], v[40:43]
    v_mfma_f32_16x16x32_bf16 v[44:47], v[200:203], a[236:239], v[44:47]
    buffer_load_dwordx4 v239, s[20:23], s56 offen offset:0 sc1 lds
    v_mfma_f32_16x16x32_bf16 v[44:47], v[204:207], a[252:255], v[44:47]
    s_waitcnt lgkmcnt(4)
    ds_read_b64_tr_b16 v[200:201], v233 offset:24576
    v_mfma_f32_16x16x32_bf16 v[48:51], v[208:211], a[224:227], v[48:51]
    s_cmp_lt_u32 s52, 2
    s_cselect_b32 s28, s28, s32
    s_cselect_b32 s29, s29, s33
    v_mfma_f32_16x16x32_bf16 v[48:51], v[212:215], a[240:243], v[48:51]
    ds_read_b64_tr_b16 v[202:203], v233 offset:26624
    v_lshrrev_b32 v160, 4, v255
    v_mfma_f32_16x16x32_bf16 v[52:55], v[208:211], a[228:231], v[52:55]
    buffer_load_dwordx4 v240, s[20:23], s56 offen offset:1024 sc1 lds
    v_mfma_f32_16x16x32_bf16 v[52:55], v[212:215], a[244:247], v[52:55]
    s_mul_i32 s56, s82, 4096
    s_add_u32 m0, s57, 81920
    ds_read_b64_tr_b16 v[204:205], v233 offset:28672
    v_mfma_f32_16x16x32_bf16 v[56:59], v[208:211], a[232:235], v[56:59]
    s_lshl_b32 s100, s54, 7
    v_bfe_u32 v161, v255, 2, 2
    v_mfma_f32_16x16x32_bf16 v[56:59], v[212:215], a[248:251], v[56:59]
    s_add_u32 s100, s100, 58720256
    ds_read_b64_tr_b16 v[206:207], v233 offset:30720
    v_lshl_add_u32 v161, v160, 3, v161
    v_mfma_f32_16x16x32_bf16 v[60:63], v[208:211], a[236:239], v[60:63]
    buffer_load_dwordx4 v239, s[20:23], s56 offen offset:0 sc1 lds
    v_mfma_f32_16x16x32_bf16 v[60:63], v[212:215], a[252:255], v[60:63]
    s_waitcnt lgkmcnt(4)
    s_and_b32 s73, s52, 1
    ds_read_b64_tr_b16 v[208:209], v234 offset:24576
    v_mfma_f32_16x16x32_bf16 v[64:67], v[192:195], a[224:227], v[64:67]
    s_lshl_b32 s74, s73, 5
    ds_read_b64_tr_b16 v[210:211], v234 offset:26624
    v_add_u32 v161, s74, v161
    v_mfma_f32_16x16x32_bf16 v[64:67], v[196:199], a[240:243], v[64:67]
    v_mul_u32_u24 v161, 2752, v161
    v_mfma_f32_16x16x32_bf16 v[68:71], v[192:195], a[228:231], v[68:71]
    buffer_load_dwordx4 v240, s[20:23], s56 offen offset:1024 sc1 lds
    v_mfma_f32_16x16x32_bf16 v[68:71], v[196:199], a[244:247], v[68:71]
    ds_read_b64_tr_b16 v[212:213], v234 offset:28672
    v_and_b32 v160, 1, v160
    v_mfma_f32_16x16x32_bf16 v[72:75], v[192:195], a[232:235], v[72:75]
    buffer_load_dword v231, v250, s[48:51], s100 offen sc1
    v_mfma_f32_16x16x32_bf16 v[72:75], v[196:199], a[248:251], v[72:75]
    s_mul_i32 s56, s82, 4096
    s_add_u32 s56, s56, 128
    v_mfma_f32_16x16x32_bf16 v[76:79], v[192:195], a[236:239], v[76:79]
    s_add_u32 m0, s57, 90112
    ds_read_b64_tr_b16 v[214:215], v234 offset:30720
    v_lshlrev_b32 v160, 1, v160
    v_mfma_f32_16x16x32_bf16 v[76:79], v[196:199], a[252:255], v[76:79]
    s_waitcnt lgkmcnt(4)
    ds_read_b64_tr_b16 v[192:193], v235 offset:24576
    ds_read_b64_tr_b16 v[194:195], v235 offset:26624
    v_mfma_f32_16x16x32_bf16 v[80:83], v[200:203], a[224:227], v[80:83]
    ds_read_b64_tr_b16 v[196:197], v235 offset:28672
    ds_read_b64_tr_b16 v[198:199], v235 offset:30720
    v_mfma_f32_16x16x32_bf16 v[80:83], v[204:207], a[240:243], v[80:83]
    buffer_load_dwordx4 v239, s[20:23], s56 offen offset:0 sc1 lds
    v_mfma_f32_16x16x32_bf16 v[84:87], v[200:203], a[228:231], v[84:87]
    v_and_b32 v162, 3, v255
    v_cvt_pk_bf16_f32 v0, v0, v1
    v_mfma_f32_16x16x32_bf16 v[84:87], v[204:207], a[244:247], v[84:87]
    v_xor_b32 v160, v160, v162
    v_cvt_pk_bf16_f32 v1, v2, v3
    v_mfma_f32_16x16x32_bf16 v[88:91], v[200:203], a[232:235], v[88:91]
    s_lshl_b32 s74, s53, 6
    v_lshl_add_u32 v160, v160, 4, v161
    v_cvt_pk_bf16_f32 v2, v16, v17
    v_mfma_f32_16x16x32_bf16 v[88:91], v[204:207], a[248:251], v[88:91]
    buffer_load_dwordx4 v240, s[20:23], s56 offen offset:1024 sc1 lds
    v_mfma_f32_16x16x32_bf16 v[92:95], v[200:203], a[236:239], v[92:95]
    v_add_u32 v241, s74, v160
    v_cvt_pk_bf16_f32 v3, v18, v19
    v_mfma_f32_16x16x32_bf16 v[92:95], v[204:207], a[252:255], v[92:95]
    s_waitcnt lgkmcnt(4)
    v_add_u32 v242, 9984, v241
    v_cvt_pk_bf16_f32 v16, v32, v33
    v_mfma_f32_16x16x32_bf16 v[96:99], v[208:211], a[224:227], v[96:99]
    v_bfe_u32 v160, v255, 3, 2
    v_cvt_pk_bf16_f32 v17, v34, v35
    v_mfma_f32_16x16x32_bf16 v[96:99], v[212:215], a[240:243], v[96:99]
    v_bfe_u32 v161, v255, 1, 2
    v_cvt_pk_bf16_f32 v18, v48, v49
    v_mfma_f32_16x16x32_bf16 v[100:103], v[208:211], a[228:231], v[100:103]
    s_waitcnt vmcnt(13) lgkmcnt(0)
    s_barrier
    v_lshl_add_u32 v160, v160, 3, v161
    v_mfma_f32_16x16x32_bf16 v[100:103], v[212:215], a[244:247], v[100:103]
    s_mul_i32 s56, s82, 4096
    ds_read_b64_tr_b16 v[200:201], v232 offset:49152
    ds_read_b64_tr_b16 v[202:203], v232 offset:51200
    v_mfma_f32_16x16x32_bf16 v[104:107], v[208:211], a[232:235], v[104:107]
    s_add_u32 s56, s56, 524288
    ds_read_b64_tr_b16 v[204:205], v232 offset:53248
    ds_read_b64_tr_b16 v[206:207], v232 offset:55296
    v_mfma_f32_16x16x32_bf16 v[104:107], v[212:215], a[248:251], v[104:107]
    s_add_u32 m0, s57, 16384
    v_lshrrev_b32 v161, 5, v255
    v_cvt_pk_bf16_f32 v19, v50, v51
    v_mfma_f32_16x16x32_bf16 v[108:111], v[208:211], a[236:239], v[108:111]
    buffer_load_dwordx4 v239, s[20:23], s56 offen offset:0 sc1 lds
    v_mfma_f32_16x16x32_bf16 v[108:111], v[212:215], a[252:255], v[108:111]
    ds_read_b64_tr_b16 v[208:209], v233 offset:49152
    v_lshl_add_u32 v160, v161, 2, v160
    v_mfma_f32_16x16x32_bf16 v[112:115], v[192:195], a[224:227], v[112:115]
    s_lshl_b32 s74, s73, 6
    v_add_u32 v160, s74, v160
    v_cvt_pk_bf16_f32 v4, v4, v5
    v_mfma_f32_16x16x32_bf16 v[112:115], v[196:199], a[240:243], v[112:115]
    ds_read_b64_tr_b16 v[210:211], v233 offset:51200
    v_mul_u32_u24 v160, 2752, v160
    v_mfma_f32_16x16x32_bf16 v[116:119], v[192:195], a[228:231], v[116:119]
    buffer_load_dwordx4 v240, s[20:23], s56 offen offset:1024 sc1 lds
    v_mfma_f32_16x16x32_bf16 v[116:119], v[196:199], a[244:247], v[116:119]
    ds_read_b64_tr_b16 v[212:213], v233 offset:53248
    v_and_b32 v161, 1, v255
    v_mfma_f32_16x16x32_bf16 v[120:123], v[192:195], a[232:235], v[120:123]
    s_min_u32 s74, s53, 21
    s_lshl_b32 s74, s74, 5
    s_add_u32 s74, s74, 2048
    v_lshl_add_u32 v160, v161, 4, v160
    v_mfma_f32_16x16x32_bf16 v[120:123], v[196:199], a[248:251], v[120:123]
    s_cmp_lt_u32 s53, 22
    s_cselect_b32 s74, s74, 2147483392
    v_add_u32 v243, s74, v160
    s_and_b32 s74, s53, 1
    s_lshl_b32 s74, s74, 3
    v_add_u32 v244, 87040, v243
    s_cmp_lt_u32 s53, 22
    s_cselect_b32 s74, s74, 2147483392
    v_add_u32 v252, s74, v245
    v_mfma_f32_16x16x32_bf16 v[124:127], v[192:195], a[236:239], v[124:127]
    ds_read_b64_tr_b16 v[214:215], v233 offset:55296
    v_cvt_pk_bf16_f32 v5, v6, v7
    v_mfma_f32_16x16x32_bf16 v[124:127], v[196:199], a[252:255], v[124:127]
    s_waitcnt lgkmcnt(4)
    v_cvt_pk_bf16_f32 v6, v20, v21
    v_mfma_f32_16x16x32_bf16 v[128:131], a[0:3], v[200:203], 0
    ds_read_b64_tr_b16 v[192:193], v234 offset:49152
    v_cvt_pk_bf16_f32 v7, v22, v23
    v_mfma_f32_16x16x32_bf16 v[128:131], a[16:19], v[204:207], v[128:131]
    s_mul_i32 s56, s82, 4096
    s_add_u32 s56, s56, 524416
    ds_read_b64_tr_b16 v[194:195], v234 offset:51200
    v_mfma_f32_16x16x32_bf16 v[132:135], a[4:7], v[200:203], 0
    v_cvt_pk_bf16_f32 v20, v36, v37
    v_mfma_f32_16x16x32_bf16 v[132:135], a[20:23], v[204:207], v[132:135]
    s_add_u32 m0, s57, 24576
    ds_read_b64_tr_b16 v[196:197], v234 offset:53248
    v_cvt_pk_bf16_f32 v21, v38, v39
    v_mfma_f32_16x16x32_bf16 v[136:139], a[8:11], v[200:203], 0
    buffer_load_dwordx4 v239, s[20:23], s56 offen offset:0 sc1 lds
    v_mfma_f32_16x16x32_bf16 v[136:139], a[24:27], v[204:207], v[136:139]
    ds_read_b64_tr_b16 v[198:199], v234 offset:55296
    v_cvt_pk_bf16_f32 v22, v52, v53
    v_mfma_f32_16x16x32_bf16 v[140:143], a[12:15], v[200:203], 0
    v_cvt_pk_bf16_f32 v23, v54, v55
    v_mfma_f32_16x16x32_bf16 v[140:143], a[28:31], v[204:207], v[140:143]
    s_waitcnt lgkmcnt(4)
    ds_read_b64_tr_b16 v[200:201], v235 offset:49152
    v_cvt_pk_bf16_f32 v8, v8, v9
    v_mfma_f32_16x16x32_bf16 v[144:147], a[0:3], v[208:211], 0
    buffer_load_dwordx4 v240, s[20:23], s56 offen offset:1024 sc1 lds
    v_mfma_f32_16x16x32_bf16 v[144:147], a[16:19], v[212:215], v[144:147]
    ds_read_b64_tr_b16 v[202:203], v235 offset:51200
    v_cvt_pk_bf16_f32 v64, v64, v65
    v_mfma_f32_16x16x32_bf16 v[148:151], a[4:7], v[208:211], 0
    v_cvt_pk_bf16_f32 v65, v66, v67
    v_cvt_pk_bf16_f32 v9, v10, v11
    v_mfma_f32_16x16x32_bf16 v[148:151], a[20:23], v[212:215], v[148:151]
    ds_read_b64_tr_b16 v[204:205], v235 offset:53248
    v_cvt_pk_bf16_f32 v66, v80, v81
    v_mfma_f32_16x16x32_bf16 v[152:155], a[8:11], v[208:211], 0
    v_cvt_pk_bf16_f32 v67, v82, v83
    v_cvt_pk_bf16_f32 v10, v24, v25
    v_mfma_f32_16x16x32_bf16 v[152:155], a[24:27], v[212:215], v[152:155]
    ds_read_b64_tr_b16 v[206:207], v235 offset:55296
    v_cvt_pk_bf16_f32 v80, v96, v97
    v_mfma_f32_16x16x32_bf16 v[156:159], a[12:15], v[208:211], 0
    v_cvt_pk_bf16_f32 v81, v98, v99
    v_cvt_pk_bf16_f32 v11, v26, v27
    v_mfma_f32_16x16x32_bf16 v[156:159], a[28:31], v[212:215], v[156:159]
    s_waitcnt lgkmcnt(4)
    ds_read_b64_tr_b16 v[208:209], v232 offset:0
    v_cvt_pk_bf16_f32 v82, v112, v113
    v_mfma_f32_16x16x32_bf16 v[160:163], a[0:3], v[192:195], 0
    v_cvt_pk_bf16_f32 v83, v114, v115
    v_cvt_pk_bf16_f32 v24, v40, v41
    v_mfma_f32_16x16x32_bf16 v[160:163], a[16:19], v[196:199], v[160:163]
    ds_read_b64_tr_b16 v[210:211], v232 offset:2048
    v_cvt_pk_bf16_f32 v68, v68, v69
    v_mfma_f32_16x16x32_bf16 v[164:167], a[4:7], v[192:195], 0
    v_cvt_pk_bf16_f32 v69, v70, v71
    v_cvt_pk_bf16_f32 v25, v42, v43
    v_mfma_f32_16x16x32_bf16 v[164:167], a[20:23], v[196:199], v[164:167]
    ds_read_b64_tr_b16 v[212:213], v232 offset:4096
    v_cvt_pk_bf16_f32 v70, v84, v85
    v_mfma_f32_16x16x32_bf16 v[168:171], a[8:11], v[192:195], 0
    v_cvt_pk_bf16_f32 v71, v86, v87
    v_cvt_pk_bf16_f32 v26, v56, v57
    v_mfma_f32_16x16x32_bf16 v[168:171], a[24:27], v[196:199], v[168:171]
    ds_read_b64_tr_b16 v[214:215], v232 offset:6144
    v_cvt_pk_bf16_f32 v84, v100, v101
    v_mfma_f32_16x16x32_bf16 v[172:175], a[12:15], v[192:195], 0
    v_cvt_pk_bf16_f32 v27, v58, v59
    v_cvt_pk_bf16_f32 v12, v12, v13
    v_cvt_pk_bf16_f32 v13, v14, v15
    v_mfma_f32_16x16x32_bf16 v[172:175], a[28:31], v[196:199], v[172:175]
    s_waitcnt lgkmcnt(4)
    s_mul_i32 s56, s85, 4096
    ds_read_b64_tr_b16 v[192:193], v233 offset:0
    v_mfma_f32_16x16x32_bf16 v[176:179], a[0:3], v[200:203], 0
    s_add_u32 m0, s57, 98304
    v_cvt_pk_bf16_f32 v85, v102, v103
    v_cvt_pk_bf16_f32 v14, v28, v29
    v_cvt_pk_bf16_f32 v15, v30, v31
    v_cvt_pk_bf16_f32 v28, v44, v45
    v_cvt_pk_bf16_f32 v29, v46, v47
    v_cvt_pk_bf16_f32 v30, v60, v61
    v_mfma_f32_16x16x32_bf16 v[176:179], a[16:19], v[204:207], v[176:179]
    ds_read_b64_tr_b16 v[194:195], v233 offset:2048
    v_cvt_pk_bf16_f32 v86, v116, v117
    v_mfma_f32_16x16x32_bf16 v[180:183], a[4:7], v[200:203], 0
    buffer_load_dwordx4 v239, s[20:23], s56 offen offset:0 sc1 lds
    v_cvt_pk_bf16_f32 v31, v62, v63
    v_mfma_f32_16x16x32_bf16 v[180:183], a[20:23], v[204:207], v[180:183]
    ds_read_b64_tr_b16 v[196:197], v233 offset:4096
    v_cvt_pk_bf16_f32 v87, v118, v119
    v_mfma_f32_16x16x32_bf16 v[184:187], a[8:11], v[200:203], 0
    ds_read_b64_tr_b16 v[198:199], v233 offset:6144
    v_cvt_pk_bf16_f32 v72, v72, v73
    v_mfma_f32_16x16x32_bf16 v[184:187], a[24:27], v[204:207], v[184:187]
    v_cvt_pk_bf16_f32 v73, v74, v75
    v_mfma_f32_16x16x32_bf16 v[188:191], a[12:15], v[200:203], 0
    buffer_load_dwordx4 v240, s[20:23], s56 offen offset:1024 sc1 lds
    v_mfma_f32_16x16x32_bf16 v[188:191], a[28:31], v[204:207], v[188:191]
    s_waitcnt lgkmcnt(4)
    v_cvt_pk_bf16_f32 v74, v88, v89
    v_mfma_f32_16x16x32_bf16 v[32:35], a[0:3], v[208:211], 0
    ds_read_b64_tr_b16 v[200:201], v234 offset:0
    v_cvt_pk_bf16_f32 v75, v90, v91
    v_mfma_f32_16x16x32_bf16 v[32:35], a[16:19], v[212:215], v[32:35]
    ds_read_b64_tr_b16 v[202:203], v234 offset:2048
    v_cvt_pk_bf16_f32 v88, v104, v105
    v_mfma_f32_16x16x32_bf16 v[36:39], a[4:7], v[208:211], 0
    buffer_store_dwordx4 v[0:3], v245, s[48:51], s59 offen offset:0 sc1
    v_mfma_f32_16x16x32_bf16 v[36:39], a[20:23], v[212:215], v[36:39]
    ds_read_b64_tr_b16 v[204:205], v234 offset:4096
    v_cvt_pk_bf16_f32 v89, v106, v107
    v_mfma_f32_16x16x32_bf16 v[40:43], a[8:11], v[208:211], 0
    ds_read_b64_tr_b16 v[206:207], v234 offset:6144
    v_cvt_pk_bf16_f32 v90, v120, v121
    v_mfma_f32_16x16x32_bf16 v[40:43], a[24:27], v[212:215], v[40:43]
    v_cvt_pk_bf16_f32 v91, v122, v123
    v_mfma_f32_16x16x32_bf16 v[44:47], a[12:15], v[208:211], 0
    v_cvt_pk_bf16_f32 v76, v76, v77
    v_mfma_f32_16x16x32_bf16 v[44:47], a[28:31], v[212:215], v[44:47]
    s_waitcnt lgkmcnt(4)
    ds_read_b64_tr_b16 v[208:209], v235 offset:0
    v_cvt_pk_bf16_f32 v77, v78, v79
    v_mfma_f32_16x16x32_bf16 v[48:51], a[0:3], v[192:195], 0
    v_cvt_pk_bf16_f32 v78, v92, v93
    v_mfma_f32_16x16x32_bf16 v[48:51], a[16:19], v[196:199], v[48:51]
    v_cvt_pk_bf16_f32 v79, v94, v95
    v_mfma_f32_16x16x32_bf16 v[52:55], a[4:7], v[192:195], 0
    ds_read_b64_tr_b16 v[210:211], v235 offset:2048
    v_cvt_pk_bf16_f32 v92, v108, v109
    v_mfma_f32_16x16x32_bf16 v[52:55], a[20:23], v[196:199], v[52:55]
    ds_read_b64_tr_b16 v[212:213], v235 offset:4096
    v_cvt_pk_bf16_f32 v93, v110, v111
    v_mfma_f32_16x16x32_bf16 v[56:59], a[8:11], v[192:195], 0
    v_cvt_pk_bf16_f32 v94, v124, v125
    v_cvt_pk_bf16_f32 v95, v126, v127
    v_mfma_f32_16x16x32_bf16 v[56:59], a[24:27], v[196:199], v[56:59]
    s_mul_i32 s56, s85, 4096
    s_add_u32 s56, s56, 128
    ds_read_b64_tr_b16 v[214:215], v235 offset:6144
    v_mfma_f32_16x16x32_bf16 v[60:63], a[12:15], v[192:195], 0
    v_mfma_f32_16x16x32_bf16 v[60:63], a[28:31], v[196:199], v[60:63]
    s_waitcnt lgkmcnt(4)
    s_add_u32 m0, s57, 106496
    ds_read_b64_tr_b16 v[192:193], v232 offset:32768
    v_mfma_f32_16x16x32_bf16 v[96:99], a[0:3], v[200:203], 0
    buffer_load_dwordx4 v239, s[20:23], s56 offen offset:0 sc1 lds
    v_mfma_f32_16x16x32_bf16 v[96:99], a[16:19], v[204:207], v[96:99]
    v_mfma_f32_16x16x32_bf16 v[100:103], a[4:7], v[200:203], 0
    ds_read_b64_tr_b16 v[194:195], v232 offset:34816
    v_mfma_f32_16x16x32_bf16 v[100:103], a[20:23], v[204:207], v[100:103]
    ds_read_b64_tr_b16 v[196:197], v232 offset:36864
    v_mfma_f32_16x16x32_bf16 v[104:107], a[8:11], v[200:203], 0
    buffer_load_dwordx4 v240, s[20:23], s56 offen offset:1024 sc1 lds
    v_mfma_f32_16x16x32_bf16 v[104:107], a[24:27], v[204:207], v[104:107]
    v_mfma_f32_16x16x32_bf16 v[108:111], a[12:15], v[200:203], 0
    s_waitcnt vmcnt(11)
    ds_read_b64_tr_b16 v[198:199], v232 offset:38912
    v_cmp_ne_u32 vcc, 1, v231
    v_mfma_f32_16x16x32_bf16 v[108:111], a[28:31], v[204:207], v[108:111]
    s_waitcnt lgkmcnt(4)
    ds_read_b64_tr_b16 v[200:201], v233 offset:32768
    v_mfma_f32_16x16x32_bf16 v[112:115], a[0:3], v[208:211], 0
    ds_read_b64_tr_b16 v[202:203], v233 offset:34816
    v_mfma_f32_16x16x32_bf16 v[112:115], a[16:19], v[212:215], v[112:115]
    s_cbranch_vccnz L_spin_4
L_back_5:
    v_mfma_f32_16x16x32_bf16 v[116:119], a[4:7], v[208:211], 0
    v_mfma_f32_16x16x32_bf16 v[116:119], a[20:23], v[212:215], v[116:119]
    ds_read_b64_tr_b16 v[204:205], v233 offset:36864
    v_mfma_f32_16x16x32_bf16 v[120:123], a[8:11], v[208:211], 0
    v_mfma_f32_16x16x32_bf16 v[120:123], a[24:27], v[212:215], v[120:123]
    ds_read_b64_tr_b16 v[206:207], v233 offset:38912
    v_mfma_f32_16x16x32_bf16 v[124:127], a[12:15], v[208:211], 0
    buffer_store_dwordx4 v[16:19], v245, s[48:51], s59 offen offset:1024 sc1
    v_mfma_f32_16x16x32_bf16 v[124:127], a[28:31], v[212:215], v[124:127]
    s_waitcnt lgkmcnt(4)
    ds_read_b64_tr_b16 v[208:209], v234 offset:32768
    v_mfma_f32_16x16x32_bf16 v[128:131], a[32:35], v[192:195], v[128:131]
    v_mfma_f32_16x16x32_bf16 v[128:131], a[48:51], v[196:199], v[128:131]
    v_mfma_f32_16x16x32_bf16 v[132:135], a[36:39], v[192:195], v[132:135]
    ds_read_b64_tr_b16 v[210:211], v234 offset:34816
    v_mfma_f32_16x16x32_bf16 v[132:135], a[52:55], v[196:199], v[132:135]
    s_mul_i32 s56, s85, 4096
    s_add_u32 s56, s56, 524288
    ds_read_b64_tr_b16 v[212:213], v234 offset:36864
    v_mfma_f32_16x16x32_bf16 v[136:139], a[40:43], v[192:195], v[136:139]
    s_add_u32 m0, s57, 114688
    ds_read_b64_tr_b16 v[214:215], v234 offset:38912
    v_mfma_f32_16x16x32_bf16 v[136:139], a[56:59], v[196:199], v[136:139]
    v_mfma_f32_16x16x32_bf16 v[140:143], a[44:47], v[192:195], v[140:143]
    buffer_load_dwordx4 v239, s[20:23], s56 offen offset:0 sc1 lds
    v_mfma_f32_16x16x32_bf16 v[140:143], a[60:63], v[196:199], v[140:143]
    s_waitcnt lgkmcnt(4)
    ds_read_b64_tr_b16 v[192:193], v235 offset:32768
    v_mfma_f32_16x16x32_bf16 v[144:147], a[32:35], v[200:203], v[144:147]
    v_mfma_f32_16x16x32_bf16 v[144:147], a[48:51], v[204:207], v[144:147]
    ds_read_b64_tr_b16 v[194:195], v235 offset:34816
    v_mfma_f32_16x16x32_bf16 v[148:151], a[36:39], v[200:203], v[148:151]
    v_mfma_f32_16x16x32_bf16 v[148:151], a[52:55], v[204:207], v[148:151]
    ds_read_b64_tr_b16 v[196:197], v235 offset:36864
    v_mfma_f32_16x16x32_bf16 v[152:155], a[40:43], v[200:203], v[152:155]
    buffer_load_dwordx4 v240, s[20:23], s56 offen offset:1024 sc1 lds
    v_mfma_f32_16x16x32_bf16 v[152:155], a[56:59], v[204:207], v[152:155]
    ds_read_b64_tr_b16 v[198:199], v235 offset:38912
    v_mfma_f32_16x16x32_bf16 v[156:159], a[44:47], v[200:203], v[156:159]
    v_mfma_f32_16x16x32_bf16 v[156:159], a[60:63], v[204:207], v[156:159]
    s_waitcnt lgkmcnt(4)
    ds_read_b64_tr_b16 v[200:201], v232 offset:8192
    ds_read_b64_tr_b16 v[202:203], v232 offset:10240
    v_mfma_f32_16x16x32_bf16 v[160:163], a[32:35], v[208:211], v[160:163]
    v_mfma_f32_16x16x32_bf16 v[160:163], a[48:51], v[212:215], v[160:163]
    ds_read_b64_tr_b16 v[204:205], v232 offset:12288
    v_mfma_f32_16x16x32_bf16 v[164:167], a[36:39], v[208:211], v[164:167]
    v_mfma_f32_16x16x32_bf16 v[164:167], a[52:55], v[212:215], v[164:167]
    v_mfma_f32_16x16x32_bf16 v[168:171], a[40:43], v[208:211], v[168:171]
    ds_read_b64_tr_b16 v[206:207], v232 offset:14336
    v_mfma_f32_16x16x32_bf16 v[168:171], a[56:59], v[212:215], v[168:171]
    v_mfma_f32_16x16x32_bf16 v[172:175], a[44:47], v[208:211], v[172:175]
    v_mfma_f32_16x16x32_bf16 v[172:175], a[60:63], v[212:215], v[172:175]
    s_waitcnt lgkmcnt(4)
    buffer_load_dwordx4 a[0:3], v216, s[48:51], s61 offen offset:0 sc1
    v_mfma_f32_16x16x32_bf16 v[176:179], a[32:35], v[192:195], v[176:179]
    ds_read_b64_tr_b16 v[208:209], v233 offset:8192
    v_mfma_f32_16x16x32_bf16 v[176:179], a[48:51], v[196:199], v[176:179]
    s_mul_i32 s56, s85, 4096
    s_add_u32 s56, s56, 524416
    ds_read_b64_tr_b16 v[210:211], v233 offset:10240
    v_mfma_f32_16x16x32_bf16 v[180:183], a[36:39], v[192:195], v[180:183]
    v_mfma_f32_16x16x32_bf16 v[180:183], a[52:55], v[196:199], v[180:183]
    s_add_u32 m0, s57, 122880
    ds_read_b64_tr_b16 v[212:213], v233 offset:12288
    v_mfma_f32_16x16x32_bf16 v[184:187], a[40:43], v[192:195], v[184:187]
    buffer_load_dwordx4 v239, s[20:23], s56 offen offset:0 sc1 lds
    v_mfma_f32_16x16x32_bf16 v[184:187], a[56:59], v[196:199], v[184:187]
    ds_read_b64_tr_b16 v[214:215], v233 offset:14336
    v_mfma_f32_16x16x32_bf16 v[188:191], a[44:47], v[192:195], v[188:191]
    v_mfma_f32_16x16x32_bf16 v[188:191], a[60:63], v[196:199], v[188:191]
    s_waitcnt lgkmcnt(4)
    v_mfma_f32_16x16x32_bf16 v[32:35], a[32:35], v[200:203], v[32:35]
    buffer_load_dwordx4 v240, s[20:23], s56 offen offset:1024 sc1 lds
    v_mfma_f32_16x16x32_bf16 v[32:35], a[48:51], v[204:207], v[32:35]
    ds_read_b64_tr_b16 v[192:193], v234 offset:8192
    ds_read_b64_tr_b16 v[194:195], v234 offset:10240
    v_mfma_f32_16x16x32_bf16 v[36:39], a[36:39], v[200:203], v[36:39]
    v_mfma_f32_16x16x32_bf16 v[36:39], a[52:55], v[204:207], v[36:39]
    ds_read_b64_tr_b16 v[196:197], v234 offset:12288
    v_mfma_f32_16x16x32_bf16 v[40:43], a[40:43], v[200:203], v[40:43]
    buffer_load_dwordx4 a[4:7], v216, s[48:51], s62 offen offset:0 sc1
    v_mfma_f32_16x16x32_bf16 v[40:43], a[56:59], v[204:207], v[40:43]
    ds_read_b64_tr_b16 v[198:199], v234 offset:14336
    v_mfma_f32_16x16x32_bf16 v[44:47], a[44:47], v[200:203], v[44:47]
    buffer_store_dwordx4 v[4:7], v246, s[48:51], s59 offen offset:0 sc1
    v_mfma_f32_16x16x32_bf16 v[44:47], a[60:63], v[204:207], v[44:47]
    s_waitcnt lgkmcnt(4)
    ds_read_b64_tr_b16 v[200:201], v235 offset:8192
    ds_read_b64_tr_b16 v[202:203], v235 offset:10240
    v_mfma_f32_16x16x32_bf16 v[48:51], a[32:35], v[208:211], v[48:51]
    ds_read_b64_tr_b16 v[204:205], v235 offset:12288
    v_mfma_f32_16x16x32_bf16 v[48:51], a[48:51], v[212:215], v[48:51]
    ds_read_b64_tr_b16 v[206:207], v235 offset:14336
    v_mfma_f32_16x16x32_bf16 v[52:55], a[36:39], v[208:211], v[52:55]
    v_mfma_f32_16x16x32_bf16 v[52:55], a[52:55], v[212:215], v[52:55]
    v_mfma_f32_16x16x32_bf16 v[56:59], a[40:43], v[208:211], v[56:59]
    buffer_load_dwordx4 a[8:11], v216, s[48:51], s63 offen offset:0 sc1
    v_mfma_f32_16x16x32_bf16 v[56:59], a[56:59], v[212:215], v[56:59]
    v_mfma_f32_16x16x32_bf16 v[60:63], a[44:47], v[208:211], v[60:63]
    v_mfma_f32_16x16x32_bf16 v[60:63], a[60:63], v[212:215], v[60:63]
    s_waitcnt lgkmcnt(4)
    s_mul_i32 s56, s80, 1376
    s_add_u32 m0, s57, 131072
    v_mfma_f32_16x16x32_bf16 v[96:99], a[32:35], v[192:195], v[96:99]
    buffer_load_dwordx4 v241, s[28:31], s56 offen offset:0 sc1 lds
    v_mfma_f32_16x16x32_bf16 v[96:99], a[48:51], v[196:199], v[96:99]
    v_mfma_f32_16x16x32_bf16 v[100:103], a[36:39], v[192:195], v[100:103]
    s_waitcnt lgkmcnt(0)
    s_barrier
    v_mfma_f32_16x16x32_bf16 v[100:103], a[52:55], v[196:199], v[100:103]
    ds_read_b64_tr_b16 v[208:209], v232 offset:40960
    ds_read_b64_tr_b16 v[210:211], v232 offset:43008
    v_mfma_f32_16x16x32_bf16 v[104:107], a[40:43], v[192:195], v[104:107]
    ds_read_b64_tr_b16 v[212:213], v232 offset:45056
    ds_read_b64_tr_b16 v[214:215], v232 offset:47104
    v_mfma_f32_16x16x32_bf16 v[104:107], a[56:59], v[196:199], v[104:107]
    buffer_load_dwordx4 v242, s[28:31], s56 offen offset:1024 sc1 lds
    v_mfma_f32_16x16x32_bf16 v[108:111], a[44:47], v[192:195], v[108:111]
    v_mfma_f32_16x16x32_bf16 v[108:111], a[60:63], v[196:199], v[108:111]
    ds_read_b64_tr_b16 v[192:193], v233 offset:40960
    v_mfma_f32_16x16x32_bf16 v[112:115], a[32:35], v[200:203], v[112:115]
    ds_read_b64_tr_b16 v[194:195], v233 offset:43008
    ds_read_b64_tr_b16 v[196:197], v233 offset:45056
    v_mfma_f32_16x16x32_bf16 v[112:115], a[48:51], v[204:207], v[112:115]
    buffer_store_dwordx4 v[20:23], v246, s[48:51], s59 offen offset:1024 sc1
    v_mfma_f32_16x16x32_bf16 v[116:119], a[36:39], v[200:203], v[116:119]
    v_mfma_f32_16x16x32_bf16 v[116:119], a[52:55], v[204:207], v[116:119]
    v_mfma_f32_16x16x32_bf16 v[120:123], a[40:43], v[200:203], v[120:123]
    ds_read_b64_tr_b16 v[198:199], v233 offset:47104
    v_mfma_f32_16x16x32_bf16 v[120:123], a[56:59], v[204:207], v[120:123]
    buffer_load_dwordx4 a[12:15], v216, s[48:51], s64 offen offset:0 sc1
    v_mfma_f32_16x16x32_bf16 v[124:127], a[44:47], v[200:203], v[124:127]
    v_mfma_f32_16x16x32_bf16 v[124:127], a[60:63], v[204:207], v[124:127]
    s_waitcnt lgkmcnt(4)
    ds_read_b64_tr_b16 v[200:201], v234 offset:40960
    v_mfma_f32_16x16x32_bf16 v[128:131], a[64:67], v[208:211], v[128:131]
    v_mfma_f32_16x16x32_bf16 v[128:131], a[80:83], v[212:215], v[128:131]
    ds_read_b64_tr_b16 v[202:203], v234 offset:43008
    v_mfma_f32_16x16x32_bf16 v[132:135], a[68:71], v[208:211], v[132:135]
    buffer_load_dwordx4 a[16:19], v216, s[48:51], s61 offen offset:1024 sc1
    v_mfma_f32_16x16x32_bf16 v[132:135], a[84:87], v[212:215], v[132:135]
    ds_read_b64_tr_b16 v[204:205], v234 offset:45056
    ds_read_b64_tr_b16 v[206:207], v234 offset:47104
    v_mfma_f32_16x16x32_bf16 v[136:139], a[72:75], v[208:211], v[136:139]
    v_mfma_f32_16x16x32_bf16 v[136:139], a[88:91], v[212:215], v[136:139]
    s_mul_i32 s56, s80, 1376
    s_add_u32 s56, s56, 176128
    v_mfma_f32_16x16x32_bf16 v[140:143], a[76:79], v[208:211], v[140:143]
    s_add_u32 m0, s57, 0
    v_mfma_f32_16x16x32_bf16 v[140:143], a[92:95], v[212:215], v[140:143]
    s_waitcnt lgkmcnt(4)
    v_mfma_f32_16x16x32_bf16 v[144:147], a[64:67], v[192:195], v[144:147]
    buffer_load_dwordx4 v241, s[28:31], s56 offen offset:0 sc1 lds
    v_mfma_f32_16x16x32_bf16 v[144:147], a[80:83], v[196:199], v[144:147]
    ds_read_b64_tr_b16 v[208:209], v235 offset:40960
    v_mfma_f32_16x16x32_bf16 v[148:151], a[68:71], v[192:195], v[148:151]
    ds_read_b64_tr_b16 v[210:211], v235 offset:43008
    v_mfma_f32_16x16x32_bf16 v[148:151], a[84:87], v[196:199], v[148:151]
    ds_read_b64_tr_b16 v[212:213], v235 offset:45056
    v_mfma_f32_16x16x32_bf16 v[152:155], a[72:75], v[192:195], v[152:155]
    buffer_load_dwordx4 v242, s[28:31], s56 offen offset:1024 sc1 lds
    v_mfma_f32_16x16x32_bf16 v[152:155], a[88:91], v[196:199], v[152:155]
    ds_read_b64_tr_b16 v[214:215], v235 offset:47104
    v_mfma_f32_16x16x32_bf16 v[156:159], a[76:79], v[192:195], v[156:159]
    v_mfma_f32_16x16x32_bf16 v[156:159], a[92:95], v[196:199], v[156:159]
    s_waitcnt lgkmcnt(4)
    ds_read_b64_tr_b16 v[192:193], v232 offset:57344
    v_mfma_f32_16x16x32_bf16 v[160:163], a[64:67], v[200:203], v[160:163]
    buffer_load_dwordx4 a[20:23], v216, s[48:51], s62 offen offset:1024 sc1
    v_mfma_f32_16x16x32_bf16 v[160:163], a[80:83], v[204:207], v[160:163]
    v_mfma_f32_16x16x32_bf16 v[164:167], a[68:71], v[200:203], v[164:167]
    ds_read_b64_tr_b16 v[194:195], v232 offset:59392
    ds_read_b64_tr_b16 v[196:197], v232 offset:61440
    v_mfma_f32_16x16x32_bf16 v[164:167], a[84:87], v[204:207], v[164:167]
    v_mfma_f32_16x16x32_bf16 v[168:171], a[72:75], v[200:203], v[168:171]
    v_mfma_f32_16x16x32_bf16 v[168:171], a[88:91], v[204:207], v[168:171]
    ds_read_b64_tr_b16 v[198:199], v232 offset:63488
    v_mfma_f32_16x16x32_bf16 v[172:175], a[76:79], v[200:203], v[172:175]
    buffer_store_dwordx4 v[8:11], v247, s[48:51], s59 offen offset:0 sc1
    v_mfma_f32_16x16x32_bf16 v[172:175], a[92:95], v[204:207], v[172:175]
    s_waitcnt lgkmcnt(4)
    ds_read_b64_tr_b16 v[200:201], v233 offset:57344
    v_mfma_f32_16x16x32_bf16 v[176:179], a[64:67], v[208:211], v[176:179]
    v_mfma_f32_16x16x32_bf16 v[176:179], a[80:83], v[212:215], v[176:179]
    ds_read_b64_tr_b16 v[202:203], v233 offset:59392
    v_mfma_f32_16x16x32_bf16 v[180:183], a[68:71], v[208:211], v[180:183]
    buffer_load_dwordx4 a[24:27], v216, s[48:51], s63 offen offset:1024 sc1
    v_mfma_f32_16x16x32_bf16 v[180:183], a[84:87], v[212:215], v[180:183]
    ds_read_b64_tr_b16 v[204:205], v233 offset:61440
    v_mfma_f32_16x16x32_bf16 v[184:187], a[72:75], v[208:211], v[184:187]
    v_mfma_f32_16x16x32_bf16 v[184:187], a[88:91], v[212:215], v[184:187]
    ds_read_b64_tr_b16 v[206:207], v233 offset:63488
    v_mfma_f32_16x16x32_bf16 v[188:191], a[76:79], v[208:211], v[188:191]
    buffer_load_dwordx4 a[28:31], v216, s[48:51], s64 offen offset:1024 sc1
    v_mfma_f32_16x16x32_bf16 v[188:191], a[92:95], v[212:215], v[188:191]
    s_waitcnt lgkmcnt(4)
    s_mul_i32 s56, s80, 1376
    ds_read_b64_tr_b16 v[208:209], v234 offset:57344
    v_mfma_f32_16x16x32_bf16 v[32:35], a[64:67], v[192:195], v[32:35]
    s_add_u32 m0, s57, 8192
    v_mfma_f32_16x16x32_bf16 v[32:35], a[80:83], v[196:199], v[32:35]
    ds_read_b64_tr_b16 v[210:211], v234 offset:59392
    ds_read_b64_tr_b16 v[212:213], v234 offset:61440
    v_mfma_f32_16x16x32_bf16 v[36:39], a[68:71], v[192:195], v[36:39]
    buffer_load_dwordx4 v243, s[28:31], s56 offen offset:0 sc1 lds
    v_mfma_f32_16x16x32_bf16 v[36:39], a[84:87], v[196:199], v[36:39]
    v_mfma_f32_16x16x32_bf16 v[40:43], a[72:75], v[192:195], v[40:43]
    v_mfma_f32_16x16x32_bf16 v[40:43], a[88:91], v[196:199], v[40:43]
    ds_read_b64_tr_b16 v[214:215], v234 offset:63488
    v_mfma_f32_16x16x32_bf16 v[44:47], a[76:79], v[192:195], v[44:47]
    buffer_load_dwordx4 v244, s[28:31], s56 offen offset:1024 sc1 lds
    v_mfma_f32_16x16x32_bf16 v[44:47], a[92:95], v[196:199], v[44:47]
    s_waitcnt lgkmcnt(4)
    ds_read_b64_tr_b16 v[192:193], v235 offset:57344
    ds_read_b64_tr_b16 v[194:195], v235 offset:59392
    v_mfma_f32_16x16x32_bf16 v[48:51], a[64:67], v[200:203], v[48:51]
    v_mfma_f32_16x16x32_bf16 v[48:51], a[80:83], v[204:207], v[48:51]
    v_mfma_f32_16x16x32_bf16 v[52:55], a[68:71], v[200:203], v[52:55]
    ds_read_b64_tr_b16 v[196:197], v235 offset:61440
    v_mfma_f32_16x16x32_bf16 v[52:55], a[84:87], v[204:207], v[52:55]
    v_mfma_f32_16x16x32_bf16 v[56:59], a[72:75], v[200:203], v[56:59]
    v_mfma_f32_16x16x32_bf16 v[56:59], a[88:91], v[204:207], v[56:59]
    v_mfma_f32_16x16x32_bf16 v[60:63], a[76:79], v[200:203], v[60:63]
    ds_read_b64_tr_b16 v[198:199], v235 offset:63488
    v_mfma_f32_16x16x32_bf16 v[60:63], a[92:95], v[204:207], v[60:63]
    s_waitcnt lgkmcnt(4)
    v_add_u32 v232, 0x10000, v232
    v_add_u32 v233, 0x10000, v233
    v_add_u32 v234, 0x10000, v234
    v_add_u32 v235, 0x10000, v235
    ds_read_b64_tr_b16 v[200:201], v232 offset:0
    v_mfma_f32_16x16x32_bf16 v[96:99], a[64:67], v[208:211], v[96:99]
    buffer_load_dwordx4 a[32:35], v216, s[48:51], s61 offen offset:2048 sc1
    v_mfma_f32_16x16x32_bf16 v[96:99], a[80:83], v[212:215], v[96:99]
    ds_read_b64_tr_b16 v[202:203], v232 offset:2048
    v_mfma_f32_16x16x32_bf16 v[100:103], a[68:71], v[208:211], v[100:103]
    v_mfma_f32_16x16x32_bf16 v[100:103], a[84:87], v[212:215], v[100:103]
    ds_read_b64_tr_b16 v[204:205], v232 offset:4096
    v_mfma_f32_16x16x32_bf16 v[104:107], a[72:75], v[208:211], v[104:107]
    buffer_store_dwordx4 v[24:27], v247, s[48:51], s59 offen offset:1024 sc1
    v_mfma_f32_16x16x32_bf16 v[104:107], a[88:91], v[212:215], v[104:107]
    ds_read_b64_tr_b16 v[206:207], v232 offset:6144
    v_mfma_f32_16x16x32_bf16 v[108:111], a[76:79], v[208:211], v[108:111]
    v_mfma_f32_16x16x32_bf16 v[108:111], a[92:95], v[212:215], v[108:111]
    s_waitcnt lgkmcnt(4)
    v_mfma_f32_16x16x32_bf16 v[112:115], a[64:67], v[192:195], v[112:115]
    buffer_load_dwordx4 a[36:39], v216, s[48:51], s62 offen offset:2048 sc1
    v_mfma_f32_16x16x32_bf16 v[112:115], a[80:83], v[196:199], v[112:115]
    v_mfma_f32_16x16x32_bf16 v[116:119], a[68:71], v[192:195], v[116:119]
    ds_read_b64_tr_b16 v[208:209], v233 offset:0
    v_mfma_f32_16x16x32_bf16 v[116:119], a[84:87], v[196:199], v[116:119]
    ds_read_b64_tr_b16 v[210:211], v233 offset:2048
    ds_read_b64_tr_b16 v[212:213], v233 offset:4096
    v_mfma_f32_16x16x32_bf16 v[120:123], a[72:75], v[192:195], v[120:123]
    v_mfma_f32_16x16x32_bf16 v[120:123], a[88:91], v[196:199], v[120:123]
    ds_read_b64_tr_b16 v[214:215], v233 offset:6144
    v_mfma_f32_16x16x32_bf16 v[124:127], a[76:79], v[192:195], v[124:127]
    v_mfma_f32_16x16x32_bf16 v[124:127], a[92:95], v[196:199], v[124:127]
    s_waitcnt lgkmcnt(4)
    s_mul_i32 s56, s81, 1376
    ds_read_b64_tr_b16 v[192:193], v234 offset:0
    v_mfma_f32_16x16x32_bf16 v[128:131], a[96:99], v[200:203], v[128:131]
    s_add_u32 m0, s57, 32768
    v_mfma_f32_16x16x32_bf16 v[128:131], a[112:115], v[204:207], v[128:131]
    v_mfma_f32_16x16x32_bf16 v[132:135], a[100:103], v[200:203], v[132:135]
    buffer_load_dwordx4 v241, s[28:31], s56 offen offset:0 sc1 lds
    v_mfma_f32_16x16x32_bf16 v[132:135], a[116:119], v[204:207], v[132:135]
    ds_read_b64_tr_b16 v[194:195], v234 offset:2048
    ds_read_b64_tr_b16 v[196:197], v234 offset:4096
    v_mfma_f32_16x16x32_bf16 v[136:139], a[104:107], v[200:203], v[136:139]
    v_mfma_f32_16x16x32_bf16 v[136:139], a[120:123], v[204:207], v[136:139]
    ds_read_b64_tr_b16 v[198:199], v234 offset:6144
    v_mfma_f32_16x16x32_bf16 v[140:143], a[108:111], v[200:203], v[140:143]
    buffer_load_dwordx4 v242, s[28:31], s56 offen offset:1024 sc1 lds
    v_mfma_f32_16x16x32_bf16 v[140:143], a[124:127], v[204:207], v[140:143]
    s_waitcnt lgkmcnt(4)
    ds_read_b64_tr_b16 v[200:201], v235 offset:0
    v_mfma_f32_16x16x32_bf16 v[144:147], a[96:99], v[208:211], v[144:147]
    v_mfma_f32_16x16x32_bf16 v[144:147], a[112:115], v[212:215], v[144:147]
    v_mfma_f32_16x16x32_bf16 v[148:151], a[100:103], v[208:211], v[148:151]
    buffer_load_dwordx4 a[40:43], v216, s[48:51], s63 offen offset:2048 sc1
    v_mfma_f32_16x16x32_bf16 v[148:151], a[116:119], v[212:215], v[148:151]
    ds_read_b64_tr_b16 v[202:203], v235 offset:2048
    v_mfma_f32_16x16x32_bf16 v[152:155], a[104:107], v[208:211], v[152:155]
    v_mfma_f32_16x16x32_bf16 v[152:155], a[120:123], v[212:215], v[152:155]
    ds_read_b64_tr_b16 v[204:205], v235 offset:4096
    ds_read_b64_tr_b16 v[206:207], v235 offset:6144
    v_mfma_f32_16x16x32_bf16 v[156:159], a[108:111], v[208:211], v[156:159]
    buffer_load_dwordx4 a[44:47], v216, s[48:51], s64 offen offset:2048 sc1
    v_mfma_f32_16x16x32_bf16 v[156:159], a[124:127], v[212:215], v[156:159]
    s_waitcnt lgkmcnt(4)
    ds_read_b64_tr_b16 v[208:209], v232 offset:8192
    v_mfma_f32_16x16x32_bf16 v[160:163], a[96:99], v[192:195], v[160:163]
    v_mfma_f32_16x16x32_bf16 v[160:163], a[112:115], v[196:199], v[160:163]
    ds_read_b64_tr_b16 v[210:211], v232 offset:10240
    v_mfma_f32_16x16x32_bf16 v[164:167], a[100:103], v[192:195], v[164:167]
    buffer_store_dwordx4 v[12:15], v248, s[48:51], s59 offen offset:0 sc1
    v_mfma_f32_16x16x32_bf16 v[164:167], a[116:119], v[196:199], v[164:167]
    v_mfma_f32_16x16x32_bf16 v[168:171], a[104:107], v[192:195], v[168:171]
    ds_read_b64_tr_b16 v[212:213], v232 offset:12288
    v_mfma_f32_16x16x32_bf16 v[168:171], a[120:123], v[196:199], v[168:171]
    ds_read_b64_tr_b16 v[214:215], v232 offset:14336
    v_mfma_f32_16x16x32_bf16 v[172:175], a[108:111], v[192:195], v[172:175]
    v_mfma_f32_16x16x32_bf16 v[172:175], a[124:127], v[196:199], v[172:175]
    s_waitcnt lgkmcnt(4)
    ds_read_b64_tr_b16 v[192:193], v233 offset:8192
    v_mfma_f32_16x16x32_bf16 v[176:179], a[96:99], v[200:203], v[176:179]
    v_mfma_f32_16x16x32_bf16 v[176:179], a[112:115], v[204:207], v[176:179]
    ds_read_b64_tr_b16 v[194:195], v233 offset:10240
    v_mfma_f32_16x16x32_bf16 v[180:183], a[100:103], v[200:203], v[180:183]
    buffer_load_dwordx4 a[48:51], v216, s[48:51], s61 offen offset:3072 sc1
    v_mfma_f32_16x16x32_bf16 v[180:183], a[116:119], v[204:207], v[180:183]
    ds_read_b64_tr_b16 v[196:197], v233 offset:12288
    ds_read_b64_tr_b16 v[198:199], v233 offset:14336
    v_mfma_f32_16x16x32_bf16 v[184:187], a[104:107], v[200:203], v[184:187]
    v_mfma_f32_16x16x32_bf16 v[184:187], a[120:123], v[204:207], v[184:187]
    v_mfma_f32_16x16x32_bf16 v[188:191], a[108:111], v[200:203], v[188:191]
    v_mfma_f32_16x16x32_bf16 v[188:191], a[124:127], v[204:207], v[188:191]
    s_waitcnt lgkmcnt(4)
    s_mul_i32 s56, s81, 1376
    v_mfma_f32_16x16x32_bf16 v[32:35], a[96:99], v[208:211], v[32:35]
    s_add_u32 s56, s56, 176128
    ds_read_b64_tr_b16 v[200:201], v234 offset:8192
    v_mfma_f32_16x16x32_bf16 v[32:35], a[112:115], v[212:215], v[32:35]
    s_add_u32 m0, s57, 49152
    ds_read_b64_tr_b16 v[202:203], v234 offset:10240
    v_mfma_f32_16x16x32_bf16 v[36:39], a[100:103], v[208:211], v[36:39]
    buffer_load_dwordx4 v241, s[28:31], s56 offen offset:0 sc1 lds
    v_mfma_f32_16x16x32_bf16 v[36:39], a[116:119], v[212:215], v[36:39]
    v_mfma_f32_16x16x32_bf16 v[40:43], a[104:107], v[208:211], v[40:43]
    ds_read_b64_tr_b16 v[204:205], v234 offset:12288
    v_mfma_f32_16x16x32_bf16 v[40:43], a[120:123], v[212:215], v[40:43]
    ds_read_b64_tr_b16 v[206:207], v234 offset:14336
    v_mfma_f32_16x16x32_bf16 v[44:47], a[108:111], v[208:211], v[44:47]
    buffer_load_dwordx4 v242, s[28:31], s56 offen offset:1024 sc1 lds
    v_mfma_f32_16x16x32_bf16 v[44:47], a[124:127], v[212:215], v[44:47]
    s_waitcnt lgkmcnt(4)
    ds_read_b64_tr_b16 v[208:209], v235 offset:8192
    ds_read_b64_tr_b16 v[210:211], v235 offset:10240
    v_mfma_f32_16x16x32_bf16 v[48:51], a[96:99], v[192:195], v[48:51]
    ds_read_b64_tr_b16 v[212:213], v235 offset:12288
    ds_read_b64_tr_b16 v[214:215], v235 offset:14336
    v_mfma_f32_16x16x32_bf16 v[48:51], a[112:115], v[196:199], v[48:51]
    v_mfma_f32_16x16x32_bf16 v[52:55], a[100:103], v[192:195], v[52:55]
    buffer_load_dwordx4 a[52:55], v216, s[48:51], s62 offen offset:3072 sc1
    v_mfma_f32_16x16x32_bf16 v[52:55], a[116:119], v[196:199], v[52:55]
    v_mfma_f32_16x16x32_bf16 v[56:59], a[104:107], v[192:195], v[56:59]
    v_mfma_f32_16x16x32_bf16 v[56:59], a[120:123], v[196:199], v[56:59]
    v_mfma_f32_16x16x32_bf16 v[60:63], a[108:111], v[192:195], v[60:63]
    v_mfma_f32_16x16x32_bf16 v[60:63], a[124:127], v[196:199], v[60:63]
    s_waitcnt lgkmcnt(4)
    v_mfma_f32_16x16x32_bf16 v[96:99], a[96:99], v[200:203], v[96:99]
    v_mfma_f32_16x16x32_bf16 v[96:99], a[112:115], v[204:207], v[96:99]
    buffer_store_dwordx4 v[28:31], v248, s[48:51], s59 offen offset:1024 sc1
    v_mfma_f32_16x16x32_bf16 v[100:103], a[100:103], v[200:203], v[100:103]
    s_waitcnt vmcnt(40) lgkmcnt(0)
    s_barrier
    v_mfma_f32_16x16x32_bf16 v[100:103], a[116:119], v[204:207], v[100:103]
    ds_read_b64_tr_b16 v[192:193], v232 offset:16384
    ds_read_b64_tr_b16 v[194:195], v232 offset:18432
    v_mfma_f32_16x16x32_bf16 v[104:107], a[104:107], v[200:203], v[104:107]
    ds_read_b64_tr_b16 v[196:197], v232 offset:20480
    ds_read_b64_tr_b16 v[198:199], v232 offset:22528
    v_mfma_f32_16x16x32_bf16 v[104:107], a[120:123], v[204:207], v[104:107]
    buffer_load_dwordx4 a[56:59], v216, s[48:51], s63 offen offset:3072 sc1
    v_mfma_f32_16x16x32_bf16 v[108:111], a[108:111], v[200:203], v[108:111]
    v_mfma_f32_16x16x32_bf16 v[108:111], a[124:127], v[204:207], v[108:111]
    v_mfma_f32_16x16x32_bf16 v[112:115], a[96:99], v[208:211], v[112:115]
    ds_read_b64_tr_b16 v[200:201], v233 offset:16384
    v_mfma_f32_16x16x32_bf16 v[112:115], a[112:115], v[212:215], v[112:115]
    ds_read_b64_tr_b16 v[202:203], v233 offset:18432
    ds_read_b64_tr_b16 v[204:205], v233 offset:20480
    v_mfma_f32_16x16x32_bf16 v[116:119], a[100:103], v[208:211], v[116:119]
    buffer_load_dwordx4 a[60:63], v216, s[48:51], s64 offen offset:3072 sc1
    v_mfma_f32_16x16x32_bf16 v[116:119], a[116:119], v[212:215], v[116:119]
    ds_read_b64_tr_b16 v[206:207], v233 offset:22528
    v_mfma_f32_16x16x32_bf16 v[120:123], a[104:107], v[208:211], v[120:123]
    v_mfma_f32_16x16x32_bf16 v[120:123], a[120:123], v[212:215], v[120:123]
    v_mfma_f32_16x16x32_bf16 v[124:127], a[108:111], v[208:211], v[124:127]
    v_mfma_f32_16x16x32_bf16 v[124:127], a[124:127], v[212:215], v[124:127]
    s_waitcnt lgkmcnt(4)
    v_mfma_f32_16x16x32_bf16 v[128:131], a[128:131], v[192:195], v[128:131]
    s_mul_i32 s56, s81, 1376
    v_mfma_f32_16x16x32_bf16 v[128:131], a[144:147], v[196:199], v[128:131]
    s_add_u32 m0, s57, 40960
    ds_read_b64_tr_b16 v[208:209], v234 offset:16384
    ds_read_b64_tr_b16 v[210:211], v234 offset:18432
    v_mfma_f32_16x16x32_bf16 v[132:135], a[132:135], v[192:195], v[132:135]
    buffer_load_dwordx4 v243, s[28:31], s56 offen offset:0 sc1 lds
    v_mfma_f32_16x16x32_bf16 v[132:135], a[148:151], v[196:199], v[132:135]
    ds_read_b64_tr_b16 v[212:213], v234 offset:20480
    v_mfma_f32_16x16x32_bf16 v[136:139], a[136:139], v[192:195], v[136:139]
    v_mfma_f32_16x16x32_bf16 v[136:139], a[152:155], v[196:199], v[136:139]
    ds_read_b64_tr_b16 v[214:215], v234 offset:22528
    v_mfma_f32_16x16x32_bf16 v[140:143], a[140:143], v[192:195], v[140:143]
    buffer_load_dwordx4 v244, s[28:31], s56 offen offset:1024 sc1 lds
    v_mfma_f32_16x16x32_bf16 v[140:143], a[156:159], v[196:199], v[140:143]
    s_waitcnt lgkmcnt(4)
    ds_read_b64_tr_b16 v[192:193], v235 offset:16384
    v_mfma_f32_16x16x32_bf16 v[144:147], a[128:131], v[200:203], v[144:147]
    v_mfma_f32_16x16x32_bf16 v[144:147], a[144:147], v[204:207], v[144:147]
    ds_read_b64_tr_b16 v[194:195], v235 offset:18432
    v_mfma_f32_16x16x32_bf16 v[148:151], a[132:135], v[200:203], v[148:151]
    buffer_load_dwordx4 a[64:67], v217, s[48:51], s61 offen offset:0 sc1
    v_mfma_f32_16x16x32_bf16 v[148:151], a[148:151], v[204:207], v[148:151]
    ds_read_b64_tr_b16 v[196:197], v235 offset:20480
    v_mfma_f32_16x16x32_bf16 v[152:155], a[136:139], v[200:203], v[152:155]
    v_mfma_f32_16x16x32_bf16 v[152:155], a[152:155], v[204:207], v[152:155]
    ds_read_b64_tr_b16 v[198:199], v235 offset:22528
    v_mfma_f32_16x16x32_bf16 v[156:159], a[140:143], v[200:203], v[156:159]
    buffer_store_dwordx4 v[64:67], v245, s[48:51], s59 offen offset:2048 sc1
    v_mfma_f32_16x16x32_bf16 v[156:159], a[156:159], v[204:207], v[156:159]
    s_waitcnt lgkmcnt(4)
    ds_read_b64_tr_b16 v[200:201], v232 offset:24576
    v_mfma_f32_16x16x32_bf16 v[160:163], a[128:131], v[208:211], v[160:163]
    ds_read_b64_tr_b16 v[202:203], v232 offset:26624
    v_mfma_f32_16x16x32_bf16 v[160:163], a[144:147], v[212:215], v[160:163]
    v_mfma_f32_16x16x32_bf16 v[164:167], a[132:135], v[208:211], v[164:167]
    buffer_load_dwordx4 a[68:71], v217, s[48:51], s62 offen offset:0 sc1
    v_mfma_f32_16x16x32_bf16 v[164:167], a[148:151], v[212:215], v[164:167]
    v_mfma_f32_16x16x32_bf16 v[168:171], a[136:139], v[208:211], v[168:171]
    ds_read_b64_tr_b16 v[204:205], v232 offset:28672
    v_mfma_f32_16x16x32_bf16 v[168:171], a[152:155], v[212:215], v[168:171]
    ds_read_b64_tr_b16 v[206:207], v232 offset:30720
    v_mfma_f32_16x16x32_bf16 v[172:175], a[140:143], v[208:211], v[172:175]
    v_mfma_f32_16x16x32_bf16 v[172:175], a[156:159], v[212:215], v[172:175]
    s_waitcnt lgkmcnt(4)
    v_mfma_f32_16x16x32_bf16 v[176:179], a[128:131], v[192:195], v[176:179]
    ds_read_b64_tr_b16 v[208:209], v233 offset:24576
    v_mfma_f32_16x16x32_bf16 v[176:179], a[144:147], v[196:199], v[176:179]
    ds_read_b64_tr_b16 v[210:211], v233 offset:26624
    v_mfma_f32_16x16x32_bf16 v[180:183], a[132:135], v[192:195], v[180:183]
    v_mfma_f32_16x16x32_bf16 v[180:183], a[148:151], v[196:199], v[180:183]
    ds_read_b64_tr_b16 v[212:213], v233 offset:28672
    v_mfma_f32_16x16x32_bf16 v[184:187], a[136:139], v[192:195], v[184:187]
    buffer_load_dwordx4 a[72:75], v217, s[48:51], s63 offen offset:0 sc1
    v_mfma_f32_16x16x32_bf16 v[184:187], a[152:155], v[196:199], v[184:187]
    ds_read_b64_tr_b16 v[214:215], v233 offset:30720
    v_mfma_f32_16x16x32_bf16 v[188:191], a[140:143], v[192:195], v[188:191]
    v_mfma_f32_16x16x32_bf16 v[188:191], a[156:159], v[196:199], v[188:191]
    s_waitcnt lgkmcnt(4)
    s_mul_i32 s56, s82, 1376
    ds_read_b64_tr_b16 v[192:193], v234 offset:24576
    v_mfma_f32_16x16x32_bf16 v[32:35], a[128:131], v[200:203], v[32:35]
    s_add_u32 m0, s57, 57344
    ds_read_b64_tr_b16 v[194:195], v234 offset:26624
    v_mfma_f32_16x16x32_bf16 v[32:35], a[144:147], v[204:207], v[32:35]
    v_mfma_f32_16x16x32_bf16 v[36:39], a[132:135], v[200:203], v[36:39]
    buffer_load_dwordx4 v241, s[28:31], s56 offen offset:0 sc1 lds
    v_mfma_f32_16x16x32_bf16 v[36:39], a[148:151], v[204:207], v[36:39]
    v_mfma_f32_16x16x32_bf16 v[40:43], a[136:139], v[200:203], v[40:43]
    v_mfma_f32_16x16x32_bf16 v[40:43], a[152:155], v[204:207], v[40:43]
    ds_read_b64_tr_b16 v[196:197], v234 offset:28672
    ds_read_b64_tr_b16 v[198:199], v234 offset:30720
    v_mfma_f32_16x16x32_bf16 v[44:47], a[140:143], v[200:203], v[44:47]
    v_mfma_f32_16x16x32_bf16 v[44:47], a[156:159], v[204:207], v[44:47]
    s_waitcnt lgkmcnt(4)
    ds_read_b64_tr_b16 v[200:201], v235 offset:24576
    v_mfma_f32_16x16x32_bf16 v[48:51], a[128:131], v[208:211], v[48:51]
    buffer_load_dwordx4 a[76:79], v217, s[48:51], s64 offen offset:0 sc1
    v_mfma_f32_16x16x32_bf16 v[48:51], a[144:147], v[212:215], v[48:51]
    ds_read_b64_tr_b16 v[202:203], v235 offset:26624
    ds_read_b64_tr_b16 v[204:205], v235 offset:28672
    v_mfma_f32_16x16x32_bf16 v[52:55], a[132:135], v[208:211], v[52:55]
    v_mfma_f32_16x16x32_bf16 v[52:55], a[148:151], v[212:215], v[52:55]
    v_mfma_f32_16x16x32_bf16 v[56:59], a[136:139], v[208:211], v[56:59]
    v_mfma_f32_16x16x32_bf16 v[56:59], a[152:155], v[212:215], v[56:59]
    ds_read_b64_tr_b16 v[206:207], v235 offset:30720
    v_mfma_f32_16x16x32_bf16 v[60:63], a[140:143], v[208:211], v[60:63]
    buffer_store_dwordx4 v[80:83], v245, s[48:51], s59 offen offset:3072 sc1
    v_mfma_f32_16x16x32_bf16 v[60:63], a[156:159], v[212:215], v[60:63]
    s_waitcnt lgkmcnt(4)
    v_subrev_u32 v232, 0x10000, v232
    v_subrev_u32 v233, 0x10000, v233
    v_subrev_u32 v234, 0x10000, v234
    v_subrev_u32 v235, 0x10000, v235
    ds_read_b64_tr_b16 v[208:209], v232 offset:16384
    v_mfma_f32_16x16x32_bf16 v[96:99], a[128:131], v[192:195], v[96:99]
    ds_read_b64_tr_b16 v[210:211], v232 offset:18432
    v_mfma_f32_16x16x32_bf16 v[96:99], a[144:147], v[196:199], v[96:99]
    v_mfma_f32_16x16x32_bf16 v[100:103], a[132:135], v[192:195], v[100:103]
    buffer_load_dwordx4 a[80:83], v217, s[48:51], s61 offen offset:1024 sc1
    v_mfma_f32_16x16x32_bf16 v[100:103], a[148:151], v[196:199], v[100:103]
    v_mfma_f32_16x16x32_bf16 v[104:107], a[136:139], v[192:195], v[104:107]
    ds_read_b64_tr_b16 v[212:213], v232 offset:20480
    v_mfma_f32_16x16x32_bf16 v[104:107], a[152:155], v[196:199], v[104:107]
    ds_read_b64_tr_b16 v[214:215], v232 offset:22528
    v_mfma_f32_16x16x32_bf16 v[108:111], a[140:143], v[192:195], v[108:111]
    buffer_load_dwordx4 v242, s[28:31], s56 offen offset:1024 sc1 lds
    v_mfma_f32_16x16x32_bf16 v[108:111], a[156:159], v[196:199], v[108:111]
    s_waitcnt lgkmcnt(4)
    ds_read_b64_tr_b16 v[192:193], v233 offset:16384
    v_mfma_f32_16x16x32_bf16 v[112:115], a[128:131], v[200:203], v[112:115]
    ds_read_b64_tr_b16 v[194:195], v233 offset:18432
    v_mfma_f32_16x16x32_bf16 v[112:115], a[144:147], v[204:207], v[112:115]
    v_mfma_f32_16x16x32_bf16 v[116:119], a[132:135], v[200:203], v[116:119]
    v_mfma_f32_16x16x32_bf16 v[116:119], a[148:151], v[204:207], v[116:119]
    ds_read_b64_tr_b16 v[196:197], v233 offset:20480
    v_mfma_f32_16x16x32_bf16 v[120:123], a[136:139], v[200:203], v[120:123]
    v_mfma_f32_16x16x32_bf16 v[120:123], a[152:155], v[204:207], v[120:123]
    ds_read_b64_tr_b16 v[198:199], v233 offset:22528
    v_mfma_f32_16x16x32_bf16 v[124:127], a[140:143], v[200:203], v[124:127]
    buffer_load_dwordx4 a[84:87], v217, s[48:51], s62 offen offset:1024 sc1
    v_mfma_f32_16x16x32_bf16 v[124:127], a[156:159], v[204:207], v[124:127]
    s_waitcnt lgkmcnt(4)
    s_mul_i32 s56, s82, 1376
    v_mfma_f32_16x16x32_bf16 v[128:131], a[160:163], v[208:211], v[128:131]
    s_add_u32 s56, s56, 176128
    s_add_u32 m0, s57, 65536
    ds_read_b64_tr_b16 v[200:201], v234 offset:16384
    v_mfma_f32_16x16x32_bf16 v[128:131], a[176:179], v[212:215], v[128:131]
    ds_read_b64_tr_b16 v[202:203], v234 offset:18432
    v_mfma_f32_16x16x32_bf16 v[132:135], a[164:167], v[208:211], v[132:135]
    buffer_load_dwordx4 v241, s[28:31], s56 offen offset:0 sc1 lds
    v_mfma_f32_16x16x32_bf16 v[132:135], a[180:183], v[212:215], v[132:135]
    ds_read_b64_tr_b16 v[204:205], v234 offset:20480
    v_mfma_f32_16x16x32_bf16 v[136:139], a[168:171], v[208:211], v[136:139]
    v_mfma_f32_16x16x32_bf16 v[136:139], a[184:187], v[212:215], v[136:139]
    ds_read_b64_tr_b16 v[206:207], v234 offset:22528
    v_mfma_f32_16x16x32_bf16 v[140:143], a[172:175], v[208:211], v[140:143]
    buffer_load_dwordx4 v242, s[28:31], s56 offen offset:1024 sc1 lds
    v_mfma_f32_16x16x32_bf16 v[140:143], a[188:191], v[212:215], v[140:143]
    s_waitcnt lgkmcnt(4)
    v_mfma_f32_16x16x32_bf16 v[144:147], a[160:163], v[192:195], v[144:147]
    v_mfma_f32_16x16x32_bf16 v[144:147], a[176:179], v[196:199], v[144:147]
    ds_read_b64_tr_b16 v[208:209], v235 offset:16384
    ds_read_b64_tr_b16 v[210:211], v235 offset:18432
    v_mfma_f32_16x16x32_bf16 v[148:151], a[164:167], v[192:195], v[148:151]
    buffer_store_dwordx4 v[68:71], v246, s[48:51], s59 offen offset:2048 sc1
    v_mfma_f32_16x16x32_bf16 v[148:151], a[180:183], v[196:199], v[148:151]
    v_mfma_f32_16x16x32_bf16 v[152:155], a[168:171], v[192:195], v[152:155]
    ds_read_b64_tr_b16 v[212:213], v235 offset:20480
    v_mfma_f32_16x16x32_bf16 v[152:155], a[184:187], v[196:199], v[152:155]
    ds_read_b64_tr_b16 v[214:215], v235 offset:22528
    v_mfma_f32_16x16x32_bf16 v[156:159], a[172:175], v[192:195], v[156:159]
    buffer_load_dwordx4 a[88:91], v217, s[48:51], s63 offen offset:1024 sc1
    v_mfma_f32_16x16x32_bf16 v[156:159], a[188:191], v[196:199], v[156:159]
    s_waitcnt lgkmcnt(4)
    ds_read_b64_tr_b16 v[192:193], v232 offset:24576
    ds_read_b64_tr_b16 v[194:195], v232 offset:26624
    v_mfma_f32_16x16x32_bf16 v[160:163], a[160:163], v[200:203], v[160:163]
    ds_read_b64_tr_b16 v[196:197], v232 offset:28672
    v_mfma_f32_16x16x32_bf16 v[160:163], a[176:179], v[204:207], v[160:163]
    v_mfma_f32_16x16x32_bf16 v[164:167], a[164:167], v[200:203], v[164:167]
    buffer_load_dwordx4 a[92:95], v217, s[48:51], s64 offen offset:1024 sc1
    v_mfma_f32_16x16x32_bf16 v[164:167], a[180:183], v[204:207], v[164:167]
    v_mfma_f32_16x16x32_bf16 v[168:171], a[168:171], v[200:203], v[168:171]
    ds_read_b64_tr_b16 v[198:199], v232 offset:30720
    v_mfma_f32_16x16x32_bf16 v[168:171], a[184:187], v[204:207], v[168:171]
    v_mfma_f32_16x16x32_bf16 v[172:175], a[172:175], v[200:203], v[172:175]
    v_mfma_f32_16x16x32_bf16 v[172:175], a[188:191], v[204:207], v[172:175]
    s_waitcnt lgkmcnt(4)
    ds_read_b64_tr_b16 v[200:201], v233 offset:24576
    v_mfma_f32_16x16x32_bf16 v[176:179], a[160:163], v[208:211], v[176:179]
    v_mfma_f32_16x16x32_bf16 v[176:179], a[176:179], v[212:215], v[176:179]
    v_mfma_f32_16x16x32_bf16 v[180:183], a[164:167], v[208:211], v[180:183]
    v_mfma_f32_16x16x32_bf16 v[180:183], a[180:183], v[212:215], v[180:183]
    ds_read_b64_tr_b16 v[202:203], v233 offset:26624
    v_mfma_f32_16x16x32_bf16 v[184:187], a[168:171], v[208:211], v[184:187]
    v_mfma_f32_16x16x32_bf16 v[184:187], a[184:187], v[212:215], v[184:187]
    ds_read_b64_tr_b16 v[204:205], v233 offset:28672
    v_mfma_f32_16x16x32_bf16 v[188:191], a[172:175], v[208:211], v[188:191]
    ds_read_b64_tr_b16 v[206:207], v233 offset:30720
    v_mfma_f32_16x16x32_bf16 v[188:191], a[188:191], v[212:215], v[188:191]
    s_waitcnt lgkmcnt(4)
    buffer_load_dwordx4 a[96:99], v217, s[48:51], s61 offen offset:2048 sc1
    v_mfma_f32_16x16x32_bf16 v[32:35], a[160:163], v[192:195], v[32:35]
    s_mul_i32 s56, s82, 1376
    s_add_u32 m0, s57, 73728
    ds_read_b64_tr_b16 v[208:209], v234 offset:24576
    v_mfma_f32_16x16x32_bf16 v[32:35], a[176:179], v[196:199], v[32:35]
    ds_read_b64_tr_b16 v[210:211], v234 offset:26624
    v_mfma_f32_16x16x32_bf16 v[36:39], a[164:167], v[192:195], v[36:39]
    buffer_load_dwordx4 v243, s[28:31], s56 offen offset:0 sc1 lds
    v_mfma_f32_16x16x32_bf16 v[36:39], a[180:183], v[196:199], v[36:39]
    ds_read_b64_tr_b16 v[212:213], v234 offset:28672
    v_mfma_f32_16x16x32_bf16 v[40:43], a[168:171], v[192:195], v[40:43]
    v_mfma_f32_16x16x32_bf16 v[40:43], a[184:187], v[196:199], v[40:43]
    ds_read_b64_tr_b16 v[214:215], v234 offset:30720
    v_mfma_f32_16x16x32_bf16 v[44:47], a[172:175], v[192:195], v[44:47]
    buffer_load_dwordx4 v244, s[28:31], s56 offen offset:1024 sc1 lds
    v_mfma_f32_16x16x32_bf16 v[44:47], a[188:191], v[196:199], v[44:47]
    s_waitcnt lgkmcnt(4)
    ds_read_b64_tr_b16 v[192:193], v235 offset:24576
    ds_read_b64_tr_b16 v[194:195], v235 offset:26624
    v_mfma_f32_16x16x32_bf16 v[48:51], a[160:163], v[200:203], v[48:51]
    ds_read_b64_tr_b16 v[196:197], v235 offset:28672
    ds_read_b64_tr_b16 v[198:199], v235 offset:30720
    v_mfma_f32_16x16x32_bf16 v[48:51], a[176:179], v[204:207], v[48:51]
    v_mfma_f32_16x16x32_bf16 v[52:55], a[164:167], v[200:203], v[52:55]
    s_waitcnt vmcnt(46)
    buffer_store_dwordx4 v[84:87], v246, s[48:51], s59 offen offset:3072 sc1
    v_mfma_f32_16x16x32_bf16 v[52:55], a[180:183], v[204:207], v[52:55]
    v_mfma_f32_16x16x32_bf16 v[56:59], a[168:171], v[200:203], v[56:59]
    v_mfma_f32_16x16x32_bf16 v[56:59], a[184:187], v[204:207], v[56:59]
    v_mfma_f32_16x16x32_bf16 v[60:63], a[172:175], v[200:203], v[60:63]
    buffer_load_dwordx4 a[100:103], v217, s[48:51], s62 offen offset:2048 sc1
    v_mfma_f32_16x16x32_bf16 v[60:63], a[188:191], v[204:207], v[60:63]
    s_waitcnt lgkmcnt(4)
    v_mfma_f32_16x16x32_bf16 v[96:99], a[160:163], v[208:211], v[96:99]
    v_mfma_f32_16x16x32_bf16 v[96:99], a[176:179], v[212:215], v[96:99]
    v_mfma_f32_16x16x32_bf16 v[100:103], a[164:167], v[208:211], v[100:103]
    s_waitcnt lgkmcnt(0)
    s_barrier
    v_mfma_f32_16x16x32_bf16 v[100:103], a[180:183], v[212:215], v[100:103]
    v_add_u32 v232, 0x10000, v232
    v_add_u32 v233, 0x10000, v233
    v_add_u32 v234, 0x10000, v234
    v_add_u32 v235, 0x10000, v235
    ds_read_b64_tr_b16 v[200:201], v232 offset:32768
    v_mfma_f32_16x16x32_bf16 v[104:107], a[168:171], v[208:211], v[104:107]
    ds_read_b64_tr_b16 v[202:203], v232 offset:34816
    ds_read_b64_tr_b16 v[204:205], v232 offset:36864
    v_mfma_f32_16x16x32_bf16 v[104:107], a[184:187], v[212:215], v[104:107]
    ds_read_b64_tr_b16 v[206:207], v232 offset:38912
    v_mfma_f32_16x16x32_bf16 v[108:111], a[172:175], v[208:211], v[108:111]
    buffer_load_dwordx4 a[104:107], v217, s[48:51], s63 offen offset:2048 sc1
    v_mfma_f32_16x16x32_bf16 v[108:111], a[188:191], v[212:215], v[108:111]
    v_mfma_f32_16x16x32_bf16 v[112:115], a[160:163], v[192:195], v[112:115]
    v_mfma_f32_16x16x32_bf16 v[112:115], a[176:179], v[196:199], v[112:115]
    ds_read_b64_tr_b16 v[208:209], v233 offset:32768
    ds_read_b64_tr_b16 v[210:211], v233 offset:34816
    v_mfma_f32_16x16x32_bf16 v[116:119], a[164:167], v[192:195], v[116:119]
    v_mfma_f32_16x16x32_bf16 v[116:119], a[180:183], v[196:199], v[116:119]
    v_mfma_f32_16x16x32_bf16 v[120:123], a[168:171], v[192:195], v[120:123]
    v_mfma_f32_16x16x32_bf16 v[120:123], a[184:187], v[196:199], v[120:123]
    ds_read_b64_tr_b16 v[212:213], v233 offset:36864
    ds_read_b64_tr_b16 v[214:215], v233 offset:38912
    v_mfma_f32_16x16x32_bf16 v[124:127], a[172:175], v[192:195], v[124:127]
    buffer_load_dwordx4 a[108:111], v217, s[48:51], s64 offen offset:2048 sc1
    v_mfma_f32_16x16x32_bf16 v[124:127], a[188:191], v[196:199], v[124:127]
    s_waitcnt lgkmcnt(4)
    s_mul_i32 s56, s85, 1376
    s_add_u32 m0, s57, 16384
    v_mfma_f32_16x16x32_bf16 v[128:131], a[192:195], v[200:203], v[128:131]
    ds_read_b64_tr_b16 v[192:193], v234 offset:32768
    v_mfma_f32_16x16x32_bf16 v[128:131], a[208:211], v[204:207], v[128:131]
    ds_read_b64_tr_b16 v[194:195], v234 offset:34816
    v_mfma_f32_16x16x32_bf16 v[132:135], a[196:199], v[200:203], v[132:135]
    buffer_load_dwordx4 v241, s[28:31], s56 offen offset:0 sc1 lds
    v_mfma_f32_16x16x32_bf16 v[132:135], a[212:215], v[204:207], v[132:135]
    v_mfma_f32_16x16x32_bf16 v[136:139], a[200:203], v[200:203], v[136:139]
    ds_read_b64_tr_b16 v[196:197], v234 offset:36864
    v_mfma_f32_16x16x32_bf16 v[136:139], a[216:219], v[204:207], v[136:139]
    ds_read_b64_tr_b16 v[198:199], v234 offset:38912
    v_mfma_f32_16x16x32_bf16 v[140:143], a[204:207], v[200:203], v[140:143]
    buffer_load_dwordx4 v242, s[28:31], s56 offen offset:1024 sc1 lds
    v_mfma_f32_16x16x32_bf16 v[140:143], a[220:223], v[204:207], v[140:143]
    s_waitcnt lgkmcnt(4)
    v_mfma_f32_16x16x32_bf16 v[144:147], a[192:195], v[208:211], v[144:147]
    v_mfma_f32_16x16x32_bf16 v[144:147], a[208:211], v[212:215], v[144:147]
    ds_read_b64_tr_b16 v[200:201], v235 offset:32768
    v_mfma_f32_16x16x32_bf16 v[148:151], a[196:199], v[208:211], v[148:151]
    ds_read_b64_tr_b16 v[202:203], v235 offset:34816
    v_mfma_f32_16x16x32_bf16 v[148:151], a[212:215], v[212:215], v[148:151]
    buffer_store_dwordx4 v[72:75], v247, s[48:51], s59 offen offset:2048 sc1
    v_mfma_f32_16x16x32_bf16 v[152:155], a[200:203], v[208:211], v[152:155]
    v_mfma_f32_16x16x32_bf16 v[152:155], a[216:219], v[212:215], v[152:155]
    ds_read_b64_tr_b16 v[204:205], v235 offset:36864
    ds_read_b64_tr_b16 v[206:207], v235 offset:38912
    v_mfma_f32_16x16x32_bf16 v[156:159], a[204:207], v[208:211], v[156:159]
    v_mfma_f32_16x16x32_bf16 v[156:159], a[220:223], v[212:215], v[156:159]
    s_waitcnt lgkmcnt(4)
    ds_read_b64_tr_b16 v[208:209], v232 offset:40960
    v_mfma_f32_16x16x32_bf16 v[160:163], a[192:195], v[192:195], v[160:163]
    buffer_load_dwordx4 a[112:115], v217, s[48:51], s61 offen offset:3072 sc1
    v_mfma_f32_16x16x32_bf16 v[160:163], a[208:211], v[196:199], v[160:163]
    ds_read_b64_tr_b16 v[210:211], v232 offset:43008
    ds_read_b64_tr_b16 v[212:213], v232 offset:45056
    v_mfma_f32_16x16x32_bf16 v[164:167], a[196:199], v[192:195], v[164:167]
    v_mfma_f32_16x16x32_bf16 v[164:167], a[212:215], v[196:199], v[164:167]
    v_mfma_f32_16x16x32_bf16 v[168:171], a[200:203], v[192:195], v[168:171]
    buffer_load_dwordx4 a[116:119], v217, s[48:51], s62 offen offset:3072 sc1
    v_mfma_f32_16x16x32_bf16 v[168:171], a[216:219], v[196:199], v[168:171]
    ds_read_b64_tr_b16 v[214:215], v232 offset:47104
    v_mfma_f32_16x16x32_bf16 v[172:175], a[204:207], v[192:195], v[172:175]
    v_mfma_f32_16x16x32_bf16 v[172:175], a[220:223], v[196:199], v[172:175]
    s_waitcnt lgkmcnt(4)
    ds_read_b64_tr_b16 v[192:193], v233 offset:40960
    v_mfma_f32_16x16x32_bf16 v[176:179], a[192:195], v[200:203], v[176:179]
    v_mfma_f32_16x16x32_bf16 v[176:179], a[208:211], v[204:207], v[176:179]
    ds_read_b64_tr_b16 v[194:195], v233 offset:43008
    v_mfma_f32_16x16x32_bf16 v[180:183], a[196:199], v[200:203], v[180:183]
    v_mfma_f32_16x16x32_bf16 v[180:183], a[212:215], v[204:207], v[180:183]
    v_mfma_f32_16x16x32_bf16 v[184:187], a[200:203], v[200:203], v[184:187]
    buffer_load_dwordx4 a[120:123], v217, s[48:51], s63 offen offset:3072 sc1
    v_mfma_f32_16x16x32_bf16 v[184:187], a[216:219], v[204:207], v[184:187]
    ds_read_b64_tr_b16 v[196:197], v233 offset:45056
    ds_read_b64_tr_b16 v[198:199], v233 offset:47104
    v_mfma_f32_16x16x32_bf16 v[188:191], a[204:207], v[200:203], v[188:191]
    v_mfma_f32_16x16x32_bf16 v[188:191], a[220:223], v[204:207], v[188:191]
    s_waitcnt lgkmcnt(4)
    ds_read_b64_tr_b16 v[200:201], v234 offset:40960
    v_mfma_f32_16x16x32_bf16 v[32:35], a[192:195], v[208:211], v[32:35]
    s_mul_i32 s56, s85, 1376
    s_add_u32 s56, s56, 176128
    s_add_u32 m0, s57, 24576
    v_mfma_f32_16x16x32_bf16 v[32:35], a[208:211], v[212:215], v[32:35]
    ds_read_b64_tr_b16 v[202:203], v234 offset:43008
    v_mfma_f32_16x16x32_bf16 v[36:39], a[196:199], v[208:211], v[36:39]
    buffer_load_dwordx4 v241, s[28:31], s56 offen offset:0 sc1 lds
    v_mfma_f32_16x16x32_bf16 v[36:39], a[212:215], v[212:215], v[36:39]
    v_mfma_f32_16x16x32_bf16 v[40:43], a[200:203], v[208:211], v[40:43]
    v_mfma_f32_16x16x32_bf16 v[40:43], a[216:219], v[212:215], v[40:43]
    ds_read_b64_tr_b16 v[204:205], v234 offset:45056
    ds_read_b64_tr_b16 v[206:207], v234 offset:47104
    v_mfma_f32_16x16x32_bf16 v[44:47], a[204:207], v[208:211], v[44:47]
    buffer_load_dwordx4 v242, s[28:31], s56 offen offset:1024 sc1 lds
    v_mfma_f32_16x16x32_bf16 v[44:47], a[220:223], v[212:215], v[44:47]
    s_waitcnt lgkmcnt(4)
    ds_read_b64_tr_b16 v[208:209], v235 offset:40960
    ds_read_b64_tr_b16 v[210:211], v235 offset:43008
    v_mfma_f32_16x16x32_bf16 v[48:51], a[192:195], v[192:195], v[48:51]
    v_mfma_f32_16x16x32_bf16 v[48:51], a[208:211], v[196:199], v[48:51]
    v_mfma_f32_16x16x32_bf16 v[52:55], a[196:199], v[192:195], v[52:55]
    buffer_store_dwordx4 v[88:91], v247, s[48:51], s59 offen offset:3072 sc1
    v_mfma_f32_16x16x32_bf16 v[52:55], a[212:215], v[196:199], v[52:55]
    v_mfma_f32_16x16x32_bf16 v[56:59], a[200:203], v[192:195], v[56:59]
    ds_read_b64_tr_b16 v[212:213], v235 offset:45056
    v_mfma_f32_16x16x32_bf16 v[56:59], a[216:219], v[196:199], v[56:59]
    ds_read_b64_tr_b16 v[214:215], v235 offset:47104
    v_mfma_f32_16x16x32_bf16 v[60:63], a[204:207], v[192:195], v[60:63]
    v_mfma_f32_16x16x32_bf16 v[60:63], a[220:223], v[196:199], v[60:63]
    s_waitcnt lgkmcnt(4)
    ds_read_b64_tr_b16 v[192:193], v232 offset:49152
    v_mfma_f32_16x16x32_bf16 v[96:99], a[192:195], v[200:203], v[96:99]
    v_mfma_f32_16x16x32_bf16 v[96:99], a[208:211], v[204:207], v[96:99]
    ds_read_b64_tr_b16 v[194:195], v232 offset:51200
    v_mfma_f32_16x16x32_bf16 v[100:103], a[196:199], v[200:203], v[100:103]
    buffer_load_dwordx4 a[124:127], v217, s[48:51], s64 offen offset:3072 sc1
    v_mfma_f32_16x16x32_bf16 v[100:103], a[212:215], v[204:207], v[100:103]
    ds_read_b64_tr_b16 v[196:197], v232 offset:53248
    v_mfma_f32_16x16x32_bf16 v[104:107], a[200:203], v[200:203], v[104:107]
    v_mfma_f32_16x16x32_bf16 v[104:107], a[216:219], v[204:207], v[104:107]
    ds_read_b64_tr_b16 v[198:199], v232 offset:55296
    v_mfma_f32_16x16x32_bf16 v[108:111], a[204:207], v[200:203], v[108:111]
    v_mfma_f32_16x16x32_bf16 v[108:111], a[220:223], v[204:207], v[108:111]
    s_waitcnt lgkmcnt(4)
    ds_read_b64_tr_b16 v[200:201], v233 offset:49152
    v_mfma_f32_16x16x32_bf16 v[112:115], a[192:195], v[208:211], v[112:115]
    buffer_load_dwordx4 a[128:131], v218, s[48:51], s61 offen offset:0 sc1
    v_mfma_f32_16x16x32_bf16 v[112:115], a[208:211], v[212:215], v[112:115]
    ds_read_b64_tr_b16 v[202:203], v233 offset:51200
    ds_read_b64_tr_b16 v[204:205], v233 offset:53248
    v_mfma_f32_16x16x32_bf16 v[116:119], a[196:199], v[208:211], v[116:119]
    v_mfma_f32_16x16x32_bf16 v[116:119], a[212:215], v[212:215], v[116:119]
    v_mfma_f32_16x16x32_bf16 v[120:123], a[200:203], v[208:211], v[120:123]
    buffer_load_dwordx4 a[132:135], v218, s[48:51], s62 offen offset:0 sc1
    v_mfma_f32_16x16x32_bf16 v[120:123], a[216:219], v[212:215], v[120:123]
    ds_read_b64_tr_b16 v[206:207], v233 offset:55296
    v_mfma_f32_16x16x32_bf16 v[124:127], a[204:207], v[208:211], v[124:127]
    v_mfma_f32_16x16x32_bf16 v[124:127], a[220:223], v[212:215], v[124:127]
    s_waitcnt lgkmcnt(4)
    v_mfma_f32_16x16x32_bf16 v[128:131], a[224:227], v[192:195], v[128:131]
    s_mul_i32 s56, s85, 1376
    s_add_u32 m0, s57, 81920
    ds_read_b64_tr_b16 v[208:209], v234 offset:49152
    s_waitcnt vmcnt(46)
    buffer_store_dwordx4 v[76:79], v248, s[48:51], s59 offen offset:2048 sc1
    v_mfma_f32_16x16x32_bf16 v[128:131], a[240:243], v[196:199], v[128:131]
    ds_read_b64_tr_b16 v[210:211], v234 offset:51200
    ds_read_b64_tr_b16 v[212:213], v234 offset:53248
    v_mfma_f32_16x16x32_bf16 v[132:135], a[228:231], v[192:195], v[132:135]
    v_mfma_f32_16x16x32_bf16 v[132:135], a[244:247], v[196:199], v[132:135]
    v_mfma_f32_16x16x32_bf16 v[136:139], a[232:235], v[192:195], v[136:139]
    buffer_load_dwordx4 v243, s[28:31], s56 offen offset:0 sc1 lds
    v_mfma_f32_16x16x32_bf16 v[136:139], a[248:251], v[196:199], v[136:139]
    ds_read_b64_tr_b16 v[214:215], v234 offset:55296
    v_mfma_f32_16x16x32_bf16 v[140:143], a[236:239], v[192:195], v[140:143]
    v_mfma_f32_16x16x32_bf16 v[140:143], a[252:255], v[196:199], v[140:143]
    s_waitcnt lgkmcnt(4)
    ds_read_b64_tr_b16 v[192:193], v235 offset:49152
    v_mfma_f32_16x16x32_bf16 v[144:147], a[224:227], v[200:203], v[144:147]
    buffer_load_dwordx4 v244, s[28:31], s56 offen offset:1024 sc1 lds
    v_mfma_f32_16x16x32_bf16 v[144:147], a[240:243], v[204:207], v[144:147]
    ds_read_b64_tr_b16 v[194:195], v235 offset:51200
    ds_read_b64_tr_b16 v[196:197], v235 offset:53248
    v_mfma_f32_16x16x32_bf16 v[148:151], a[228:231], v[200:203], v[148:151]
    v_mfma_f32_16x16x32_bf16 v[148:151], a[244:247], v[204:207], v[148:151]
    v_mfma_f32_16x16x32_bf16 v[152:155], a[232:235], v[200:203], v[152:155]
    buffer_load_dwordx4 a[136:139], v218, s[48:51], s63 offen offset:0 sc1
    v_mfma_f32_16x16x32_bf16 v[152:155], a[248:251], v[204:207], v[152:155]
    ds_read_b64_tr_b16 v[198:199], v235 offset:55296
    v_mfma_f32_16x16x32_bf16 v[156:159], a[236:239], v[200:203], v[156:159]
    v_mfma_f32_16x16x32_bf16 v[156:159], a[252:255], v[204:207], v[156:159]
    s_waitcnt lgkmcnt(4)
    ds_read_b64_tr_b16 v[200:201], v232 offset:57344
    v_mfma_f32_16x16x32_bf16 v[160:163], a[224:227], v[208:211], v[160:163]
    v_mfma_f32_16x16x32_bf16 v[160:163], a[240:243], v[212:215], v[160:163]
    ds_read_b64_tr_b16 v[202:203], v232 offset:59392
    ds_read_b64_tr_b16 v[204:205], v232 offset:61440
    v_mfma_f32_16x16x32_bf16 v[164:167], a[228:231], v[208:211], v[164:167]
    v_mfma_f32_16x16x32_bf16 v[164:167], a[244:247], v[212:215], v[164:167]
    v_mfma_f32_16x16x32_bf16 v[168:171], a[232:235], v[208:211], v[168:171]
    v_mfma_f32_16x16x32_bf16 v[168:171], a[248:251], v[212:215], v[168:171]
    ds_read_b64_tr_b16 v[206:207], v232 offset:63488
    v_mfma_f32_16x16x32_bf16 v[172:175], a[236:239], v[208:211], v[172:175]
    buffer_load_dwordx4 a[140:143], v218, s[48:51], s64 offen offset:0 sc1
    v_mfma_f32_16x16x32_bf16 v[172:175], a[252:255], v[212:215], v[172:175]
    s_waitcnt lgkmcnt(4)
    v_add_u32 v236, 0x20000, v236
    v_mfma_f32_16x16x32_bf16 v[176:179], a[224:227], v[192:195], v[176:179]
    v_mfma_f32_16x16x32_bf16 v[176:179], a[240:243], v[196:199], v[176:179]
    ds_read_b64_tr_b16 v[208:209], v233 offset:57344
    ds_read_b64_tr_b16 v[210:211], v233 offset:59392
    v_mfma_f32_16x16x32_bf16 v[180:183], a[228:231], v[192:195], v[180:183]
    v_mfma_f32_16x16x32_bf16 v[180:183], a[244:247], v[196:199], v[180:183]
    ds_read_b64_tr_b16 v[212:213], v233 offset:61440
    v_mfma_f32_16x16x32_bf16 v[184:187], a[232:235], v[192:195], v[184:187]
    v_mfma_f32_16x16x32_bf16 v[184:187], a[248:251], v[196:199], v[184:187]
    ds_read_b64_tr_b16 v[214:215], v233 offset:63488
    v_mfma_f32_16x16x32_bf16 v[188:191], a[236:239], v[192:195], v[188:191]
    buffer_store_dwordx4 v[92:95], v248, s[48:51], s59 offen offset:3072 sc1
    v_mfma_f32_16x16x32_bf16 v[188:191], a[252:255], v[196:199], v[188:191]
    s_waitcnt lgkmcnt(4)
    s_mul_i32 s56, s80, 4096
    v_mfma_f32_16x16x32_bf16 v[32:35], a[224:227], v[200:203], v[32:35]
    s_add_u32 m0, s57, 90112
    v_mfma_f32_16x16x32_bf16 v[32:35], a[240:243], v[204:207], v[32:35]
    ds_read_b64_tr_b16 v[192:193], v234 offset:57344
    ds_read_b64_tr_b16 v[194:195], v234 offset:59392
    v_mfma_f32_16x16x32_bf16 v[36:39], a[228:231], v[200:203], v[36:39]
    buffer_load_dwordx4 v239, s[12:15], s56 offen offset:0 sc1 lds
    v_mfma_f32_16x16x32_bf16 v[36:39], a[244:247], v[204:207], v[36:39]
    v_add_u32 v237, 0x20000, v237
    v_mfma_f32_16x16x32_bf16 v[40:43], a[232:235], v[200:203], v[40:43]
    v_mfma_f32_16x16x32_bf16 v[40:43], a[248:251], v[204:207], v[40:43]
    ds_read_b64_tr_b16 v[196:197], v234 offset:61440
    ds_read_b64_tr_b16 v[198:199], v234 offset:63488
    v_mfma_f32_16x16x32_bf16 v[44:47], a[236:239], v[200:203], v[44:47]
    buffer_load_dwordx4 a[144:147], v218, s[48:51], s61 offen offset:1024 sc1
    v_mfma_f32_16x16x32_bf16 v[44:47], a[252:255], v[204:207], v[44:47]
    s_waitcnt lgkmcnt(4)
    ds_read_b64_tr_b16 v[200:201], v235 offset:57344
    ds_read_b64_tr_b16 v[202:203], v235 offset:59392
    v_mfma_f32_16x16x32_bf16 v[48:51], a[224:227], v[208:211], v[48:51]
    ds_read_b64_tr_b16 v[204:205], v235 offset:61440
    ds_read_b64_tr_b16 v[206:207], v235 offset:63488
    v_mfma_f32_16x16x32_bf16 v[48:51], a[240:243], v[212:215], v[48:51]
    v_cvt_pk_bf16_f32 v128, v128, v129
    v_mfma_f32_16x16x32_bf16 v[52:55], a[228:231], v[208:211], v[52:55]
    v_cvt_pk_bf16_f32 v129, v130, v131
    v_mfma_f32_16x16x32_bf16 v[52:55], a[244:247], v[212:215], v[52:55]
    v_cvt_pk_bf16_f32 v130, v132, v133
    v_mfma_f32_16x16x32_bf16 v[56:59], a[232:235], v[208:211], v[56:59]
    v_cvt_pk_bf16_f32 v131, v134, v135
    v_mfma_f32_16x16x32_bf16 v[56:59], a[248:251], v[212:215], v[56:59]
    buffer_load_dwordx4 a[148:151], v218, s[48:51], s62 offen offset:1024 sc1
    v_mfma_f32_16x16x32_bf16 v[60:63], a[236:239], v[208:211], v[60:63]
    v_cvt_pk_bf16_f32 v136, v136, v137
    v_mfma_f32_16x16x32_bf16 v[60:63], a[252:255], v[212:215], v[60:63]
    s_waitcnt lgkmcnt(4)
    v_cvt_pk_bf16_f32 v137, v138, v139
    v_mfma_f32_16x16x32_bf16 v[96:99], a[224:227], v[192:195], v[96:99]
    v_cvt_pk_bf16_f32 v138, v140, v141
    v_cvt_pk_bf16_f32 v139, v142, v143
    v_mfma_f32_16x16x32_bf16 v[96:99], a[240:243], v[196:199], v[96:99]
    buffer_load_dwordx4 v240, s[12:15], s56 offen offset:1024 sc1 lds
    v_mfma_f32_16x16x32_bf16 v[100:103], a[228:231], v[192:195], v[100:103]
    s_waitcnt lgkmcnt(0)
    s_barrier
    v_cvt_pk_bf16_f32 v144, v144, v145
    v_mfma_f32_16x16x32_bf16 v[100:103], a[244:247], v[196:199], v[100:103]
    ds_read_b64_tr_b16 v[208:209], v236 offset:0
    ds_read_b64_tr_b16 v[210:211], v236 offset:1024
    v_mfma_f32_16x16x32_bf16 v[104:107], a[232:235], v[192:195], v[104:107]
    ds_read_b64_tr_b16 v[212:213], v236 offset:2048
    v_mfma_f32_16x16x32_bf16 v[104:107], a[248:251], v[196:199], v[104:107]
    ds_read_b64_tr_b16 v[214:215], v236 offset:3072
    v_cvt_pk_bf16_f32 v145, v146, v147
    v_mfma_f32_16x16x32_bf16 v[108:111], a[236:239], v[192:195], v[108:111]
    v_cvt_pk_bf16_f32 v146, v148, v149
    v_mfma_f32_16x16x32_bf16 v[108:111], a[252:255], v[196:199], v[108:111]
    ds_read_b64_tr_b16 v[192:193], v237 offset:0
    v_cvt_pk_bf16_f32 v147, v150, v151
    v_mfma_f32_16x16x32_bf16 v[112:115], a[224:227], v[200:203], v[112:115]
    buffer_load_dwordx4 a[152:155], v218, s[48:51], s63 offen offset:1024 sc1
    v_mfma_f32_16x16x32_bf16 v[112:115], a[240:243], v[204:207], v[112:115]
    ds_read_b64_tr_b16 v[194:195], v237 offset:1024
    v_cvt_pk_bf16_f32 v152, v152, v153
    v_mfma_f32_16x16x32_bf16 v[116:119], a[228:231], v[200:203], v[116:119]
    v_cvt_pk_bf16_f32 v153, v154, v155
    v_mfma_f32_16x16x32_bf16 v[116:119], a[244:247], v[204:207], v[116:119]
    v_cvt_pk_bf16_f32 v154, v156, v157
    v_mfma_f32_16x16x32_bf16 v[120:123], a[232:235], v[200:203], v[120:123]
    ds_read_b64_tr_b16 v[196:197], v237 offset:2048
    v_cvt_pk_bf16_f32 v155, v158, v159
    v_mfma_f32_16x16x32_bf16 v[120:123], a[248:251], v[204:207], v[120:123]
    ds_read_b64_tr_b16 v[198:199], v237 offset:3072
    v_cvt_pk_bf16_f32 v132, v160, v161
    v_mfma_f32_16x16x32_bf16 v[124:127], a[236:239], v[200:203], v[124:127]
    buffer_load_dwordx4 a[156:159], v218, s[48:51], s64 offen offset:1024 sc1
    v_mfma_f32_16x16x32_bf16 v[124:127], a[252:255], v[204:207], v[124:127]
    s_waitcnt lgkmcnt(4)
    s_mul_i32 s56, s80, 4096
    ds_read_b64_tr_b16 v[200:201], v236 offset:4096
    v_cvt_pk_bf16_f32 v133, v162, v163
    v_mfma_f32_16x16x32_bf16 v[0:3], v[208:211], a[0:3], 0
    s_add_u32 s56, s56, 524288
    s_add_u32 m0, s57, 98304
    v_cvt_pk_bf16_f32 v134, v164, v165
    v_mfma_f32_16x16x32_bf16 v[0:3], v[212:215], a[16:19], v[0:3]
    ds_read_b64_tr_b16 v[202:203], v236 offset:5120
    v_cvt_pk_bf16_f32 v135, v166, v167
    v_mfma_f32_16x16x32_bf16 v[4:7], v[208:211], a[4:7], 0
    buffer_load_dwordx4 v239, s[12:15], s56 offen offset:0 sc1 lds
    v_mfma_f32_16x16x32_bf16 v[4:7], v[212:215], a[20:23], v[4:7]
    v_cvt_pk_bf16_f32 v140, v168, v169
    v_mfma_f32_16x16x32_bf16 v[8:11], v[208:211], a[8:11], 0
    ds_read_b64_tr_b16 v[204:205], v236 offset:6144
    v_cvt_pk_bf16_f32 v141, v170, v171
    v_mfma_f32_16x16x32_bf16 v[8:11], v[212:215], a[24:27], v[8:11]
    ds_read_b64_tr_b16 v[206:207], v236 offset:7168
    v_cvt_pk_bf16_f32 v142, v172, v173
    v_mfma_f32_16x16x32_bf16 v[12:15], v[208:211], a[12:15], 0
    buffer_load_dwordx4 v240, s[12:15], s56 offen offset:1024 sc1 lds
    v_mfma_f32_16x16x32_bf16 v[12:15], v[212:215], a[28:31], v[12:15]
    s_waitcnt lgkmcnt(4)
    ds_read_b64_tr_b16 v[208:209], v237 offset:4096
    v_cvt_pk_bf16_f32 v143, v174, v175
    v_mfma_f32_16x16x32_bf16 v[16:19], v[192:195], a[0:3], 0
    ds_read_b64_tr_b16 v[210:211], v237 offset:5120
    v_cvt_pk_bf16_f32 v148, v176, v177
    v_mfma_f32_16x16x32_bf16 v[16:19], v[196:199], a[16:19], v[16:19]
    v_cvt_pk_bf16_f32 v149, v178, v179
    v_mfma_f32_16x16x32_bf16 v[20:23], v[192:195], a[4:7], 0
    v_mfma_f32_16x16x32_bf16 v[20:23], v[196:199], a[20:23], v[20:23]
    ds_read_b64_tr_b16 v[212:213], v237 offset:6144
    v_cvt_pk_bf16_f32 v150, v180, v181
    v_mfma_f32_16x16x32_bf16 v[24:27], v[192:195], a[8:11], 0
    v_cvt_pk_bf16_f32 v151, v182, v183
    v_cvt_pk_bf16_f32 v156, v184, v185
    v_cvt_pk_bf16_f32 v157, v186, v187
    v_mfma_f32_16x16x32_bf16 v[24:27], v[196:199], a[24:27], v[24:27]
    v_cvt_pk_bf16_f32 v158, v188, v189
    v_cvt_pk_bf16_f32 v159, v190, v191
    v_mfma_f32_16x16x32_bf16 v[28:31], v[192:195], a[12:15], 0
    ds_read_b64_tr_b16 v[214:215], v237 offset:7168
    v_cvt_pk_bf16_f32 v32, v32, v33
    v_mfma_f32_16x16x32_bf16 v[28:31], v[196:199], a[28:31], v[28:31]
    s_waitcnt lgkmcnt(4)
    v_subrev_u32 v236, 0x20000, v236
    v_subrev_u32 v237, 0x20000, v237
    ds_read_b64_tr_b16 v[192:193], v236 offset:0
    v_mfma_f32_16x16x32_bf16 v[160:163], v[200:203], a[0:3], 0
    buffer_load_dwordx4 a[160:163], v218, s[48:51], s61 offen offset:2048 sc1
    v_mfma_f32_16x16x32_bf16 v[160:163], v[204:207], a[16:19], v[160:163]
    v_cvt_pk_bf16_f32 v33, v34, v35
    v_mfma_f32_16x16x32_bf16 v[164:167], v[200:203], a[4:7], 0
    ds_read_b64_tr_b16 v[194:195], v236 offset:1024
    v_cvt_pk_bf16_f32 v34, v36, v37
    v_mfma_f32_16x16x32_bf16 v[164:167], v[204:207], a[20:23], v[164:167]
    ds_read_b64_tr_b16 v[196:197], v236 offset:2048
    v_cvt_pk_bf16_f32 v35, v38, v39
    v_mfma_f32_16x16x32_bf16 v[168:171], v[200:203], a[8:11], 0
    buffer_store_dwordx4 v[128:131], v245, s[48:51], s60 offen offset:0 sc1
    v_mfma_f32_16x16x32_bf16 v[168:171], v[204:207], a[24:27], v[168:171]
    ds_read_b64_tr_b16 v[198:199], v236 offset:3072
    v_cvt_pk_bf16_f32 v40, v40, v41
    v_mfma_f32_16x16x32_bf16 v[172:175], v[200:203], a[12:15], 0
    v_cvt_pk_bf16_f32 v41, v42, v43
    v_mfma_f32_16x16x32_bf16 v[172:175], v[204:207], a[28:31], v[172:175]
    s_waitcnt lgkmcnt(4)
    ds_read_b64_tr_b16 v[200:201], v237 offset:0
    v_cvt_pk_bf16_f32 v42, v44, v45
    v_mfma_f32_16x16x32_bf16 v[176:179], v[208:211], a[0:3], 0
    s_waitcnt vmcnt(46)
    buffer_load_dwordx4 a[164:167], v218, s[48:51], s62 offen offset:2048 sc1
    v_mfma_f32_16x16x32_bf16 v[176:179], v[212:215], a[16:19], v[176:179]
    v_cvt_pk_bf16_f32 v43, v46, v47
    v_mfma_f32_16x16x32_bf16 v[180:183], v[208:211], a[4:7], 0
    ds_read_b64_tr_b16 v[202:203], v237 offset:1024
    v_cvt_pk_bf16_f32 v48, v48, v49
    v_mfma_f32_16x16x32_bf16 v[180:183], v[212:215], a[20:23], v[180:183]
    ds_read_b64_tr_b16 v[204:205], v237 offset:2048
    v_cvt_pk_bf16_f32 v49, v50, v51
    v_mfma_f32_16x16x32_bf16 v[184:187], v[208:211], a[8:11], 0
    ds_read_b64_tr_b16 v[206:207], v237 offset:3072
    v_mfma_f32_16x16x32_bf16 v[184:187], v[212:215], a[24:27], v[184:187]
    v_cvt_pk_bf16_f32 v50, v52, v53
    v_mfma_f32_16x16x32_bf16 v[188:191], v[208:211], a[12:15], 0
    v_cvt_pk_bf16_f32 v51, v54, v55
    v_mfma_f32_16x16x32_bf16 v[188:191], v[212:215], a[28:31], v[188:191]
    s_waitcnt lgkmcnt(4)
    ds_read_b64_tr_b16 v[208:209], v236 offset:4096
    v_mfma_f32_16x16x32_bf16 v[0:3], v[192:195], a[32:35], v[0:3]
    s_mul_i32 s56, s81, 4096
    s_add_u32 m0, s57, 106496
    v_cvt_pk_bf16_f32 v56, v56, v57
    v_mfma_f32_16x16x32_bf16 v[0:3], v[196:199], a[48:51], v[0:3]
    ds_read_b64_tr_b16 v[210:211], v236 offset:5120
    v_cvt_pk_bf16_f32 v57, v58, v59
    v_mfma_f32_16x16x32_bf16 v[4:7], v[192:195], a[36:39], v[4:7]
    buffer_load_dwordx4 v239, s[12:15], s56 offen offset:0 sc1 lds
    v_mfma_f32_16x16x32_bf16 v[4:7], v[196:199], a[52:55], v[4:7]
    ds_read_b64_tr_b16 v[212:213], v236 offset:6144
    v_cvt_pk_bf16_f32 v58, v60, v61
    v_mfma_f32_16x16x32_bf16 v[8:11], v[192:195], a[40:43], v[8:11]
    v_cvt_pk_bf16_f32 v59, v62, v63
    v_mfma_f32_16x16x32_bf16 v[8:11], v[196:199], a[56:59], v[8:11]
    ds_read_b64_tr_b16 v[214:215], v236 offset:7168
    v_cvt_pk_bf16_f32 v36, v96, v97
    v_mfma_f32_16x16x32_bf16 v[12:15], v[192:195], a[44:47], v[12:15]
    buffer_load_dwordx4 v240, s[12:15], s56 offen offset:1024 sc1 lds
    v_mfma_f32_16x16x32_bf16 v[12:15], v[196:199], a[60:63], v[12:15]
    s_waitcnt lgkmcnt(4)
    ds_read_b64_tr_b16 v[192:193], v237 offset:4096
    v_mfma_f32_16x16x32_bf16 v[16:19], v[200:203], a[32:35], v[16:19]
    v_cvt_pk_bf16_f32 v37, v98, v99
    v_mfma_f32_16x16x32_bf16 v[16:19], v[204:207], a[48:51], v[16:19]
    ds_read_b64_tr_b16 v[194:195], v237 offset:5120
    v_cvt_pk_bf16_f32 v38, v100, v101
    v_mfma_f32_16x16x32_bf16 v[20:23], v[200:203], a[36:39], v[20:23]
    buffer_load_dwordx4 a[168:171], v218, s[48:51], s63 offen offset:2048 sc1
    v_mfma_f32_16x16x32_bf16 v[20:23], v[204:207], a[52:55], v[20:23]
    ds_read_b64_tr_b16 v[196:197], v237 offset:6144
    v_cvt_pk_bf16_f32 v39, v102, v103
    v_mfma_f32_16x16x32_bf16 v[24:27], v[200:203], a[40:43], v[24:27]
    v_cvt_pk_bf16_f32 v44, v104, v105
    v_mfma_f32_16x16x32_bf16 v[24:27], v[204:207], a[56:59], v[24:27]
    ds_read_b64_tr_b16 v[198:199], v237 offset:7168
    v_mfma_f32_16x16x32_bf16 v[28:31], v[200:203], a[44:47], v[28:31]
    v_cvt_pk_bf16_f32 v45, v106, v107
    v_mfma_f32_16x16x32_bf16 v[28:31], v[204:207], a[60:63], v[28:31]
    s_waitcnt lgkmcnt(4)
    ds_read_b64_tr_b16 v[200:201], v238 offset:8192
    v_cvt_pk_bf16_f32 v46, v108, v109
    v_mfma_f32_16x16x32_bf16 v[160:163], v[208:211], a[32:35], v[160:163]
    buffer_store_dwordx4 v[136:139], v247, s[48:51], s60 offen offset:0 sc1
    v_mfma_f32_16x16x32_bf16 v[160:163], v[212:215], a[48:51], v[160:163]
    ds_read_b64_tr_b16 v[202:203], v238 offset:8704
    v_cvt_pk_bf16_f32 v47, v110, v111
    v_mfma_f32_16x16x32_bf16 v[164:167], v[208:211], a[36:39], v[164:167]
    v_cvt_pk_bf16_f32 v52, v112, v113
    v_mfma_f32_16x16x32_bf16 v[164:167], v[212:215], a[52:55], v[164:167]
    ds_read_b64_tr_b16 v[204:205], v238 offset:9216
    v_cvt_pk_bf16_f32 v53, v114, v115
    v_mfma_f32_16x16x32_bf16 v[168:171], v[208:211], a[40:43], v[168:171]
    buffer_load_dwordx4 a[172:175], v218, s[48:51], s64 offen offset:2048 sc1
    v_mfma_f32_16x16x32_bf16 v[168:171], v[212:215], a[56:59], v[168:171]
    ds_read_b64_tr_b16 v[206:207], v238 offset:9728
    v_cvt_pk_bf16_f32 v54, v116, v117
    v_mfma_f32_16x16x32_bf16 v[172:175], v[208:211], a[44:47], v[172:175]
    v_cvt_pk_bf16_f32 v55, v118, v119
    v_mfma_f32_16x16x32_bf16 v[172:175], v[212:215], a[60:63], v[172:175]
    s_waitcnt lgkmcnt(4)
    ds_read_b64_tr_b16 v[208:209], v238 offset:12288
    v_cvt_pk_bf16_f32 v60, v120, v121
    v_mfma_f32_16x16x32_bf16 v[176:179], v[192:195], a[32:35], v[176:179]
    v_mfma_f32_16x16x32_bf16 v[176:179], v[196:199], a[48:51], v[176:179]
    ds_read_b64_tr_b16 v[210:211], v238 offset:12800
    v_cvt_pk_bf16_f32 v61, v122, v123
    v_mfma_f32_16x16x32_bf16 v[180:183], v[192:195], a[36:39], v[180:183]
    buffer_load_dwordx4 a[176:179], v218, s[48:51], s61 offen offset:3072 sc1
    v_mfma_f32_16x16x32_bf16 v[180:183], v[196:199], a[52:55], v[180:183]
    v_cvt_pk_bf16_f32 v62, v124, v125
    v_mfma_f32_16x16x32_bf16 v[184:187], v[192:195], a[40:43], v[184:187]
    v_cvt_pk_bf16_f32 v63, v126, v127
    v_mfma_f32_16x16x32_bf16 v[184:187], v[196:199], a[56:59], v[184:187]
    ds_read_b64_tr_b16 v[212:213], v238 offset:13312
    ds_read_b64_tr_b16 v[214:215], v238 offset:13824
    v_mfma_f32_16x16x32_bf16 v[188:191], v[192:195], a[44:47], v[188:191]
    buffer_load_dwordx4 a[180:183], v218, s[48:51], s62 offen offset:3072 sc1
    v_mfma_f32_16x16x32_bf16 v[188:191], v[196:199], a[60:63], v[188:191]
    s_waitcnt lgkmcnt(4)
    s_mul_i32 s56, s81, 4096
    v_mfma_f32_16x16x32_bf16 v[96:99], v[200:203], a[0:3], 0
    s_add_u32 s56, s56, 524288
    v_mfma_f32_16x16x32_bf16 v[96:99], v[204:207], a[16:19], v[96:99]
    s_add_u32 m0, s57, 114688
    ds_read_b64_tr_b16 v[192:193], v238 offset:10240
    ds_read_b64_tr_b16 v[194:195], v238 offset:10752
    v_mfma_f32_16x16x32_bf16 v[100:103], v[200:203], a[4:7], 0
    buffer_load_dwordx4 v239, s[12:15], s56 offen offset:0 sc1 lds
    v_mfma_f32_16x16x32_bf16 v[100:103], v[204:207], a[20:23], v[100:103]
    ds_read_b64_tr_b16 v[196:197], v238 offset:11264
    ds_read_b64_tr_b16 v[198:199], v238 offset:11776
    v_mfma_f32_16x16x32_bf16 v[104:107], v[200:203], a[8:11], 0
    v_mfma_f32_16x16x32_bf16 v[104:107], v[204:207], a[24:27], v[104:107]
    v_mfma_f32_16x16x32_bf16 v[108:111], v[200:203], a[12:15], 0
    buffer_load_dwordx4 v240, s[12:15], s56 offen offset:1024 sc1 lds
    v_mfma_f32_16x16x32_bf16 v[108:111], v[204:207], a[28:31], v[108:111]
    s_waitcnt lgkmcnt(4)
    ds_read_b64_tr_b16 v[200:201], v238 offset:14336
    v_mfma_f32_16x16x32_bf16 v[112:115], v[208:211], a[0:3], 0
    ds_read_b64_tr_b16 v[202:203], v238 offset:14848
    v_mfma_f32_16x16x32_bf16 v[112:115], v[212:215], a[16:19], v[112:115]
    v_mfma_f32_16x16x32_bf16 v[116:119], v[208:211], a[4:7], 0
    v_mfma_f32_16x16x32_bf16 v[116:119], v[212:215], a[20:23], v[116:119]
    ds_read_b64_tr_b16 v[204:205], v238 offset:15360
    ds_read_b64_tr_b16 v[206:207], v238 offset:15872
    v_mfma_f32_16x16x32_bf16 v[120:123], v[208:211], a[8:11], 0
    buffer_store_dwordx4 v[144:147], v245, s[48:51], s60 offen offset:1024 sc1
    v_mfma_f32_16x16x32_bf16 v[120:123], v[212:215], a[24:27], v[120:123]
    v_mfma_f32_16x16x32_bf16 v[124:127], v[208:211], a[12:15], 0
    v_mfma_f32_16x16x32_bf16 v[124:127], v[212:215], a[28:31], v[124:127]
    s_waitcnt lgkmcnt(4)
    v_mfma_f32_16x16x32_bf16 v[96:99], v[192:195], a[32:35], v[96:99]
    buffer_load_dwordx4 a[184:187], v218, s[48:51], s63 offen offset:3072 sc1
    v_mfma_f32_16x16x32_bf16 v[96:99], v[196:199], a[48:51], v[96:99]
    ds_read_b64_tr_b16 v[208:209], v236 offset:32768
    ds_read_b64_tr_b16 v[210:211], v236 offset:33792
    v_mfma_f32_16x16x32_bf16 v[100:103], v[192:195], a[36:39], v[100:103]
    v_mfma_f32_16x16x32_bf16 v[100:103], v[196:199], a[52:55], v[100:103]
    ds_read_b64_tr_b16 v[212:213], v236 offset:34816
    ds_read_b64_tr_b16 v[214:215], v236 offset:35840
    v_mfma_f32_16x16x32_bf16 v[104:107], v[192:195], a[40:43], v[104:107]
    v_mfma_f32_16x16x32_bf16 v[104:107], v[196:199], a[56:59], v[104:107]
    v_mfma_f32_16x16x32_bf16 v[108:111], v[192:195], a[44:47], v[108:111]
    v_mfma_f32_16x16x32_bf16 v[108:111], v[196:199], a[60:63], v[108:111]
    s_waitcnt lgkmcnt(4)
    v_mfma_f32_16x16x32_bf16 v[112:115], v[200:203], a[32:35], v[112:115]
    ds_read_b64_tr_b16 v[192:193], v237 offset:32768
    v_mfma_f32_16x16x32_bf16 v[112:115], v[204:207], a[48:51], v[112:115]
    v_mfma_f32_16x16x32_bf16 v[116:119], v[200:203], a[36:39], v[116:119]
    buffer_load_dwordx4 a[188:191], v218, s[48:51], s64 offen offset:3072 sc1
    v_mfma_f32_16x16x32_bf16 v[116:119], v[204:207], a[52:55], v[116:119]
    ds_read_b64_tr_b16 v[194:195], v237 offset:33792
    ds_read_b64_tr_b16 v[196:197], v237 offset:34816
    v_mfma_f32_16x16x32_bf16 v[120:123], v[200:203], a[40:43], v[120:123]
    ds_read_b64_tr_b16 v[198:199], v237 offset:35840
    v_mfma_f32_16x16x32_bf16 v[120:123], v[204:207], a[56:59], v[120:123]
    v_mfma_f32_16x16x32_bf16 v[124:127], v[200:203], a[44:47], v[124:127]
    v_mfma_f32_16x16x32_bf16 v[124:127], v[204:207], a[60:63], v[124:127]
    s_waitcnt lgkmcnt(4)
    s_mul_i32 s56, s82, 4096
    v_mfma_f32_16x16x32_bf16 v[0:3], v[208:211], a[64:67], v[0:3]
    s_waitcnt vmcnt(48)
    s_add_u32 m0, s57, 122880
    ds_read_b64_tr_b16 v[200:201], v236 offset:36864
    v_mfma_f32_16x16x32_bf16 v[0:3], v[212:215], a[80:83], v[0:3]
    ds_read_b64_tr_b16 v[202:203], v236 offset:37888
    v_mfma_f32_16x16x32_bf16 v[4:7], v[208:211], a[68:71], v[4:7]
    buffer_load_dwordx4 v239, s[12:15], s56 offen offset:0 sc1 lds
    v_mfma_f32_16x16x32_bf16 v[4:7], v[212:215], a[84:87], v[4:7]
    ds_read_b64_tr_b16 v[204:205], v236 offset:38912
    v_mfma_f32_16x16x32_bf16 v[8:11], v[208:211], a[72:75], v[8:11]
    v_mfma_f32_16x16x32_bf16 v[8:11], v[212:215], a[88:91], v[8:11]
    ds_read_b64_tr_b16 v[206:207], v236 offset:39936
    v_mfma_f32_16x16x32_bf16 v[12:15], v[208:211], a[76:79], v[12:15]
    buffer_load_dwordx4 v240, s[12:15], s56 offen offset:1024 sc1 lds
    v_mfma_f32_16x16x32_bf16 v[12:15], v[212:215], a[92:95], v[12:15]
    s_waitcnt lgkmcnt(4)
    ds_read_b64_tr_b16 v[208:209], v237 offset:36864
    ds_read_b64_tr_b16 v[210:211], v237 offset:37888
    v_mfma_f32_16x16x32_bf16 v[16:19], v[192:195], a[64:67], v[16:19]
    ds_read_b64_tr_b16 v[212:213], v237 offset:38912
    ds_read_b64_tr_b16 v[214:215], v237 offset:39936
    v_mfma_f32_16x16x32_bf16 v[16:19], v[196:199], a[80:83], v[16:19]
    v_mfma_f32_16x16x32_bf16 v[20:23], v[192:195], a[68:71], v[20:23]
    buffer_store_dwordx4 v[152:155], v247, s[48:51], s60 offen offset:1024 sc1
    v_mfma_f32_16x16x32_bf16 v[20:23], v[196:199], a[84:87], v[20:23]
    v_mfma_f32_16x16x32_bf16 v[24:27], v[192:195], a[72:75], v[24:27]
    v_mfma_f32_16x16x32_bf16 v[24:27], v[196:199], a[88:91], v[24:27]
    buffer_load_dwordx4 a[192:195], v219, s[48:51], s61 offen offset:0 sc1
    v_mfma_f32_16x16x32_bf16 v[28:31], v[192:195], a[76:79], v[28:31]
    v_mfma_f32_16x16x32_bf16 v[28:31], v[196:199], a[92:95], v[28:31]
    s_waitcnt lgkmcnt(4)
    v_mfma_f32_16x16x32_bf16 v[160:163], v[200:203], a[64:67], v[160:163]
    v_mfma_f32_16x16x32_bf16 v[160:163], v[204:207], a[80:83], v[160:163]
    buffer_load_dwordx4 a[196:199], v219, s[48:51], s62 offen offset:0 sc1
    v_mfma_f32_16x16x32_bf16 v[164:167], v[200:203], a[68:71], v[164:167]
    s_waitcnt lgkmcnt(0)
    s_barrier
    v_mfma_f32_16x16x32_bf16 v[164:167], v[204:207], a[84:87], v[164:167]
    ds_read_b64_tr_b16 v[192:193], v236 offset:49152
    ds_read_b64_tr_b16 v[194:195], v236 offset:50176
    v_mfma_f32_16x16x32_bf16 v[168:171], v[200:203], a[72:75], v[168:171]
    ds_read_b64_tr_b16 v[196:197], v236 offset:51200
    v_mfma_f32_16x16x32_bf16 v[168:171], v[204:207], a[88:91], v[168:171]
    v_mfma_f32_16x16x32_bf16 v[172:175], v[200:203], a[76:79], v[172:175]
    ds_read_b64_tr_b16 v[198:199], v236 offset:52224
    v_mfma_f32_16x16x32_bf16 v[172:175], v[204:207], a[92:95], v[172:175]
    ds_read_b64_tr_b16 v[200:201], v237 offset:49152
    v_mfma_f32_16x16x32_bf16 v[176:179], v[208:211], a[64:67], v[176:179]
    v_mfma_f32_16x16x32_bf16 v[176:179], v[212:215], a[80:83], v[176:179]
    v_mfma_f32_16x16x32_bf16 v[180:183], v[208:211], a[68:71], v[180:183]
    ds_read_b64_tr_b16 v[202:203], v237 offset:50176
    v_mfma_f32_16x16x32_bf16 v[180:183], v[212:215], a[84:87], v[180:183]
    v_mfma_f32_16x16x32_bf16 v[184:187], v[208:211], a[72:75], v[184:187]
    buffer_load_dwordx4 a[200:203], v219, s[48:51], s63 offen offset:0 sc1
    v_mfma_f32_16x16x32_bf16 v[184:187], v[212:215], a[88:91], v[184:187]
    ds_read_b64_tr_b16 v[204:205], v237 offset:51200
    v_mfma_f32_16x16x32_bf16 v[188:191], v[208:211], a[76:79], v[188:191]
    ds_read_b64_tr_b16 v[206:207], v237 offset:52224
    v_mfma_f32_16x16x32_bf16 v[188:191], v[212:215], a[92:95], v[188:191]
    s_waitcnt vmcnt(37) lgkmcnt(4)
    ds_read_b64_tr_b16 v[208:209], v236 offset:53248
    v_mfma_f32_16x16x32_bf16 v[0:3], v[192:195], a[96:99], v[0:3]
    s_mul_i32 s56, s82, 4096
    s_add_u32 s56, s56, 524288
    v_mfma_f32_16x16x32_bf16 v[0:3], v[196:199], a[112:115], v[0:3]
    s_add_u32 m0, s57, 0
    ds_read_b64_tr_b16 v[210:211], v236 offset:54272
    v_mfma_f32_16x16x32_bf16 v[4:7], v[192:195], a[100:103], v[4:7]
    buffer_load_dwordx4 v239, s[12:15], s56 offen offset:0 sc1 lds
    v_mfma_f32_16x16x32_bf16 v[4:7], v[196:199], a[116:119], v[4:7]
    ds_read_b64_tr_b16 v[212:213], v236 offset:55296
    v_mfma_f32_16x16x32_bf16 v[8:11], v[192:195], a[104:107], v[8:11]
    ds_read_b64_tr_b16 v[214:215], v236 offset:56320
    v_mfma_f32_16x16x32_bf16 v[8:11], v[196:199], a[120:123], v[8:11]
    v_mfma_f32_16x16x32_bf16 v[12:15], v[192:195], a[108:111], v[12:15]
    buffer_load_dwordx4 v240, s[12:15], s56 offen offset:1024 sc1 lds
    v_mfma_f32_16x16x32_bf16 v[12:15], v[196:199], a[124:127], v[12:15]
    s_waitcnt lgkmcnt(4)
    v_mfma_f32_16x16x32_bf16 v[16:19], v[200:203], a[96:99], v[16:19]
    v_mfma_f32_16x16x32_bf16 v[16:19], v[204:207], a[112:115], v[16:19]
    ds_read_b64_tr_b16 v[192:193], v237 offset:53248
    ds_read_b64_tr_b16 v[194:195], v237 offset:54272
    v_mfma_f32_16x16x32_bf16 v[20:23], v[200:203], a[100:103], v[20:23]
    buffer_load_dwordx4 a[204:207], v219, s[48:51], s64 offen offset:0 sc1
    v_mfma_f32_16x16x32_bf16 v[20:23], v[204:207], a[116:119], v[20:23]
    ds_read_b64_tr_b16 v[196:197], v237 offset:55296
    v_mfma_f32_16x16x32_bf16 v[24:27], v[200:203], a[104:107], v[24:27]
    buffer_store_dwordx4 v[132:135], v245, s[48:51], s60 offen offset:2048 sc1
    v_mfma_f32_16x16x32_bf16 v[24:27], v[204:207], a[120:123], v[24:27]
    v_mfma_f32_16x16x32_bf16 v[28:31], v[200:203], a[108:111], v[28:31]
    ds_read_b64_tr_b16 v[198:199], v237 offset:56320
    v_mfma_f32_16x16x32_bf16 v[28:31], v[204:207], a[124:127], v[28:31]
    s_waitcnt lgkmcnt(4)
    v_mfma_f32_16x16x32_bf16 v[160:163], v[208:211], a[96:99], v[160:163]
    v_mfma_f32_16x16x32_bf16 v[160:163], v[212:215], a[112:115], v[160:163]
    ds_read_b64_tr_b16 v[200:201], v238 offset:40960
    ds_read_b64_tr_b16 v[202:203], v238 offset:41472
    v_mfma_f32_16x16x32_bf16 v[164:167], v[208:211], a[100:103], v[164:167]
    buffer_load_dwordx4 a[208:211], v219, s[48:51], s61 offen offset:1024 sc1
    v_mfma_f32_16x16x32_bf16 v[164:167], v[212:215], a[116:119], v[164:167]
    ds_read_b64_tr_b16 v[204:205], v238 offset:41984
    v_mfma_f32_16x16x32_bf16 v[168:171], v[208:211], a[104:107], v[168:171]
    v_mfma_f32_16x16x32_bf16 v[168:171], v[212:215], a[120:123], v[168:171]
    ds_read_b64_tr_b16 v[206:207], v238 offset:42496
    v_mfma_f32_16x16x32_bf16 v[172:175], v[208:211], a[108:111], v[172:175]
    buffer_load_dwordx4 a[212:215], v219, s[48:51], s62 offen offset:1024 sc1
    v_mfma_f32_16x16x32_bf16 v[172:175], v[212:215], a[124:127], v[172:175]
    s_waitcnt lgkmcnt(4)
    v_mfma_f32_16x16x32_bf16 v[176:179], v[192:195], a[96:99], v[176:179]
    ds_read_b64_tr_b16 v[208:209], v238 offset:45056
    ds_read_b64_tr_b16 v[210:211], v238 offset:45568
    v_mfma_f32_16x16x32_bf16 v[176:179], v[196:199], a[112:115], v[176:179]
    v_mfma_f32_16x16x32_bf16 v[180:183], v[192:195], a[100:103], v[180:183]
    ds_read_b64_tr_b16 v[212:213], v238 offset:46080
    v_mfma_f32_16x16x32_bf16 v[180:183], v[196:199], a[116:119], v[180:183]
    v_mfma_f32_16x16x32_bf16 v[184:187], v[192:195], a[104:107], v[184:187]
    buffer_store_dwordx4 v[140:143], v247, s[48:51], s60 offen offset:2048 sc1
    v_mfma_f32_16x16x32_bf16 v[184:187], v[196:199], a[120:123], v[184:187]
    v_mfma_f32_16x16x32_bf16 v[188:191], v[192:195], a[108:111], v[188:191]
    ds_read_b64_tr_b16 v[214:215], v238 offset:46592
    v_mfma_f32_16x16x32_bf16 v[188:191], v[196:199], a[124:127], v[188:191]
    s_waitcnt lgkmcnt(4)
    s_mul_i32 s56, s85, 4096
    v_mfma_f32_16x16x32_bf16 v[96:99], v[200:203], a[64:67], v[96:99]
    ds_read_b64_tr_b16 v[192:193], v238 offset:43008
    v_mfma_f32_16x16x32_bf16 v[96:99], v[204:207], a[80:83], v[96:99]
    s_add_u32 m0, s57, 8192
    ds_read_b64_tr_b16 v[194:195], v238 offset:43520
    ds_read_b64_tr_b16 v[196:197], v238 offset:44032
    v_mfma_f32_16x16x32_bf16 v[100:103], v[200:203], a[68:71], v[100:103]
    buffer_load_dwordx4 v239, s[12:15], s56 offen offset:0 sc1 lds
    v_mfma_f32_16x16x32_bf16 v[100:103], v[204:207], a[84:87], v[100:103]
    v_mfma_f32_16x16x32_bf16 v[104:107], v[200:203], a[72:75], v[104:107]
    v_mfma_f32_16x16x32_bf16 v[104:107], v[204:207], a[88:91], v[104:107]
    ds_read_b64_tr_b16 v[198:199], v238 offset:44544
    v_mfma_f32_16x16x32_bf16 v[108:111], v[200:203], a[76:79], v[108:111]
    buffer_load_dwordx4 v240, s[12:15], s56 offen offset:1024 sc1 lds
    v_mfma_f32_16x16x32_bf16 v[108:111], v[204:207], a[92:95], v[108:111]
    s_waitcnt lgkmcnt(4)
    ds_read_b64_tr_b16 v[200:201], v238 offset:47104
    v_mfma_f32_16x16x32_bf16 v[112:115], v[208:211], a[64:67], v[112:115]
    v_mfma_f32_16x16x32_bf16 v[112:115], v[212:215], a[80:83], v[112:115]
    ds_read_b64_tr_b16 v[202:203], v238 offset:47616
    v_mfma_f32_16x16x32_bf16 v[116:119], v[208:211], a[68:71], v[116:119]
    v_mfma_f32_16x16x32_bf16 v[116:119], v[212:215], a[84:87], v[116:119]
    ds_read_b64_tr_b16 v[204:205], v238 offset:48128
    ds_read_b64_tr_b16 v[206:207], v238 offset:48640
    v_mfma_f32_16x16x32_bf16 v[120:123], v[208:211], a[72:75], v[120:123]
    v_mfma_f32_16x16x32_bf16 v[120:123], v[212:215], a[88:91], v[120:123]
    buffer_load_dwordx4 a[216:219], v219, s[48:51], s63 offen offset:1024 sc1
    v_mfma_f32_16x16x32_bf16 v[124:127], v[208:211], a[76:79], v[124:127]
    v_mfma_f32_16x16x32_bf16 v[124:127], v[212:215], a[92:95], v[124:127]
    s_waitcnt lgkmcnt(4)
    ds_read_b64_tr_b16 v[208:209], v236 offset:57344
    v_mfma_f32_16x16x32_bf16 v[96:99], v[192:195], a[96:99], v[96:99]
    ds_read_b64_tr_b16 v[210:211], v236 offset:58368
    v_mfma_f32_16x16x32_bf16 v[96:99], v[196:199], a[112:115], v[96:99]
    v_mfma_f32_16x16x32_bf16 v[100:103], v[192:195], a[100:103], v[100:103]
    buffer_load_dwordx4 a[220:223], v219, s[48:51], s64 offen offset:1024 sc1
    v_mfma_f32_16x16x32_bf16 v[100:103], v[196:199], a[116:119], v[100:103]
    ds_read_b64_tr_b16 v[212:213], v236 offset:59392
    v_mfma_f32_16x16x32_bf16 v[104:107], v[192:195], a[104:107], v[104:107]
    v_mfma_f32_16x16x32_bf16 v[104:107], v[196:199], a[120:123], v[104:107]
    ds_read_b64_tr_b16 v[214:215], v236 offset:60416
    v_mfma_f32_16x16x32_bf16 v[108:111], v[192:195], a[108:111], v[108:111]
    v_mfma_f32_16x16x32_bf16 v[108:111], v[196:199], a[124:127], v[108:111]
    s_waitcnt lgkmcnt(4)
    ds_read_b64_tr_b16 v[192:193], v237 offset:57344
    v_mfma_f32_16x16x32_bf16 v[112:115], v[200:203], a[96:99], v[112:115]
    buffer_store_dwordx4 v[148:151], v245, s[48:51], s60 offen offset:3072 sc1
    v_mfma_f32_16x16x32_bf16 v[112:115], v[204:207], a[112:115], v[112:115]
    ds_read_b64_tr_b16 v[194:195], v237 offset:58368
    v_mfma_f32_16x16x32_bf16 v[116:119], v[200:203], a[100:103], v[116:119]
    v_mfma_f32_16x16x32_bf16 v[116:119], v[204:207], a[116:119], v[116:119]
    ds_read_b64_tr_b16 v[196:197], v237 offset:59392
    v_mfma_f32_16x16x32_bf16 v[120:123], v[200:203], a[104:107], v[120:123]
    v_mfma_f32_16x16x32_bf16 v[120:123], v[204:207], a[120:123], v[120:123]
    v_mfma_f32_16x16x32_bf16 v[124:127], v[200:203], a[108:111], v[124:127]
    ds_read_b64_tr_b16 v[198:199], v237 offset:60416
    v_mfma_f32_16x16x32_bf16 v[124:127], v[204:207], a[124:127], v[124:127]
    s_waitcnt vmcnt(35) lgkmcnt(4)
    buffer_load_dwordx4 a[224:227], v219, s[48:51], s61 offen offset:2048 sc1
    v_mfma_f32_16x16x32_bf16 v[0:3], v[208:211], a[128:131], v[0:3]
    s_mul_i32 s56, s85, 4096
    s_add_u32 s56, s56, 524288
    v_mfma_f32_16x16x32_bf16 v[0:3], v[212:215], a[144:147], v[0:3]
    s_add_u32 m0, s57, 32768
    ds_read_b64_tr_b16 v[200:201], v236 offset:61440
    ds_read_b64_tr_b16 v[202:203], v236 offset:62464
    v_mfma_f32_16x16x32_bf16 v[4:7], v[208:211], a[132:135], v[4:7]
    buffer_load_dwordx4 v239, s[12:15], s56 offen offset:0 sc1 lds
    v_mfma_f32_16x16x32_bf16 v[4:7], v[212:215], a[148:151], v[4:7]
    ds_read_b64_tr_b16 v[204:205], v236 offset:63488
    ds_read_b64_tr_b16 v[206:207], v236 offset:64512
    v_mfma_f32_16x16x32_bf16 v[8:11], v[208:211], a[136:139], v[8:11]
    v_mfma_f32_16x16x32_bf16 v[8:11], v[212:215], a[152:155], v[8:11]
    v_mfma_f32_16x16x32_bf16 v[12:15], v[208:211], a[140:143], v[12:15]
    buffer_load_dwordx4 v240, s[12:15], s56 offen offset:1024 sc1 lds
    v_mfma_f32_16x16x32_bf16 v[12:15], v[212:215], a[156:159], v[12:15]
    s_waitcnt lgkmcnt(4)
    v_mfma_f32_16x16x32_bf16 v[16:19], v[192:195], a[128:131], v[16:19]
    v_mfma_f32_16x16x32_bf16 v[16:19], v[196:199], a[144:147], v[16:19]
    ds_read_b64_tr_b16 v[208:209], v237 offset:61440
    ds_read_b64_tr_b16 v[210:211], v237 offset:62464
    v_mfma_f32_16x16x32_bf16 v[20:23], v[192:195], a[132:135], v[20:23]
    buffer_load_dwordx4 a[228:231], v219, s[48:51], s62 offen offset:2048 sc1
    v_mfma_f32_16x16x32_bf16 v[20:23], v[196:199], a[148:151], v[20:23]
    v_mfma_f32_16x16x32_bf16 v[24:27], v[192:195], a[136:139], v[24:27]
    ds_read_b64_tr_b16 v[212:213], v237 offset:63488
    v_mfma_f32_16x16x32_bf16 v[24:27], v[196:199], a[152:155], v[24:27]
    v_mfma_f32_16x16x32_bf16 v[28:31], v[192:195], a[140:143], v[28:31]
    ds_read_b64_tr_b16 v[214:215], v237 offset:64512
    v_mfma_f32_16x16x32_bf16 v[28:31], v[196:199], a[156:159], v[28:31]
    s_waitcnt lgkmcnt(4)
    v_mfma_f32_16x16x32_bf16 v[160:163], v[200:203], a[128:131], v[160:163]
    v_add_u32 v236, 0x10000, v236
    v_add_u32 v237, 0x10000, v237
    ds_read_b64_tr_b16 v[192:193], v236 offset:0
    v_mfma_f32_16x16x32_bf16 v[160:163], v[204:207], a[144:147], v[160:163]
    ds_read_b64_tr_b16 v[194:195], v236 offset:1024
    v_mfma_f32_16x16x32_bf16 v[164:167], v[200:203], a[132:135], v[164:167]
    buffer_store_dwordx4 v[156:159], v247, s[48:51], s60 offen offset:3072 sc1
    v_mfma_f32_16x16x32_bf16 v[164:167], v[204:207], a[148:151], v[164:167]
    v_mfma_f32_16x16x32_bf16 v[168:171], v[200:203], a[136:139], v[168:171]
    v_mfma_f32_16x16x32_bf16 v[168:171], v[204:207], a[152:155], v[168:171]
    ds_read_b64_tr_b16 v[196:197], v236 offset:2048
    ds_read_b64_tr_b16 v[198:199], v236 offset:3072
    v_mfma_f32_16x16x32_bf16 v[172:175], v[200:203], a[140:143], v[172:175]
    buffer_load_dwordx4 a[232:235], v219, s[48:51], s63 offen offset:2048 sc1
    v_mfma_f32_16x16x32_bf16 v[172:175], v[204:207], a[156:159], v[172:175]
    s_waitcnt lgkmcnt(4)
    ds_read_b64_tr_b16 v[200:201], v237 offset:0
    v_add_u32 v238, 0x10000, v238
    v_mfma_f32_16x16x32_bf16 v[176:179], v[208:211], a[128:131], v[176:179]
    v_mfma_f32_16x16x32_bf16 v[176:179], v[212:215], a[144:147], v[176:179]
    ds_read_b64_tr_b16 v[202:203], v237 offset:1024
    v_mfma_f32_16x16x32_bf16 v[180:183], v[208:211], a[132:135], v[180:183]
    v_mfma_f32_16x16x32_bf16 v[180:183], v[212:215], a[148:151], v[180:183]
    v_mfma_f32_16x16x32_bf16 v[184:187], v[208:211], a[136:139], v[184:187]
    v_mfma_f32_16x16x32_bf16 v[184:187], v[212:215], a[152:155], v[184:187]
    ds_read_b64_tr_b16 v[204:205], v237 offset:2048
    ds_read_b64_tr_b16 v[206:207], v237 offset:3072
    v_mfma_f32_16x16x32_bf16 v[188:191], v[208:211], a[140:143], v[188:191]
    buffer_load_dwordx4 a[236:239], v219, s[48:51], s64 offen offset:2048 sc1
    v_mfma_f32_16x16x32_bf16 v[188:191], v[212:215], a[156:159], v[188:191]
    s_waitcnt vmcnt(25) lgkmcnt(4)
    ds_read_b64_tr_b16 v[208:209], v236 offset:4096
    v_mfma_f32_16x16x32_bf16 v[0:3], v[192:195], a[160:163], v[0:3]
    v_mfma_f32_16x16x32_bf16 v[0:3], v[196:199], a[176:179], v[0:3]
    v_mfma_f32_16x16x32_bf16 v[4:7], v[192:195], a[164:167], v[4:7]
    ds_read_b64_tr_b16 v[210:211], v236 offset:5120
    v_mfma_f32_16x16x32_bf16 v[4:7], v[196:199], a[180:183], v[4:7]
    ds_read_b64_tr_b16 v[212:213], v236 offset:6144
    v_mfma_f32_16x16x32_bf16 v[8:11], v[192:195], a[168:171], v[8:11]
    ds_read_b64_tr_b16 v[214:215], v236 offset:7168
    v_mfma_f32_16x16x32_bf16 v[8:11], v[196:199], a[184:187], v[8:11]
    v_mfma_f32_16x16x32_bf16 v[12:15], v[192:195], a[172:175], v[12:15]
    v_mfma_f32_16x16x32_bf16 v[12:15], v[196:199], a[188:191], v[12:15]
    s_waitcnt lgkmcnt(4)
    ds_read_b64_tr_b16 v[192:193], v237 offset:4096
    ds_read_b64_tr_b16 v[194:195], v237 offset:5120
    v_mfma_f32_16x16x32_bf16 v[16:19], v[200:203], a[160:163], v[16:19]
    ds_read_b64_tr_b16 v[196:197], v237 offset:6144
    ds_read_b64_tr_b16 v[198:199], v237 offset:7168
    v_mfma_f32_16x16x32_bf16 v[16:19], v[204:207], a[176:179], v[16:19]
    buffer_load_dwordx4 a[240:243], v219, s[48:51], s61 offen offset:3072 sc1
    v_mfma_f32_16x16x32_bf16 v[20:23], v[200:203], a[164:167], v[20:23]
    v_mfma_f32_16x16x32_bf16 v[20:23], v[204:207], a[180:183], v[20:23]
    v_mfma_f32_16x16x32_bf16 v[24:27], v[200:203], a[168:171], v[24:27]
    v_mfma_f32_16x16x32_bf16 v[24:27], v[204:207], a[184:187], v[24:27]
    buffer_store_dwordx4 v[32:35], v246, s[48:51], s60 offen offset:0 sc1
    v_mfma_f32_16x16x32_bf16 v[28:31], v[200:203], a[172:175], v[28:31]
    v_mfma_f32_16x16x32_bf16 v[28:31], v[204:207], a[188:191], v[28:31]
    s_waitcnt lgkmcnt(4)
    v_mfma_f32_16x16x32_bf16 v[160:163], v[208:211], a[160:163], v[160:163]
    v_mfma_f32_16x16x32_bf16 v[160:163], v[212:215], a[176:179], v[160:163]
    buffer_load_dwordx4 a[244:247], v219, s[48:51], s62 offen offset:3072 sc1
    v_mfma_f32_16x16x32_bf16 v[164:167], v[208:211], a[164:167], v[164:167]
    s_waitcnt lgkmcnt(0)
    s_barrier
    v_mfma_f32_16x16x32_bf16 v[164:167], v[212:215], a[180:183], v[164:167]
    s_mul_i32 s56, s80, 4096
    ds_read_b64_tr_b16 v[200:201], v238 offset:8192
    ds_read_b64_tr_b16 v[202:203], v238 offset:8704
    v_mfma_f32_16x16x32_bf16 v[168:171], v[208:211], a[168:171], v[168:171]
    s_add_u32 s56, s56, 128
    ds_read_b64_tr_b16 v[204:205], v238 offset:9216
    ds_read_b64_tr_b16 v[206:207], v238 offset:9728
    v_mfma_f32_16x16x32_bf16 v[168:171], v[212:215], a[184:187], v[168:171]
    s_add_u32 m0, s57, 40960
    v_mfma_f32_16x16x32_bf16 v[172:175], v[208:211], a[172:175], v[172:175]
    buffer_load_dwordx4 v239, s[12:15], s56 offen offset:0 sc1 lds
    v_mfma_f32_16x16x32_bf16 v[172:175], v[212:215], a[188:191], v[172:175]
    ds_read_b64_tr_b16 v[208:209], v238 offset:12288
    v_mfma_f32_16x16x32_bf16 v[176:179], v[192:195], a[160:163], v[176:179]
    v_subrev_u32 v236, 0x10000, v236
    v_mfma_f32_16x16x32_bf16 v[176:179], v[196:199], a[176:179], v[176:179]
    ds_read_b64_tr_b16 v[210:211], v238 offset:12800
    v_mfma_f32_16x16x32_bf16 v[180:183], v[192:195], a[164:167], v[180:183]
    buffer_load_dwordx4 v240, s[12:15], s56 offen offset:1024 sc1 lds
    v_mfma_f32_16x16x32_bf16 v[180:183], v[196:199], a[180:183], v[180:183]
    v_mfma_f32_16x16x32_bf16 v[184:187], v[192:195], a[168:171], v[184:187]
    v_mfma_f32_16x16x32_bf16 v[184:187], v[196:199], a[184:187], v[184:187]
    ds_read_b64_tr_b16 v[212:213], v238 offset:13312
    ds_read_b64_tr_b16 v[214:215], v238 offset:13824
    v_mfma_f32_16x16x32_bf16 v[188:191], v[192:195], a[172:175], v[188:191]
    v_mfma_f32_16x16x32_bf16 v[188:191], v[196:199], a[188:191], v[188:191]
    s_waitcnt lgkmcnt(4)
    ds_read_b64_tr_b16 v[192:193], v238 offset:10240
    v_mfma_f32_16x16x32_bf16 v[96:99], v[200:203], a[128:131], v[96:99]
    buffer_load_dwordx4 a[248:251], v219, s[48:51], s63 offen offset:3072 sc1
    v_mfma_f32_16x16x32_bf16 v[96:99], v[204:207], a[144:147], v[96:99]
    ds_read_b64_tr_b16 v[194:195], v238 offset:10752
    v_mfma_f32_16x16x32_bf16 v[100:103], v[200:203], a[132:135], v[100:103]
    ds_read_b64_tr_b16 v[196:197], v238 offset:11264
    v_mfma_f32_16x16x32_bf16 v[100:103], v[204:207], a[148:151], v[100:103]
    v_subrev_u32 v237, 0x10000, v237
    v_mfma_f32_16x16x32_bf16 v[104:107], v[200:203], a[136:139], v[104:107]
    buffer_load_dwordx4 a[252:255], v219, s[48:51], s64 offen offset:3072 sc1
    v_mfma_f32_16x16x32_bf16 v[104:107], v[204:207], a[152:155], v[104:107]
    ds_read_b64_tr_b16 v[198:199], v238 offset:11776
    v_mfma_f32_16x16x32_bf16 v[108:111], v[200:203], a[140:143], v[108:111]
    v_mfma_f32_16x16x32_bf16 v[108:111], v[204:207], a[156:159], v[108:111]
    s_waitcnt lgkmcnt(4)
    v_mfma_f32_16x16x32_bf16 v[112:115], v[208:211], a[128:131], v[112:115]
    buffer_store_dwordx4 v[40:43], v248, s[48:51], s60 offen offset:0 sc1
    v_mfma_f32_16x16x32_bf16 v[112:115], v[212:215], a[144:147], v[112:115]
    s_mul_i32 s56, s80, 4096
    v_mfma_f32_16x16x32_bf16 v[116:119], v[208:211], a[132:135], v[116:119]
    s_add_u32 s56, s56, 524416
    s_add_u32 m0, s57, 49152
    ds_read_b64_tr_b16 v[200:201], v238 offset:14336
    v_mfma_f32_16x16x32_bf16 v[116:119], v[212:215], a[148:151], v[116:119]
    ds_read_b64_tr_b16 v[202:203], v238 offset:14848
    ds_read_b64_tr_b16 v[204:205], v238 offset:15360
    v_mfma_f32_16x16x32_bf16 v[120:123], v[208:211], a[136:139], v[120:123]
    buffer_load_dwordx4 v239, s[12:15], s56 offen offset:0 sc1 lds
    v_mfma_f32_16x16x32_bf16 v[120:123], v[212:215], a[152:155], v[120:123]
    ds_read_b64_tr_b16 v[206:207], v238 offset:15872
    v_mfma_f32_16x16x32_bf16 v[124:127], v[208:211], a[140:143], v[124:127]
    v_mfma_f32_16x16x32_bf16 v[124:127], v[212:215], a[156:159], v[124:127]
    s_waitcnt lgkmcnt(4)
    v_mfma_f32_16x16x32_bf16 v[96:99], v[192:195], a[160:163], v[96:99]
    v_mfma_f32_16x16x32_bf16 v[96:99], v[196:199], a[176:179], v[96:99]
    ds_read_b64_tr_b16 v[208:209], v236 offset:16384
    ds_read_b64_tr_b16 v[210:211], v236 offset:17408
    v_mfma_f32_16x16x32_bf16 v[100:103], v[192:195], a[164:167], v[100:103]
    buffer_load_dwordx4 v240, s[12:15], s56 offen offset:1024 sc1 lds
    v_mfma_f32_16x16x32_bf16 v[100:103], v[196:199], a[180:183], v[100:103]
    ds_read_b64_tr_b16 v[212:213], v236 offset:18432
    v_mfma_f32_16x16x32_bf16 v[104:107], v[192:195], a[168:171], v[104:107]
    ds_read_b64_tr_b16 v[214:215], v236 offset:19456
    v_mfma_f32_16x16x32_bf16 v[104:107], v[196:199], a[184:187], v[104:107]
    v_mfma_f32_16x16x32_bf16 v[108:111], v[192:195], a[172:175], v[108:111]
    v_mfma_f32_16x16x32_bf16 v[108:111], v[196:199], a[188:191], v[108:111]
    s_waitcnt lgkmcnt(4)
    ds_read_b64_tr_b16 v[192:193], v237 offset:16384
    v_mfma_f32_16x16x32_bf16 v[112:115], v[200:203], a[160:163], v[112:115]
    ds_read_b64_tr_b16 v[194:195], v237 offset:17408
    v_mfma_f32_16x16x32_bf16 v[112:115], v[204:207], a[176:179], v[112:115]
    v_mfma_f32_16x16x32_bf16 v[116:119], v[200:203], a[164:167], v[116:119]
    v_mfma_f32_16x16x32_bf16 v[116:119], v[204:207], a[180:183], v[116:119]
    ds_read_b64_tr_b16 v[196:197], v237 offset:18432
    v_mfma_f32_16x16x32_bf16 v[120:123], v[200:203], a[168:171], v[120:123]
    v_mfma_f32_16x16x32_bf16 v[120:123], v[204:207], a[184:187], v[120:123]
    v_mfma_f32_16x16x32_bf16 v[124:127], v[200:203], a[172:175], v[124:127]
    ds_read_b64_tr_b16 v[198:199], v237 offset:19456
    v_mfma_f32_16x16x32_bf16 v[124:127], v[204:207], a[188:191], v[124:127]
    s_waitcnt vmcnt(18) lgkmcnt(4)
    s_mul_i32 s56, s81, 4096
    v_mfma_f32_16x16x32_bf16 v[0:3], v[208:211], a[192:195], v[0:3]
    s_add_u32 s56, s56, 128
    s_add_u32 m0, s57, 57344
    v_mfma_f32_16x16x32_bf16 v[0:3], v[212:215], a[208:211], v[0:3]
    ds_read_b64_tr_b16 v[200:201], v236 offset:20480
    v_mfma_f32_16x16x32_bf16 v[4:7], v[208:211], a[196:199], v[4:7]
    buffer_load_dwordx4 v239, s[12:15], s56 offen offset:0 sc1 lds
    v_mfma_f32_16x16x32_bf16 v[4:7], v[212:215], a[212:215], v[4:7]
    ds_read_b64_tr_b16 v[202:203], v236 offset:21504
    v_mfma_f32_16x16x32_bf16 v[8:11], v[208:211], a[200:203], v[8:11]
    v_mfma_f32_16x16x32_bf16 v[8:11], v[212:215], a[216:219], v[8:11]
    ds_read_b64_tr_b16 v[204:205], v236 offset:22528
    ds_read_b64_tr_b16 v[206:207], v236 offset:23552
    v_mfma_f32_16x16x32_bf16 v[12:15], v[208:211], a[204:207], v[12:15]
    buffer_load_dwordx4 v240, s[12:15], s56 offen offset:1024 sc1 lds
    v_mfma_f32_16x16x32_bf16 v[12:15], v[212:215], a[220:223], v[12:15]
    s_waitcnt lgkmcnt(4)
    v_mfma_f32_16x16x32_bf16 v[16:19], v[192:195], a[192:195], v[16:19]
    ds_read_b64_tr_b16 v[208:209], v237 offset:20480
    ds_read_b64_tr_b16 v[210:211], v237 offset:21504
    v_mfma_f32_16x16x32_bf16 v[16:19], v[196:199], a[208:211], v[16:19]
    v_mfma_f32_16x16x32_bf16 v[20:23], v[192:195], a[196:199], v[20:23]
    buffer_store_dwordx4 v[48:51], v246, s[48:51], s60 offen offset:1024 sc1
    v_mfma_f32_16x16x32_bf16 v[20:23], v[196:199], a[212:215], v[20:23]
    ds_read_b64_tr_b16 v[212:213], v237 offset:22528
    v_mfma_f32_16x16x32_bf16 v[24:27], v[192:195], a[200:203], v[24:27]
    v_mfma_f32_16x16x32_bf16 v[24:27], v[196:199], a[216:219], v[24:27]
    v_mfma_f32_16x16x32_bf16 v[28:31], v[192:195], a[204:207], v[28:31]
    ds_read_b64_tr_b16 v[214:215], v237 offset:23552
    v_mfma_f32_16x16x32_bf16 v[28:31], v[196:199], a[220:223], v[28:31]
    s_waitcnt lgkmcnt(4)
    ds_read_b64_tr_b16 v[192:193], v236 offset:24576
    v_mfma_f32_16x16x32_bf16 v[160:163], v[200:203], a[192:195], v[160:163]
    v_mfma_f32_16x16x32_bf16 v[160:163], v[204:207], a[208:211], v[160:163]
    ds_read_b64_tr_b16 v[194:195], v236 offset:25600
    v_mfma_f32_16x16x32_bf16 v[164:167], v[200:203], a[196:199], v[164:167]
    v_mfma_f32_16x16x32_bf16 v[164:167], v[204:207], a[212:215], v[164:167]
    ds_read_b64_tr_b16 v[196:197], v236 offset:26624
    v_mfma_f32_16x16x32_bf16 v[168:171], v[200:203], a[200:203], v[168:171]
    v_mfma_f32_16x16x32_bf16 v[168:171], v[204:207], a[216:219], v[168:171]
    v_mfma_f32_16x16x32_bf16 v[172:175], v[200:203], a[204:207], v[172:175]
    ds_read_b64_tr_b16 v[198:199], v236 offset:27648
    v_mfma_f32_16x16x32_bf16 v[172:175], v[204:207], a[220:223], v[172:175]
    s_waitcnt lgkmcnt(4)
    v_mfma_f32_16x16x32_bf16 v[176:179], v[208:211], a[192:195], v[176:179]
    ds_read_b64_tr_b16 v[200:201], v237 offset:24576
    v_mfma_f32_16x16x32_bf16 v[176:179], v[212:215], a[208:211], v[176:179]
    ds_read_b64_tr_b16 v[202:203], v237 offset:25600
    ds_read_b64_tr_b16 v[204:205], v237 offset:26624
    v_mfma_f32_16x16x32_bf16 v[180:183], v[208:211], a[196:199], v[180:183]
    v_mfma_f32_16x16x32_bf16 v[180:183], v[212:215], a[212:215], v[180:183]
    v_mfma_f32_16x16x32_bf16 v[184:187], v[208:211], a[200:203], v[184:187]
    ds_read_b64_tr_b16 v[206:207], v237 offset:27648
    v_mfma_f32_16x16x32_bf16 v[184:187], v[212:215], a[216:219], v[184:187]
    v_mfma_f32_16x16x32_bf16 v[188:191], v[208:211], a[204:207], v[188:191]
    v_mfma_f32_16x16x32_bf16 v[188:191], v[212:215], a[220:223], v[188:191]
    s_waitcnt vmcnt(6) lgkmcnt(4)
    s_mul_i32 s56, s81, 4096
    v_mfma_f32_16x16x32_bf16 v[0:3], v[192:195], a[224:227], v[0:3]
    s_add_u32 s56, s56, 524416
    s_add_u32 m0, s57, 65536
    v_mfma_f32_16x16x32_bf16 v[0:3], v[196:199], a[240:243], v[0:3]
    ds_read_b64_tr_b16 v[208:209], v236 offset:28672
    v_mfma_f32_16x16x32_bf16 v[4:7], v[192:195], a[228:231], v[4:7]
    buffer_load_dwordx4 v239, s[12:15], s56 offen offset:0 sc1 lds
    v_mfma_f32_16x16x32_bf16 v[4:7], v[196:199], a[244:247], v[4:7]
    ds_read_b64_tr_b16 v[210:211], v236 offset:29696
    ds_read_b64_tr_b16 v[212:213], v236 offset:30720
    v_mfma_f32_16x16x32_bf16 v[8:11], v[192:195], a[232:235], v[8:11]
    v_mfma_f32_16x16x32_bf16 v[8:11], v[196:199], a[248:251], v[8:11]
    ds_read_b64_tr_b16 v[214:215], v236 offset:31744
    v_mfma_f32_16x16x32_bf16 v[12:15], v[192:195], a[236:239], v[12:15]
    buffer_load_dwordx4 v240, s[12:15], s56 offen offset:1024 sc1 lds
    v_mfma_f32_16x16x32_bf16 v[12:15], v[196:199], a[252:255], v[12:15]
    s_waitcnt lgkmcnt(4)
    ds_read_b64_tr_b16 v[192:193], v237 offset:28672
    v_mfma_f32_16x16x32_bf16 v[16:19], v[200:203], a[224:227], v[16:19]
    v_mfma_f32_16x16x32_bf16 v[16:19], v[204:207], a[240:243], v[16:19]
    ds_read_b64_tr_b16 v[194:195], v237 offset:29696
    v_mfma_f32_16x16x32_bf16 v[20:23], v[200:203], a[228:231], v[20:23]
    buffer_store_dwordx4 v[56:59], v248, s[48:51], s60 offen offset:1024 sc1
    v_mfma_f32_16x16x32_bf16 v[20:23], v[204:207], a[244:247], v[20:23]
    v_mfma_f32_16x16x32_bf16 v[24:27], v[200:203], a[232:235], v[24:27]
    ds_read_b64_tr_b16 v[196:197], v237 offset:30720
    ds_read_b64_tr_b16 v[198:199], v237 offset:31744
    v_mfma_f32_16x16x32_bf16 v[24:27], v[204:207], a[248:251], v[24:27]
    v_mfma_f32_16x16x32_bf16 v[28:31], v[200:203], a[236:239], v[28:31]
    v_mfma_f32_16x16x32_bf16 v[28:31], v[204:207], a[252:255], v[28:31]
    s_waitcnt lgkmcnt(4)
    v_mfma_f32_16x16x32_bf16 v[160:163], v[208:211], a[224:227], v[160:163]
    ds_read_b64_tr_b16 v[200:201], v238 offset:16384
    v_mfma_f32_16x16x32_bf16 v[160:163], v[212:215], a[240:243], v[160:163]
    ds_read_b64_tr_b16 v[202:203], v238 offset:16896
    v_mfma_f32_16x16x32_bf16 v[164:167], v[208:211], a[228:231], v[164:167]
    v_mfma_f32_16x16x32_bf16 v[164:167], v[212:215], a[244:247], v[164:167]
    v_mfma_f32_16x16x32_bf16 v[168:171], v[208:211], a[232:235], v[168:171]
    v_mfma_f32_16x16x32_bf16 v[168:171], v[212:215], a[248:251], v[168:171]
    ds_read_b64_tr_b16 v[204:205], v238 offset:17408
    ds_read_b64_tr_b16 v[206:207], v238 offset:17920
    v_mfma_f32_16x16x32_bf16 v[172:175], v[208:211], a[236:239], v[172:175]
    v_mfma_f32_16x16x32_bf16 v[172:175], v[212:215], a[252:255], v[172:175]
    s_waitcnt lgkmcnt(4)
    v_mfma_f32_16x16x32_bf16 v[176:179], v[192:195], a[224:227], v[176:179]
    ds_read_b64_tr_b16 v[208:209], v238 offset:20480
    ds_read_b64_tr_b16 v[210:211], v238 offset:20992
    v_mfma_f32_16x16x32_bf16 v[176:179], v[196:199], a[240:243], v[176:179]
    v_mfma_f32_16x16x32_bf16 v[180:183], v[192:195], a[228:231], v[180:183]
    buffer_store_dwordx4 v[36:39], v246, s[48:51], s60 offen offset:2048 sc1
    v_mfma_f32_16x16x32_bf16 v[180:183], v[196:199], a[244:247], v[180:183]
    ds_read_b64_tr_b16 v[212:213], v238 offset:21504
    v_mfma_f32_16x16x32_bf16 v[184:187], v[192:195], a[232:235], v[184:187]
    v_mfma_f32_16x16x32_bf16 v[184:187], v[196:199], a[248:251], v[184:187]
    ds_read_b64_tr_b16 v[214:215], v238 offset:22016
    v_mfma_f32_16x16x32_bf16 v[188:191], v[192:195], a[236:239], v[188:191]
    v_mfma_f32_16x16x32_bf16 v[188:191], v[196:199], a[252:255], v[188:191]
    s_waitcnt lgkmcnt(4)
    ds_read_b64_tr_b16 v[192:193], v238 offset:18432
    ds_read_b64_tr_b16 v[194:195], v238 offset:18944
    v_mfma_f32_16x16x32_bf16 v[96:99], v[200:203], a[192:195], v[96:99]
    v_mfma_f32_16x16x32_bf16 v[96:99], v[204:207], a[208:211], v[96:99]
    v_mfma_f32_16x16x32_bf16 v[100:103], v[200:203], a[196:199], v[100:103]
    ds_read_b64_tr_b16 v[196:197], v238 offset:19456
    v_mfma_f32_16x16x32_bf16 v[100:103], v[204:207], a[212:215], v[100:103]
    ds_read_b64_tr_b16 v[198:199], v238 offset:19968
    v_mfma_f32_16x16x32_bf16 v[104:107], v[200:203], a[200:203], v[104:107]
    v_mfma_f32_16x16x32_bf16 v[104:107], v[204:207], a[216:219], v[104:107]
    v_mfma_f32_16x16x32_bf16 v[108:111], v[200:203], a[204:207], v[108:111]
    v_mfma_f32_16x16x32_bf16 v[108:111], v[204:207], a[220:223], v[108:111]
    s_waitcnt lgkmcnt(4)
    ds_read_b64_tr_b16 v[200:201], v238 offset:22528
    ds_read_b64_tr_b16 v[202:203], v238 offset:23040
    v_mfma_f32_16x16x32_bf16 v[112:115], v[208:211], a[192:195], v[112:115]
    ds_read_b64_tr_b16 v[204:205], v238 offset:23552
    v_mfma_f32_16x16x32_bf16 v[112:115], v[212:215], a[208:211], v[112:115]
    v_mul_f32 v228, v0, v0
    v_mfma_f32_16x16x32_bf16 v[116:119], v[208:211], a[196:199], v[116:119]
    ds_read_b64_tr_b16 v[206:207], v238 offset:24064
    v_mul_f32 v229, v1, v1
    v_mfma_f32_16x16x32_bf16 v[116:119], v[212:215], a[212:215], v[116:119]
    v_mul_f32 v224, v16, v16
    v_mfma_f32_16x16x32_bf16 v[120:123], v[208:211], a[200:203], v[120:123]
    v_fmaak_f32 v228, v228, v230, 0xc0135761
    v_mfma_f32_16x16x32_bf16 v[120:123], v[212:215], a[216:219], v[120:123]
    v_mul_f32 v225, v17, v17
    v_mfma_f32_16x16x32_bf16 v[124:127], v[208:211], a[204:207], v[124:127]
    v_fmaak_f32 v229, v229, v230, 0xc0135761
    v_mfma_f32_16x16x32_bf16 v[124:127], v[212:215], a[220:223], v[124:127]
    s_waitcnt lgkmcnt(4)
    v_fmaak_f32 v224, v224, v230, 0xc0135761
    v_mfma_f32_16x16x32_bf16 v[96:99], v[192:195], a[224:227], v[96:99]
    v_mul_f32 v228, v228, v0
    v_mfma_f32_16x16x32_bf16 v[96:99], v[196:199], a[240:243], v[96:99]
    v_fmaak_f32 v225, v225, v230, 0xc0135761
    v_mfma_f32_16x16x32_bf16 v[100:103], v[192:195], a[228:231], v[100:103]
    s_waitcnt lgkmcnt(0)
    s_barrier
    v_mul_f32 v229, v229, v1
    v_mfma_f32_16x16x32_bf16 v[100:103], v[196:199], a[244:247], v[100:103]
    s_mul_i32 s56, s82, 4096
    ds_read_b64_tr_b16 v[208:209], v232 offset:24576
    ds_read_b64_tr_b16 v[210:211], v232 offset:26624
    v_mfma_f32_16x16x32_bf16 v[104:107], v[192:195], a[232:235], v[104:107]
    s_add_u32 s56, s56, 128
    s_add_u32 m0, s57, 16384
    ds_read_b64_tr_b16 v[212:213], v232 offset:28672
    v_mfma_f32_16x16x32_bf16 v[104:107], v[196:199], a[248:251], v[104:107]
    ds_read_b64_tr_b16 v[214:215], v232 offset:30720
    v_mfma_f32_16x16x32_bf16 v[108:111], v[192:195], a[236:239], v[108:111]
    buffer_load_dwordx4 v239, s[12:15], s56 offen offset:0 sc1 lds
    v_mfma_f32_16x16x32_bf16 v[108:111], v[196:199], a[252:255], v[108:111]
    ds_read_b64_tr_b16 v[192:193], v233 offset:24576
    v_mul_f32 v224, v224, v16
    v_mfma_f32_16x16x32_bf16 v[112:115], v[200:203], a[224:227], v[112:115]
    v_exp_f32 v228, v228
    v_mfma_f32_16x16x32_bf16 v[112:115], v[204:207], a[240:243], v[112:115]
    ds_read_b64_tr_b16 v[194:195], v233 offset:26624
    v_mul_f32 v225, v225, v17
    v_mfma_f32_16x16x32_bf16 v[116:119], v[200:203], a[228:231], v[116:119]
    buffer_load_dwordx4 v240, s[12:15], s56 offen offset:1024 sc1 lds
    v_mfma_f32_16x16x32_bf16 v[116:119], v[204:207], a[244:247], v[116:119]
    ds_read_b64_tr_b16 v[196:197], v233 offset:28672
    v_exp_f32 v224, v224
    v_mfma_f32_16x16x32_bf16 v[120:123], v[200:203], a[232:235], v[120:123]
    v_exp_f32 v229, v229
    v_mfma_f32_16x16x32_bf16 v[120:123], v[204:207], a[248:251], v[120:123]
    ds_read_b64_tr_b16 v[198:199], v233 offset:30720
    v_mul_f32 v0, v0, v160
    v_mfma_f32_16x16x32_bf16 v[124:127], v[200:203], a[236:239], v[124:127]
    v_mul_f32 v1, v1, v161
    v_exp_f32 v225, v225
    v_mfma_f32_16x16x32_bf16 v[124:127], v[204:207], a[252:255], v[124:127]
    s_waitcnt lgkmcnt(4)
    ds_read_b64_tr_b16 v[200:201], v234 offset:24576
    v_add_f32 v228, 1.0, v228
    v_mfma_f32_16x16x32_bf16 v[64:67], v[208:211], a[0:3], 0
    buffer_store_dwordx4 v[44:47], v248, s[48:51], s60 offen offset:2048 sc1
    v_mul_f32 v16, v16, v176
    v_mfma_f32_16x16x32_bf16 v[64:67], v[212:215], a[16:19], v[64:67]
    ds_read_b64_tr_b16 v[202:203], v234 offset:26624
    v_add_f32 v229, 1.0, v229
    v_mfma_f32_16x16x32_bf16 v[68:71], v[208:211], a[4:7], 0
    v_rcp_f32 v228, v228
    v_mfma_f32_16x16x32_bf16 v[68:71], v[212:215], a[20:23], v[68:71]
    ds_read_b64_tr_b16 v[204:205], v234 offset:28672
    v_mul_f32 v17, v17, v177
    v_mfma_f32_16x16x32_bf16 v[72:75], v[208:211], a[8:11], 0
    v_rcp_f32 v229, v229
    v_mfma_f32_16x16x32_bf16 v[72:75], v[212:215], a[24:27], v[72:75]
    ds_read_b64_tr_b16 v[206:207], v234 offset:30720
    v_mul_f32 v0, v0, v228
    v_mfma_f32_16x16x32_bf16 v[76:79], v[208:211], a[12:15], 0
    v_mul_f32 v1, v1, v229
    v_mfma_f32_16x16x32_bf16 v[76:79], v[212:215], a[28:31], v[76:79]
    s_waitcnt lgkmcnt(4)
    ds_read_b64_tr_b16 v[208:209], v235 offset:24576
    v_add_f32 v224, 1.0, v224
    v_mfma_f32_16x16x32_bf16 v[80:83], v[192:195], a[0:3], 0
    v_mul_f32 v228, v2, v2
    v_mfma_f32_16x16x32_bf16 v[80:83], v[196:199], a[16:19], v[80:83]
    s_mul_i32 s56, s82, 4096
    ds_read_b64_tr_b16 v[210:211], v235 offset:26624
    v_add_f32 v225, 1.0, v225
    v_mfma_f32_16x16x32_bf16 v[84:87], v[192:195], a[4:7], 0
    s_add_u32 s56, s56, 524416
    s_add_u32 m0, s57, 24576
    v_mul_f32 v229, v3, v3
    v_mfma_f32_16x16x32_bf16 v[84:87], v[196:199], a[20:23], v[84:87]
    ds_read_b64_tr_b16 v[212:213], v235 offset:28672
    v_fmaak_f32 v228, v228, v230, 0xc0135761
    v_mfma_f32_16x16x32_bf16 v[88:91], v[192:195], a[8:11], 0
    buffer_load_dwordx4 v239, s[12:15], s56 offen offset:0 sc1 lds
    v_mfma_f32_16x16x32_bf16 v[88:91], v[196:199], a[24:27], v[88:91]
    ds_read_b64_tr_b16 v[214:215], v235 offset:30720
    v_fmaak_f32 v229, v229, v230, 0xc0135761
    v_mfma_f32_16x16x32_bf16 v[92:95], v[192:195], a[12:15], 0
    v_rcp_f32 v224, v224
    v_mfma_f32_16x16x32_bf16 v[92:95], v[196:199], a[28:31], v[92:95]
    s_waitcnt lgkmcnt(4)
    ds_read_b64_tr_b16 v[192:193], v232 offset:32768
    v_mul_f32 v228, v228, v2
    v_mfma_f32_16x16x32_bf16 v[128:131], v[200:203], a[0:3], 0
    buffer_load_dwordx4 v240, s[12:15], s56 offen offset:1024 sc1 lds
    v_mfma_f32_16x16x32_bf16 v[128:131], v[204:207], a[16:19], v[128:131]
    ds_read_b64_tr_b16 v[194:195], v232 offset:34816
    v_mul_f32 v229, v229, v3
    v_mfma_f32_16x16x32_bf16 v[132:135], v[200:203], a[4:7], 0
    v_exp_f32 v228, v228
    v_mfma_f32_16x16x32_bf16 v[132:135], v[204:207], a[20:23], v[132:135]
    ds_read_b64_tr_b16 v[196:197], v232 offset:36864
    v_rcp_f32 v225, v225
    v_mfma_f32_16x16x32_bf16 v[136:139], v[200:203], a[8:11], 0
    buffer_store_dwordx4 v[52:55], v246, s[48:51], s60 offen offset:3072 sc1
    v_mfma_f32_16x16x32_bf16 v[136:139], v[204:207], a[24:27], v[136:139]
    ds_read_b64_tr_b16 v[198:199], v232 offset:38912
    v_mul_f32 v16, v16, v224
    v_mfma_f32_16x16x32_bf16 v[140:143], v[200:203], a[12:15], 0
    v_exp_f32 v229, v229
    v_mfma_f32_16x16x32_bf16 v[140:143], v[204:207], a[28:31], v[140:143]
    s_waitcnt lgkmcnt(4)
    ds_read_b64_tr_b16 v[200:201], v233 offset:32768
    v_mul_f32 v2, v2, v162
    v_mfma_f32_16x16x32_bf16 v[144:147], v[208:211], a[0:3], 0
    v_mul_f32 v17, v17, v225
    v_mov_b32 v220, -1
    v_mov_b32 v221, -1
    v_mfma_f32_16x16x32_bf16 v[144:147], v[212:215], a[16:19], v[144:147]
    ds_read_b64_tr_b16 v[202:203], v233 offset:34816
    v_mul_f32 v3, v3, v163
    v_mfma_f32_16x16x32_bf16 v[148:151], v[208:211], a[4:7], 0
    v_mul_f32 v224, v18, v18
    v_mov_b32 v222, -1
    v_mfma_f32_16x16x32_bf16 v[148:151], v[212:215], a[20:23], v[148:151]
    ds_read_b64_tr_b16 v[204:205], v233 offset:36864
    v_add_f32 v228, 1.0, v228
    v_mfma_f32_16x16x32_bf16 v[152:155], v[208:211], a[8:11], 0
    v_mul_f32 v225, v19, v19
    v_mov_b32 v223, -1
    v_mfma_f32_16x16x32_bf16 v[152:155], v[212:215], a[24:27], v[152:155]
    ds_read_b64_tr_b16 v[206:207], v233 offset:38912
    v_add_f32 v229, 1.0, v229
    v_mfma_f32_16x16x32_bf16 v[156:159], v[208:211], a[12:15], 0
    v_rcp_f32 v228, v228
    v_mfma_f32_16x16x32_bf16 v[156:159], v[212:215], a[28:31], v[156:159]
    s_waitcnt lgkmcnt(4)
    s_mul_i32 s56, s85, 4096
    ds_read_b64_tr_b16 v[208:209], v234 offset:32768
    v_mfma_f32_16x16x32_bf16 v[64:67], v[192:195], a[32:35], v[64:67]
    s_add_u32 s56, s56, 128
    s_add_u32 m0, s57, 73728
    v_fmaak_f32 v224, v224, v230, 0xc0135761
    v_mfma_f32_16x16x32_bf16 v[64:67], v[196:199], a[48:51], v[64:67]
    s_bfe_u32 s73, s55, 0x10002
    ds_read_b64_tr_b16 v[210:211], v234 offset:34816
    v_fmaak_f32 v225, v225, v230, 0xc0135761
    v_mfma_f32_16x16x32_bf16 v[68:71], v[192:195], a[36:39], v[68:71]
    buffer_load_dwordx4 v239, s[12:15], s56 offen offset:0 sc1 lds
    v_mfma_f32_16x16x32_bf16 v[68:71], v[196:199], a[52:55], v[68:71]
    ds_read_b64_tr_b16 v[212:213], v234 offset:36864
    v_mul_f32 v224, v224, v18
    v_mul_f32 v225, v225, v19
    v_mul_f32 v18, v18, v178
    v_mul_f32 v19, v19, v179
    v_exp_f32 v224, v224
    s_nop 0
    v_add_f32 v224, 1.0, v224
    v_exp_f32 v225, v225
    s_nop 0
    v_add_f32 v225, 1.0, v225
    v_rcp_f32 v224, v224
    v_mfma_f32_16x16x32_bf16 v[72:75], v[192:195], a[40:43], v[72:75]
    s_lshl_b32 s73, s73, 5
    v_rcp_f32 v229, v229
    v_rcp_f32 v225, v225
    v_mfma_f32_16x16x32_bf16 v[72:75], v[196:199], a[56:59], v[72:75]
    ds_read_b64_tr_b16 v[214:215], v234 offset:38912
    v_mul_f32 v2, v2, v228
    v_mul_f32 v18, v18, v224
    v_mul_f32 v19, v19, v225
    v_mfma_f32_16x16x32_bf16 v[76:79], v[192:195], a[44:47], v[76:79]
    buffer_load_dwordx4 v240, s[12:15], s56 offen offset:1024 sc1 lds
    v_mul_f32 v3, v3, v229
    v_mfma_f32_16x16x32_bf16 v[76:79], v[196:199], a[60:63], v[76:79]
    s_waitcnt lgkmcnt(4)
    ds_read_b64_tr_b16 v[192:193], v235 offset:32768
    v_cvt_pk_bf16_f32 v0, v0, v1
    v_mfma_f32_16x16x32_bf16 v[80:83], v[200:203], a[32:35], v[80:83]
    v_mul_f32 v228, v4, v4
    v_mul_f32 v224, v20, v20
    v_mfma_f32_16x16x32_bf16 v[80:83], v[204:207], a[48:51], v[80:83]
    ds_read_b64_tr_b16 v[194:195], v235 offset:34816
    v_cvt_pk_bf16_f32 v1, v2, v3
    v_mfma_f32_16x16x32_bf16 v[84:87], v[200:203], a[36:39], v[84:87]
    v_mul_f32 v229, v5, v5
    v_mul_f32 v225, v21, v21
    v_mfma_f32_16x16x32_bf16 v[84:87], v[204:207], a[52:55], v[84:87]
    s_lshr_b32 s74, s55, 3
    ds_read_b64_tr_b16 v[196:197], v235 offset:36864
    v_cvt_pk_bf16_f32 v2, v16, v17
    v_mfma_f32_16x16x32_bf16 v[88:91], v[200:203], a[40:43], v[88:91]
    buffer_store_dwordx4 v[60:63], v248, s[48:51], s60 offen offset:3072 sc1
    v_mfma_f32_16x16x32_bf16 v[88:91], v[204:207], a[56:59], v[88:91]
    s_add_u32 s73, s73, s74
    ds_read_b64_tr_b16 v[198:199], v235 offset:38912
    v_fmaak_f32 v228, v228, v230, 0xc0135761
    v_mfma_f32_16x16x32_bf16 v[92:95], v[200:203], a[44:47], v[92:95]
    v_fmaak_f32 v229, v229, v230, 0xc0135761
    v_fmaak_f32 v224, v224, v230, 0xc0135761
    v_mfma_f32_16x16x32_bf16 v[92:95], v[204:207], a[60:63], v[92:95]
    s_waitcnt lgkmcnt(4)
    ds_read_b64_tr_b16 v[200:201], v232 offset:40960
    v_cvt_pk_bf16_f32 v3, v18, v19
    v_mfma_f32_16x16x32_bf16 v[128:131], v[208:211], a[32:35], v[128:131]
    v_mul_f32 v228, v228, v4
    v_mfma_f32_16x16x32_bf16 v[128:131], v[212:215], a[48:51], v[128:131]
    s_mul_i32 s73, s73, 98304
    ds_read_b64_tr_b16 v[202:203], v232 offset:43008
    v_mul_f32 v229, v229, v5
    v_mfma_f32_16x16x32_bf16 v[132:135], v[208:211], a[36:39], v[132:135]
    buffer_store_dwordx4 v[0:3], v245, s[48:51], s65 offen sc1
    v_mfma_f32_16x16x32_bf16 v[132:135], v[212:215], a[52:55], v[132:135]
    ds_read_b64_tr_b16 v[204:205], v232 offset:45056
    v_fmaak_f32 v225, v225, v230, 0xc0135761
    v_mfma_f32_16x16x32_bf16 v[136:139], v[208:211], a[40:43], v[136:139]
    v_exp_f32 v228, v228
    v_mfma_f32_16x16x32_bf16 v[136:139], v[212:215], a[56:59], v[136:139]
    ds_read_b64_tr_b16 v[206:207], v232 offset:47104
    v_mul_f32 v224, v224, v20
    v_mfma_f32_16x16x32_bf16 v[140:143], v[208:211], a[44:47], v[140:143]
    s_lshl_b32 s74, s52, 11
    v_exp_f32 v229, v229
    v_mfma_f32_16x16x32_bf16 v[140:143], v[212:215], a[60:63], v[140:143]
    s_waitcnt lgkmcnt(4)
    ds_read_b64_tr_b16 v[208:209], v233 offset:40960
    v_mul_f32 v4, v4, v164
    v_mfma_f32_16x16x32_bf16 v[144:147], v[192:195], a[32:35], v[144:147]
    v_mul_f32 v5, v5, v165
    v_add_f32 v228, 1.0, v228
    v_mfma_f32_16x16x32_bf16 v[144:147], v[196:199], a[48:51], v[144:147]
    s_add_u32 s73, s73, s74
    ds_read_b64_tr_b16 v[210:211], v233 offset:43008
    v_mul_f32 v225, v225, v21
    v_mfma_f32_16x16x32_bf16 v[148:151], v[192:195], a[36:39], v[148:151]
    v_exp_f32 v224, v224
    v_mfma_f32_16x16x32_bf16 v[148:151], v[196:199], a[52:55], v[148:151]
    v_exp_f32 v225, v225
    v_mfma_f32_16x16x32_bf16 v[152:155], v[192:195], a[40:43], v[152:155]
    ds_read_b64_tr_b16 v[212:213], v233 offset:45056
    v_add_f32 v229, 1.0, v229
    v_mfma_f32_16x16x32_bf16 v[152:155], v[196:199], a[56:59], v[152:155]
    ds_read_b64_tr_b16 v[214:215], v233 offset:47104
    v_mul_f32 v20, v20, v180
    v_mfma_f32_16x16x32_bf16 v[156:159], v[192:195], a[44:47], v[156:159]
    s_add_u32 s73, s73, 67108864
    v_rcp_f32 v228, v228
    v_mfma_f32_16x16x32_bf16 v[156:159], v[196:199], a[60:63], v[156:159]
    s_waitcnt lgkmcnt(4)
    s_mul_i32 s56, s85, 4096
    ds_read_b64_tr_b16 v[192:193], v234 offset:40960
    v_mfma_f32_16x16x32_bf16 v[64:67], v[200:203], a[64:67], v[64:67]
    s_add_u32 s56, s56, 524416
    s_add_u32 m0, s57, 81920
    v_mul_f32 v21, v21, v181
    v_mfma_f32_16x16x32_bf16 v[64:67], v[204:207], a[80:83], v[64:67]
    ds_read_b64_tr_b16 v[194:195], v234 offset:43008
    v_add_f32 v224, 1.0, v224
    v_mfma_f32_16x16x32_bf16 v[68:71], v[200:203], a[68:71], v[68:71]
    buffer_load_dwordx4 v239, s[12:15], s56 offen offset:0 sc1 lds
    v_mfma_f32_16x16x32_bf16 v[68:71], v[204:207], a[84:87], v[68:71]
    s_xor_b32 s74, s55, 1
    ds_read_b64_tr_b16 v[196:197], v234 offset:45056
    v_add_f32 v225, 1.0, v225
    v_mfma_f32_16x16x32_bf16 v[72:75], v[200:203], a[72:75], v[72:75]
    v_rcp_f32 v229, v229
    v_mfma_f32_16x16x32_bf16 v[72:75], v[204:207], a[88:91], v[72:75]
    ds_read_b64_tr_b16 v[198:199], v234 offset:47104
    v_mul_f32 v4, v4, v228
    v_mfma_f32_16x16x32_bf16 v[76:79], v[200:203], a[76:79], v[76:79]
    buffer_load_dwordx4 v240, s[12:15], s56 offen offset:1024 sc1 lds
    v_mfma_f32_16x16x32_bf16 v[76:79], v[204:207], a[92:95], v[76:79]
    s_waitcnt lgkmcnt(4)
    ds_read_b64_tr_b16 v[200:201], v235 offset:40960
    v_mul_f32 v5, v5, v229
    v_mul_f32 v228, v6, v6
    v_mfma_f32_16x16x32_bf16 v[80:83], v[208:211], a[64:67], v[80:83]
    s_and_b32 s74, s74, 3
    v_rcp_f32 v224, v224
    v_mfma_f32_16x16x32_bf16 v[80:83], v[212:215], a[80:83], v[80:83]
    ds_read_b64_tr_b16 v[202:203], v235 offset:43008
    v_mul_f32 v229, v7, v7
    v_mfma_f32_16x16x32_bf16 v[84:87], v[208:211], a[68:71], v[84:87]
    v_rcp_f32 v225, v225
    v_mfma_f32_16x16x32_bf16 v[84:87], v[212:215], a[84:87], v[84:87]
    ds_read_b64_tr_b16 v[204:205], v235 offset:45056
    v_mul_f32 v20, v20, v224
    v_mfma_f32_16x16x32_bf16 v[88:91], v[208:211], a[72:75], v[88:91]
    v_fmaak_f32 v228, v228, v230, 0xc0135761
    v_fmaak_f32 v229, v229, v230, 0xc0135761
    v_mfma_f32_16x16x32_bf16 v[88:91], v[212:215], a[88:91], v[88:91]
    v_mul_f32 v21, v21, v225
    v_mfma_f32_16x16x32_bf16 v[92:95], v[208:211], a[76:79], v[92:95]
    s_mul_i32 s74, s74, 24576
    ds_read_b64_tr_b16 v[206:207], v235 offset:47104
    v_mul_f32 v228, v228, v6
    v_mfma_f32_16x16x32_bf16 v[92:95], v[212:215], a[92:95], v[92:95]
    s_waitcnt lgkmcnt(4)
    ds_read_b64_tr_b16 v[208:209], v232 offset:49152
    v_mul_f32 v224, v22, v22
    v_mfma_f32_16x16x32_bf16 v[128:131], v[192:195], a[64:67], v[128:131]
    ds_read_b64_tr_b16 v[210:211], v232 offset:51200
    v_mul_f32 v229, v229, v7
    v_mfma_f32_16x16x32_bf16 v[128:131], v[196:199], a[80:83], v[128:131]
    v_mul_f32 v225, v23, v23
    v_mfma_f32_16x16x32_bf16 v[132:135], v[192:195], a[68:71], v[132:135]
    v_exp_f32 v228, v228
    v_mfma_f32_16x16x32_bf16 v[132:135], v[196:199], a[84:87], v[132:135]
    s_add_u32 s74, s74, s73
    ds_read_b64_tr_b16 v[212:213], v232 offset:53248
    v_fmaak_f32 v224, v224, v230, 0xc0135761
    v_mfma_f32_16x16x32_bf16 v[136:139], v[192:195], a[72:75], v[136:139]
    s_add_u32 s75, s74, 0
    v_exp_f32 v229, v229
    v_mfma_f32_16x16x32_bf16 v[136:139], v[196:199], a[88:91], v[136:139]
    ds_read_b64_tr_b16 v[214:215], v232 offset:55296
    v_fmaak_f32 v225, v225, v230, 0xc0135761
    v_mfma_f32_16x16x32_bf16 v[140:143], v[192:195], a[76:79], v[140:143]
    v_mul_f32 v6, v6, v166
    v_mul_f32 v7, v7, v167
    v_add_f32 v228, 1.0, v228
    v_mfma_f32_16x16x32_bf16 v[140:143], v[196:199], a[92:95], v[140:143]
    s_waitcnt lgkmcnt(4)
    ds_read_b64_tr_b16 v[192:193], v233 offset:49152
    v_mul_f32 v224, v224, v22
    v_mfma_f32_16x16x32_bf16 v[144:147], v[200:203], a[64:67], v[144:147]
    buffer_store_dwordx4 v[220:223], v245, s[48:51], s75 offen offset:0 sc1
    v_mfma_f32_16x16x32_bf16 v[144:147], v[204:207], a[80:83], v[144:147]
    ds_read_b64_tr_b16 v[194:195], v233 offset:51200
    v_mul_f32 v225, v225, v23
    v_mfma_f32_16x16x32_bf16 v[148:151], v[200:203], a[68:71], v[148:151]
    v_add_f32 v229, 1.0, v229
    v_exp_f32 v224, v224
    v_mfma_f32_16x16x32_bf16 v[148:151], v[204:207], a[84:87], v[148:151]
    v_exp_f32 v225, v225
    v_mfma_f32_16x16x32_bf16 v[152:155], v[200:203], a[72:75], v[152:155]
    ds_read_b64_tr_b16 v[196:197], v233 offset:53248
    buffer_store_dwordx4 v[220:223], v245, s[48:51], s75 offen offset:1024 sc1
    v_mfma_f32_16x16x32_bf16 v[152:155], v[204:207], a[88:91], v[152:155]
    ds_read_b64_tr_b16 v[198:199], v233 offset:55296
    v_mul_f32 v22, v22, v182
    v_mfma_f32_16x16x32_bf16 v[156:159], v[200:203], a[76:79], v[156:159]
    s_xor_b32 s74, s55, 2
    v_rcp_f32 v228, v228
    v_mfma_f32_16x16x32_bf16 v[156:159], v[204:207], a[92:95], v[156:159]
    s_waitcnt lgkmcnt(4)
    ds_read_b64_tr_b16 v[200:201], v234 offset:49152
    v_mul_f32 v23, v23, v183
    v_mfma_f32_16x16x32_bf16 v[64:67], v[208:211], a[96:99], v[64:67]
    v_rcp_f32 v229, v229
    v_mfma_f32_16x16x32_bf16 v[64:67], v[212:215], a[112:115], v[64:67]
    ds_read_b64_tr_b16 v[202:203], v234 offset:51200
    v_add_f32 v224, 1.0, v224
    v_mfma_f32_16x16x32_bf16 v[68:71], v[208:211], a[100:103], v[68:71]
    s_and_b32 s74, s74, 3
    v_mul_f32 v6, v6, v228
    v_mul_f32 v7, v7, v229
    v_mfma_f32_16x16x32_bf16 v[68:71], v[212:215], a[116:119], v[68:71]
    ds_read_b64_tr_b16 v[204:205], v234 offset:53248
    v_add_f32 v225, 1.0, v225
    v_mfma_f32_16x16x32_bf16 v[72:75], v[208:211], a[104:107], v[72:75]
    v_rcp_f32 v224, v224
    v_mfma_f32_16x16x32_bf16 v[72:75], v[212:215], a[120:123], v[72:75]
    v_mul_f32 v22, v22, v224
    v_rcp_f32 v225, v225
    s_nop 0
    v_mul_f32 v23, v23, v225
    v_mfma_f32_16x16x32_bf16 v[76:79], v[208:211], a[108:111], v[76:79]
    ds_read_b64_tr_b16 v[206:207], v234 offset:55296
    v_cvt_pk_bf16_f32 v4, v4, v5
    v_mfma_f32_16x16x32_bf16 v[76:79], v[212:215], a[124:127], v[76:79]
    s_waitcnt lgkmcnt(4)
    ds_read_b64_tr_b16 v[208:209], v235 offset:49152
    ds_read_b64_tr_b16 v[210:211], v235 offset:51200
    v_mfma_f32_16x16x32_bf16 v[80:83], v[192:195], a[96:99], v[80:83]
    ds_read_b64_tr_b16 v[212:213], v235 offset:53248
    ds_read_b64_tr_b16 v[214:215], v235 offset:55296
    v_mfma_f32_16x16x32_bf16 v[80:83], v[196:199], a[112:115], v[80:83]
    s_mul_i32 s74, s74, 24576
    v_cvt_pk_bf16_f32 v5, v6, v7
    v_mul_f32 v224, v24, v24
    v_mul_f32 v225, v25, v25
    v_mfma_f32_16x16x32_bf16 v[84:87], v[192:195], a[100:103], v[84:87]
    v_mul_f32 v228, v8, v8
    v_fmaak_f32 v224, v224, v230, 0xc0135761
    v_mfma_f32_16x16x32_bf16 v[84:87], v[196:199], a[116:119], v[84:87]
    s_add_u32 s74, s74, s73
    v_cvt_pk_bf16_f32 v6, v20, v21
    v_fmaak_f32 v225, v225, v230, 0xc0135761
    v_mfma_f32_16x16x32_bf16 v[88:91], v[192:195], a[104:107], v[88:91]
    v_cvt_pk_bf16_f32 v7, v22, v23
    v_mul_f32 v229, v9, v9
    v_mfma_f32_16x16x32_bf16 v[88:91], v[196:199], a[120:123], v[88:91]
    v_fmaak_f32 v228, v228, v230, 0xc0135761
    v_mul_f32 v224, v224, v24
    v_mfma_f32_16x16x32_bf16 v[92:95], v[192:195], a[108:111], v[92:95]
    v_mul_f32 v225, v225, v25
    v_mfma_f32_16x16x32_bf16 v[92:95], v[196:199], a[124:127], v[92:95]
    s_waitcnt lgkmcnt(4)
    v_fmaak_f32 v229, v229, v230, 0xc0135761
    v_mul_f32 v228, v228, v8
    v_mfma_f32_16x16x32_bf16 v[128:131], v[200:203], a[96:99], v[128:131]
    v_exp_f32 v224, v224
    v_mfma_f32_16x16x32_bf16 v[128:131], v[204:207], a[112:115], v[128:131]
    buffer_store_dwordx4 v[4:7], v245, s[48:51], s66 offen sc1
    v_mfma_f32_16x16x32_bf16 v[132:135], v[200:203], a[100:103], v[132:135]
    s_waitcnt vmcnt(6) lgkmcnt(0)
    s_barrier
    v_mul_f32 v229, v229, v9
    v_mfma_f32_16x16x32_bf16 v[132:135], v[204:207], a[116:119], v[132:135]
    s_add_u32 s75, s74, 8192
    ds_read_b64_tr_b16 v[192:193], v232 offset:57344
    ds_read_b64_tr_b16 v[194:195], v232 offset:59392
    v_mfma_f32_16x16x32_bf16 v[136:139], v[200:203], a[104:107], v[136:139]
    ds_read_b64_tr_b16 v[196:197], v232 offset:61440
    ds_read_b64_tr_b16 v[198:199], v232 offset:63488
    v_mfma_f32_16x16x32_bf16 v[136:139], v[204:207], a[120:123], v[136:139]
    v_exp_f32 v228, v228
    v_mfma_f32_16x16x32_bf16 v[140:143], v[200:203], a[108:111], v[140:143]
    buffer_store_dword v254, v249, s[48:51], s95 offen sc1
    v_mfma_f32_16x16x32_bf16 v[140:143], v[204:207], a[124:127], v[140:143]
    ds_read_b64_tr_b16 v[200:201], v233 offset:57344
    v_exp_f32 v225, v225
    v_mfma_f32_16x16x32_bf16 v[144:147], v[208:211], a[96:99], v[144:147]
    v_exp_f32 v229, v229
    v_mfma_f32_16x16x32_bf16 v[144:147], v[212:215], a[112:115], v[144:147]
    ds_read_b64_tr_b16 v[202:203], v233 offset:59392
    v_mul_f32 v8, v8, v168
    v_mfma_f32_16x16x32_bf16 v[148:151], v[208:211], a[100:103], v[148:151]
    buffer_store_dwordx4 v[220:223], v245, s[48:51], s75 offen offset:0 sc1
    v_mul_f32 v9, v9, v169
    v_mfma_f32_16x16x32_bf16 v[148:151], v[212:215], a[116:119], v[148:151]
    ds_read_b64_tr_b16 v[204:205], v233 offset:61440
    v_add_f32 v228, 1.0, v228
    v_mfma_f32_16x16x32_bf16 v[152:155], v[208:211], a[104:107], v[152:155]
    v_add_f32 v229, 1.0, v229
    v_rcp_f32 v228, v228
    v_mfma_f32_16x16x32_bf16 v[152:155], v[212:215], a[120:123], v[152:155]
    ds_read_b64_tr_b16 v[206:207], v233 offset:63488
    v_mul_f32 v24, v24, v184
    v_mfma_f32_16x16x32_bf16 v[156:159], v[208:211], a[108:111], v[156:159]
    buffer_store_dwordx4 v[220:223], v245, s[48:51], s75 offen offset:1024 sc1
    v_mfma_f32_16x16x32_bf16 v[156:159], v[212:215], a[124:127], v[156:159]
    s_waitcnt lgkmcnt(4)
    ds_read_b64_tr_b16 v[208:209], v234 offset:57344
    v_mul_f32 v25, v25, v185
    v_mfma_f32_16x16x32_bf16 v[64:67], v[192:195], a[128:131], v[64:67]
    s_xor_b32 s74, s55, 3
    v_rcp_f32 v229, v229
    v_mfma_f32_16x16x32_bf16 v[64:67], v[196:199], a[144:147], v[64:67]
    ds_read_b64_tr_b16 v[210:211], v234 offset:59392
    v_mul_f32 v8, v8, v228
    v_mfma_f32_16x16x32_bf16 v[68:71], v[192:195], a[132:135], v[68:71]
    ds_read_b64_tr_b16 v[212:213], v234 offset:61440
    v_add_f32 v224, 1.0, v224
    v_mfma_f32_16x16x32_bf16 v[68:71], v[196:199], a[148:151], v[68:71]
    v_mul_f32 v9, v9, v229
    v_mfma_f32_16x16x32_bf16 v[72:75], v[192:195], a[136:139], v[72:75]
    v_add_f32 v225, 1.0, v225
    v_mfma_f32_16x16x32_bf16 v[72:75], v[196:199], a[152:155], v[72:75]
    s_and_b32 s74, s74, 3
    ds_read_b64_tr_b16 v[214:215], v234 offset:63488
    v_mul_f32 v228, v10, v10
    v_mfma_f32_16x16x32_bf16 v[76:79], v[192:195], a[140:143], v[76:79]
    s_mul_i32 s74, s74, 24576
    v_rcp_f32 v224, v224
    v_mfma_f32_16x16x32_bf16 v[76:79], v[196:199], a[156:159], v[76:79]
    s_waitcnt lgkmcnt(4)
    ds_read_b64_tr_b16 v[192:193], v235 offset:57344
    v_mul_f32 v229, v11, v11
    v_mfma_f32_16x16x32_bf16 v[80:83], v[200:203], a[128:131], v[80:83]
    v_rcp_f32 v225, v225
    v_mfma_f32_16x16x32_bf16 v[80:83], v[204:207], a[144:147], v[80:83]
    ds_read_b64_tr_b16 v[194:195], v235 offset:59392
    v_fmaak_f32 v228, v228, v230, 0xc0135761
    v_mfma_f32_16x16x32_bf16 v[84:87], v[200:203], a[132:135], v[84:87]
    v_mul_f32 v24, v24, v224
    v_mfma_f32_16x16x32_bf16 v[84:87], v[204:207], a[148:151], v[84:87]
    s_add_u32 s74, s74, s73
    ds_read_b64_tr_b16 v[196:197], v235 offset:61440
    v_fmaak_f32 v229, v229, v230, 0xc0135761
    v_mfma_f32_16x16x32_bf16 v[88:91], v[200:203], a[136:139], v[88:91]
    ds_read_b64_tr_b16 v[198:199], v235 offset:63488
    v_mul_f32 v25, v25, v225
    v_mfma_f32_16x16x32_bf16 v[88:91], v[204:207], a[152:155], v[88:91]
    v_mul_f32 v228, v228, v10
    v_mfma_f32_16x16x32_bf16 v[92:95], v[200:203], a[140:143], v[92:95]
    v_mul_f32 v229, v229, v11
    v_mfma_f32_16x16x32_bf16 v[92:95], v[204:207], a[156:159], v[92:95]
    s_waitcnt lgkmcnt(4)
    v_subrev_u32 v232, 0x10000, v232
    v_subrev_u32 v233, 0x10000, v233
    v_subrev_u32 v234, 0x10000, v234
    v_subrev_u32 v235, 0x10000, v235
    ds_read_b64_tr_b16 v[200:201], v232 offset:0
    v_mfma_f32_16x16x32_bf16 v[128:131], v[208:211], a[128:131], v[128:131]
    s_add_u32 s75, s74, 16384
    v_exp_f32 v228, v228
    v_mfma_f32_16x16x32_bf16 v[128:131], v[212:215], a[144:147], v[128:131]
    ds_read_b64_tr_b16 v[202:203], v232 offset:2048
    v_mul_f32 v224, v26, v26
    v_mfma_f32_16x16x32_bf16 v[132:135], v[208:211], a[132:135], v[132:135]
    v_exp_f32 v229, v229
    v_mfma_f32_16x16x32_bf16 v[132:135], v[212:215], a[148:151], v[132:135]
    ds_read_b64_tr_b16 v[204:205], v232 offset:4096
    v_mul_f32 v225, v27, v27
    v_mfma_f32_16x16x32_bf16 v[136:139], v[208:211], a[136:139], v[136:139]
    buffer_store_dwordx4 v[220:223], v245, s[48:51], s75 offen offset:0 sc1
    v_mfma_f32_16x16x32_bf16 v[136:139], v[212:215], a[152:155], v[136:139]
    ds_read_b64_tr_b16 v[206:207], v232 offset:6144
    v_mul_f32 v10, v10, v170
    v_mfma_f32_16x16x32_bf16 v[140:143], v[208:211], a[140:143], v[140:143]
    v_fmaak_f32 v224, v224, v230, 0xc0135761
    v_fmaak_f32 v225, v225, v230, 0xc0135761
    v_mfma_f32_16x16x32_bf16 v[140:143], v[212:215], a[156:159], v[140:143]
    s_waitcnt lgkmcnt(4)
    ds_read_b64_tr_b16 v[208:209], v233 offset:0
    v_mul_f32 v11, v11, v171
    v_mfma_f32_16x16x32_bf16 v[144:147], v[192:195], a[128:131], v[144:147]
    buffer_store_dwordx4 v[220:223], v245, s[48:51], s75 offen offset:1024 sc1
    v_mfma_f32_16x16x32_bf16 v[144:147], v[196:199], a[144:147], v[144:147]
    ds_read_b64_tr_b16 v[210:211], v233 offset:2048
    v_add_f32 v228, 1.0, v228
    v_mfma_f32_16x16x32_bf16 v[148:151], v[192:195], a[132:135], v[148:151]
    v_mul_f32 v224, v224, v26
    v_mfma_f32_16x16x32_bf16 v[148:151], v[196:199], a[148:151], v[148:151]
    ds_read_b64_tr_b16 v[212:213], v233 offset:4096
    v_add_f32 v229, 1.0, v229
    v_mfma_f32_16x16x32_bf16 v[152:155], v[192:195], a[136:139], v[152:155]
    v_rcp_f32 v228, v228
    v_mfma_f32_16x16x32_bf16 v[152:155], v[196:199], a[152:155], v[152:155]
    ds_read_b64_tr_b16 v[214:215], v233 offset:6144
    v_mul_f32 v225, v225, v27
    v_mfma_f32_16x16x32_bf16 v[156:159], v[192:195], a[140:143], v[156:159]
    v_rcp_f32 v229, v229
    v_mfma_f32_16x16x32_bf16 v[156:159], v[196:199], a[156:159], v[156:159]
    s_waitcnt lgkmcnt(4)
    ds_read_b64_tr_b16 v[192:193], v234 offset:0
    v_mul_f32 v10, v10, v228
    v_mfma_f32_16x16x32_bf16 v[64:67], v[200:203], a[160:163], v[64:67]
    v_exp_f32 v224, v224
    v_mfma_f32_16x16x32_bf16 v[64:67], v[204:207], a[176:179], v[64:67]
    s_lshl_b32 s73, s53, 19
    ds_read_b64_tr_b16 v[194:195], v234 offset:2048
    ds_read_b64_tr_b16 v[196:197], v234 offset:4096
    v_mfma_f32_16x16x32_bf16 v[68:71], v[200:203], a[164:167], v[68:71]
    s_and_b32 s74, s52, 1
    v_exp_f32 v225, v225
    v_mfma_f32_16x16x32_bf16 v[68:71], v[204:207], a[180:183], v[68:71]
    v_mul_f32 v11, v11, v229
    v_mfma_f32_16x16x32_bf16 v[72:75], v[200:203], a[168:171], v[72:75]
    v_mul_f32 v26, v26, v186
    v_mul_f32 v27, v27, v187
    v_add_f32 v224, 1.0, v224
    v_add_f32 v225, 1.0, v225
    v_rcp_f32 v224, v224
    s_nop 0
    v_mul_f32 v26, v26, v224
    v_rcp_f32 v225, v225
    s_nop 0
    v_mul_f32 v27, v27, v225
    v_mfma_f32_16x16x32_bf16 v[72:75], v[204:207], a[184:187], v[72:75]
    ds_read_b64_tr_b16 v[198:199], v234 offset:6144
    v_cvt_pk_bf16_f32 v8, v8, v9
    v_mfma_f32_16x16x32_bf16 v[76:79], v[200:203], a[172:175], v[76:79]
    s_lshl_b32 s74, s74, 12
    v_mul_f32 v228, v12, v12
    v_mul_f32 v224, v28, v28
    v_mfma_f32_16x16x32_bf16 v[76:79], v[204:207], a[188:191], v[76:79]
    s_waitcnt lgkmcnt(4)
    ds_read_b64_tr_b16 v[200:201], v235 offset:0
    v_cvt_pk_bf16_f32 v9, v10, v11
    v_mfma_f32_16x16x32_bf16 v[80:83], v[208:211], a[160:163], v[80:83]
    v_mul_f32 v229, v13, v13
    v_mul_f32 v225, v29, v29
    v_mfma_f32_16x16x32_bf16 v[80:83], v[212:215], a[176:179], v[80:83]
    ds_read_b64_tr_b16 v[202:203], v235 offset:2048
    v_fmaak_f32 v228, v228, v230, 0xc0135761
    v_mfma_f32_16x16x32_bf16 v[84:87], v[208:211], a[164:167], v[84:87]
    s_add_u32 s73, s73, s74
    v_cvt_pk_bf16_f32 v10, v24, v25
    v_mfma_f32_16x16x32_bf16 v[84:87], v[212:215], a[180:183], v[84:87]
    ds_read_b64_tr_b16 v[204:205], v235 offset:4096
    v_fmaak_f32 v229, v229, v230, 0xc0135761
    v_mfma_f32_16x16x32_bf16 v[88:91], v[208:211], a[168:171], v[88:91]
    v_mul_f32 v228, v228, v12
    v_fmaak_f32 v224, v224, v230, 0xc0135761
    v_mfma_f32_16x16x32_bf16 v[88:91], v[212:215], a[184:187], v[88:91]
    ds_read_b64_tr_b16 v[206:207], v235 offset:6144
    v_cvt_pk_bf16_f32 v11, v26, v27
    v_mfma_f32_16x16x32_bf16 v[92:95], v[208:211], a[172:175], v[92:95]
    s_lshl_b32 s75, s54, 2
    v_mul_f32 v229, v229, v13
    v_mfma_f32_16x16x32_bf16 v[92:95], v[212:215], a[188:191], v[92:95]
    s_waitcnt lgkmcnt(4)
    ds_read_b64_tr_b16 v[208:209], v232 offset:8192
    v_fmaak_f32 v225, v225, v230, 0xc0135761
    v_mfma_f32_16x16x32_bf16 v[128:131], v[192:195], a[160:163], v[128:131]
    buffer_store_dwordx4 v[8:11], v245, s[48:51], s67 offen sc1
    v_mfma_f32_16x16x32_bf16 v[128:131], v[196:199], a[176:179], v[128:131]
    s_sub_u32 s75, 64, s75
    ds_read_b64_tr_b16 v[210:211], v232 offset:10240
    v_mul_f32 v224, v224, v28
    v_mfma_f32_16x16x32_bf16 v[132:135], v[192:195], a[164:167], v[132:135]
    v_exp_f32 v228, v228
    v_mfma_f32_16x16x32_bf16 v[132:135], v[196:199], a[180:183], v[132:135]
    ds_read_b64_tr_b16 v[212:213], v232 offset:12288
    v_mul_f32 v225, v225, v29
    v_mfma_f32_16x16x32_bf16 v[136:139], v[192:195], a[168:171], v[136:139]
    s_lshl_b32 s75, s75, 13
    v_exp_f32 v229, v229
    v_mfma_f32_16x16x32_bf16 v[136:139], v[196:199], a[184:187], v[136:139]
    ds_read_b64_tr_b16 v[214:215], v232 offset:14336
    v_mul_f32 v12, v12, v172
    v_mfma_f32_16x16x32_bf16 v[140:143], v[192:195], a[172:175], v[140:143]
    v_mul_f32 v13, v13, v173
    v_exp_f32 v224, v224
    v_mfma_f32_16x16x32_bf16 v[140:143], v[196:199], a[188:191], v[140:143]
    s_waitcnt lgkmcnt(4)
    v_exp_f32 v225, v225
    v_mfma_f32_16x16x32_bf16 v[144:147], v[200:203], a[160:163], v[144:147]
    s_sub_u32 s75, s75, s74
    ds_read_b64_tr_b16 v[192:193], v233 offset:8192
    v_add_f32 v228, 1.0, v228
    v_mfma_f32_16x16x32_bf16 v[144:147], v[204:207], a[176:179], v[144:147]
    ds_read_b64_tr_b16 v[194:195], v233 offset:10240
    v_mul_f32 v28, v28, v188
    v_mfma_f32_16x16x32_bf16 v[148:151], v[200:203], a[164:167], v[148:151]
    s_cmp_lt_u32 s52, 2
    s_cselect_b32 s74, 16760832, 0
    v_add_f32 v229, 1.0, v229
    v_mfma_f32_16x16x32_bf16 v[148:151], v[204:207], a[180:183], v[148:151]
    ds_read_b64_tr_b16 v[196:197], v233 offset:12288
    v_mul_f32 v29, v29, v189
    v_mfma_f32_16x16x32_bf16 v[152:155], v[200:203], a[168:171], v[152:155]
    s_add_u32 s73, s73, s74
    v_rcp_f32 v228, v228
    v_mfma_f32_16x16x32_bf16 v[152:155], v[204:207], a[184:187], v[152:155]
    ds_read_b64_tr_b16 v[198:199], v233 offset:14336
    v_add_f32 v224, 1.0, v224
    v_mfma_f32_16x16x32_bf16 v[156:159], v[200:203], a[172:175], v[156:159]
    v_rcp_f32 v229, v229
    v_mfma_f32_16x16x32_bf16 v[156:159], v[204:207], a[188:191], v[156:159]
    s_waitcnt lgkmcnt(4)
    ds_read_b64_tr_b16 v[200:201], v234 offset:8192
    v_add_f32 v225, 1.0, v225
    v_mfma_f32_16x16x32_bf16 v[64:67], v[208:211], a[192:195], v[64:67]
    v_rcp_f32 v224, v224
    v_mfma_f32_16x16x32_bf16 v[64:67], v[212:215], a[208:211], v[64:67]
    v_rcp_f32 v225, v225
    v_mfma_f32_16x16x32_bf16 v[68:71], v[208:211], a[196:199], v[68:71]
    s_add_u32 s73, s73, 2113536
    ds_read_b64_tr_b16 v[202:203], v234 offset:10240
    v_mul_f32 v12, v12, v228
    v_mfma_f32_16x16x32_bf16 v[68:71], v[212:215], a[212:215], v[68:71]
    ds_read_b64_tr_b16 v[204:205], v234 offset:12288
    v_mul_f32 v13, v13, v229
    v_mul_f32 v28, v28, v224
    v_mfma_f32_16x16x32_bf16 v[72:75], v[208:211], a[200:203], v[72:75]
    s_cmp_lt_u32 s52, 2
    s_cselect_b32 s74, 0, 16384
    v_mul_f32 v228, v14, v14
    v_mfma_f32_16x16x32_bf16 v[72:75], v[212:215], a[216:219], v[72:75]
    ds_read_b64_tr_b16 v[206:207], v234 offset:14336
    v_mul_f32 v29, v29, v225
    v_mfma_f32_16x16x32_bf16 v[76:79], v[208:211], a[204:207], v[76:79]
    v_mul_f32 v229, v15, v15
    v_mfma_f32_16x16x32_bf16 v[76:79], v[212:215], a[220:223], v[76:79]
    s_waitcnt lgkmcnt(4)
    v_mul_f32 v224, v30, v30
    v_mfma_f32_16x16x32_bf16 v[80:83], v[192:195], a[192:195], v[80:83]
    s_sub_u32 s34, s75, s74
    ds_read_b64_tr_b16 v[208:209], v235 offset:8192
    v_fmaak_f32 v228, v228, v230, 0xc0135761
    v_mfma_f32_16x16x32_bf16 v[80:83], v[196:199], a[208:211], v[80:83]
    ds_read_b64_tr_b16 v[210:211], v235 offset:10240
    v_mul_f32 v225, v31, v31
    v_mfma_f32_16x16x32_bf16 v[84:87], v[192:195], a[196:199], v[84:87]
    v_fmaak_f32 v229, v229, v230, 0xc0135761
    v_lshrrev_b32 v238, 4, v255
    v_mfma_f32_16x16x32_bf16 v[84:87], v[196:199], a[212:215], v[84:87]
    ds_read_b64_tr_b16 v[212:213], v235 offset:12288
    v_fmaak_f32 v224, v224, v230, 0xc0135761
    v_mfma_f32_16x16x32_bf16 v[88:91], v[192:195], a[200:203], v[88:91]
    s_add_u32 s32, s48, s73
    s_addc_u32 s33, s49, 0
    v_mul_f32 v228, v228, v14
    v_mfma_f32_16x16x32_bf16 v[88:91], v[196:199], a[216:219], v[88:91]
    ds_read_b64_tr_b16 v[214:215], v235 offset:14336
    v_fmaak_f32 v225, v225, v230, 0xc0135761
    v_mfma_f32_16x16x32_bf16 v[92:95], v[192:195], a[204:207], v[92:95]
    s_lshr_b32 s73, s52, 1
    v_mul_f32 v229, v229, v15
    v_and_b32 v239, 15, v255
    v_mfma_f32_16x16x32_bf16 v[92:95], v[196:199], a[220:223], v[92:95]
    s_waitcnt lgkmcnt(4)
    ds_read_b64_tr_b16 v[192:193], v232 offset:32768
    v_mul_f32 v224, v224, v30
    v_mfma_f32_16x16x32_bf16 v[128:131], v[200:203], a[192:195], v[128:131]
    v_exp_f32 v228, v228
    v_mfma_f32_16x16x32_bf16 v[128:131], v[204:207], a[208:211], v[128:131]
    ds_read_b64_tr_b16 v[194:195], v232 offset:34816
    ds_read_b64_tr_b16 v[196:197], v232 offset:36864
    v_mul_f32 v225, v225, v31
    v_mfma_f32_16x16x32_bf16 v[132:135], v[200:203], a[196:199], v[132:135]
    s_sub_u32 s74, 3, s73
    v_exp_f32 v229, v229
    v_mfma_f32_16x16x32_bf16 v[132:135], v[204:207], a[212:215], v[132:135]
    v_exp_f32 v224, v224
    v_mfma_f32_16x16x32_bf16 v[136:139], v[200:203], a[200:203], v[136:139]
    v_exp_f32 v225, v225
    v_mfma_f32_16x16x32_bf16 v[136:139], v[204:207], a[216:219], v[136:139]
    ds_read_b64_tr_b16 v[198:199], v232 offset:38912
    v_mul_f32 v30, v30, v190
    v_mfma_f32_16x16x32_bf16 v[140:143], v[200:203], a[204:207], v[140:143]
    s_lshl_b32 s75, s54, 2
    v_mul_f32 v14, v14, v174
    v_lshlrev_b32 v238, 2, v238
    v_mfma_f32_16x16x32_bf16 v[140:143], v[204:207], a[220:223], v[140:143]
    s_waitcnt lgkmcnt(4)
    ds_read_b64_tr_b16 v[200:201], v233 offset:32768
    v_mul_f32 v31, v31, v191
    v_mfma_f32_16x16x32_bf16 v[144:147], v[208:211], a[192:195], v[144:147]
    s_add_u32 s89, s75, s73
    v_mul_f32 v15, v15, v175
    v_add_f32 v228, 1.0, v228
    v_sub_u32 v239, v239, v238
    v_mfma_f32_16x16x32_bf16 v[144:147], v[212:215], a[208:211], v[144:147]
    ds_read_b64_tr_b16 v[202:203], v233 offset:34816
    v_add_f32 v224, 1.0, v224
    v_mfma_f32_16x16x32_bf16 v[148:151], v[208:211], a[196:199], v[148:151]
    s_add_u32 s88, s75, s74
    v_add_f32 v229, 1.0, v229
    v_mov_b32 v238, s52
    v_mfma_f32_16x16x32_bf16 v[148:151], v[212:215], a[212:215], v[148:151]
    ds_read_b64_tr_b16 v[204:205], v233 offset:36864
    v_add_f32 v225, 1.0, v225
    v_mfma_f32_16x16x32_bf16 v[152:155], v[208:211], a[200:203], v[152:155]
    v_rcp_f32 v228, v228
    v_mfma_f32_16x16x32_bf16 v[152:155], v[212:215], a[216:219], v[152:155]
    ds_read_b64_tr_b16 v[206:207], v233 offset:38912
    v_rcp_f32 v224, v224
    v_mfma_f32_16x16x32_bf16 v[156:159], v[208:211], a[204:207], v[156:159]
    s_sub_u32 s75, 60, s75
    v_rcp_f32 v229, v229
    v_mfma_f32_16x16x32_bf16 v[156:159], v[212:215], a[220:223], v[156:159]
    s_waitcnt lgkmcnt(4)
    v_rcp_f32 v225, v225
    v_mfma_f32_16x16x32_bf16 v[64:67], v[192:195], a[224:227], v[64:67]
    s_add_u32 s87, s75, s73
    ds_read_b64_tr_b16 v[208:209], v234 offset:32768
    v_mul_f32 v14, v14, v228
    v_mfma_f32_16x16x32_bf16 v[64:67], v[196:199], a[240:243], v[64:67]
    ds_read_b64_tr_b16 v[210:211], v234 offset:34816
    v_mul_f32 v30, v30, v224
    v_mfma_f32_16x16x32_bf16 v[68:71], v[192:195], a[228:231], v[68:71]
    v_mul_f32 v15, v15, v229
    v_and_b32 v238, 1, v238
    v_mfma_f32_16x16x32_bf16 v[68:71], v[196:199], a[244:247], v[68:71]
    ds_read_b64_tr_b16 v[212:213], v234 offset:36864
    v_mul_f32 v31, v31, v225
    v_mfma_f32_16x16x32_bf16 v[72:75], v[192:195], a[232:235], v[72:75]
    v_cvt_pk_bf16_f32 v12, v12, v13
    v_mfma_f32_16x16x32_bf16 v[72:75], v[196:199], a[248:251], v[72:75]
    v_lshlrev_b32 v238, 4, v238
    v_mfma_f32_16x16x32_bf16 v[76:79], v[192:195], a[236:239], v[76:79]
    s_add_u32 s86, s75, s74
    ds_read_b64_tr_b16 v[214:215], v234 offset:38912
    v_cvt_pk_bf16_f32 v13, v14, v15
    v_mfma_f32_16x16x32_bf16 v[76:79], v[196:199], a[252:255], v[76:79]
    s_waitcnt lgkmcnt(4)
    ds_read_b64_tr_b16 v[192:193], v235 offset:32768
    ds_read_b64_tr_b16 v[194:195], v235 offset:34816
    v_mfma_f32_16x16x32_bf16 v[80:83], v[200:203], a[224:227], v[80:83]
    ds_read_b64_tr_b16 v[196:197], v235 offset:36864
    ds_read_b64_tr_b16 v[198:199], v235 offset:38912
    v_mfma_f32_16x16x32_bf16 v[80:83], v[204:207], a[240:243], v[80:83]
    s_sub_u32 s90, s86, 1
    v_cvt_pk_bf16_f32 v14, v28, v29
    v_mfma_f32_16x16x32_bf16 v[84:87], v[200:203], a[228:231], v[84:87]
    v_add_u32 v237, v238, v239
    v_mfma_f32_16x16x32_bf16 v[84:87], v[204:207], a[244:247], v[84:87]
    v_sub_u32 v238, 16, v238
    v_mfma_f32_16x16x32_bf16 v[88:91], v[200:203], a[232:235], v[88:91]
    v_cvt_pk_bf16_f32 v15, v30, v31
    v_mfma_f32_16x16x32_bf16 v[88:91], v[204:207], a[248:251], v[88:91]
    s_sub_u32 s91, s87, 1
    v_add_u32 v236, v238, v239
    v_mfma_f32_16x16x32_bf16 v[92:95], v[200:203], a[236:239], v[92:95]
    buffer_store_dwordx4 v[12:15], v245, s[48:51], s68 offen sc1
    v_mfma_f32_16x16x32_bf16 v[92:95], v[204:207], a[252:255], v[92:95]
    s_waitcnt lgkmcnt(4)
    v_mul_f32 v228, v96, v96
    v_mul_f32 v229, v97, v97
    v_mfma_f32_16x16x32_bf16 v[128:131], v[208:211], a[224:227], v[128:131]
    s_sub_u32 s92, s88, 1
    v_fmaak_f32 v228, v228, v230, 0xc0135761
    v_mul_f32 v224, v100, v100
    v_mfma_f32_16x16x32_bf16 v[128:131], v[212:215], a[240:243], v[128:131]
    v_mov_b32 v240, 0x3f803f80
    v_mfma_f32_16x16x32_bf16 v[132:135], v[208:211], a[228:231], v[132:135]
    s_waitcnt lgkmcnt(0)
    s_barrier
    v_fmaak_f32 v229, v229, v230, 0xc0135761
    v_mfma_f32_16x16x32_bf16 v[132:135], v[212:215], a[244:247], v[132:135]
    ds_read_b64_tr_b16 v[200:201], v232 offset:40960
    ds_read_b64_tr_b16 v[202:203], v232 offset:43008
    v_mfma_f32_16x16x32_bf16 v[136:139], v[208:211], a[232:235], v[136:139]
    s_sub_u32 s93, s89, 1
    ds_read_b64_tr_b16 v[204:205], v232 offset:45056
    ds_read_b64_tr_b16 v[206:207], v232 offset:47104
    v_mfma_f32_16x16x32_bf16 v[136:139], v[212:215], a[248:251], v[136:139]
    v_mul_f32 v225, v101, v101
    v_mfma_f32_16x16x32_bf16 v[140:143], v[208:211], a[236:239], v[140:143]
    v_mul_f32 v228, v228, v96
    v_mfma_f32_16x16x32_bf16 v[140:143], v[212:215], a[252:255], v[140:143]
    ds_read_b64_tr_b16 v[208:209], v233 offset:40960
    v_fmaak_f32 v224, v224, v230, 0xc0135761
    v_mfma_f32_16x16x32_bf16 v[144:147], v[192:195], a[224:227], v[144:147]
    v_mul_f32 v229, v229, v97
    v_mfma_f32_16x16x32_bf16 v[144:147], v[196:199], a[240:243], v[144:147]
    ds_read_b64_tr_b16 v[210:211], v233 offset:43008
    v_fmaak_f32 v225, v225, v230, 0xc0135761
    v_mfma_f32_16x16x32_bf16 v[148:151], v[192:195], a[228:231], v[148:151]
    v_exp_f32 v228, v228
    v_mfma_f32_16x16x32_bf16 v[148:151], v[196:199], a[244:247], v[148:151]
    ds_read_b64_tr_b16 v[212:213], v233 offset:45056
    v_mul_f32 v224, v224, v100
    v_mfma_f32_16x16x32_bf16 v[152:155], v[192:195], a[232:235], v[152:155]
    v_exp_f32 v229, v229
    v_mfma_f32_16x16x32_bf16 v[152:155], v[196:199], a[248:251], v[152:155]
    ds_read_b64_tr_b16 v[214:215], v233 offset:47104
    v_mul_f32 v225, v225, v101
    v_mfma_f32_16x16x32_bf16 v[156:159], v[192:195], a[236:239], v[156:159]
    v_exp_f32 v224, v224
    v_mfma_f32_16x16x32_bf16 v[156:159], v[196:199], a[252:255], v[156:159]
    s_waitcnt lgkmcnt(4)
    ds_read_b64_tr_b16 v[192:193], v234 offset:40960
    v_mul_f32 v96, v96, v112
    v_mfma_f32_16x16x32_bf16 v[0:3], v[200:203], a[0:3], 0
    v_exp_f32 v225, v225
    v_mfma_f32_16x16x32_bf16 v[0:3], v[204:207], a[16:19], v[0:3]
    ds_read_b64_tr_b16 v[194:195], v234 offset:43008
    v_mul_f32 v97, v97, v113
    v_mfma_f32_16x16x32_bf16 v[8:11], v[200:203], a[4:7], 0
    v_mul_f32 v100, v100, v116
    v_mov_b64 v[160:161], 0
    v_mfma_f32_16x16x32_bf16 v[8:11], v[204:207], a[20:23], v[8:11]
    ds_read_b64_tr_b16 v[196:197], v234 offset:45056
    v_add_f32 v228, 1.0, v228
    v_mfma_f32_16x16x32_bf16 v[16:19], v[200:203], a[8:11], 0
    ds_read_b64_tr_b16 v[198:199], v234 offset:47104
    v_mul_f32 v101, v101, v117
    v_mfma_f32_16x16x32_bf16 v[16:19], v[204:207], a[24:27], v[16:19]
    s_lshl_b32 s100, s53, 7
    v_add_f32 v224, 1.0, v224
    v_mfma_f32_16x16x32_bf16 v[24:27], v[200:203], a[12:15], 0
    v_add_f32 v229, 1.0, v229
    v_mfma_f32_16x16x32_bf16 v[24:27], v[204:207], a[28:31], v[24:27]
    s_waitcnt lgkmcnt(4)
    ds_read_b64_tr_b16 v[200:201], v235 offset:40960
    v_add_f32 v225, 1.0, v225
    v_mfma_f32_16x16x32_bf16 v[4:7], v[208:211], a[0:3], 0
    s_add_u32 s100, s100, 58721280
    v_rcp_f32 v228, v228
    v_mfma_f32_16x16x32_bf16 v[4:7], v[212:215], a[16:19], v[4:7]
    ds_read_b64_tr_b16 v[202:203], v235 offset:43008
    v_mov_b64 v[162:163], 0
    v_mfma_f32_16x16x32_bf16 v[12:15], v[208:211], a[4:7], 0
    v_rcp_f32 v229, v229
    v_mfma_f32_16x16x32_bf16 v[12:15], v[212:215], a[20:23], v[12:15]
    ds_read_b64_tr_b16 v[204:205], v235 offset:45056
    buffer_load_dword v231, v251, s[48:51], s100 offen sc1
    v_mfma_f32_16x16x32_bf16 v[20:23], v[208:211], a[8:11], 0
    v_rcp_f32 v224, v224
    v_mfma_f32_16x16x32_bf16 v[20:23], v[212:215], a[24:27], v[20:23]
    ds_read_b64_tr_b16 v[206:207], v235 offset:47104
    v_mul_f32 v96, v96, v228
    v_mfma_f32_16x16x32_bf16 v[28:31], v[208:211], a[12:15], 0
    v_rcp_f32 v225, v225
    v_mfma_f32_16x16x32_bf16 v[28:31], v[212:215], a[28:31], v[28:31]
    s_waitcnt lgkmcnt(4)
    ds_read_b64_tr_b16 v[208:209], v232 offset:49152
    v_mul_f32 v97, v97, v229
    v_mfma_f32_16x16x32_bf16 v[32:35], v[192:195], a[0:3], 0
    v_mul_f32 v100, v100, v224
    v_mov_b64 v[164:165], 0
    v_mfma_f32_16x16x32_bf16 v[32:35], v[196:199], a[16:19], v[32:35]
    ds_read_b64_tr_b16 v[210:211], v232 offset:51200
    v_mul_f32 v228, v98, v98
    v_mfma_f32_16x16x32_bf16 v[40:43], v[192:195], a[4:7], 0
    v_mul_f32 v101, v101, v225
    v_mov_b64 v[166:167], 0
    v_mfma_f32_16x16x32_bf16 v[40:43], v[196:199], a[20:23], v[40:43]
    ds_read_b64_tr_b16 v[212:213], v232 offset:53248
    v_mul_f32 v229, v99, v99
    v_mfma_f32_16x16x32_bf16 v[48:51], v[192:195], a[8:11], 0
    v_mul_f32 v224, v102, v102
    v_mov_b64 v[168:169], 0
    v_mfma_f32_16x16x32_bf16 v[48:51], v[196:199], a[24:27], v[48:51]
    ds_read_b64_tr_b16 v[214:215], v232 offset:55296
    v_mul_f32 v225, v103, v103
    v_mfma_f32_16x16x32_bf16 v[56:59], v[192:195], a[12:15], 0
    v_fmaak_f32 v228, v228, v230, 0xc0135761
    v_mfma_f32_16x16x32_bf16 v[56:59], v[196:199], a[28:31], v[56:59]
    s_waitcnt lgkmcnt(4)
    ds_read_b64_tr_b16 v[192:193], v233 offset:49152
    v_fmaak_f32 v224, v224, v230, 0xc0135761
    v_mfma_f32_16x16x32_bf16 v[36:39], v[200:203], a[0:3], 0
    v_fmaak_f32 v229, v229, v230, 0xc0135761
    v_mfma_f32_16x16x32_bf16 v[36:39], v[204:207], a[16:19], v[36:39]
    ds_read_b64_tr_b16 v[194:195], v233 offset:51200
    v_fmaak_f32 v225, v225, v230, 0xc0135761
    v_mfma_f32_16x16x32_bf16 v[44:47], v[200:203], a[4:7], 0
    ds_read_b64_tr_b16 v[196:197], v233 offset:53248
    v_mul_f32 v228, v228, v98
    v_mfma_f32_16x16x32_bf16 v[44:47], v[204:207], a[20:23], v[44:47]
    v_mul_f32 v224, v224, v102
    v_mfma_f32_16x16x32_bf16 v[52:55], v[200:203], a[8:11], 0
    v_mul_f32 v225, v225, v103
    v_mfma_f32_16x16x32_bf16 v[52:55], v[204:207], a[24:27], v[52:55]
    ds_read_b64_tr_b16 v[198:199], v233 offset:55296
    v_mul_f32 v229, v229, v99
    v_mfma_f32_16x16x32_bf16 v[60:63], v[200:203], a[12:15], 0
    v_exp_f32 v228, v228
    v_mfma_f32_16x16x32_bf16 v[60:63], v[204:207], a[28:31], v[60:63]
    s_waitcnt lgkmcnt(4)
    ds_read_b64_tr_b16 v[200:201], v234 offset:49152
    v_mov_b64 v[170:171], 0
    v_mfma_f32_16x16x32_bf16 v[0:3], v[208:211], a[32:35], v[0:3]
    v_exp_f32 v229, v229
    v_mfma_f32_16x16x32_bf16 v[0:3], v[212:215], a[48:51], v[0:3]
    ds_read_b64_tr_b16 v[202:203], v234 offset:51200
    v_mov_b64 v[172:173], 0
    v_mfma_f32_16x16x32_bf16 v[8:11], v[208:211], a[36:39], v[8:11]
    v_exp_f32 v224, v224
    v_mfma_f32_16x16x32_bf16 v[8:11], v[212:215], a[52:55], v[8:11]
    s_mov_b32 s3, 0x3e0293ee
    v_exp_f32 v225, v225
    v_mfma_f32_16x16x32_bf16 v[16:19], v[208:211], a[40:43], v[16:19]
    ds_read_b64_tr_b16 v[204:205], v234 offset:53248
    v_mul_f32 v64, s3, v64
    v_mfma_f32_16x16x32_bf16 v[16:19], v[212:215], a[56:59], v[16:19]
    ds_read_b64_tr_b16 v[206:207], v234 offset:55296
    v_mul_f32 v102, v102, v118
    v_mfma_f32_16x16x32_bf16 v[24:27], v[208:211], a[44:47], v[24:27]
    v_mul_f32 v98, v98, v114
    v_mul_f32 v99, v99, v115
    v_mul_f32 v65, s3, v65
    v_mfma_f32_16x16x32_bf16 v[24:27], v[212:215], a[60:63], v[24:27]
    s_waitcnt lgkmcnt(4)
    ds_read_b64_tr_b16 v[208:209], v235 offset:49152
    v_mul_f32 v103, v103, v119
    v_mfma_f32_16x16x32_bf16 v[4:7], v[192:195], a[32:35], v[4:7]
    v_add_f32 v228, 1.0, v228
    v_mul_f32 v66, s3, v66
    v_mfma_f32_16x16x32_bf16 v[4:7], v[196:199], a[48:51], v[4:7]
    ds_read_b64_tr_b16 v[210:211], v235 offset:51200
    v_add_f32 v224, 1.0, v224
    v_mfma_f32_16x16x32_bf16 v[12:15], v[192:195], a[36:39], v[12:15]
    v_add_f32 v229, 1.0, v229
    v_mov_b64 v[174:175], 0
    v_mfma_f32_16x16x32_bf16 v[12:15], v[196:199], a[52:55], v[12:15]
    ds_read_b64_tr_b16 v[212:213], v235 offset:53248
    v_add_f32 v225, 1.0, v225
    v_mfma_f32_16x16x32_bf16 v[20:23], v[192:195], a[40:43], v[20:23]
    v_rcp_f32 v228, v228
    v_mfma_f32_16x16x32_bf16 v[20:23], v[196:199], a[56:59], v[20:23]
    ds_read_b64_tr_b16 v[214:215], v235 offset:55296
    v_mul_f32 v67, s3, v67
    v_mfma_f32_16x16x32_bf16 v[28:31], v[192:195], a[44:47], v[28:31]
    v_rcp_f32 v229, v229
    v_mfma_f32_16x16x32_bf16 v[28:31], v[196:199], a[60:63], v[28:31]
    s_waitcnt lgkmcnt(4)
    ds_read_b64_tr_b16 v[192:193], v232 offset:57344
    v_mul_f32 v80, s3, v80
    v_mfma_f32_16x16x32_bf16 v[32:35], v[200:203], a[32:35], v[32:35]
    v_rcp_f32 v224, v224
    v_mfma_f32_16x16x32_bf16 v[32:35], v[204:207], a[48:51], v[32:35]
    ds_read_b64_tr_b16 v[194:195], v232 offset:59392
    v_mul_f32 v98, v98, v228
    v_mfma_f32_16x16x32_bf16 v[40:43], v[200:203], a[36:39], v[40:43]
    v_rcp_f32 v225, v225
    v_mfma_f32_16x16x32_bf16 v[40:43], v[204:207], a[52:55], v[40:43]
    ds_read_b64_tr_b16 v[196:197], v232 offset:61440
    v_mul_f32 v102, v102, v224
    v_mfma_f32_16x16x32_bf16 v[48:51], v[200:203], a[40:43], v[48:51]
    v_mul_f32 v99, v99, v229
    v_mul_f32 v81, s3, v81
    v_mov_b64 v[176:177], 0
    v_mfma_f32_16x16x32_bf16 v[48:51], v[204:207], a[56:59], v[48:51]
    ds_read_b64_tr_b16 v[198:199], v232 offset:63488
    v_mul_f32 v103, v103, v225
    v_mfma_f32_16x16x32_bf16 v[56:59], v[200:203], a[44:47], v[56:59]
    v_cvt_pk_bf16_f32 v96, v96, v97
    v_mov_b64 v[178:179], 0
    v_mfma_f32_16x16x32_bf16 v[56:59], v[204:207], a[60:63], v[56:59]
    s_waitcnt lgkmcnt(4)
    ds_read_b64_tr_b16 v[200:201], v233 offset:57344
    v_cvt_pk_bf16_f32 v100, v100, v101
    v_mfma_f32_16x16x32_bf16 v[36:39], v[208:211], a[32:35], v[36:39]
    v_cvt_pk_bf16_f32 v97, v98, v99
    v_mov_b64 v[180:181], 0
    v_mfma_f32_16x16x32_bf16 v[36:39], v[212:215], a[48:51], v[36:39]
    ds_read_b64_tr_b16 v[202:203], v233 offset:59392
    v_cvt_pk_bf16_f32 v101, v102, v103
    v_mfma_f32_16x16x32_bf16 v[44:47], v[208:211], a[36:39], v[44:47]
    s_add_u32 s0, s65, s99
    v_mul_f32 v82, s3, v82
    v_mfma_f32_16x16x32_bf16 v[44:47], v[212:215], a[52:55], v[44:47]
    ds_read_b64_tr_b16 v[204:205], v233 offset:61440
    v_mul_f32 v83, s3, v83
    v_mfma_f32_16x16x32_bf16 v[52:55], v[208:211], a[40:43], v[52:55]
    buffer_store_dwordx2 v[96:97], v252, s[48:51], s0 offen sc1
    v_mfma_f32_16x16x32_bf16 v[52:55], v[212:215], a[56:59], v[52:55]
    s_add_u32 s1, s66, s99
    ds_read_b64_tr_b16 v[206:207], v233 offset:63488
    v_cvt_pk_bf16_f32 v64, v64, v65
    v_mfma_f32_16x16x32_bf16 v[60:63], v[208:211], a[44:47], v[60:63]
    v_cvt_pk_bf16_f32 v65, v66, v67
    v_cvt_pk_bf16_f32 v66, v80, v81
    v_mfma_f32_16x16x32_bf16 v[60:63], v[212:215], a[60:63], v[60:63]
    s_waitcnt lgkmcnt(4)
    ds_read_b64_tr_b16 v[208:209], v234 offset:57344
    v_mul_f32 v228, v104, v104
    v_mfma_f32_16x16x32_bf16 v[0:3], v[192:195], a[64:67], v[0:3]
    buffer_store_dwordx2 v[100:101], v252, s[48:51], s1 offen sc1
    v_mfma_f32_16x16x32_bf16 v[0:3], v[196:199], a[80:83], v[0:3]
    ds_read_b64_tr_b16 v[210:211], v234 offset:59392
    v_mul_f32 v229, v105, v105
    v_mfma_f32_16x16x32_bf16 v[8:11], v[192:195], a[68:71], v[8:11]
    v_mul_f32 v224, v108, v108
    v_cvt_pk_bf16_f32 v67, v82, v83
    v_mov_b64 v[182:183], 0
    v_mfma_f32_16x16x32_bf16 v[8:11], v[196:199], a[84:87], v[8:11]
    ds_read_b64_tr_b16 v[212:213], v234 offset:61440
    v_mul_f32 v225, v109, v109
    v_mfma_f32_16x16x32_bf16 v[16:19], v[192:195], a[72:75], v[16:19]
    v_fmaak_f32 v228, v228, v230, 0xc0135761
    v_accvgpr_write_b32 a0, v64
    v_mfma_f32_16x16x32_bf16 v[16:19], v[196:199], a[88:91], v[16:19]
    ds_read_b64_tr_b16 v[214:215], v234 offset:63488
    v_fmaak_f32 v224, v224, v230, 0xc0135761
    v_mfma_f32_16x16x32_bf16 v[24:27], v[192:195], a[76:79], v[24:27]
    v_fmaak_f32 v229, v229, v230, 0xc0135761
    v_mul_f32 v228, v228, v104
    v_mfma_f32_16x16x32_bf16 v[24:27], v[196:199], a[92:95], v[24:27]
    s_waitcnt lgkmcnt(4)
    ds_read_b64_tr_b16 v[192:193], v235 offset:57344
    v_fmaak_f32 v225, v225, v230, 0xc0135761
    v_mfma_f32_16x16x32_bf16 v[4:7], v[200:203], a[64:67], v[4:7]
    v_accvgpr_write_b32 a1, v65
    v_accvgpr_write_b32 a2, v66
    v_accvgpr_write_b32 a3, v67
    v_mfma_f32_16x16x32_bf16 v[4:7], v[204:207], a[80:83], v[4:7]
    ds_read_b64_tr_b16 v[194:195], v235 offset:59392
    v_mul_f32 v224, v224, v108
    v_mfma_f32_16x16x32_bf16 v[12:15], v[200:203], a[68:71], v[12:15]
    v_mul_f32 v229, v229, v105
    v_mov_b64 v[184:185], 0
    v_mov_b64 v[186:187], 0
    v_mfma_f32_16x16x32_bf16 v[12:15], v[204:207], a[84:87], v[12:15]
    ds_read_b64_tr_b16 v[196:197], v235 offset:61440
    v_mul_f32 v225, v225, v109
    v_mfma_f32_16x16x32_bf16 v[20:23], v[200:203], a[72:75], v[20:23]
    v_exp_f32 v228, v228
    v_mfma_f32_16x16x32_bf16 v[20:23], v[204:207], a[88:91], v[20:23]
    ds_read_b64_tr_b16 v[198:199], v235 offset:63488
    v_mul_f32 v128, s3, v128
    v_mul_f32 v129, s3, v129
    v_mul_f32 v130, s3, v130
    v_mul_f32 v131, s3, v131
    v_mul_f32 v144, s3, v144
    v_mul_f32 v145, s3, v145
    v_mul_f32 v146, s3, v146
    v_mul_f32 v147, s3, v147
    v_cvt_pk_bf16_f32 v128, v128, v129
    v_cvt_pk_bf16_f32 v129, v130, v131
    v_cvt_pk_bf16_f32 v130, v144, v145
    v_cvt_pk_bf16_f32 v131, v146, v147
    v_accvgpr_write_b32 a16, v128
    v_accvgpr_write_b32 a17, v129
    v_accvgpr_write_b32 a18, v130
    v_accvgpr_write_b32 a19, v131
    v_mul_f32 v68, s3, v68
    v_mfma_f32_16x16x32_bf16 v[28:31], v[200:203], a[76:79], v[28:31]
    v_exp_f32 v229, v229
    v_mfma_f32_16x16x32_bf16 v[28:31], v[204:207], a[92:95], v[28:31]
    s_waitcnt lgkmcnt(4)
    v_add_u32 v232, 0x10000, v232
    v_add_u32 v233, 0x10000, v233
    v_add_u32 v234, 0x10000, v234
    v_add_u32 v235, 0x10000, v235
    ds_read_b64_tr_b16 v[200:201], v232 offset:0
    v_mfma_f32_16x16x32_bf16 v[32:35], v[208:211], a[64:67], v[32:35]
    v_mul_f32 v69, s3, v69
    v_exp_f32 v224, v224
    v_mfma_f32_16x16x32_bf16 v[32:35], v[212:215], a[80:83], v[32:35]
    ds_read_b64_tr_b16 v[202:203], v232 offset:2048
    v_mul_f32 v104, v104, v120
    v_mfma_f32_16x16x32_bf16 v[40:43], v[208:211], a[68:71], v[40:43]
    v_exp_f32 v225, v225
    v_mfma_f32_16x16x32_bf16 v[40:43], v[212:215], a[84:87], v[40:43]
    ds_read_b64_tr_b16 v[204:205], v232 offset:4096
    v_mul_f32 v108, v108, v124
    v_mfma_f32_16x16x32_bf16 v[48:51], v[208:211], a[72:75], v[48:51]
    v_mul_f32 v105, v105, v121
    v_mul_f32 v70, s3, v70
    v_mov_b64 v[188:189], 0
    v_mfma_f32_16x16x32_bf16 v[48:51], v[212:215], a[88:91], v[48:51]
    ds_read_b64_tr_b16 v[206:207], v232 offset:6144
    v_mul_f32 v109, v109, v125
    v_mfma_f32_16x16x32_bf16 v[56:59], v[208:211], a[76:79], v[56:59]
    v_add_f32 v228, 1.0, v228
    v_mul_f32 v71, s3, v71
    v_mov_b64 v[190:191], 0
    v_mfma_f32_16x16x32_bf16 v[56:59], v[212:215], a[92:95], v[56:59]
    s_waitcnt lgkmcnt(4)
    ds_read_b64_tr_b16 v[208:209], v233 offset:0
    v_add_f32 v224, 1.0, v224
    v_mfma_f32_16x16x32_bf16 v[36:39], v[192:195], a[64:67], v[36:39]
    v_add_f32 v229, 1.0, v229
    v_mul_f32 v84, s3, v84
    v_mul_f32 v85, s3, v85
    v_mfma_f32_16x16x32_bf16 v[36:39], v[196:199], a[80:83], v[36:39]
    ds_read_b64_tr_b16 v[210:211], v233 offset:2048
    v_add_f32 v225, 1.0, v225
    v_mfma_f32_16x16x32_bf16 v[44:47], v[192:195], a[68:71], v[44:47]
    v_rcp_f32 v228, v228
    v_mfma_f32_16x16x32_bf16 v[44:47], v[196:199], a[84:87], v[44:47]
    s_waitcnt vmcnt(2)
    ds_read_b64_tr_b16 v[212:213], v233 offset:4096
    v_cmp_ne_u32 vcc, 1, v231
    v_mfma_f32_16x16x32_bf16 v[52:55], v[192:195], a[72:75], v[52:55]
    v_rcp_f32 v229, v229
    v_mfma_f32_16x16x32_bf16 v[52:55], v[196:199], a[88:91], v[52:55]
    s_cbranch_vccnz L_spin_6
L_back_7:
    ds_read_b64_tr_b16 v[214:215], v233 offset:6144
    v_mul_f32 v86, s3, v86
    v_mul_f32 v87, s3, v87
    v_cvt_pk_bf16_f32 v68, v68, v69
    v_cvt_pk_bf16_f32 v69, v70, v71
    v_cvt_pk_bf16_f32 v70, v84, v85
    v_cvt_pk_bf16_f32 v71, v86, v87
    v_accvgpr_write_b32 a4, v68
    v_accvgpr_write_b32 a5, v69
    v_accvgpr_write_b32 a6, v70
    v_mfma_f32_16x16x32_bf16 v[60:63], v[192:195], a[76:79], v[60:63]
    v_accvgpr_write_b32 a7, v71
    v_rcp_f32 v224, v224
    v_mfma_f32_16x16x32_bf16 v[60:63], v[196:199], a[92:95], v[60:63]
    s_waitcnt lgkmcnt(4)
    ds_read_b64_tr_b16 v[192:193], v234 offset:0
    v_mul_f32 v104, v104, v228
    v_mfma_f32_16x16x32_bf16 v[0:3], v[200:203], a[96:99], v[0:3]
    v_mul_f32 v105, v105, v229
    v_rcp_f32 v225, v225
    v_mfma_f32_16x16x32_bf16 v[0:3], v[204:207], a[112:115], v[0:3]
    s_lshl_b32 s56, s53, 19
    s_lshl_b32 s84, s52, 12
    ds_read_b64_tr_b16 v[194:195], v234 offset:2048
    v_mfma_f32_16x16x32_bf16 v[8:11], v[200:203], a[100:103], v[8:11]
    s_add_u32 s56, s56, s84
    s_add_u32 s56, s56, 2097152
    s_add_u32 m0, s84, 98304
    v_mfma_f32_16x16x32_bf16 v[8:11], v[204:207], a[116:119], v[8:11]
    ds_read_b64_tr_b16 v[196:197], v234 offset:4096
    v_mul_f32 v228, v106, v106
    v_mfma_f32_16x16x32_bf16 v[16:19], v[200:203], a[104:107], v[16:19]
    buffer_load_dwordx4 v245, s[48:51], s56 offen offset:0 sc1 lds
    v_mfma_f32_16x16x32_bf16 v[16:19], v[204:207], a[120:123], v[16:19]
    ds_read_b64_tr_b16 v[198:199], v234 offset:6144
    v_mul_f32 v108, v108, v224
    v_mfma_f32_16x16x32_bf16 v[24:27], v[200:203], a[108:111], v[24:27]
    v_mul_f32 v229, v107, v107
    v_mul_f32 v109, v109, v225
    v_mul_f32 v132, s3, v132
    v_mfma_f32_16x16x32_bf16 v[24:27], v[204:207], a[124:127], v[24:27]
    s_waitcnt lgkmcnt(4)
    ds_read_b64_tr_b16 v[200:201], v235 offset:0
    ds_read_b64_tr_b16 v[202:203], v235 offset:2048
    v_mfma_f32_16x16x32_bf16 v[4:7], v[208:211], a[96:99], v[4:7]
    ds_read_b64_tr_b16 v[204:205], v235 offset:4096
    ds_read_b64_tr_b16 v[206:207], v235 offset:6144
    v_mfma_f32_16x16x32_bf16 v[4:7], v[212:215], a[112:115], v[4:7]
    buffer_load_dwordx4 v245, s[48:51], s56 offen offset:1024 sc1 lds
    v_mfma_f32_16x16x32_bf16 v[12:15], v[208:211], a[100:103], v[12:15]
    v_fmaak_f32 v228, v228, v230, 0xc0135761
    v_mul_f32 v224, v110, v110
    v_mfma_f32_16x16x32_bf16 v[12:15], v[212:215], a[116:119], v[12:15]
    v_fmaak_f32 v229, v229, v230, 0xc0135761
    v_mul_f32 v133, s3, v133
    v_mul_f32 v134, s3, v134
    v_mfma_f32_16x16x32_bf16 v[20:23], v[208:211], a[104:107], v[20:23]
    v_mul_f32 v228, v228, v106
    v_mul_f32 v135, s3, v135
    v_mfma_f32_16x16x32_bf16 v[20:23], v[212:215], a[120:123], v[20:23]
    buffer_load_dwordx4 v245, s[48:51], s56 offen offset:2048 sc1 lds
    v_mfma_f32_16x16x32_bf16 v[28:31], v[208:211], a[108:111], v[28:31]
    v_mul_f32 v225, v111, v111
    v_fmaak_f32 v224, v224, v230, 0xc0135761
    v_mul_f32 v148, s3, v148
    v_mfma_f32_16x16x32_bf16 v[28:31], v[212:215], a[124:127], v[28:31]
    v_mul_f32 v229, v229, v107
    v_fmaak_f32 v225, v225, v230, 0xc0135761
    v_mul_f32 v149, s3, v149
    v_mul_f32 v150, s3, v150
    v_mul_f32 v151, s3, v151
    v_cvt_pk_bf16_f32 v132, v132, v133
    v_cvt_pk_bf16_f32 v133, v134, v135
    v_cvt_pk_bf16_f32 v134, v148, v149
    v_cvt_pk_bf16_f32 v135, v150, v151
    v_accvgpr_write_b32 a20, v132
    v_accvgpr_write_b32 a21, v133
    s_waitcnt lgkmcnt(4)
    v_mfma_f32_16x16x32_bf16 v[32:35], v[192:195], a[96:99], v[32:35]
    v_accvgpr_write_b32 a22, v134
    v_exp_f32 v228, v228
    v_mfma_f32_16x16x32_bf16 v[32:35], v[196:199], a[112:115], v[32:35]
    buffer_load_dwordx4 v245, s[48:51], s56 offen offset:3072 sc1 lds
    v_accvgpr_write_b32 a23, v135
    v_mfma_f32_16x16x32_bf16 v[40:43], v[192:195], a[100:103], v[40:43]
    s_waitcnt lgkmcnt(0)
    s_barrier
    s_add_u32 m0, s84, 114688
    v_mfma_f32_16x16x32_bf16 v[40:43], v[196:199], a[116:119], v[40:43]
    s_mov_b32 s83, 0
    v_subrev_u32 v232, 0x10000, v232
    v_subrev_u32 v233, 0x10000, v233
    v_subrev_u32 v234, 0x10000, v234
    v_subrev_u32 v235, 0x10000, v235
    ds_read_b64_tr_b16 v[208:209], v232 offset:16384
    v_mfma_f32_16x16x32_bf16 v[48:51], v[192:195], a[104:107], v[48:51]
    ds_read_b64_tr_b16 v[210:211], v232 offset:18432
    ds_read_b64_tr_b16 v[212:213], v232 offset:20480
    v_mul_f32 v72, s3, v72
    v_mfma_f32_16x16x32_bf16 v[48:51], v[196:199], a[120:123], v[48:51]
    ds_read_b64_tr_b16 v[214:215], v232 offset:22528
    v_mul_f32 v73, s3, v73
    v_mfma_f32_16x16x32_bf16 v[56:59], v[192:195], a[108:111], v[56:59]
    buffer_load_dwordx4 v245, s[32:35], s83 offen offset:0 sc1 lds
    v_mul_f32 v224, v224, v110
    v_mul_f32 v74, s3, v74
    v_mfma_f32_16x16x32_bf16 v[56:59], v[196:199], a[124:127], v[56:59]
    ds_read_b64_tr_b16 v[192:193], v233 offset:16384
    v_mul_f32 v225, v225, v111
    v_mul_f32 v75, s3, v75
    v_mfma_f32_16x16x32_bf16 v[36:39], v[200:203], a[96:99], v[36:39]
    v_exp_f32 v229, v229
    v_mfma_f32_16x16x32_bf16 v[36:39], v[204:207], a[112:115], v[36:39]
    ds_read_b64_tr_b16 v[194:195], v233 offset:18432
    v_mul_f32 v106, v106, v122
    v_mul_f32 v88, s3, v88
    v_mfma_f32_16x16x32_bf16 v[44:47], v[200:203], a[100:103], v[44:47]
    buffer_load_dwordx4 v245, s[32:35], s83 offen offset:1024 sc1 lds
    v_mul_f32 v89, s3, v89
    v_mfma_f32_16x16x32_bf16 v[44:47], v[204:207], a[116:119], v[44:47]
    ds_read_b64_tr_b16 v[196:197], v233 offset:20480
    v_mul_f32 v107, v107, v123
    v_mul_f32 v90, s3, v90
    v_mul_f32 v91, s3, v91
    v_mfma_f32_16x16x32_bf16 v[52:55], v[200:203], a[104:107], v[52:55]
    v_exp_f32 v224, v224
    v_mfma_f32_16x16x32_bf16 v[52:55], v[204:207], a[120:123], v[52:55]
    ds_read_b64_tr_b16 v[198:199], v233 offset:22528
    v_add_f32 v228, 1.0, v228
    v_add_f32 v229, 1.0, v229
    v_mfma_f32_16x16x32_bf16 v[60:63], v[200:203], a[108:111], v[60:63]
    buffer_load_dwordx4 v245, s[32:35], s83 offen offset:2048 sc1 lds
    v_cvt_pk_bf16_f32 v72, v72, v73
    v_cvt_pk_bf16_f32 v73, v74, v75
    v_mfma_f32_16x16x32_bf16 v[60:63], v[204:207], a[124:127], v[60:63]
    s_waitcnt lgkmcnt(4)
    ds_read_b64_tr_b16 v[200:201], v234 offset:16384
    ds_read_b64_tr_b16 v[202:203], v234 offset:18432
    v_exp_f32 v225, v225
    v_mfma_f32_16x16x32_bf16 v[0:3], v[208:211], a[128:131], v[0:3]
    v_cvt_pk_bf16_f32 v74, v88, v89
    v_rcp_f32 v228, v228
    v_rcp_f32 v229, v229
    v_mfma_f32_16x16x32_bf16 v[0:3], v[212:215], a[144:147], v[0:3]
    v_mul_f32 v110, v110, v126
    v_mul_f32 v111, v111, v127
    v_add_f32 v224, 1.0, v224
    v_add_f32 v225, 1.0, v225
    v_rcp_f32 v224, v224
    v_mfma_f32_16x16x32_bf16 v[8:11], v[208:211], a[132:135], v[8:11]
    buffer_load_dwordx4 v245, s[32:35], s83 offen offset:3072 sc1 lds
    v_cvt_pk_bf16_f32 v75, v90, v91
    v_mfma_f32_16x16x32_bf16 v[8:11], v[212:215], a[148:151], v[8:11]
    s_add_u32 m0, s84, 131072
    ds_read_b64_tr_b16 v[204:205], v234 offset:20480
    v_accvgpr_write_b32 a8, v72
    v_mfma_f32_16x16x32_bf16 v[16:19], v[208:211], a[136:139], v[16:19]
    s_and_b32 s58, s55, 3
    v_accvgpr_write_b32 a9, v73
    v_rcp_f32 v225, v225
    v_mfma_f32_16x16x32_bf16 v[16:19], v[212:215], a[152:155], v[16:19]
    s_mov_b32 s83, 8192
    s_bfe_u32 s73, s55, 0x10002
    ds_read_b64_tr_b16 v[206:207], v234 offset:22528
    v_accvgpr_write_b32 a10, v74
    v_accvgpr_write_b32 a11, v75
    v_mfma_f32_16x16x32_bf16 v[24:27], v[208:211], a[140:143], v[24:27]
    buffer_load_dwordx4 v245, s[32:35], s83 offen offset:0 sc1 lds
    v_mul_f32 v106, v106, v228
    v_mfma_f32_16x16x32_bf16 v[24:27], v[212:215], a[156:159], v[24:27]
    s_waitcnt lgkmcnt(4)
    ds_read_b64_tr_b16 v[208:209], v235 offset:16384
    v_mul_f32 v107, v107, v229
    v_mul_f32 v136, s3, v136
    v_mfma_f32_16x16x32_bf16 v[4:7], v[192:195], a[128:131], v[4:7]
    s_lshr_b32 s74, s55, 3
    s_lshl_b32 s64, s73, 5
    v_cvt_pk_bf16_f32 v104, v104, v105
    v_mul_f32 v110, v110, v224
    v_mfma_f32_16x16x32_bf16 v[4:7], v[196:199], a[144:147], v[4:7]
    s_add_u32 s64, s64, s74
    ds_read_b64_tr_b16 v[210:211], v235 offset:18432
    v_mul_f32 v137, s3, v137
    v_mfma_f32_16x16x32_bf16 v[12:15], v[192:195], a[132:135], v[12:15]
    buffer_load_dwordx4 v245, s[32:35], s83 offen offset:1024 sc1 lds
    v_mul_f32 v138, s3, v138
    v_mfma_f32_16x16x32_bf16 v[12:15], v[196:199], a[148:151], v[12:15]
    s_add_u32 s0, s67, s99
    ds_read_b64_tr_b16 v[212:213], v235 offset:20480
    v_cvt_pk_bf16_f32 v105, v106, v107
    v_mfma_f32_16x16x32_bf16 v[20:23], v[192:195], a[136:139], v[20:23]
    s_lshr_b32 s60, s74, 3
    s_and_b32 s74, s74, 7
    v_mul_f32 v111, v111, v225
    v_mfma_f32_16x16x32_bf16 v[20:23], v[196:199], a[152:155], v[20:23]
    ds_read_b64_tr_b16 v[214:215], v235 offset:22528
    buffer_store_dwordx2 v[104:105], v252, s[48:51], s0 offen sc1
    v_mul_f32 v139, s3, v139
    v_mfma_f32_16x16x32_bf16 v[28:31], v[192:195], a[140:143], v[28:31]
    buffer_load_dwordx4 v245, s[32:35], s83 offen offset:2048 sc1 lds
    v_cvt_pk_bf16_f32 v108, v108, v109
    v_mfma_f32_16x16x32_bf16 v[28:31], v[196:199], a[156:159], v[28:31]
    s_waitcnt lgkmcnt(4)
    ds_read_b64_tr_b16 v[192:193], v232 offset:24576
    v_cvt_pk_bf16_f32 v109, v110, v111
    v_mfma_f32_16x16x32_bf16 v[32:35], v[200:203], a[128:131], v[32:35]
    s_add_u32 s1, s68, s99
    ds_read_b64_tr_b16 v[194:195], v232 offset:26624
    v_mul_f32 v152, s3, v152
    v_mfma_f32_16x16x32_bf16 v[32:35], v[204:207], a[144:147], v[32:35]
    buffer_store_dwordx2 v[108:109], v252, s[48:51], s1 offen sc1
    v_mfma_f32_16x16x32_bf16 v[40:43], v[200:203], a[132:135], v[40:43]
    buffer_load_dwordx4 v245, s[32:35], s83 offen offset:3072 sc1 lds
    v_mfma_f32_16x16x32_bf16 v[40:43], v[204:207], a[148:151], v[40:43]
    s_add_u32 m0, s84, 147456
    s_mov_b32 s83, 16384
    ds_read_b64_tr_b16 v[196:197], v232 offset:28672
    v_mfma_f32_16x16x32_bf16 v[48:51], v[200:203], a[136:139], v[48:51]
    s_lshl_b32 s73, s73, 3
    v_mul_f32 v153, s3, v153
    v_mfma_f32_16x16x32_bf16 v[48:51], v[204:207], a[152:155], v[48:51]
    s_add_u32 s59, s73, s74
    ds_read_b64_tr_b16 v[198:199], v232 offset:30720
    v_lshrrev_b32 v220, 4, v255
    v_mfma_f32_16x16x32_bf16 v[56:59], v[200:203], a[140:143], v[56:59]
    buffer_load_dwordx4 v245, s[32:35], s83 offen offset:0 sc1 lds
    v_mfma_f32_16x16x32_bf16 v[56:59], v[204:207], a[156:159], v[56:59]
    s_waitcnt lgkmcnt(4)
    ds_read_b64_tr_b16 v[200:201], v233 offset:24576
    v_and_b32 v221, 15, v255
    v_mfma_f32_16x16x32_bf16 v[36:39], v[208:211], a[128:131], v[36:39]
    v_mul_f32 v154, s3, v154
    v_mov_b64 v[96:97], 0
    v_mfma_f32_16x16x32_bf16 v[36:39], v[212:215], a[144:147], v[36:39]
    ds_read_b64_tr_b16 v[202:203], v233 offset:26624
    v_lshlrev_b32 v222, 1, v220
    v_mfma_f32_16x16x32_bf16 v[44:47], v[208:211], a[132:135], v[44:47]
    buffer_load_dwordx4 v245, s[32:35], s83 offen offset:1024 sc1 lds
    v_mfma_f32_16x16x32_bf16 v[44:47], v[212:215], a[148:151], v[44:47]
    ds_read_b64_tr_b16 v[204:205], v233 offset:28672
    v_xor_b32 v222, v222, v221
    v_mfma_f32_16x16x32_bf16 v[52:55], v[208:211], a[136:139], v[52:55]
    v_mul_f32 v155, s3, v155
    v_mov_b64 v[98:99], 0
    v_mfma_f32_16x16x32_bf16 v[52:55], v[212:215], a[152:155], v[52:55]
    ds_read_b64_tr_b16 v[206:207], v233 offset:30720
    v_lshlrev_b32 v222, 4, v222
    v_mfma_f32_16x16x32_bf16 v[60:63], v[208:211], a[140:143], v[60:63]
    buffer_load_dwordx4 v245, s[32:35], s83 offen offset:2048 sc1 lds
    v_mfma_f32_16x16x32_bf16 v[60:63], v[212:215], a[156:159], v[60:63]
    s_waitcnt lgkmcnt(4)
    ds_read_b64_tr_b16 v[208:209], v234 offset:24576
    v_lshl_add_u32 v222, v220, 10, v222
    v_mfma_f32_16x16x32_bf16 v[0:3], v[192:195], a[160:163], v[0:3]
    v_cvt_pk_bf16_f32 v136, v136, v137
    v_mov_b64 v[100:101], 0
    v_mfma_f32_16x16x32_bf16 v[0:3], v[196:199], a[176:179], v[0:3]
    s_lshl_b32 s73, s52, 13
    ds_read_b64_tr_b16 v[210:211], v234 offset:26624
    v_cvt_pk_bf16_f32 v137, v138, v139
    v_mfma_f32_16x16x32_bf16 v[8:11], v[192:195], a[164:167], v[8:11]
    buffer_load_dwordx4 v245, s[32:35], s83 offen offset:3072 sc1 lds
    v_mfma_f32_16x16x32_bf16 v[8:11], v[196:199], a[180:183], v[8:11]
    s_lshl_b32 s74, s60, 8
    ds_read_b64_tr_b16 v[212:213], v234 offset:28672
    v_cvt_pk_bf16_f32 v138, v152, v153
    v_mfma_f32_16x16x32_bf16 v[16:19], v[192:195], a[168:171], v[16:19]
    s_add_u32 s73, s73, s74
    v_cvt_pk_bf16_f32 v139, v154, v155
    v_mov_b64 v[102:103], 0
    v_accvgpr_write_b32 a144, v240
    v_mfma_f32_16x16x32_bf16 v[16:19], v[196:199], a[184:187], v[16:19]
    ds_read_b64_tr_b16 v[214:215], v234 offset:30720
    v_accvgpr_write_b32 a24, v136
    v_mfma_f32_16x16x32_bf16 v[24:27], v[192:195], a[172:175], v[24:27]
    v_accvgpr_write_b32 a25, v137
    v_mov_b64 v[104:105], 0
    v_accvgpr_write_b32 a145, v240
    v_mfma_f32_16x16x32_bf16 v[24:27], v[196:199], a[188:191], v[24:27]
    s_waitcnt lgkmcnt(4)
    ds_read_b64_tr_b16 v[192:193], v235 offset:24576
    v_accvgpr_write_b32 a26, v138
    v_mfma_f32_16x16x32_bf16 v[4:7], v[200:203], a[160:163], v[4:7]
    v_add_u32 v243, s73, v222
    v_mov_b64 v[106:107], 0
    v_mfma_f32_16x16x32_bf16 v[4:7], v[204:207], a[176:179], v[4:7]
    ds_read_b64_tr_b16 v[194:195], v235 offset:26624
    v_accvgpr_write_b32 a27, v139
    v_mfma_f32_16x16x32_bf16 v[12:15], v[200:203], a[164:167], v[12:15]
    v_xor_b32 v244, 128, v243
    v_mov_b64 v[108:109], 0
    v_mfma_f32_16x16x32_bf16 v[12:15], v[204:207], a[180:183], v[12:15]
    ds_read_b64_tr_b16 v[196:197], v235 offset:28672
    v_mul_f32 v76, s3, v76
    v_mfma_f32_16x16x32_bf16 v[20:23], v[200:203], a[168:171], v[20:23]
    v_add_u32 v244, 3072, v244
    v_mov_b64 v[110:111], 0
    v_accvgpr_write_b32 a146, v240
    v_mfma_f32_16x16x32_bf16 v[20:23], v[204:207], a[184:187], v[20:23]
    ds_read_b64_tr_b16 v[198:199], v235 offset:30720
    v_mul_f32 v77, s3, v77
    v_mfma_f32_16x16x32_bf16 v[28:31], v[200:203], a[172:175], v[28:31]
    s_lshl_b32 s73, s59, 1
    v_mul_f32 v78, s3, v78
    v_mov_b64 v[112:113], 0
    v_mfma_f32_16x16x32_bf16 v[28:31], v[204:207], a[188:191], v[28:31]
    s_waitcnt lgkmcnt(4)
    v_add_u32 v232, 0x10000, v232
    v_add_u32 v233, 0x10000, v233
    v_add_u32 v234, 0x10000, v234
    v_add_u32 v235, 0x10000, v235
    ds_read_b64_tr_b16 v[200:201], v232 offset:8192
    v_mfma_f32_16x16x32_bf16 v[32:35], v[208:211], a[160:163], v[32:35]
    s_mov_b32 s80, 0x11111111
    v_mul_f32 v79, s3, v79
    v_accvgpr_write_b32 a147, v240
    v_mfma_f32_16x16x32_bf16 v[32:35], v[212:215], a[176:179], v[32:35]
    s_lshr_b32 s74, s52, 1
    ds_read_b64_tr_b16 v[202:203], v232 offset:10240
    v_mul_f32 v92, s3, v92
    v_mfma_f32_16x16x32_bf16 v[40:43], v[208:211], a[164:167], v[40:43]
    s_mov_b32 s81, 0x11111111
    s_add_u32 s73, s73, s74
    v_mul_f32 v93, s3, v93
    v_mfma_f32_16x16x32_bf16 v[40:43], v[212:215], a[180:183], v[40:43]
    ds_read_b64_tr_b16 v[204:205], v232 offset:12288
    v_mul_f32 v94, s3, v94
    v_mfma_f32_16x16x32_bf16 v[48:51], v[208:211], a[168:171], v[48:51]
    s_and_b32 s74, s52, 1
    v_mul_f32 v95, s3, v95
    v_mov_b64 v[114:115], 0
    v_accvgpr_write_b32 a128, 0
    v_mfma_f32_16x16x32_bf16 v[48:51], v[212:215], a[184:187], v[48:51]
    s_lshl_b32 s65, s54, 2
    ds_read_b64_tr_b16 v[206:207], v232 offset:14336
    v_cvt_pk_bf16_f32 v76, v76, v77
    v_mfma_f32_16x16x32_bf16 v[56:59], v[208:211], a[172:175], v[56:59]
    v_cvt_pk_bf16_f32 v77, v78, v79
    v_mov_b64 v[116:117], 0
    v_mfma_f32_16x16x32_bf16 v[56:59], v[212:215], a[188:191], v[56:59]
    s_waitcnt lgkmcnt(4)
    s_lshl_b32 s74, s74, 11
    ds_read_b64_tr_b16 v[208:209], v233 offset:8192
    v_mfma_f32_16x16x32_bf16 v[36:39], v[192:195], a[160:163], v[36:39]
    s_mul_i32 s75, s73, 176128
    v_cvt_pk_bf16_f32 v78, v92, v93
    v_accvgpr_write_b32 a129, 0
    v_mfma_f32_16x16x32_bf16 v[36:39], v[196:199], a[176:179], v[36:39]
    s_sub_u32 s65, 60, s65
    ds_read_b64_tr_b16 v[210:211], v233 offset:10240
    v_mfma_f32_16x16x32_bf16 v[44:47], v[192:195], a[164:167], v[44:47]
    v_cvt_pk_bf16_f32 v79, v94, v95
    v_mov_b64 v[118:119], 0
    v_mfma_f32_16x16x32_bf16 v[44:47], v[196:199], a[180:183], v[44:47]
    s_add_u32 s75, s75, s74
    ds_read_b64_tr_b16 v[212:213], v233 offset:12288
    v_accvgpr_write_b32 a12, v76
    v_mfma_f32_16x16x32_bf16 v[52:55], v[192:195], a[168:171], v[52:55]
    s_add_u32 s75, s75, 52428800
    v_accvgpr_write_b32 a13, v77
    v_accvgpr_write_b32 a130, 0
    v_mfma_f32_16x16x32_bf16 v[52:55], v[196:199], a[184:187], v[52:55]
    s_mov_b32 s62, 0x1100
    ds_read_b64_tr_b16 v[214:215], v233 offset:14336
    v_mfma_f32_16x16x32_bf16 v[60:63], v[192:195], a[172:175], v[60:63]
    s_add_u32 s8, s48, s75
    s_addc_u32 s9, s49, 0
    v_accvgpr_write_b32 a14, v78
    v_mfma_f32_16x16x32_bf16 v[60:63], v[196:199], a[188:191], v[60:63]
    s_waitcnt lgkmcnt(4)
    ds_read_b64_tr_b16 v[192:193], v234 offset:8192
    v_accvgpr_write_b32 a15, v79
    v_mfma_f32_16x16x32_bf16 v[0:3], v[200:203], a[192:195], v[0:3]
    s_mov_b32 s63, 0
    v_mul_f32 v140, s3, v140
    v_accvgpr_write_b32 a131, 0
    v_mfma_f32_16x16x32_bf16 v[0:3], v[204:207], a[208:211], v[0:3]
    s_sub_u32 s10, 176128, s74
    ds_read_b64_tr_b16 v[194:195], v234 offset:10240
    v_mul_f32 v141, s3, v141
    v_mfma_f32_16x16x32_bf16 v[8:11], v[200:203], a[196:199], v[8:11]
    v_mul_f32 v142, s3, v142
    v_mul_f32 v143, s3, v143
    v_accvgpr_write_b32 a132, 0
    v_mfma_f32_16x16x32_bf16 v[8:11], v[204:207], a[212:215], v[8:11]
    s_lshl_b32 s73, s73, 19
    v_mul_f32 v156, s3, v156
    v_mul_f32 v157, s3, v157
    v_mul_f32 v158, s3, v158
    v_mul_f32 v159, s3, v159
    v_cvt_pk_bf16_f32 v140, v140, v141
    v_cvt_pk_bf16_f32 v141, v142, v143
    v_cvt_pk_bf16_f32 v142, v156, v157
    v_cvt_pk_bf16_f32 v143, v158, v159
    v_accvgpr_write_b32 a28, v140
    v_accvgpr_write_b32 a29, v141
    v_accvgpr_write_b32 a30, v142
    v_accvgpr_write_b32 a31, v143
    v_mfma_f32_16x16x32_bf16 v[16:19], v[200:203], a[200:203], v[16:19]
    s_mov_b32 s61, 0x40004000
    ds_read_b64_tr_b16 v[196:197], v234 offset:12288
    v_mov_b64 v[120:121], 0
    v_mfma_f32_16x16x32_bf16 v[16:19], v[204:207], a[216:219], v[16:19]
    s_lshl_b32 s75, s58, 17
    ds_read_b64_tr_b16 v[198:199], v234 offset:14336
    v_mov_b64 v[122:123], 0
    v_mfma_f32_16x16x32_bf16 v[24:27], v[200:203], a[204:207], v[24:27]
    s_add_u32 s73, s73, s75
    v_mov_b64 v[124:125], 0
    v_mfma_f32_16x16x32_bf16 v[24:27], v[204:207], a[220:223], v[24:27]
    s_waitcnt lgkmcnt(4)
    ds_read_b64_tr_b16 v[200:201], v235 offset:8192
    v_mov_b64 v[64:65], 0
    v_mfma_f32_16x16x32_bf16 v[4:7], v[208:211], a[192:195], v[4:7]
    s_bitset1_b64 s[62:63], s86
    v_mov_b64 v[66:67], 0
    v_accvgpr_write_b32 a133, 0
    v_mfma_f32_16x16x32_bf16 v[4:7], v[212:215], a[208:211], v[4:7]
    ds_read_b64_tr_b16 v[202:203], v235 offset:10240
    v_mov_b64 v[68:69], 0
    v_mfma_f32_16x16x32_bf16 v[12:15], v[208:211], a[196:199], v[12:15]
    s_add_u32 s73, s73, s74
    v_mov_b64 v[126:127], 0
    v_mfma_f32_16x16x32_bf16 v[12:15], v[212:215], a[212:215], v[12:15]
    ds_read_b64_tr_b16 v[204:205], v235 offset:12288
    v_mov_b64 v[70:71], 0
    v_mfma_f32_16x16x32_bf16 v[20:23], v[208:211], a[200:203], v[20:23]
    s_add_u32 s73, s73, 35651584
    v_mov_b64 v[72:73], 0
    v_mfma_f32_16x16x32_bf16 v[20:23], v[212:215], a[216:219], v[20:23]
    s_bitset1_b64 s[62:63], s90
    ds_read_b64_tr_b16 v[206:207], v235 offset:14336
    v_accvgpr_write_b32 a134, 0
    v_mfma_f32_16x16x32_bf16 v[28:31], v[208:211], a[204:207], v[28:31]
    s_add_u32 s12, s48, s73
    s_addc_u32 s13, s49, 0
    v_mov_b64 v[74:75], 0
    v_mfma_f32_16x16x32_bf16 v[28:31], v[212:215], a[220:223], v[28:31]
    s_waitcnt lgkmcnt(4)
    s_bitset1_b64 s[62:63], s87
    ds_read_b64_tr_b16 v[208:209], v232 offset:16384
    v_mfma_f32_16x16x32_bf16 v[32:35], v[192:195], a[192:195], v[32:35]
    s_bitset1_b64 s[62:63], s91
    v_mov_b64 v[76:77], 0
    v_mfma_f32_16x16x32_bf16 v[32:35], v[196:199], a[208:211], v[32:35]
    s_sub_u32 s14, 131072, s74
    ds_read_b64_tr_b16 v[210:211], v232 offset:18432
    v_mov_b64 v[78:79], 0
    v_mfma_f32_16x16x32_bf16 v[40:43], v[192:195], a[196:199], v[40:43]
    s_lshl_b32 s74, s58, 20
    v_accvgpr_write_b32 a135, 0
    v_mfma_f32_16x16x32_bf16 v[40:43], v[196:199], a[212:215], v[40:43]
    ds_read_b64_tr_b16 v[212:213], v232 offset:20480
    v_mov_b64 v[80:81], 0
    v_mfma_f32_16x16x32_bf16 v[48:51], v[192:195], a[200:203], v[48:51]
    s_add_u32 s24, s24, s74
    s_addc_u32 s25, s25, 0
    v_accvgpr_write_b32 a136, 0
    v_mfma_f32_16x16x32_bf16 v[48:51], v[196:199], a[216:219], v[48:51]
    ds_read_b64_tr_b16 v[214:215], v232 offset:22528
    v_mov_b64 v[82:83], 0
    v_mfma_f32_16x16x32_bf16 v[56:59], v[192:195], a[204:207], v[56:59]
    s_bitset1_b64 s[62:63], s88
    s_mov_b32 s26, 1048576
    v_accvgpr_write_b32 a137, 0
    v_mfma_f32_16x16x32_bf16 v[56:59], v[196:199], a[220:223], v[56:59]
    s_waitcnt lgkmcnt(4)
    ds_read_b64_tr_b16 v[192:193], v233 offset:16384
    v_mov_b64 v[84:85], 0
    v_mfma_f32_16x16x32_bf16 v[36:39], v[200:203], a[192:195], v[36:39]
    s_mul_i32 s94, s58, 45056
    ds_read_b64_tr_b16 v[194:195], v233 offset:18432
    v_accvgpr_write_b32 a138, 0
    v_mfma_f32_16x16x32_bf16 v[36:39], v[204:207], a[208:211], v[36:39]
    v_mov_b64 v[86:87], 0
    v_mfma_f32_16x16x32_bf16 v[44:47], v[200:203], a[196:199], v[44:47]
    s_bitset1_b64 s[62:63], s92
    v_accvgpr_write_b32 a139, 0
    v_mfma_f32_16x16x32_bf16 v[44:47], v[204:207], a[212:215], v[44:47]
    s_mul_i32 s95, s58, 360448
    ds_read_b64_tr_b16 v[196:197], v233 offset:20480
    v_mov_b64 v[88:89], 0
    v_mfma_f32_16x16x32_bf16 v[52:55], v[200:203], a[200:203], v[52:55]
    v_mov_b64 v[90:91], 0
    v_mfma_f32_16x16x32_bf16 v[52:55], v[204:207], a[216:219], v[52:55]
    ds_read_b64_tr_b16 v[198:199], v233 offset:22528
    v_mfma_f32_16x16x32_bf16 v[60:63], v[200:203], a[204:207], v[60:63]
    s_bitset1_b64 s[62:63], s89
    s_bitset1_b64 s[62:63], s93
    v_mov_b64 v[92:93], 0
    v_mfma_f32_16x16x32_bf16 v[60:63], v[204:207], a[220:223], v[60:63]
    s_waitcnt lgkmcnt(4)
    s_lshl_b32 s73, s59, 2
    s_add_u32 s73, s73, s52
    v_mfma_f32_16x16x32_bf16 v[0:3], v[208:211], a[224:227], v[0:3]
    v_mov_b64 v[94:95], 0
    v_mfma_f32_16x16x32_bf16 v[0:3], v[212:215], a[240:243], v[0:3]
    s_lshl_b32 s73, s73, 15
    ds_read_b64_tr_b16 v[200:201], v234 offset:16384
    v_mfma_f32_16x16x32_bf16 v[8:11], v[208:211], a[228:231], v[8:11]
    ds_read_b64_tr_b16 v[202:203], v234 offset:18432
    v_mov_b64 v[128:129], 0
    v_mfma_f32_16x16x32_bf16 v[8:11], v[212:215], a[244:247], v[8:11]
    s_lshl_b32 s74, s60, 8
    ds_read_b64_tr_b16 v[204:205], v234 offset:20480
    v_accvgpr_write_b32 a140, 0
    v_mfma_f32_16x16x32_bf16 v[16:19], v[208:211], a[232:235], v[16:19]
    s_bitset1_b64 s[62:63], s65
    v_mov_b64 v[130:131], 0
    v_mfma_f32_16x16x32_bf16 v[16:19], v[212:215], a[248:251], v[16:19]
    s_add_u32 s73, s73, s74
    ds_read_b64_tr_b16 v[206:207], v234 offset:22528
    v_accvgpr_write_b32 a141, 0
    v_mfma_f32_16x16x32_bf16 v[24:27], v[208:211], a[236:239], v[24:27]
    v_mov_b64 v[132:133], 0
    v_mfma_f32_16x16x32_bf16 v[24:27], v[212:215], a[252:255], v[24:27]
    s_waitcnt lgkmcnt(4)
    s_and_b32 s74, s58, 1
    ds_read_b64_tr_b16 v[208:209], v235 offset:16384
    v_mfma_f32_16x16x32_bf16 v[4:7], v[192:195], a[224:227], v[4:7]
    s_lshl_b32 s74, s74, 14
    v_mov_b64 v[134:135], 0
    v_mfma_f32_16x16x32_bf16 v[4:7], v[196:199], a[240:243], v[4:7]
    ds_read_b64_tr_b16 v[210:211], v235 offset:18432
    v_mov_b64 v[136:137], 0
    v_mfma_f32_16x16x32_bf16 v[12:15], v[192:195], a[228:231], v[12:15]
    v_accvgpr_write_b32 a142, 0
    v_accvgpr_write_b32 a143, 0
    v_mfma_f32_16x16x32_bf16 v[12:15], v[196:199], a[244:247], v[12:15]
    s_or_b64 s[80:81], s[80:81], s[62:63]
    ds_read_b64_tr_b16 v[212:213], v235 offset:20480
    v_mov_b64 v[138:139], 0
    v_mfma_f32_16x16x32_bf16 v[20:23], v[192:195], a[232:235], v[20:23]
    s_add_u32 s73, s73, s74
    v_mfma_f32_16x16x32_bf16 v[20:23], v[196:199], a[248:251], v[20:23]
    v_mov_b64 v[140:141], 0
    v_mfma_f32_16x16x32_bf16 v[28:31], v[192:195], a[236:239], v[28:31]
    s_lshr_b32 s74, s58, 1
    s_lshl_b32 s74, s74, 7
    ds_read_b64_tr_b16 v[214:215], v235 offset:22528
    v_mfma_f32_16x16x32_bf16 v[28:31], v[196:199], a[252:255], v[28:31]
    s_waitcnt lgkmcnt(4)
    v_mov_b64 v[142:143], 0
    v_mfma_f32_16x16x32_bf16 v[32:35], v[200:203], a[224:227], v[32:35]
    v_mov_b64 v[144:145], 0
    v_mfma_f32_16x16x32_bf16 v[32:35], v[204:207], a[240:243], v[32:35]
    v_mfma_f32_16x16x32_bf16 v[40:43], v[200:203], a[228:231], v[40:43]
    s_add_u32 s73, s73, s74
    v_mfma_f32_16x16x32_bf16 v[40:43], v[204:207], a[244:247], v[40:43]
    v_mov_b64 v[146:147], 0
    v_mfma_f32_16x16x32_bf16 v[48:51], v[200:203], a[232:235], v[48:51]
    v_lshlrev_b32 v222, 10, v221
    v_mfma_f32_16x16x32_bf16 v[48:51], v[204:207], a[248:251], v[48:51]
    v_mov_b64 v[148:149], 0
    v_mfma_f32_16x16x32_bf16 v[56:59], v[200:203], a[236:239], v[56:59]
    v_lshl_add_u32 v222, v220, 3, v222
    v_mfma_f32_16x16x32_bf16 v[56:59], v[204:207], a[252:255], v[56:59]
    s_waitcnt lgkmcnt(0)
    v_mov_b64 v[150:151], 0
    v_mfma_f32_16x16x32_bf16 v[36:39], v[208:211], a[224:227], v[36:39]
    v_add_u32 v252, s73, v222
    v_mfma_f32_16x16x32_bf16 v[36:39], v[212:215], a[240:243], v[36:39]
    v_mov_b64 v[152:153], 0
    v_mfma_f32_16x16x32_bf16 v[44:47], v[208:211], a[228:231], v[44:47]
    v_mov_b64 v[154:155], 0
    v_mfma_f32_16x16x32_bf16 v[44:47], v[212:215], a[244:247], v[44:47]
    v_mfma_f32_16x16x32_bf16 v[52:55], v[208:211], a[232:235], v[52:55]
    v_mov_b64 v[156:157], 0
    v_mfma_f32_16x16x32_bf16 v[52:55], v[212:215], a[248:251], v[52:55]
    v_mov_b64 v[158:159], 0
    v_mfma_f32_16x16x32_bf16 v[60:63], v[208:211], a[236:239], v[60:63]
    v_mfma_f32_16x16x32_bf16 v[60:63], v[212:215], a[252:255], v[60:63]
L_att:
    v_add_u32 v234, 98304, v245
    v_mul_f32 v0, s3, v0
    v_mul_f32 v1, s3, v1
    v_mul_f32 v2, s3, v2
    v_mul_f32 v3, s3, v3
    v_mul_f32 v4, s3, v4
    v_mul_f32 v5, s3, v5
    v_mul_f32 v6, s3, v6
    v_mul_f32 v7, s3, v7
    v_cvt_pk_bf16_f32 v0, v0, v1
    v_cvt_pk_bf16_f32 v1, v2, v3
    v_cvt_pk_bf16_f32 v2, v4, v5
    v_cvt_pk_bf16_f32 v3, v6, v7
    v_accvgpr_write_b32 a32, v0
    v_accvgpr_write_b32 a33, v1
    v_accvgpr_write_b32 a34, v2
    v_accvgpr_write_b32 a35, v3
    v_mul_f32 v32, s3, v32
    v_mul_f32 v33, s3, v33
    v_mul_f32 v34, s3, v34
    v_mul_f32 v35, s3, v35
    v_mul_f32 v36, s3, v36
    v_mul_f32 v37, s3, v37
    v_mul_f32 v38, s3, v38
    v_mul_f32 v39, s3, v39
    v_cvt_pk_bf16_f32 v32, v32, v33
    v_cvt_pk_bf16_f32 v33, v34, v35
    v_cvt_pk_bf16_f32 v34, v36, v37
    v_cvt_pk_bf16_f32 v35, v38, v39
    v_accvgpr_write_b32 a48, v32
    v_accvgpr_write_b32 a49, v33
    v_accvgpr_write_b32 a50, v34
    v_accvgpr_write_b32 a51, v35
    s_waitcnt vmcnt(5)
    s_barrier
    ds_read_b128 a[64:67], v234 offset:0
    ds_read_b128 a[68:71], v234 offset:1024
    ds_read_b128 a[72:75], v234 offset:2048
    ds_read_b128 a[76:79], v234 offset:3072
    ds_read_b128 a[80:83], v234 offset:4096
    ds_read_b128 a[84:87], v234 offset:5120
    ds_read_b128 a[88:91], v234 offset:6144
    ds_read_b128 a[92:95], v234 offset:7168
    buffer_store_dword v254, v249, s[48:51], s96 offen sc1
    s_add_u32 m0, s84, 0
    s_mov_b32 s83, 24576
    buffer_load_dwordx4 v245, s[32:35], s83 offen offset:0 sc1 lds
    v_mul_f32 v8, s3, v8
    v_mul_f32 v9, s3, v9
    v_mul_f32 v10, s3, v10
    s_waitcnt lgkmcnt(4)
    v_mfma_f32_16x16x32_bf16 v[0:3], a[64:67], a[0:3], 0
    v_mul_f32 v11, s3, v11
    v_mul_f32 v12, s3, v12
    v_mul_f32 v13, s3, v13
    v_mfma_f32_16x16x32_bf16 v[0:3], a[68:71], a[16:19], v[0:3]
    buffer_load_dwordx4 v245, s[32:35], s83 offen offset:1024 sc1 lds
    v_mul_f32 v14, s3, v14
    v_mul_f32 v15, s3, v15
    v_cvt_pk_bf16_f32 v8, v8, v9
    v_cvt_pk_bf16_f32 v9, v10, v11
    v_cvt_pk_bf16_f32 v10, v12, v13
    v_cvt_pk_bf16_f32 v11, v14, v15
    v_accvgpr_write_b32 a36, v8
    v_mfma_f32_16x16x32_bf16 v[0:3], a[72:75], a[32:35], v[0:3]
    v_accvgpr_write_b32 a37, v9
    v_accvgpr_write_b32 a38, v10
    v_accvgpr_write_b32 a39, v11
    v_mul_f32 v40, s3, v40
    v_mul_f32 v41, s3, v41
    v_mul_f32 v42, s3, v42
    v_mfma_f32_16x16x32_bf16 v[0:3], a[76:79], a[48:51], v[0:3]
    s_waitcnt lgkmcnt(0)
    buffer_load_dwordx4 v245, s[32:35], s83 offen offset:2048 sc1 lds
    v_mfma_f32_16x16x32_bf16 v[4:7], a[80:83], a[0:3], 0
    buffer_load_dwordx4 v245, s[32:35], s83 offen offset:3072 sc1 lds
    v_mul_f32 v43, s3, v43
    v_mul_f32 v44, s3, v44
    v_mul_f32 v45, s3, v45
    v_mfma_f32_16x16x32_bf16 v[4:7], a[84:87], a[16:19], v[4:7]
    v_mul_f32 v46, s3, v46
    v_mul_f32 v47, s3, v47
    v_cvt_pk_bf16_f32 v40, v40, v41
    v_cvt_pk_bf16_f32 v41, v42, v43
    v_cvt_pk_bf16_f32 v42, v44, v45
    v_cvt_pk_bf16_f32 v43, v46, v47
    v_mfma_f32_16x16x32_bf16 v[4:7], a[88:91], a[32:35], v[4:7]
    s_add_u32 m0, s84, 16384
    v_accvgpr_write_b32 a52, v40
    v_accvgpr_write_b32 a53, v41
    v_accvgpr_write_b32 a54, v42
    v_accvgpr_write_b32 a55, v43
    v_mfma_f32_16x16x32_bf16 v[4:7], a[92:95], a[48:51], v[4:7]
    s_mov_b32 s83, 32768
    v_mul_f32 v16, s3, v16
    v_mul_f32 v17, s3, v17
    v_mul_f32 v18, s3, v18
    v_mul_f32 v19, s3, v19
    v_mul_f32 v20, s3, v20
    v_mul_f32 v21, s3, v21
    v_mul_f32 v22, s3, v22
    v_mul_f32 v23, s3, v23
    v_cvt_pk_bf16_f32 v16, v16, v17
    v_cvt_pk_bf16_f32 v17, v18, v19
    v_mfma_f32_16x16x32_bf16 v[8:11], a[64:67], a[4:7], 0
    v_cvt_pk_bf16_f32 v18, v20, v21
    v_cvt_pk_bf16_f32 v19, v22, v23
    v_accvgpr_write_b32 a40, v16
    v_mfma_f32_16x16x32_bf16 v[8:11], a[68:71], a[20:23], v[8:11]
    v_accvgpr_write_b32 a41, v17
    v_accvgpr_write_b32 a42, v18
    v_accvgpr_write_b32 a43, v19
    v_mfma_f32_16x16x32_bf16 v[8:11], a[72:75], a[36:39], v[8:11]
    v_mul_f32 v48, s3, v48
    v_mul_f32 v49, s3, v49
    v_mul_f32 v50, s3, v50
    v_mul_f32 v51, s3, v51
    v_max3_f32 v238, v0, v1, v2
    v_max3_f32 v239, v3, v4, v5
    v_max3_f32 v238, v238, v6, v7
    v_max_f32 v238, v238, v239
    v_mfma_f32_16x16x32_bf16 v[8:11], a[76:79], a[52:55], v[8:11]
    buffer_load_dwordx4 v245, s[32:35], s83 offen offset:0 sc1 lds
    v_mul_f32 v52, s3, v52
    v_mul_f32 v53, s3, v53
    v_mfma_f32_16x16x32_bf16 v[12:15], a[80:83], a[4:7], 0
    buffer_load_dwordx4 v245, s[32:35], s83 offen offset:1024 sc1 lds
    v_mul_f32 v54, s3, v54
    v_mfma_f32_16x16x32_bf16 v[12:15], a[84:87], a[20:23], v[12:15]
    v_mul_f32 v55, s3, v55
    v_cvt_pk_bf16_f32 v48, v48, v49
    v_cvt_pk_bf16_f32 v49, v50, v51
    v_cvt_pk_bf16_f32 v50, v52, v53
    v_mov_b32 v239, v238
    v_mfma_f32_16x16x32_bf16 v[12:15], a[88:91], a[36:39], v[12:15]
    v_cvt_pk_bf16_f32 v51, v54, v55
    v_accvgpr_write_b32 a56, v48
    v_accvgpr_write_b32 a57, v49
    v_accvgpr_write_b32 a58, v50
    v_accvgpr_write_b32 a59, v51
    v_permlane32_swap_b32 v238, v239
    v_mfma_f32_16x16x32_bf16 v[12:15], a[92:95], a[52:55], v[12:15]
    buffer_load_dwordx4 v245, s[32:35], s83 offen offset:2048 sc1 lds
    v_mul_f32 v24, s3, v24
    v_mul_f32 v25, s3, v25
    v_mul_f32 v26, s3, v26
    v_mul_f32 v27, s3, v27
    v_mul_f32 v28, s3, v28
    v_mfma_f32_16x16x32_bf16 v[16:19], a[64:67], a[8:11], 0
    v_mul_f32 v29, s3, v29
    v_mul_f32 v30, s3, v30
    v_mul_f32 v31, s3, v31
    v_max_f32 v238, v238, v239
    v_mov_b32 v239, v238
    v_mfma_f32_16x16x32_bf16 v[16:19], a[68:71], a[24:27], v[16:19]
    v_cvt_pk_bf16_f32 v24, v24, v25
    v_cvt_pk_bf16_f32 v25, v26, v27
    v_cvt_pk_bf16_f32 v26, v28, v29
    v_cvt_pk_bf16_f32 v27, v30, v31
    v_accvgpr_write_b32 a44, v24
    v_accvgpr_write_b32 a45, v25
    v_mfma_f32_16x16x32_bf16 v[16:19], a[72:75], a[40:43], v[16:19]
    buffer_load_dwordx4 v245, s[32:35], s83 offen offset:3072 sc1 lds
    v_accvgpr_write_b32 a46, v26
    v_accvgpr_write_b32 a47, v27
    v_mul_f32 v56, s3, v56
    v_mul_f32 v57, s3, v57
    v_mul_f32 v58, s3, v58
    v_mul_f32 v59, s3, v59
    v_mul_f32 v60, s3, v60
    v_mfma_f32_16x16x32_bf16 v[16:19], a[76:79], a[56:59], v[16:19]
    s_add_u32 m0, s84, 32768
    v_mul_f32 v61, s3, v61
    v_mul_f32 v62, s3, v62
    v_mul_f32 v63, s3, v63
    v_mfma_f32_16x16x32_bf16 v[20:23], a[80:83], a[8:11], 0
    s_mov_b32 s83, 40960
    v_cvt_pk_bf16_f32 v56, v56, v57
    v_cvt_pk_bf16_f32 v57, v58, v59
    v_cvt_pk_bf16_f32 v58, v60, v61
    v_mfma_f32_16x16x32_bf16 v[20:23], a[84:87], a[24:27], v[20:23]
    buffer_load_dwordx4 v245, s[32:35], s83 offen offset:0 sc1 lds
    v_cvt_pk_bf16_f32 v59, v62, v63
    v_accvgpr_write_b32 a60, v56
    v_accvgpr_write_b32 a61, v57
    v_accvgpr_write_b32 a62, v58
    v_accvgpr_write_b32 a63, v59
    v_permlane16_swap_b32 v238, v239
    v_max_f32 v238, v238, v239
    v_mfma_f32_16x16x32_bf16 v[20:23], a[88:91], a[40:43], v[20:23]
    buffer_load_dwordx4 v245, s[32:35], s83 offen offset:1024 sc1 lds
    v_add_f32 v238, 0x41000000, v238
    v_mfma_f32_16x16x32_bf16 v[20:23], a[92:95], a[56:59], v[20:23]
    buffer_load_dwordx4 v245, s[32:35], s83 offen offset:2048 sc1 lds
    v_sub_f32 v0, v0, v238
    v_sub_f32 v1, v1, v238
    v_mfma_f32_16x16x32_bf16 v[24:27], a[64:67], a[12:15], 0
    buffer_load_dwordx4 v245, s[32:35], s83 offen offset:3072 sc1 lds
    v_mfma_f32_16x16x32_bf16 v[24:27], a[68:71], a[28:31], v[24:27]
    s_add_u32 s84, s84, 49152
    v_sub_f32 v2, v2, v238
    v_sub_f32 v3, v3, v238
    v_sub_f32 v4, v4, v238
    v_mfma_f32_16x16x32_bf16 v[24:27], a[72:75], a[44:47], v[24:27]
    s_mov_b32 s85, 114688
    v_sub_f32 v5, v5, v238
    v_sub_f32 v6, v6, v238
    v_sub_f32 v7, v7, v238
    v_sub_f32 v32, 0, v238
    v_sub_f32 v33, 0, v238
    v_mov_b64 v[34:35], v[32:33]
    v_mov_b64 v[36:37], v[32:33]
    v_mfma_f32_16x16x32_bf16 v[24:27], a[76:79], a[60:63], v[24:27]
    v_mov_b64 v[38:39], v[32:33]
    v_exp_f32 v216, v0
    v_mfma_f32_16x16x32_bf16 v[28:31], a[80:83], a[12:15], 0
    v_exp_f32 v217, v1
    v_mfma_f32_16x16x32_bf16 v[28:31], a[84:87], a[28:31], v[28:31]
    s_mov_b32 s82, 0
    v_exp_f32 v218, v2
    v_exp_f32 v219, v3
    v_exp_f32 v220, v4
    v_mfma_f32_16x16x32_bf16 v[28:31], a[88:91], a[44:47], v[28:31]
    v_cvt_pk_bf16_f32 v192, v216, v217
    v_cvt_pk_bf16_f32 v193, v218, v219
    v_max3_f32 v238, v8, v9, v10
    v_max3_f32 v239, v11, v12, v13
    v_max3_f32 v238, v238, v14, v15
    v_max_f32 v238, v238, v239
    v_mov_b32 v239, v238
    s_nop 1
    v_permlane32_swap_b32 v238, v239
    v_max_f32 v238, v238, v239
    v_mov_b32 v239, v238
    s_nop 1
    v_permlane16_swap_b32 v238, v239
    v_max_f32 v238, v238, v239
    v_add_f32 v238, 0x41000000, v238
    v_exp_f32 v221, v5
    s_nop 0
    v_cvt_pk_bf16_f32 v194, v220, v221
    v_exp_f32 v222, v6
    v_exp_f32 v223, v7
    s_nop 0
    v_cvt_pk_bf16_f32 v195, v222, v223
    v_mfma_f32_16x16x32_bf16 v[28:31], a[92:95], a[60:63], v[28:31]
    v_sub_f32 v8, v8, v238
    v_sub_f32 v9, v9, v238
    v_sub_f32 v10, v10, v238
    v_sub_f32 v11, v11, v238
    v_sub_f32 v12, v12, v238
    v_sub_f32 v13, v13, v238
    v_sub_f32 v14, v14, v238
    v_sub_f32 v15, v15, v238
    v_sub_f32 v40, 0, v238
    v_sub_f32 v41, 0, v238
    v_mov_b64 v[42:43], v[40:41]
    v_mov_b64 v[44:45], v[40:41]
    v_mov_b64 v[46:47], v[40:41]
    v_exp_f32 v224, v8
    v_exp_f32 v225, v9
    s_nop 0
    v_cvt_pk_bf16_f32 v196, v224, v225
    v_exp_f32 v226, v10
    v_exp_f32 v227, v11
    s_nop 0
    v_cvt_pk_bf16_f32 v197, v226, v227
    v_exp_f32 v228, v12
    v_exp_f32 v229, v13
    s_nop 0
    v_cvt_pk_bf16_f32 v198, v228, v229
    v_exp_f32 v230, v14
    v_exp_f32 v231, v15
    s_nop 0
    v_cvt_pk_bf16_f32 v199, v230, v231
    ds_read_b128 a[64:67], v234 offset:8192
    ds_read_b128 a[68:71], v234 offset:9216
    ds_read_b128 a[72:75], v234 offset:10240
    ds_read_b128 a[76:79], v234 offset:11264
    ds_read_b128 a[80:83], v234 offset:12288
    ds_read_b128 a[84:87], v234 offset:13312
    ds_read_b128 a[88:91], v234 offset:14336
    ds_read_b128 a[92:95], v234 offset:15360
    v_add_u32 v234, s85, v245
    v_max3_f32 v238, v16, v17, v18
    v_max3_f32 v239, v19, v20, v21
    v_max3_f32 v238, v238, v22, v23
    v_max_f32 v238, v238, v239
    v_mov_b32 v239, v238
    s_nop 1
    v_permlane32_swap_b32 v238, v239
    v_max_f32 v238, v238, v239
    v_mov_b32 v239, v238
    s_nop 1
    v_permlane16_swap_b32 v238, v239
    v_max_f32 v238, v238, v239
    v_add_f32 v238, 0x41000000, v238
    v_sub_f32 v238, 0, v238
    v_pk_add_f32 v[16:17], v[16:17], v[238:239] op_sel_hi:[1,0]
    v_pk_add_f32 v[18:19], v[18:19], v[238:239] op_sel_hi:[1,0]
    v_pk_add_f32 v[20:21], v[20:21], v[238:239] op_sel_hi:[1,0]
    v_pk_add_f32 v[22:23], v[22:23], v[238:239] op_sel_hi:[1,0]
    v_pk_mov_b32 v[48:49], v[238:239], v[238:239] op_sel:[0,0]
    v_pk_mov_b32 v[50:51], v[238:239], v[238:239] op_sel:[0,0]
    v_pk_mov_b32 v[52:53], v[238:239], v[238:239] op_sel:[0,0]
    v_pk_mov_b32 v[54:55], v[238:239], v[238:239] op_sel:[0,0]
    v_exp_f32 v216, v16
    v_exp_f32 v217, v17
    v_exp_f32 v218, v18
    v_exp_f32 v219, v19
    v_exp_f32 v220, v20
    v_exp_f32 v221, v21
    v_exp_f32 v222, v22
    v_exp_f32 v223, v23
    v_cvt_pk_bf16_f32 v200, v216, v217
    v_cvt_pk_bf16_f32 v201, v218, v219
    v_cvt_pk_bf16_f32 v202, v220, v221
    v_cvt_pk_bf16_f32 v203, v222, v223
    s_cmp_lg_u32 s89, 0
    s_cbranch_scc1 L_nomask_8
    v_mov_b32 v240, 0xff800000
    v_cmp_gt_i32 s[76:77], 0, v237
    v_cmp_gt_i32 s[78:79], 1, v237
    s_nop 0
    v_cndmask_b32 v24, v24, v240, s[76:77]
    v_cndmask_b32 v25, v25, v240, s[78:79]
    v_cmp_gt_i32 s[76:77], 2, v237
    v_cmp_gt_i32 s[78:79], 3, v237
    s_nop 0
    v_cndmask_b32 v26, v26, v240, s[76:77]
    v_cndmask_b32 v27, v27, v240, s[78:79]
    v_cmp_gt_i32 s[76:77], 16, v237
    v_cmp_gt_i32 s[78:79], 17, v237
    s_nop 0
    v_cndmask_b32 v28, v28, v240, s[76:77]
    v_cndmask_b32 v29, v29, v240, s[78:79]
    v_cmp_gt_i32 s[76:77], 18, v237
    v_cmp_gt_i32 s[78:79], 19, v237
    s_nop 0
    v_cndmask_b32 v30, v30, v240, s[76:77]
    v_cndmask_b32 v31, v31, v240, s[78:79]
L_nomask_8:
    v_max3_f32 v238, v24, v25, v26
    v_max3_f32 v239, v27, v28, v29
    v_max3_f32 v238, v238, v30, v31
    v_max_f32 v238, v238, v239
    v_mov_b32 v239, v238
    s_nop 1
    v_permlane32_swap_b32 v238, v239
    v_max_f32 v238, v238, v239
    v_mov_b32 v239, v238
    s_nop 1
    v_permlane16_swap_b32 v238, v239
    v_max_f32 v238, v238, v239
    v_add_f32 v238, 0x41000000, v238
    v_sub_f32 v238, 0, v238
    v_pk_add_f32 v[24:25], v[24:25], v[238:239] op_sel_hi:[1,0]
    v_pk_add_f32 v[26:27], v[26:27], v[238:239] op_sel_hi:[1,0]
    v_pk_add_f32 v[28:29], v[28:29], v[238:239] op_sel_hi:[1,0]
    v_pk_add_f32 v[30:31], v[30:31], v[238:239] op_sel_hi:[1,0]
    v_pk_mov_b32 v[56:57], v[238:239], v[238:239] op_sel:[0,0]
    v_pk_mov_b32 v[58:59], v[238:239], v[238:239] op_sel:[0,0]
    v_pk_mov_b32 v[60:61], v[238:239], v[238:239] op_sel:[0,0]
    v_pk_mov_b32 v[62:63], v[238:239], v[238:239] op_sel:[0,0]
    v_exp_f32 v208, v24
    v_exp_f32 v209, v25
    v_exp_f32 v210, v26
    v_exp_f32 v211, v27
    v_exp_f32 v212, v28
    v_exp_f32 v213, v29
    v_exp_f32 v214, v30
    v_exp_f32 v215, v31
    s_waitcnt lgkmcnt(0)
    s_branch L_ev4
.p2align 6
L_body4:
    s_waitcnt lgkmcnt(4)
    v_cvt_pk_bf16_f32 v204, v208, v209
    v_mfma_f32_16x16x32_bf16 v[0:3], a[64:67], a[0:3], v[32:35]
    s_mov_b32 m0, s84
    ds_read_b128 a[96:99], v234 offset:0
    v_cvt_pk_bf16_f32 v205, v210, v211
    v_mfma_f32_16x16x32_bf16 v[0:3], a[68:71], a[16:19], v[0:3]
    v_cvt_pk_bf16_f32 v206, v212, v213
    v_mfma_f32_16x16x32_bf16 v[0:3], a[72:75], a[32:35], v[0:3]
    s_add_u32 s83, s83, 8192
    ds_read_b128 a[100:103], v234 offset:1024
    v_cvt_pk_bf16_f32 v207, v214, v215
    v_mfma_f32_16x16x32_bf16 v[0:3], a[76:79], a[48:51], v[0:3]
    s_waitcnt lgkmcnt(2)
    s_add_u32 s85, s85, 16384
    v_or3_b32 v232, v204, v205, v206
    v_mfma_f32_16x16x32_bf16 v[4:7], a[80:83], a[0:3], v[36:39]
    ds_read_b128 a[104:107], v234 offset:2048
    v_bitop3_b32 v232, v232, v207, s61 bitop3:0xa8
    v_mfma_f32_16x16x32_bf16 v[4:7], a[84:87], a[16:19], v[4:7]
    v_cmp_ne_u32 vcc, 0, v232
    v_mfma_f32_16x16x32_bf16 v[4:7], a[88:91], a[32:35], v[4:7]
    ds_read_b128 a[108:111], v234 offset:3072
    v_mfma_f32_16x16x32_bf16 v[4:7], a[92:95], a[48:51], v[4:7]
    s_cbranch_vccnz L_fix_9
L_fixb_10:
    v_mfma_f32_16x16x32_bf16 v[8:11], a[64:67], a[4:7], v[40:43]
    ds_read_b128 a[112:115], v234 offset:4096
    v_mfma_f32_16x16x32_bf16 v[8:11], a[68:71], a[20:23], v[8:11]
    v_exp_f32 v216, v0
    v_mfma_f32_16x16x32_bf16 v[8:11], a[72:75], a[36:39], v[8:11]
    s_sub_u32 s73, s85, 163840
    ds_read_b128 a[116:119], v234 offset:5120
    v_mfma_f32_16x16x32_bf16 v[8:11], a[76:79], a[52:55], v[8:11]
    buffer_load_dwordx4 v245, s[32:35], s83 offen offset:0 sc1 lds
    v_mfma_f32_16x16x32_bf16 v[12:15], a[80:83], a[4:7], v[44:47]
    v_mfma_f32_16x16x32_bf16 v[12:15], a[84:87], a[20:23], v[12:15]
    v_exp_f32 v217, v1
    v_mfma_f32_16x16x32_bf16 v[12:15], a[88:91], a[36:39], v[12:15]
    v_exp_f32 v218, v2
    v_mfma_f32_16x16x32_bf16 v[12:15], a[92:95], a[52:55], v[12:15]
    buffer_load_dwordx4 v245, s[32:35], s83 offen offset:1024 sc1 lds
    v_mfma_f32_16x16x32_bf16 v[16:19], a[64:67], a[8:11], v[48:51]
    v_exp_f32 v219, v3
    v_mfma_f32_16x16x32_bf16 v[16:19], a[68:71], a[24:27], v[16:19]
    ds_read_b128 a[120:123], v234 offset:6144
    v_mfma_f32_16x16x32_bf16 v[16:19], a[72:75], a[40:43], v[16:19]
    v_exp_f32 v220, v4
    v_mfma_f32_16x16x32_bf16 v[16:19], a[76:79], a[56:59], v[16:19]
    buffer_load_dwordx4 v245, s[32:35], s83 offen offset:2048 sc1 lds
    v_mfma_f32_16x16x32_bf16 v[20:23], a[80:83], a[8:11], v[52:55]
    v_exp_f32 v224, v8
    v_mfma_f32_16x16x32_bf16 v[20:23], a[84:87], a[24:27], v[20:23]
    v_mfma_f32_16x16x32_bf16 v[20:23], a[88:91], a[40:43], v[20:23]
    v_exp_f32 v221, v5
    v_mfma_f32_16x16x32_bf16 v[20:23], a[92:95], a[56:59], v[20:23]
    ds_read_b128 a[124:127], v234 offset:7168
    v_mfma_f32_16x16x32_bf16 v[24:27], a[64:67], a[12:15], v[56:59]
    v_exp_f32 v225, v9
    v_mfma_f32_16x16x32_bf16 v[24:27], a[68:71], a[28:31], v[24:27]
    s_min_u32 s85, s85, s73
    v_exp_f32 v222, v6
    v_mfma_f32_16x16x32_bf16 v[24:27], a[72:75], a[44:47], v[24:27]
    v_mfma_f32_16x16x32_bf16 v[24:27], a[76:79], a[60:63], v[24:27]
    buffer_load_dwordx4 v245, s[32:35], s83 offen offset:3072 sc1 lds
    v_mfma_f32_16x16x32_bf16 v[28:31], a[80:83], a[12:15], v[60:63]
    v_exp_f32 v226, v10
    v_mfma_f32_16x16x32_bf16 v[28:31], a[84:87], a[28:31], v[28:31]
    s_add_u32 s84, s84, 16384
    v_exp_f32 v227, v11
    v_mfma_f32_16x16x32_bf16 v[28:31], a[88:91], a[44:47], v[28:31]
    v_exp_f32 v228, v12
    v_mfma_f32_16x16x32_bf16 v[28:31], a[92:95], a[60:63], v[28:31]
    s_waitcnt lgkmcnt(4)
    ds_read_b128 a[64:67], v234 offset:8192
    v_mfma_f32_16x16x32_bf16 v[64:67], a[96:99], v[192:195], v[64:67]
    v_exp_f32 v229, v13
    v_mfma_f32_16x16x32_bf16 v[68:71], a[100:103], v[192:195], v[68:71]
    v_exp_f32 v230, v14
    v_mfma_f32_16x16x32_bf16 v[72:75], a[104:107], v[192:195], v[72:75]
    s_sub_u32 s56, s84, 163840
    v_mfma_f32_16x16x32_bf16 v[76:79], a[108:111], v[192:195], v[76:79]
    s_waitcnt lgkmcnt(1)
    v_exp_f32 v223, v7
    v_mfma_f32_16x16x32_bf16 v[80:83], a[112:115], v[192:195], v[80:83]
    ds_read_b128 a[68:71], v234 offset:9216
    v_mfma_f32_16x16x32_bf16 v[84:87], a[116:119], v[192:195], v[84:87]
    v_mfma_f32_16x16x32_bf16 v[88:91], a[120:123], v[192:195], v[88:91]
    ds_read_b128 a[72:75], v234 offset:10240
    v_mfma_f32_16x16x32_bf16 v[92:95], a[124:127], v[192:195], v[92:95]
    v_exp_f32 v231, v15
    v_mfma_f32_16x16x32_bf16 a[128:131], a[144:147], v[192:195], a[128:131]
    v_mfma_f32_16x16x32_bf16 v[96:99], a[96:99], v[196:199], v[96:99]
    ds_read_b128 a[76:79], v234 offset:11264
    v_cvt_pk_bf16_f32 v192, v216, v217
    v_mfma_f32_16x16x32_bf16 v[100:103], a[100:103], v[196:199], v[100:103]
    v_cvt_pk_bf16_f32 v193, v218, v219
    v_mfma_f32_16x16x32_bf16 v[104:107], a[104:107], v[196:199], v[104:107]
    v_cvt_pk_bf16_f32 v194, v220, v221
    v_mfma_f32_16x16x32_bf16 v[108:111], a[108:111], v[196:199], v[108:111]
    ds_read_b128 a[80:83], v234 offset:12288
    v_cvt_pk_bf16_f32 v195, v222, v223
    v_mfma_f32_16x16x32_bf16 v[112:115], a[112:115], v[196:199], v[112:115]
    v_exp_f32 v208, v24
    v_mfma_f32_16x16x32_bf16 v[116:119], a[116:119], v[196:199], v[116:119]
    v_exp_f32 v216, v16
    v_mfma_f32_16x16x32_bf16 v[120:123], a[120:123], v[196:199], v[120:123]
    s_min_u32 s84, s84, s56
    v_exp_f32 v217, v17
    v_mfma_f32_16x16x32_bf16 v[124:127], a[124:127], v[196:199], v[124:127]
    v_exp_f32 v218, v18
    v_mfma_f32_16x16x32_bf16 a[132:135], a[144:147], v[196:199], a[132:135]
    v_exp_f32 v209, v25
    v_mfma_f32_16x16x32_bf16 v[128:131], a[96:99], v[200:203], v[128:131]
    ds_read_b128 a[84:87], v234 offset:13312
    v_or3_b32 v232, v192, v193, v194
    v_mfma_f32_16x16x32_bf16 v[132:135], a[100:103], v[200:203], v[132:135]
    v_cvt_pk_bf16_f32 v196, v224, v225
    v_cvt_pk_bf16_f32 v197, v226, v227
    v_cvt_pk_bf16_f32 v198, v228, v229
    v_mfma_f32_16x16x32_bf16 v[136:139], a[104:107], v[200:203], v[136:139]
    ds_read_b128 a[88:91], v234 offset:14336
    v_cvt_pk_bf16_f32 v199, v230, v231
    v_mfma_f32_16x16x32_bf16 v[140:143], a[108:111], v[200:203], v[140:143]
    v_exp_f32 v219, v19
    v_mfma_f32_16x16x32_bf16 v[144:147], a[112:115], v[200:203], v[144:147]
    v_exp_f32 v220, v20
    v_mfma_f32_16x16x32_bf16 v[148:151], a[116:119], v[200:203], v[148:151]
    v_exp_f32 v221, v21
    v_mfma_f32_16x16x32_bf16 v[152:155], a[120:123], v[200:203], v[152:155]
    v_exp_f32 v222, v22
    v_mfma_f32_16x16x32_bf16 v[156:159], a[124:127], v[200:203], v[156:159]
    v_exp_f32 v223, v23
    v_mfma_f32_16x16x32_bf16 a[136:139], a[144:147], v[200:203], a[136:139]
    v_cvt_pk_bf16_f32 v200, v216, v217
    v_cvt_pk_bf16_f32 v201, v218, v219
    v_cvt_pk_bf16_f32 v202, v220, v221
    v_mfma_f32_16x16x32_bf16 v[160:163], a[96:99], v[204:207], v[160:163]
    v_exp_f32 v210, v26
    v_mfma_f32_16x16x32_bf16 v[164:167], a[100:103], v[204:207], v[164:167]
    v_exp_f32 v211, v27
    v_mfma_f32_16x16x32_bf16 v[168:171], a[104:107], v[204:207], v[168:171]
    v_cvt_pk_bf16_f32 v203, v222, v223
    v_or3_b32 v232, v232, v195, v196
    v_or3_b32 v232, v232, v197, v198
    v_mfma_f32_16x16x32_bf16 v[172:175], a[108:111], v[204:207], v[172:175]
    ds_read_b128 a[92:95], v234 offset:15360
    v_add_u32 v234, s85, v245
    v_mfma_f32_16x16x32_bf16 v[176:179], a[112:115], v[204:207], v[176:179]
    v_or3_b32 v232, v232, v199, v200
    v_exp_f32 v212, v28
    v_mfma_f32_16x16x32_bf16 v[180:183], a[116:119], v[204:207], v[180:183]
    s_add_u32 s82, s82, 1
    v_or3_b32 v232, v232, v201, v202
    v_bitop3_b32 v232, v232, v203, s61 bitop3:0xa8
    v_cmp_ne_u32 vcc, 0, v232
    v_mfma_f32_16x16x32_bf16 v[184:187], a[120:123], v[204:207], v[184:187]
    v_exp_f32 v213, v29
    v_mfma_f32_16x16x32_bf16 v[188:191], a[124:127], v[204:207], v[188:191]
    s_cbranch_vccnz L_fix_11
L_fixb_12:
    v_exp_f32 v214, v30
    v_mfma_f32_16x16x32_bf16 a[140:143], a[144:147], v[204:207], a[140:143]
    v_exp_f32 v215, v31
    s_bitcmp1_b64 s[80:81], s82
    s_cbranch_scc0 L_body4
L_ev4:
    s_bitcmp1_b64 s[62:63], s82
    s_cbranch_scc1 L_sp_17
    s_waitcnt vmcnt(8) lgkmcnt(0)
    s_barrier
    s_branch L_body4
L_sp_17:
    s_and_b32 s56, s82, 3
    s_cbranch_scc1 L_nb_13
    s_waitcnt vmcnt(8) lgkmcnt(0)
    s_barrier
    s_cmp_eq_u32 s82, 8
    s_cbranch_scc0 L_nh_15
    s_and_b32 s73, s55, 0xfc
    s_add_u32 s73, s73, s52
    s_lshl_b32 s74, s73, 12
    s_lshl_b32 s73, s55, 2
    s_add_u32 s73, s73, s52
    v_and_b32 v238, 31, v255
    v_lshlrev_b32 v238, 7, v238
    v_add_u32 v238, s74, v238
    s_mul_i32 s74, s73, 1408
    v_min_u32 v239, 10, v255
    v_lshlrev_b32 v239, 7, v239
    v_add_u32 v239, s74, v239
    buffer_load_dword a200, v238, s[24:27], 0 offen
    buffer_load_dword a200, v239, s[36:39], 0 offen
    s_bfe_u32 s73, s55, 0x10002
    s_lshl_b32 s73, s73, 3
    s_bfe_u32 s74, s55, 0x30003
    s_add_u32 s74, s73, s74
    s_sub_u32 s75, 15, s74
    s_min_u32 s74, s74, s75
    s_lshl_b32 s100, s74, 7
    s_add_u32 s100, s100, 58725376
    s_mov_b32 s99, 58725376
    s_sub_u32 s73, s100, s99
    v_add_u32 v238, s73, v250
    s_bfe_u32 s73, s55, 0x10002
    s_lshl_b32 s73, s73, 4
    s_and_b32 s74, s53, 3
    s_add_u32 s73, s73, s74
    s_lshl_b32 s74, s54, 5
    s_add_u32 s73, s73, s74
    s_lshl_b32 s73, s73, 2
    v_and_b32 v239, 3, v255
    v_lshlrev_b32 v239, 4, v239
    v_cmp_gt_u32 vcc, 32, v255
    v_add_u32 v239, s73, v239
    s_nop 0
    v_cndmask_b32 v242, v239, v238, vcc
    buffer_load_dword v241, v242, s[48:51], s99 offen sc1
L_nh_15:
    s_cmp_eq_u32 s82, 12
    s_cbranch_scc0 L_nh2_16
    v_cmp_ne_u32 vcc, 1, v241
    s_nop 0
    s_cbranch_vccnz L_spin_18
L_back_19:
L_nh2_16:
L_nb_13:
    s_cmp_eq_u32 s82, s93
    s_cbranch_scc0 L_nm_14
    v_mov_b32 v238, 0xff800000
    v_cmp_gt_i32 s[76:77], 16, v237
    v_cmp_gt_i32 s[78:79], 17, v237
    s_nop 0
    v_cndmask_b32 v60, v56, v238, s[76:77]
    v_cndmask_b32 v61, v56, v238, s[78:79]
    v_cmp_gt_i32 s[76:77], 18, v237
    v_cmp_gt_i32 s[78:79], 19, v237
    s_nop 0
    v_cndmask_b32 v62, v56, v238, s[76:77]
    v_cndmask_b32 v63, v56, v238, s[78:79]
    v_cmp_gt_i32 s[76:77], 3, v237
    v_cmp_gt_i32 s[78:79], 2, v237
    s_nop 0
    v_cndmask_b32 v59, v56, v238, s[76:77]
    v_cndmask_b32 v58, v56, v238, s[78:79]
    v_cmp_gt_i32 s[76:77], 1, v237
    v_cmp_gt_i32 s[78:79], 0, v237
    s_nop 0
    v_cndmask_b32 v57, v56, v238, s[76:77]
    v_cndmask_b32 v56, v56, v238, s[78:79]
L_nm_14:
    s_cmp_eq_u32 s82, s89
    s_cbranch_scc0 L_body4
    s_cmp_eq_u32 s82, s92
    s_cbranch_scc0 L_nm_20
    v_mov_b32 v238, 0xff800000
    v_cmp_gt_i32 s[76:77], 16, v236
    v_cmp_gt_i32 s[78:79], 17, v236
    s_nop 0
    v_cndmask_b32 v52, v48, v238, s[76:77]
    v_cndmask_b32 v53, v48, v238, s[78:79]
    v_cmp_gt_i32 s[76:77], 18, v236
    v_cmp_gt_i32 s[78:79], 19, v236
    s_nop 0
    v_cndmask_b32 v54, v48, v238, s[76:77]
    v_cndmask_b32 v55, v48, v238, s[78:79]
    v_cmp_gt_i32 s[76:77], 3, v236
    v_cmp_gt_i32 s[78:79], 2, v236
    s_nop 0
    v_cndmask_b32 v51, v48, v238, s[76:77]
    v_cndmask_b32 v50, v48, v238, s[78:79]
    v_cmp_gt_i32 s[76:77], 1, v236
    v_cmp_gt_i32 s[78:79], 0, v236
    s_nop 0
    v_cndmask_b32 v49, v48, v238, s[76:77]
    v_cndmask_b32 v48, v48, v238, s[78:79]
L_nm_20:
    s_waitcnt lgkmcnt(4)
    ds_read_b128 a[96:99], v234 offset:0
    v_cvt_pk_bf16_f32 v204, v208, v209
    v_mfma_f32_16x16x32_bf16 v[0:3], a[64:67], a[0:3], v[32:35]
    v_cvt_pk_bf16_f32 v205, v210, v211
    v_mfma_f32_16x16x32_bf16 v[0:3], a[68:71], a[16:19], v[0:3]
    ds_read_b128 a[100:103], v234 offset:1024
    v_cvt_pk_bf16_f32 v206, v212, v213
    v_mfma_f32_16x16x32_bf16 v[0:3], a[72:75], a[32:35], v[0:3]
    v_cvt_pk_bf16_f32 v207, v214, v215
    v_mfma_f32_16x16x32_bf16 v[0:3], a[76:79], a[48:51], v[0:3]
    s_waitcnt lgkmcnt(2)
    v_or3_b32 v232, v204, v205, v206
    v_mfma_f32_16x16x32_bf16 v[4:7], a[80:83], a[0:3], v[36:39]
    v_bitop3_b32 v232, v232, v207, s61 bitop3:0xa8
    v_mfma_f32_16x16x32_bf16 v[4:7], a[84:87], a[16:19], v[4:7]
    ds_read_b128 a[104:107], v234 offset:2048
    v_cmp_ne_u32 vcc, 0, v232
    v_mfma_f32_16x16x32_bf16 v[4:7], a[88:91], a[32:35], v[4:7]
    v_mfma_f32_16x16x32_bf16 v[4:7], a[92:95], a[48:51], v[4:7]
    s_cbranch_vccnz L_fix_21
L_fixb_22:
    ds_read_b128 a[108:111], v234 offset:3072
    v_mfma_f32_16x16x32_bf16 v[8:11], a[64:67], a[4:7], v[40:43]
    v_mfma_f32_16x16x32_bf16 v[8:11], a[68:71], a[20:23], v[8:11]
    s_mov_b32 m0, s84
    ds_read_b128 a[112:115], v234 offset:4096
    v_mfma_f32_16x16x32_bf16 v[8:11], a[72:75], a[36:39], v[8:11]
    v_exp_f32 v216, v0
    v_mfma_f32_16x16x32_bf16 v[8:11], a[76:79], a[52:55], v[8:11]
    s_add_u32 s83, s83, 8192
    v_exp_f32 v217, v1
    v_mfma_f32_16x16x32_bf16 v[12:15], a[80:83], a[4:7], v[44:47]
    buffer_load_dwordx4 v245, s[32:35], s83 offen offset:0 sc1 lds
    v_mfma_f32_16x16x32_bf16 v[12:15], a[84:87], a[20:23], v[12:15]
    ds_read_b128 a[116:119], v234 offset:5120
    v_mfma_f32_16x16x32_bf16 v[12:15], a[88:91], a[36:39], v[12:15]
    v_exp_f32 v218, v2
    v_mfma_f32_16x16x32_bf16 v[12:15], a[92:95], a[52:55], v[12:15]
    ds_read_b128 a[120:123], v234 offset:6144
    v_mfma_f32_16x16x32_bf16 v[16:19], a[64:67], a[8:11], v[48:51]
    s_add_u32 s85, s85, 16384
    v_exp_f32 v219, v3
    v_mfma_f32_16x16x32_bf16 v[16:19], a[68:71], a[24:27], v[16:19]
    buffer_load_dwordx4 v245, s[32:35], s83 offen offset:1024 sc1 lds
    v_mfma_f32_16x16x32_bf16 v[16:19], a[72:75], a[40:43], v[16:19]
    v_exp_f32 v224, v8
    v_mfma_f32_16x16x32_bf16 v[16:19], a[76:79], a[56:59], v[16:19]
    ds_read_b128 a[124:127], v234 offset:7168
    v_mfma_f32_16x16x32_bf16 v[20:23], a[80:83], a[8:11], v[52:55]
    s_sub_u32 s73, s85, 163840
    v_exp_f32 v220, v4
    v_mfma_f32_16x16x32_bf16 v[20:23], a[84:87], a[24:27], v[20:23]
    v_exp_f32 v221, v5
    v_mfma_f32_16x16x32_bf16 v[20:23], a[88:91], a[40:43], v[20:23]
    s_min_u32 s85, s85, s73
    v_exp_f32 v222, v6
    v_mfma_f32_16x16x32_bf16 v[20:23], a[92:95], a[56:59], v[20:23]
    s_waitcnt lgkmcnt(4)
    v_exp_f32 v225, v9
    v_mfma_f32_16x16x32_bf16 v[64:67], a[96:99], v[192:195], v[64:67]
    buffer_load_dwordx4 v245, s[32:35], s83 offen offset:2048 sc1 lds
    v_mfma_f32_16x16x32_bf16 v[68:71], a[100:103], v[192:195], v[68:71]
    ds_read_b128 a[64:67], v234 offset:8192
    v_mfma_f32_16x16x32_bf16 v[72:75], a[104:107], v[192:195], v[72:75]
    v_mfma_f32_16x16x32_bf16 v[76:79], a[108:111], v[192:195], v[76:79]
    s_waitcnt lgkmcnt(1)
    v_exp_f32 v223, v7
    v_mfma_f32_16x16x32_bf16 v[80:83], a[112:115], v[192:195], v[80:83]
    buffer_load_dwordx4 v245, s[32:35], s83 offen offset:3072 sc1 lds
    v_mfma_f32_16x16x32_bf16 v[84:87], a[116:119], v[192:195], v[84:87]
    v_exp_f32 v226, v10
    v_mfma_f32_16x16x32_bf16 v[88:91], a[120:123], v[192:195], v[88:91]
    ds_read_b128 a[68:71], v234 offset:9216
    v_mfma_f32_16x16x32_bf16 v[92:95], a[124:127], v[192:195], v[92:95]
    v_exp_f32 v227, v11
    v_mfma_f32_16x16x32_bf16 a[128:131], a[144:147], v[192:195], a[128:131]
    v_exp_f32 v228, v12
    v_mfma_f32_16x16x32_bf16 v[96:99], a[96:99], v[196:199], v[96:99]
    s_add_u32 s84, s84, 16384
    ds_read_b128 a[72:75], v234 offset:10240
    v_cvt_pk_bf16_f32 v192, v216, v217
    v_mfma_f32_16x16x32_bf16 v[100:103], a[100:103], v[196:199], v[100:103]
    v_cvt_pk_bf16_f32 v193, v218, v219
    v_mfma_f32_16x16x32_bf16 v[104:107], a[104:107], v[196:199], v[104:107]
    v_cvt_pk_bf16_f32 v194, v220, v221
    v_mfma_f32_16x16x32_bf16 v[108:111], a[108:111], v[196:199], v[108:111]
    v_exp_f32 v229, v13
    v_mfma_f32_16x16x32_bf16 v[112:115], a[112:115], v[196:199], v[112:115]
    s_sub_u32 s56, s84, 163840
    ds_read_b128 a[76:79], v234 offset:11264
    v_mfma_f32_16x16x32_bf16 v[116:119], a[116:119], v[196:199], v[116:119]
    v_mfma_f32_16x16x32_bf16 v[120:123], a[120:123], v[196:199], v[120:123]
    ds_read_b128 a[80:83], v234 offset:12288
    v_cvt_pk_bf16_f32 v195, v222, v223
    v_mfma_f32_16x16x32_bf16 v[124:127], a[124:127], v[196:199], v[124:127]
    v_exp_f32 v230, v14
    v_mfma_f32_16x16x32_bf16 a[132:135], a[144:147], v[196:199], a[132:135]
    v_exp_f32 v231, v15
    v_mfma_f32_16x16x32_bf16 v[128:131], a[96:99], v[200:203], v[128:131]
    v_cvt_pk_bf16_f32 v196, v224, v225
    v_mfma_f32_16x16x32_bf16 v[132:135], a[100:103], v[200:203], v[132:135]
    v_exp_f32 v208, v16
    v_mfma_f32_16x16x32_bf16 v[136:139], a[104:107], v[200:203], v[136:139]
    v_exp_f32 v209, v17
    v_mfma_f32_16x16x32_bf16 v[140:143], a[108:111], v[200:203], v[140:143]
    ds_read_b128 a[84:87], v234 offset:13312
    v_cvt_pk_bf16_f32 v197, v226, v227
    v_mfma_f32_16x16x32_bf16 v[144:147], a[112:115], v[200:203], v[144:147]
    v_exp_f32 v210, v18
    v_mfma_f32_16x16x32_bf16 v[148:151], a[116:119], v[200:203], v[148:151]
    s_min_u32 s84, s84, s56
    v_exp_f32 v211, v19
    v_mfma_f32_16x16x32_bf16 v[152:155], a[120:123], v[200:203], v[152:155]
    v_or3_b32 v232, v192, v193, v194
    v_mfma_f32_16x16x32_bf16 v[156:159], a[124:127], v[200:203], v[156:159]
    v_exp_f32 v212, v20
    v_mfma_f32_16x16x32_bf16 a[136:139], a[144:147], v[200:203], a[136:139]
    ds_read_b128 a[88:91], v234 offset:14336
    v_mfma_f32_16x16x32_bf16 v[160:163], a[96:99], v[204:207], v[160:163]
    v_exp_f32 v213, v21
    v_mfma_f32_16x16x32_bf16 v[164:167], a[100:103], v[204:207], v[164:167]
    v_cvt_pk_bf16_f32 v198, v228, v229
    v_mfma_f32_16x16x32_bf16 v[168:171], a[104:107], v[204:207], v[168:171]
    v_cvt_pk_bf16_f32 v199, v230, v231
    v_mfma_f32_16x16x32_bf16 v[172:175], a[108:111], v[204:207], v[172:175]
    s_add_u32 s82, s82, 1
    ds_read_b128 a[92:95], v234 offset:15360
    v_add_u32 v234, s85, v245
    v_mfma_f32_16x16x32_bf16 v[176:179], a[112:115], v[204:207], v[176:179]
    v_or3_b32 v232, v232, v195, v196
    v_mfma_f32_16x16x32_bf16 v[180:183], a[116:119], v[204:207], v[180:183]
    v_or3_b32 v232, v232, v197, v198
    v_mfma_f32_16x16x32_bf16 v[184:187], a[120:123], v[204:207], v[184:187]
    v_bitop3_b32 v232, v232, v199, s61 bitop3:0xa8
    v_cmp_ne_u32 vcc, 0, v232
    v_mfma_f32_16x16x32_bf16 v[188:191], a[124:127], v[204:207], v[188:191]
    v_exp_f32 v214, v22
    v_mfma_f32_16x16x32_bf16 a[140:143], a[144:147], v[204:207], a[140:143]
    s_cbranch_vccnz L_fix_23
L_fixb_24:
    v_exp_f32 v215, v23
    s_nop 5
    v_accvgpr_read_b32 v238, a140
    v_rcp_f32 v238, v238
    s_nop 0
    v_pk_mul_f32 v[160:161], v[160:161], v[238:239] op_sel_hi:[1,0]
    v_pk_mul_f32 v[162:163], v[162:163], v[238:239] op_sel_hi:[1,0]
    v_pk_mul_f32 v[164:165], v[164:165], v[238:239] op_sel_hi:[1,0]
    v_pk_mul_f32 v[166:167], v[166:167], v[238:239] op_sel_hi:[1,0]
    v_cvt_pk_bf16_f32 v216, v160, v161
    v_cvt_pk_bf16_f32 v217, v162, v163
    v_cvt_pk_bf16_f32 v218, v164, v165
    v_cvt_pk_bf16_f32 v219, v166, v167
    buffer_store_dwordx4 v[216:219], v245, s[48:51], s72 offen sc1
    v_pk_mul_f32 v[168:169], v[168:169], v[238:239] op_sel_hi:[1,0]
    v_pk_mul_f32 v[170:171], v[170:171], v[238:239] op_sel_hi:[1,0]
    v_pk_mul_f32 v[172:173], v[172:173], v[238:239] op_sel_hi:[1,0]
    v_pk_mul_f32 v[174:175], v[174:175], v[238:239] op_sel_hi:[1,0]
    v_cvt_pk_bf16_f32 v220, v168, v169
    v_cvt_pk_bf16_f32 v221, v170, v171
    v_cvt_pk_bf16_f32 v222, v172, v173
    v_cvt_pk_bf16_f32 v223, v174, v175
    buffer_store_dwordx4 v[220:223], v246, s[48:51], s72 offen sc1
    v_pk_mul_f32 v[176:177], v[176:177], v[238:239] op_sel_hi:[1,0]
    v_pk_mul_f32 v[178:179], v[178:179], v[238:239] op_sel_hi:[1,0]
    v_pk_mul_f32 v[180:181], v[180:181], v[238:239] op_sel_hi:[1,0]
    v_pk_mul_f32 v[182:183], v[182:183], v[238:239] op_sel_hi:[1,0]
    v_cvt_pk_bf16_f32 v224, v176, v177
    v_cvt_pk_bf16_f32 v225, v178, v179
    v_cvt_pk_bf16_f32 v226, v180, v181
    v_cvt_pk_bf16_f32 v227, v182, v183
    buffer_store_dwordx4 v[224:227], v247, s[48:51], s72 offen sc1
    v_pk_mul_f32 v[184:185], v[184:185], v[238:239] op_sel_hi:[1,0]
    v_pk_mul_f32 v[186:187], v[186:187], v[238:239] op_sel_hi:[1,0]
    v_pk_mul_f32 v[188:189], v[188:189], v[238:239] op_sel_hi:[1,0]
    v_pk_mul_f32 v[190:191], v[190:191], v[238:239] op_sel_hi:[1,0]
    v_cvt_pk_bf16_f32 v228, v184, v185
    v_cvt_pk_bf16_f32 v229, v186, v187
    v_cvt_pk_bf16_f32 v230, v188, v189
    v_cvt_pk_bf16_f32 v231, v190, v191
    buffer_store_dwordx4 v[228:231], v248, s[48:51], s72 offen sc1
    s_bitcmp1_b64 s[80:81], s82
    s_cbranch_scc1 L_ev3
.p2align 6
L_body3:
    s_waitcnt lgkmcnt(4)
    ds_read_b128 a[96:99], v234 offset:0
    v_cvt_pk_bf16_f32 v200, v208, v209
    v_mfma_f32_16x16x32_bf16 v[0:3], a[64:67], a[0:3], v[32:35]
    v_cvt_pk_bf16_f32 v201, v210, v211
    v_mfma_f32_16x16x32_bf16 v[0:3], a[68:71], a[16:19], v[0:3]
    s_mov_b32 m0, s84
    ds_read_b128 a[100:103], v234 offset:1024
    v_cvt_pk_bf16_f32 v202, v212, v213
    v_mfma_f32_16x16x32_bf16 v[0:3], a[72:75], a[32:35], v[0:3]
    s_add_u32 s83, s83, 8192
    v_cvt_pk_bf16_f32 v203, v214, v215
    v_mfma_f32_16x16x32_bf16 v[0:3], a[76:79], a[48:51], v[0:3]
    s_waitcnt lgkmcnt(2)
    v_or3_b32 v232, v200, v201, v202
    v_mfma_f32_16x16x32_bf16 v[4:7], a[80:83], a[0:3], v[36:39]
    s_add_u32 s85, s85, 16384
    v_bitop3_b32 v232, v232, v203, s61 bitop3:0xa8
    v_mfma_f32_16x16x32_bf16 v[4:7], a[84:87], a[16:19], v[4:7]
    ds_read_b128 a[104:107], v234 offset:2048
    v_cmp_ne_u32 vcc, 0, v232
    v_mfma_f32_16x16x32_bf16 v[4:7], a[88:91], a[32:35], v[4:7]
    buffer_load_dwordx4 v245, s[32:35], s83 offen offset:0 sc1 lds
    v_mfma_f32_16x16x32_bf16 v[4:7], a[92:95], a[48:51], v[4:7]
    s_cbranch_vccnz L_fix_25
L_fixb_26:
    ds_read_b128 a[108:111], v234 offset:3072
    v_mfma_f32_16x16x32_bf16 v[8:11], a[64:67], a[4:7], v[40:43]
    v_exp_f32 v216, v0
    v_mfma_f32_16x16x32_bf16 v[8:11], a[68:71], a[20:23], v[8:11]
    ds_read_b128 a[112:115], v234 offset:4096
    v_mfma_f32_16x16x32_bf16 v[8:11], a[72:75], a[36:39], v[8:11]
    v_exp_f32 v217, v1
    v_mfma_f32_16x16x32_bf16 v[8:11], a[76:79], a[52:55], v[8:11]
    s_sub_u32 s73, s85, 163840
    v_exp_f32 v218, v2
    v_mfma_f32_16x16x32_bf16 v[12:15], a[80:83], a[4:7], v[44:47]
    v_exp_f32 v219, v3
    v_mfma_f32_16x16x32_bf16 v[12:15], a[84:87], a[20:23], v[12:15]
    v_exp_f32 v220, v4
    v_mfma_f32_16x16x32_bf16 v[12:15], a[88:91], a[36:39], v[12:15]
    s_min_u32 s85, s85, s73
    ds_read_b128 a[116:119], v234 offset:5120
    v_mfma_f32_16x16x32_bf16 v[12:15], a[92:95], a[52:55], v[12:15]
    buffer_load_dwordx4 v245, s[32:35], s83 offen offset:1024 sc1 lds
    v_mfma_f32_16x16x32_bf16 v[16:19], a[64:67], a[8:11], v[48:51]
    v_exp_f32 v224, v8
    v_mfma_f32_16x16x32_bf16 v[16:19], a[68:71], a[24:27], v[16:19]
    ds_read_b128 a[120:123], v234 offset:6144
    v_mfma_f32_16x16x32_bf16 v[16:19], a[72:75], a[40:43], v[16:19]
    v_exp_f32 v221, v5
    v_mfma_f32_16x16x32_bf16 v[16:19], a[76:79], a[56:59], v[16:19]
    buffer_load_dwordx4 v245, s[32:35], s83 offen offset:2048 sc1 lds
    v_mfma_f32_16x16x32_bf16 v[20:23], a[80:83], a[8:11], v[52:55]
    ds_read_b128 a[124:127], v234 offset:7168
    v_mfma_f32_16x16x32_bf16 v[20:23], a[84:87], a[24:27], v[20:23]
    v_exp_f32 v222, v6
    v_mfma_f32_16x16x32_bf16 v[20:23], a[88:91], a[40:43], v[20:23]
    v_exp_f32 v225, v9
    v_mfma_f32_16x16x32_bf16 v[20:23], a[92:95], a[56:59], v[20:23]
    s_waitcnt lgkmcnt(4)
    v_exp_f32 v223, v7
    v_mfma_f32_16x16x32_bf16 v[64:67], a[96:99], v[192:195], v[64:67]
    v_exp_f32 v208, v16
    v_mfma_f32_16x16x32_bf16 v[68:71], a[100:103], v[192:195], v[68:71]
    buffer_load_dwordx4 v245, s[32:35], s83 offen offset:3072 sc1 lds
    v_mfma_f32_16x16x32_bf16 v[72:75], a[104:107], v[192:195], v[72:75]
    v_exp_f32 v226, v10
    v_mfma_f32_16x16x32_bf16 v[76:79], a[108:111], v[192:195], v[76:79]
    s_waitcnt lgkmcnt(0)
    ds_read_b128 a[64:67], v234 offset:8192
    v_mfma_f32_16x16x32_bf16 v[80:83], a[112:115], v[192:195], v[80:83]
    v_exp_f32 v227, v11
    v_mfma_f32_16x16x32_bf16 v[84:87], a[116:119], v[192:195], v[84:87]
    ds_read_b128 a[68:71], v234 offset:9216
    v_mfma_f32_16x16x32_bf16 v[88:91], a[120:123], v[192:195], v[88:91]
    v_exp_f32 v228, v12
    v_mfma_f32_16x16x32_bf16 v[92:95], a[124:127], v[192:195], v[92:95]
    v_mfma_f32_16x16x32_bf16 a[128:131], a[144:147], v[192:195], a[128:131]
    s_add_u32 s84, s84, 16384
    ds_read_b128 a[72:75], v234 offset:10240
    v_cvt_pk_bf16_f32 v192, v216, v217
    v_mfma_f32_16x16x32_bf16 v[96:99], a[96:99], v[196:199], v[96:99]
    v_exp_f32 v229, v13
    v_mfma_f32_16x16x32_bf16 v[100:103], a[100:103], v[196:199], v[100:103]
    ds_read_b128 a[76:79], v234 offset:11264
    v_cvt_pk_bf16_f32 v193, v218, v219
    v_mfma_f32_16x16x32_bf16 v[104:107], a[104:107], v[196:199], v[104:107]
    s_sub_u32 s56, s84, 163840
    v_exp_f32 v230, v14
    v_mfma_f32_16x16x32_bf16 v[108:111], a[108:111], v[196:199], v[108:111]
    ds_read_b128 a[80:83], v234 offset:12288
    v_cvt_pk_bf16_f32 v194, v220, v221
    v_mfma_f32_16x16x32_bf16 v[112:115], a[112:115], v[196:199], v[112:115]
    v_exp_f32 v231, v15
    v_mfma_f32_16x16x32_bf16 v[116:119], a[116:119], v[196:199], v[116:119]
    ds_read_b128 a[84:87], v234 offset:13312
    v_cvt_pk_bf16_f32 v195, v222, v223
    v_mfma_f32_16x16x32_bf16 v[120:123], a[120:123], v[196:199], v[120:123]
    v_exp_f32 v209, v17
    v_mfma_f32_16x16x32_bf16 v[124:127], a[124:127], v[196:199], v[124:127]
    v_exp_f32 v210, v18
    v_mfma_f32_16x16x32_bf16 a[132:135], a[144:147], v[196:199], a[132:135]
    v_cvt_pk_bf16_f32 v196, v224, v225
    v_cvt_pk_bf16_f32 v197, v226, v227
    v_cvt_pk_bf16_f32 v198, v228, v229
    v_mfma_f32_16x16x32_bf16 v[128:131], a[96:99], v[200:203], v[128:131]
    v_exp_f32 v211, v19
    v_mfma_f32_16x16x32_bf16 v[132:135], a[100:103], v[200:203], v[132:135]
    ds_read_b128 a[88:91], v234 offset:14336
    v_or3_b32 v232, v192, v193, v194
    v_mfma_f32_16x16x32_bf16 v[136:139], a[104:107], v[200:203], v[136:139]
    s_min_u32 s84, s84, s56
    v_exp_f32 v212, v20
    v_mfma_f32_16x16x32_bf16 v[140:143], a[108:111], v[200:203], v[140:143]
    s_add_u32 s82, s82, 1
    ds_read_b128 a[92:95], v234 offset:15360
    v_cvt_pk_bf16_f32 v199, v230, v231
    v_mfma_f32_16x16x32_bf16 v[144:147], a[112:115], v[200:203], v[144:147]
    v_or3_b32 v232, v232, v195, v196
    v_or3_b32 v232, v232, v197, v198
    v_bitop3_b32 v232, v232, v199, s61 bitop3:0xa8
    v_cmp_ne_u32 vcc, 0, v232
    v_mfma_f32_16x16x32_bf16 v[148:151], a[116:119], v[200:203], v[148:151]
    v_exp_f32 v213, v21
    v_mfma_f32_16x16x32_bf16 v[152:155], a[120:123], v[200:203], v[152:155]
    v_exp_f32 v214, v22
    v_mfma_f32_16x16x32_bf16 v[156:159], a[124:127], v[200:203], v[156:159]
    s_cbranch_vccnz L_fix_27
L_fixb_28:
    v_exp_f32 v215, v23
    v_mfma_f32_16x16x32_bf16 a[136:139], a[144:147], v[200:203], a[136:139]
    v_add_u32 v234, s85, v245
    s_bitcmp1_b64 s[80:81], s82
    s_cbranch_scc0 L_body3
L_ev3:
    s_bitcmp1_b64 s[62:63], s82
    s_cbranch_scc1 L_sp_33
    s_waitcnt vmcnt(8) lgkmcnt(0)
    s_barrier
    s_branch L_body3
L_sp_33:
    s_and_b32 s56, s82, 3
    s_cbranch_scc1 L_nb_29
    s_waitcnt vmcnt(8) lgkmcnt(0)
    s_barrier
    s_cmp_eq_u32 s82, 8
    s_cbranch_scc0 L_nh_31
    s_and_b32 s73, s55, 0xfc
    s_add_u32 s73, s73, s52
    s_lshl_b32 s74, s73, 12
    s_lshl_b32 s73, s55, 2
    s_add_u32 s73, s73, s52
    v_and_b32 v238, 31, v255
    v_lshlrev_b32 v238, 7, v238
    v_add_u32 v238, s74, v238
    s_mul_i32 s74, s73, 1408
    v_min_u32 v239, 10, v255
    v_lshlrev_b32 v239, 7, v239
    v_add_u32 v239, s74, v239
    buffer_load_dword a200, v238, s[24:27], 0 offen
    buffer_load_dword a200, v239, s[36:39], 0 offen
    s_bfe_u32 s73, s55, 0x10002
    s_lshl_b32 s73, s73, 3
    s_bfe_u32 s74, s55, 0x30003
    s_add_u32 s74, s73, s74
    s_sub_u32 s75, 15, s74
    s_min_u32 s74, s74, s75
    s_lshl_b32 s100, s74, 7
    s_add_u32 s100, s100, 58725376
    s_mov_b32 s99, 58725376
    s_sub_u32 s73, s100, s99
    v_add_u32 v238, s73, v250
    s_bfe_u32 s73, s55, 0x10002
    s_lshl_b32 s73, s73, 4
    s_and_b32 s74, s53, 3
    s_add_u32 s73, s73, s74
    s_lshl_b32 s74, s54, 5
    s_add_u32 s73, s73, s74
    s_lshl_b32 s73, s73, 2
    v_and_b32 v239, 3, v255
    v_lshlrev_b32 v239, 4, v239
    v_cmp_gt_u32 vcc, 32, v255
    v_add_u32 v239, s73, v239
    s_nop 0
    v_cndmask_b32 v242, v239, v238, vcc
    buffer_load_dword v241, v242, s[48:51], s99 offen sc1
L_nh_31:
    s_cmp_eq_u32 s82, 12
    s_cbranch_scc0 L_nh2_32
    v_cmp_ne_u32 vcc, 1, v241
    s_nop 0
    s_cbranch_vccnz L_spin_34
L_back_35:
L_nh2_32:
L_nb_29:
    s_cmp_eq_u32 s82, s92
    s_cbranch_scc0 L_nm_30
    v_mov_b32 v238, 0xff800000
    v_cmp_gt_i32 s[76:77], 16, v236
    v_cmp_gt_i32 s[78:79], 17, v236
    s_nop 0
    v_cndmask_b32 v52, v48, v238, s[76:77]
    v_cndmask_b32 v53, v48, v238, s[78:79]
    v_cmp_gt_i32 s[76:77], 18, v236
    v_cmp_gt_i32 s[78:79], 19, v236
    s_nop 0
    v_cndmask_b32 v54, v48, v238, s[76:77]
    v_cndmask_b32 v55, v48, v238, s[78:79]
    v_cmp_gt_i32 s[76:77], 3, v236
    v_cmp_gt_i32 s[78:79], 2, v236
    s_nop 0
    v_cndmask_b32 v51, v48, v238, s[76:77]
    v_cndmask_b32 v50, v48, v238, s[78:79]
    v_cmp_gt_i32 s[76:77], 1, v236
    v_cmp_gt_i32 s[78:79], 0, v236
    s_nop 0
    v_cndmask_b32 v49, v48, v238, s[76:77]
    v_cndmask_b32 v48, v48, v238, s[78:79]
L_nm_30:
    s_cmp_eq_u32 s82, s88
    s_cbranch_scc0 L_body3
    s_cmp_eq_u32 s82, s91
    s_cbranch_scc0 L_nm_36
    v_mov_b32 v238, 0xff800000
    v_cmp_gt_i32 s[76:77], 16, v237
    v_cmp_gt_i32 s[78:79], 17, v237
    s_nop 0
    v_cndmask_b32 v44, v40, v238, s[76:77]
    v_cndmask_b32 v45, v40, v238, s[78:79]
    v_cmp_gt_i32 s[76:77], 18, v237
    v_cmp_gt_i32 s[78:79], 19, v237
    s_nop 0
    v_cndmask_b32 v46, v40, v238, s[76:77]
    v_cndmask_b32 v47, v40, v238, s[78:79]
    v_cmp_gt_i32 s[76:77], 3, v237
    v_cmp_gt_i32 s[78:79], 2, v237
    s_nop 0
    v_cndmask_b32 v43, v40, v238, s[76:77]
    v_cndmask_b32 v42, v40, v238, s[78:79]
    v_cmp_gt_i32 s[76:77], 1, v237
    v_cmp_gt_i32 s[78:79], 0, v237
    s_nop 0
    v_cndmask_b32 v41, v40, v238, s[76:77]
    v_cndmask_b32 v40, v40, v238, s[78:79]
L_nm_36:
    s_waitcnt lgkmcnt(4)
    ds_read_b128 a[96:99], v234 offset:0
    v_cvt_pk_bf16_f32 v200, v208, v209
    v_mfma_f32_16x16x32_bf16 v[0:3], a[64:67], a[0:3], v[32:35]
    v_cvt_pk_bf16_f32 v201, v210, v211
    v_mfma_f32_16x16x32_bf16 v[0:3], a[68:71], a[16:19], v[0:3]
    s_mov_b32 m0, s84
    ds_read_b128 a[100:103], v234 offset:1024
    v_cvt_pk_bf16_f32 v202, v212, v213
    v_mfma_f32_16x16x32_bf16 v[0:3], a[72:75], a[32:35], v[0:3]
    s_add_u32 s83, s83, 8192
    s_add_u32 s85, s85, 16384
    v_cvt_pk_bf16_f32 v203, v214, v215
    v_mfma_f32_16x16x32_bf16 v[0:3], a[76:79], a[48:51], v[0:3]
    s_waitcnt lgkmcnt(2)
    ds_read_b128 a[104:107], v234 offset:2048
    v_or3_b32 v232, v200, v201, v202
    v_mfma_f32_16x16x32_bf16 v[4:7], a[80:83], a[0:3], v[36:39]
    v_bitop3_b32 v232, v232, v203, s61 bitop3:0xa8
    v_mfma_f32_16x16x32_bf16 v[4:7], a[84:87], a[16:19], v[4:7]
    ds_read_b128 a[108:111], v234 offset:3072
    v_cmp_ne_u32 vcc, 0, v232
    v_mfma_f32_16x16x32_bf16 v[4:7], a[88:91], a[32:35], v[4:7]
    buffer_load_dwordx4 v245, s[32:35], s83 offen offset:0 sc1 lds
    v_mfma_f32_16x16x32_bf16 v[4:7], a[92:95], a[48:51], v[4:7]
    s_cbranch_vccnz L_fix_37
L_fixb_38:
    ds_read_b128 a[112:115], v234 offset:4096
    v_mfma_f32_16x16x32_bf16 v[8:11], a[64:67], a[4:7], v[40:43]
    s_sub_u32 s73, s85, 163840
    v_exp_f32 v216, v0
    v_mfma_f32_16x16x32_bf16 v[8:11], a[68:71], a[20:23], v[8:11]
    v_exp_f32 v217, v1
    v_mfma_f32_16x16x32_bf16 v[8:11], a[72:75], a[36:39], v[8:11]
    ds_read_b128 a[116:119], v234 offset:5120
    v_mfma_f32_16x16x32_bf16 v[8:11], a[76:79], a[52:55], v[8:11]
    s_min_u32 s85, s85, s73
    v_exp_f32 v218, v2
    v_mfma_f32_16x16x32_bf16 v[12:15], a[80:83], a[4:7], v[44:47]
    ds_read_b128 a[120:123], v234 offset:6144
    v_mfma_f32_16x16x32_bf16 v[12:15], a[84:87], a[20:23], v[12:15]
    buffer_load_dwordx4 v245, s[32:35], s83 offen offset:1024 sc1 lds
    v_mfma_f32_16x16x32_bf16 v[12:15], a[88:91], a[36:39], v[12:15]
    ds_read_b128 a[124:127], v234 offset:7168
    v_mfma_f32_16x16x32_bf16 v[12:15], a[92:95], a[52:55], v[12:15]
    s_waitcnt lgkmcnt(4)
    v_exp_f32 v219, v3
    v_mfma_f32_16x16x32_bf16 v[64:67], a[96:99], v[192:195], v[64:67]
    v_exp_f32 v220, v4
    v_mfma_f32_16x16x32_bf16 v[68:71], a[100:103], v[192:195], v[68:71]
    buffer_load_dwordx4 v245, s[32:35], s83 offen offset:2048 sc1 lds
    v_mfma_f32_16x16x32_bf16 v[72:75], a[104:107], v[192:195], v[72:75]
    ds_read_b128 a[64:67], v234 offset:8192
    v_mfma_f32_16x16x32_bf16 v[76:79], a[108:111], v[192:195], v[76:79]
    s_waitcnt lgkmcnt(1)
    v_exp_f32 v221, v5
    v_mfma_f32_16x16x32_bf16 v[80:83], a[112:115], v[192:195], v[80:83]
    v_exp_f32 v222, v6
    v_mfma_f32_16x16x32_bf16 v[84:87], a[116:119], v[192:195], v[84:87]
    buffer_load_dwordx4 v245, s[32:35], s83 offen offset:3072 sc1 lds
    v_mfma_f32_16x16x32_bf16 v[88:91], a[120:123], v[192:195], v[88:91]
    ds_read_b128 a[68:71], v234 offset:9216
    v_mfma_f32_16x16x32_bf16 v[92:95], a[124:127], v[192:195], v[92:95]
    v_exp_f32 v223, v7
    v_mfma_f32_16x16x32_bf16 a[128:131], a[144:147], v[192:195], a[128:131]
    s_add_u32 s84, s84, 16384
    ds_read_b128 a[72:75], v234 offset:10240
    v_mfma_f32_16x16x32_bf16 v[96:99], a[96:99], v[196:199], v[96:99]
    v_mfma_f32_16x16x32_bf16 v[100:103], a[100:103], v[196:199], v[100:103]
    v_exp_f32 v208, v8
    v_mfma_f32_16x16x32_bf16 v[104:107], a[104:107], v[196:199], v[104:107]
    ds_read_b128 a[76:79], v234 offset:11264
    v_cvt_pk_bf16_f32 v192, v216, v217
    v_mfma_f32_16x16x32_bf16 v[108:111], a[108:111], v[196:199], v[108:111]
    v_exp_f32 v209, v9
    v_mfma_f32_16x16x32_bf16 v[112:115], a[112:115], v[196:199], v[112:115]
    ds_read_b128 a[80:83], v234 offset:12288
    v_mfma_f32_16x16x32_bf16 v[116:119], a[116:119], v[196:199], v[116:119]
    v_exp_f32 v210, v10
    v_mfma_f32_16x16x32_bf16 v[120:123], a[120:123], v[196:199], v[120:123]
    ds_read_b128 a[84:87], v234 offset:13312
    v_cvt_pk_bf16_f32 v193, v218, v219
    v_mfma_f32_16x16x32_bf16 v[124:127], a[124:127], v[196:199], v[124:127]
    v_exp_f32 v211, v11
    v_mfma_f32_16x16x32_bf16 a[132:135], a[144:147], v[196:199], a[132:135]
    v_exp_f32 v212, v12
    v_mfma_f32_16x16x32_bf16 v[128:131], a[96:99], v[200:203], v[128:131]
    s_sub_u32 s56, s84, 163840
    ds_read_b128 a[88:91], v234 offset:14336
    v_cvt_pk_bf16_f32 v194, v220, v221
    v_mfma_f32_16x16x32_bf16 v[132:135], a[100:103], v[200:203], v[132:135]
    s_min_u32 s84, s84, s56
    v_cvt_pk_bf16_f32 v195, v222, v223
    v_mfma_f32_16x16x32_bf16 v[136:139], a[104:107], v[200:203], v[136:139]
    v_exp_f32 v213, v13
    v_mfma_f32_16x16x32_bf16 v[140:143], a[108:111], v[200:203], v[140:143]
    s_add_u32 s82, s82, 1
    ds_read_b128 a[92:95], v234 offset:15360
    v_add_u32 v234, s85, v245
    v_mfma_f32_16x16x32_bf16 v[144:147], a[112:115], v[200:203], v[144:147]
    v_or3_b32 v232, v192, v193, v194
    v_mfma_f32_16x16x32_bf16 v[148:151], a[116:119], v[200:203], v[148:151]
    v_bitop3_b32 v232, v232, v195, s61 bitop3:0xa8
    v_mfma_f32_16x16x32_bf16 v[152:155], a[120:123], v[200:203], v[152:155]
    v_cmp_ne_u32 vcc, 0, v232
    v_mfma_f32_16x16x32_bf16 v[156:159], a[124:127], v[200:203], v[156:159]
    v_exp_f32 v214, v14
    v_mfma_f32_16x16x32_bf16 a[136:139], a[144:147], v[200:203], a[136:139]
    s_cbranch_vccnz L_fix_39
L_fixb_40:
    v_exp_f32 v215, v15
    s_nop 5
    v_accvgpr_read_b32 v238, a136
    v_rcp_f32 v238, v238
    s_nop 0
    v_pk_mul_f32 v[128:129], v[128:129], v[238:239] op_sel_hi:[1,0]
    v_pk_mul_f32 v[130:131], v[130:131], v[238:239] op_sel_hi:[1,0]
    v_pk_mul_f32 v[132:133], v[132:133], v[238:239] op_sel_hi:[1,0]
    v_pk_mul_f32 v[134:135], v[134:135], v[238:239] op_sel_hi:[1,0]
    v_cvt_pk_bf16_f32 v216, v128, v129
    v_cvt_pk_bf16_f32 v217, v130, v131
    v_cvt_pk_bf16_f32 v218, v132, v133
    v_cvt_pk_bf16_f32 v219, v134, v135
    buffer_store_dwordx4 v[216:219], v245, s[48:51], s71 offen sc1
    v_pk_mul_f32 v[136:137], v[136:137], v[238:239] op_sel_hi:[1,0]
    v_pk_mul_f32 v[138:139], v[138:139], v[238:239] op_sel_hi:[1,0]
    v_pk_mul_f32 v[140:141], v[140:141], v[238:239] op_sel_hi:[1,0]
    v_pk_mul_f32 v[142:143], v[142:143], v[238:239] op_sel_hi:[1,0]
    v_cvt_pk_bf16_f32 v220, v136, v137
    v_cvt_pk_bf16_f32 v221, v138, v139
    v_cvt_pk_bf16_f32 v222, v140, v141
    v_cvt_pk_bf16_f32 v223, v142, v143
    buffer_store_dwordx4 v[220:223], v246, s[48:51], s71 offen sc1
    v_pk_mul_f32 v[144:145], v[144:145], v[238:239] op_sel_hi:[1,0]
    v_pk_mul_f32 v[146:147], v[146:147], v[238:239] op_sel_hi:[1,0]
    v_pk_mul_f32 v[148:149], v[148:149], v[238:239] op_sel_hi:[1,0]
    v_pk_mul_f32 v[150:151], v[150:151], v[238:239] op_sel_hi:[1,0]
    v_cvt_pk_bf16_f32 v224, v144, v145
    v_cvt_pk_bf16_f32 v225, v146, v147
    v_cvt_pk_bf16_f32 v226, v148, v149
    v_cvt_pk_bf16_f32 v227, v150, v151
    buffer_store_dwordx4 v[224:227], v247, s[48:51], s71 offen sc1
    v_pk_mul_f32 v[152:153], v[152:153], v[238:239] op_sel_hi:[1,0]
    v_pk_mul_f32 v[154:155], v[154:155], v[238:239] op_sel_hi:[1,0]
    v_pk_mul_f32 v[156:157], v[156:157], v[238:239] op_sel_hi:[1,0]
    v_pk_mul_f32 v[158:159], v[158:159], v[238:239] op_sel_hi:[1,0]
    v_cvt_pk_bf16_f32 v228, v152, v153
    v_cvt_pk_bf16_f32 v229, v154, v155
    v_cvt_pk_bf16_f32 v230, v156, v157
    v_cvt_pk_bf16_f32 v231, v158, v159
    buffer_store_dwordx4 v[228:231], v248, s[48:51], s71 offen sc1
    s_bitcmp1_b64 s[80:81], s82
    s_cbranch_scc1 L_ev2
.p2align 6
L_body2:
    s_waitcnt lgkmcnt(4)
    ds_read_b128 a[96:99], v234 offset:0
    v_cvt_pk_bf16_f32 v196, v208, v209
    v_mfma_f32_16x16x32_bf16 v[0:3], a[64:67], a[0:3], v[32:35]
    ds_read_b128 a[100:103], v234 offset:1024
    v_cvt_pk_bf16_f32 v197, v210, v211
    v_mfma_f32_16x16x32_bf16 v[0:3], a[68:71], a[16:19], v[0:3]
    ds_read_b128 a[104:107], v234 offset:2048
    v_cvt_pk_bf16_f32 v198, v212, v213
    v_mfma_f32_16x16x32_bf16 v[0:3], a[72:75], a[32:35], v[0:3]
    s_mov_b32 m0, s84
    ds_read_b128 a[108:111], v234 offset:3072
    v_cvt_pk_bf16_f32 v199, v214, v215
    v_mfma_f32_16x16x32_bf16 v[0:3], a[76:79], a[48:51], v[0:3]
    s_waitcnt lgkmcnt(4)
    ds_read_b128 a[112:115], v234 offset:4096
    v_or3_b32 v232, v196, v197, v198
    v_mfma_f32_16x16x32_bf16 v[4:7], a[80:83], a[0:3], v[36:39]
    ds_read_b128 a[116:119], v234 offset:5120
    v_bitop3_b32 v232, v232, v199, s61 bitop3:0xa8
    v_mfma_f32_16x16x32_bf16 v[4:7], a[84:87], a[16:19], v[4:7]
    s_add_u32 s83, s83, 8192
    v_cmp_ne_u32 vcc, 0, v232
    v_mfma_f32_16x16x32_bf16 v[4:7], a[88:91], a[32:35], v[4:7]
    buffer_load_dwordx4 v245, s[32:35], s83 offen offset:0 sc1 lds
    v_mfma_f32_16x16x32_bf16 v[4:7], a[92:95], a[48:51], v[4:7]
    s_cbranch_vccnz L_fix_41
L_fixb_42:
    ds_read_b128 a[120:123], v234 offset:6144
    ds_read_b128 a[124:127], v234 offset:7168
    v_mfma_f32_16x16x32_bf16 v[8:11], a[64:67], a[4:7], v[40:43]
    v_exp_f32 v216, v0
    v_mfma_f32_16x16x32_bf16 v[8:11], a[68:71], a[20:23], v[8:11]
    s_add_u32 s85, s85, 16384
    v_exp_f32 v217, v1
    v_mfma_f32_16x16x32_bf16 v[8:11], a[72:75], a[36:39], v[8:11]
    buffer_load_dwordx4 v245, s[32:35], s83 offen offset:1024 sc1 lds
    v_mfma_f32_16x16x32_bf16 v[8:11], a[76:79], a[52:55], v[8:11]
    v_exp_f32 v218, v2
    v_mfma_f32_16x16x32_bf16 v[12:15], a[80:83], a[4:7], v[44:47]
    s_sub_u32 s73, s85, 163840
    v_exp_f32 v219, v3
    v_mfma_f32_16x16x32_bf16 v[12:15], a[84:87], a[20:23], v[12:15]
    s_min_u32 s85, s85, s73
    v_exp_f32 v220, v4
    v_mfma_f32_16x16x32_bf16 v[12:15], a[88:91], a[36:39], v[12:15]
    buffer_load_dwordx4 v245, s[32:35], s83 offen offset:2048 sc1 lds
    v_mfma_f32_16x16x32_bf16 v[12:15], a[92:95], a[52:55], v[12:15]
    s_waitcnt lgkmcnt(4)
    v_exp_f32 v221, v5
    v_mfma_f32_16x16x32_bf16 v[64:67], a[96:99], v[192:195], v[64:67]
    v_exp_f32 v208, v8
    v_mfma_f32_16x16x32_bf16 v[68:71], a[100:103], v[192:195], v[68:71]
    v_exp_f32 v222, v6
    v_mfma_f32_16x16x32_bf16 v[72:75], a[104:107], v[192:195], v[72:75]
    buffer_load_dwordx4 v245, s[32:35], s83 offen offset:3072 sc1 lds
    v_mfma_f32_16x16x32_bf16 v[76:79], a[108:111], v[192:195], v[76:79]
    s_waitcnt lgkmcnt(0)
    v_exp_f32 v223, v7
    v_mfma_f32_16x16x32_bf16 v[80:83], a[112:115], v[192:195], v[80:83]
    v_exp_f32 v209, v9
    v_mfma_f32_16x16x32_bf16 v[84:87], a[116:119], v[192:195], v[84:87]
    s_add_u32 s84, s84, 16384
    v_exp_f32 v210, v10
    v_mfma_f32_16x16x32_bf16 v[88:91], a[120:123], v[192:195], v[88:91]
    ds_read_b128 a[64:67], v234 offset:8192
    ds_read_b128 a[68:71], v234 offset:9216
    v_mfma_f32_16x16x32_bf16 v[92:95], a[124:127], v[192:195], v[92:95]
    ds_read_b128 a[72:75], v234 offset:10240
    ds_read_b128 a[76:79], v234 offset:11264
    v_mfma_f32_16x16x32_bf16 a[128:131], a[144:147], v[192:195], a[128:131]
    s_sub_u32 s56, s84, 163840
    ds_read_b128 a[80:83], v234 offset:12288
    ds_read_b128 a[84:87], v234 offset:13312
    v_mfma_f32_16x16x32_bf16 v[96:99], a[96:99], v[196:199], v[96:99]
    ds_read_b128 a[88:91], v234 offset:14336
    v_cvt_pk_bf16_f32 v192, v216, v217
    v_mfma_f32_16x16x32_bf16 v[100:103], a[100:103], v[196:199], v[100:103]
    v_cvt_pk_bf16_f32 v193, v218, v219
    v_cvt_pk_bf16_f32 v194, v220, v221
    v_cvt_pk_bf16_f32 v195, v222, v223
    v_mfma_f32_16x16x32_bf16 v[104:107], a[104:107], v[196:199], v[104:107]
    s_add_u32 s82, s82, 1
    v_exp_f32 v211, v11
    v_mfma_f32_16x16x32_bf16 v[108:111], a[108:111], v[196:199], v[108:111]
    s_min_u32 s84, s84, s56
    ds_read_b128 a[92:95], v234 offset:15360
    v_add_u32 v234, s85, v245
    v_mfma_f32_16x16x32_bf16 v[112:115], a[112:115], v[196:199], v[112:115]
    v_or3_b32 v232, v192, v193, v194
    v_bitop3_b32 v232, v232, v195, s61 bitop3:0xa8
    v_cmp_ne_u32 vcc, 0, v232
    v_mfma_f32_16x16x32_bf16 v[116:119], a[116:119], v[196:199], v[116:119]
    v_exp_f32 v212, v12
    v_mfma_f32_16x16x32_bf16 v[120:123], a[120:123], v[196:199], v[120:123]
    v_exp_f32 v213, v13
    v_mfma_f32_16x16x32_bf16 v[124:127], a[124:127], v[196:199], v[124:127]
    v_exp_f32 v214, v14
    v_mfma_f32_16x16x32_bf16 a[132:135], a[144:147], v[196:199], a[132:135]
    s_cbranch_vccnz L_fix_43
L_fixb_44:
    v_exp_f32 v215, v15
    s_bitcmp1_b64 s[80:81], s82
    s_cbranch_scc0 L_body2
L_ev2:
    s_bitcmp1_b64 s[62:63], s82
    s_cbranch_scc1 L_sp_49
    s_waitcnt vmcnt(8) lgkmcnt(0)
    s_barrier
    s_branch L_body2
L_sp_49:
    s_and_b32 s56, s82, 3
    s_cbranch_scc1 L_nb_45
    s_waitcnt vmcnt(8) lgkmcnt(0)
    s_barrier
    s_cmp_eq_u32 s82, 8
    s_cbranch_scc0 L_nh_47
    s_and_b32 s73, s55, 0xfc
    s_add_u32 s73, s73, s52
    s_lshl_b32 s74, s73, 12
    s_lshl_b32 s73, s55, 2
    s_add_u32 s73, s73, s52
    v_and_b32 v238, 31, v255
    v_lshlrev_b32 v238, 7, v238
    v_add_u32 v238, s74, v238
    s_mul_i32 s74, s73, 1408
    v_min_u32 v239, 10, v255
    v_lshlrev_b32 v239, 7, v239
    v_add_u32 v239, s74, v239
    buffer_load_dword a200, v238, s[24:27], 0 offen
    buffer_load_dword a200, v239, s[36:39], 0 offen
    s_bfe_u32 s73, s55, 0x10002
    s_lshl_b32 s73, s73, 3
    s_bfe_u32 s74, s55, 0x30003
    s_add_u32 s74, s73, s74
    s_sub_u32 s75, 15, s74
    s_min_u32 s74, s74, s75
    s_lshl_b32 s100, s74, 7
    s_add_u32 s100, s100, 58725376
    s_mov_b32 s99, 58725376
    s_sub_u32 s73, s100, s99
    v_add_u32 v238, s73, v250
    s_bfe_u32 s73, s55, 0x10002
    s_lshl_b32 s73, s73, 4
    s_and_b32 s74, s53, 3
    s_add_u32 s73, s73, s74
    s_lshl_b32 s74, s54, 5
    s_add_u32 s73, s73, s74
    s_lshl_b32 s73, s73, 2
    v_and_b32 v239, 3, v255
    v_lshlrev_b32 v239, 4, v239
    v_cmp_gt_u32 vcc, 32, v255
    v_add_u32 v239, s73, v239
    s_nop 0
    v_cndmask_b32 v242, v239, v238, vcc
    buffer_load_dword v241, v242, s[48:51], s99 offen sc1
L_nh_47:
    s_cmp_eq_u32 s82, 12
    s_cbranch_scc0 L_nh2_48
    v_cmp_ne_u32 vcc, 1, v241
    s_nop 0
    s_cbranch_vccnz L_spin_50
L_back_51:
L_nh2_48:
    s_cmp_eq_u32 s82, s65
    s_cbranch_scc0 L_ne_52
    s_and_b32 s73, s58, 1
    s_lshl_b32 s73, s73, 10
    v_add_u32 v241, s73, v245
    v_xor_b32 v242, 0x400, v241
    buffer_load_dwordx4 v[128:131], v241, s[8:11], s94 offen offset:0 sc1
    buffer_load_dwordx4 v[132:135], v242, s[8:11], s94 offen offset:0 sc1
    s_add_u32 s94, s94, 4096
    buffer_load_dwordx4 v[136:139], v241, s[8:11], s94 offen offset:0 sc1
    buffer_load_dwordx4 v[140:143], v242, s[8:11], s94 offen offset:0 sc1
    s_add_u32 s94, s94, 4096
    buffer_load_dwordx4 v[144:147], v241, s[8:11], s94 offen offset:0 sc1
    buffer_load_dwordx4 v[148:151], v242, s[8:11], s94 offen offset:0 sc1
    s_add_u32 s94, s94, 4096
    buffer_load_dwordx4 v[152:155], v241, s[8:11], s94 offen offset:0 sc1
    buffer_load_dwordx4 v[156:159], v242, s[8:11], s94 offen offset:0 sc1
    s_add_u32 s94, s94, 4096
    buffer_load_dwordx2 a[208:209], v252, s[4:7], 0 offen offset:0
    buffer_load_dwordx2 a[210:211], v252, s[4:7], 0 offen offset:32
    buffer_load_dwordx2 a[212:213], v252, s[4:7], 0 offen offset:64
    buffer_load_dwordx2 a[214:215], v252, s[4:7], 0 offen offset:96
    s_and_b32 s73, s59, 7
    s_mul_i32 s73, s73, 44
    s_mul_i32 s74, s52, 11
    s_add_u32 s73, s73, s74
    s_lshl_b32 s73, s73, 10
    s_add_u32 s73, s73, s95
    s_lshl_b32 s74, s60, 8
    s_add_u32 s73, s73, s74
    v_min_u32 v238, 21, v255
    v_lshrrev_b32 v239, 1, v238
    v_and_b32 v238, 1, v238
    v_lshlrev_b32 v238, 7, v238
    v_lshl_add_u32 v238, v239, 10, v238
    buffer_load_dword a200, v238, s[36:39], s73 offen
L_ne_52:
L_nb_45:
    s_cmp_eq_u32 s82, s91
    s_cbranch_scc0 L_nm_46
    v_mov_b32 v238, 0xff800000
    v_cmp_gt_i32 s[76:77], 16, v237
    v_cmp_gt_i32 s[78:79], 17, v237
    s_nop 0
    v_cndmask_b32 v44, v40, v238, s[76:77]
    v_cndmask_b32 v45, v40, v238, s[78:79]
    v_cmp_gt_i32 s[76:77], 18, v237
    v_cmp_gt_i32 s[78:79], 19, v237
    s_nop 0
    v_cndmask_b32 v46, v40, v238, s[76:77]
    v_cndmask_b32 v47, v40, v238, s[78:79]
    v_cmp_gt_i32 s[76:77], 3, v237
    v_cmp_gt_i32 s[78:79], 2, v237
    s_nop 0
    v_cndmask_b32 v43, v40, v238, s[76:77]
    v_cndmask_b32 v42, v40, v238, s[78:79]
    v_cmp_gt_i32 s[76:77], 1, v237
    v_cmp_gt_i32 s[78:79], 0, v237
    s_nop 0
    v_cndmask_b32 v41, v40, v238, s[76:77]
    v_cndmask_b32 v40, v40, v238, s[78:79]
L_nm_46:
    s_cmp_eq_u32 s82, s87
    s_cbranch_scc0 L_body2
    s_cmp_eq_u32 s82, s90
    s_cbranch_scc0 L_nm_53
    v_mov_b32 v238, 0xff800000
    v_cmp_gt_i32 s[76:77], 16, v236
    v_cmp_gt_i32 s[78:79], 17, v236
    s_nop 0
    v_cndmask_b32 v36, v32, v238, s[76:77]
    v_cndmask_b32 v37, v32, v238, s[78:79]
    v_cmp_gt_i32 s[76:77], 18, v236
    v_cmp_gt_i32 s[78:79], 19, v236
    s_nop 0
    v_cndmask_b32 v38, v32, v238, s[76:77]
    v_cndmask_b32 v39, v32, v238, s[78:79]
    v_cmp_gt_i32 s[76:77], 3, v236
    v_cmp_gt_i32 s[78:79], 2, v236
    s_nop 0
    v_cndmask_b32 v35, v32, v238, s[76:77]
    v_cndmask_b32 v34, v32, v238, s[78:79]
    v_cmp_gt_i32 s[76:77], 1, v236
    v_cmp_gt_i32 s[78:79], 0, v236
    s_nop 0
    v_cndmask_b32 v33, v32, v238, s[76:77]
    v_cndmask_b32 v32, v32, v238, s[78:79]
L_nm_53:
    s_waitcnt lgkmcnt(4)
    ds_read_b128 a[96:99], v234 offset:0
    v_cvt_pk_bf16_f32 v196, v208, v209
    v_mfma_f32_16x16x32_bf16 v[0:3], a[64:67], a[0:3], v[32:35]
    s_mov_b32 m0, s84
    ds_read_b128 a[100:103], v234 offset:1024
    v_cvt_pk_bf16_f32 v197, v210, v211
    v_mfma_f32_16x16x32_bf16 v[0:3], a[68:71], a[16:19], v[0:3]
    s_add_u32 s83, s83, 8192
    ds_read_b128 a[104:107], v234 offset:2048
    v_cvt_pk_bf16_f32 v198, v212, v213
    v_mfma_f32_16x16x32_bf16 v[0:3], a[72:75], a[32:35], v[0:3]
    s_add_u32 s85, s85, 16384
    ds_read_b128 a[108:111], v234 offset:3072
    v_cvt_pk_bf16_f32 v199, v214, v215
    v_mfma_f32_16x16x32_bf16 v[0:3], a[76:79], a[48:51], v[0:3]
    s_waitcnt lgkmcnt(4)
    ds_read_b128 a[112:115], v234 offset:4096
    v_or3_b32 v232, v196, v197, v198
    v_mfma_f32_16x16x32_bf16 v[4:7], a[80:83], a[0:3], v[36:39]
    ds_read_b128 a[116:119], v234 offset:5120
    v_bitop3_b32 v232, v232, v199, s61 bitop3:0xa8
    v_mfma_f32_16x16x32_bf16 v[4:7], a[84:87], a[16:19], v[4:7]
    s_sub_u32 s73, s85, 163840
    ds_read_b128 a[120:123], v234 offset:6144
    v_cmp_ne_u32 vcc, 0, v232
    v_mfma_f32_16x16x32_bf16 v[4:7], a[88:91], a[32:35], v[4:7]
    s_min_u32 s85, s85, s73
    ds_read_b128 a[124:127], v234 offset:7168
    v_mfma_f32_16x16x32_bf16 v[4:7], a[92:95], a[48:51], v[4:7]
    s_cbranch_vccnz L_fix_54
L_fixb_55:
    s_waitcnt lgkmcnt(4)
    ds_read_b128 a[64:67], v234 offset:8192
    v_mfma_f32_16x16x32_bf16 v[64:67], a[96:99], v[192:195], v[64:67]
    buffer_load_dwordx4 v245, s[32:35], s83 offen offset:0 sc1 lds
    v_mfma_f32_16x16x32_bf16 v[68:71], a[100:103], v[192:195], v[68:71]
    v_exp_f32 v208, v0
    v_mfma_f32_16x16x32_bf16 v[72:75], a[104:107], v[192:195], v[72:75]
    v_exp_f32 v209, v1
    v_mfma_f32_16x16x32_bf16 v[76:79], a[108:111], v[192:195], v[76:79]
    s_waitcnt lgkmcnt(1)
    ds_read_b128 a[68:71], v234 offset:9216
    ds_read_b128 a[72:75], v234 offset:10240
    v_mfma_f32_16x16x32_bf16 v[80:83], a[112:115], v[192:195], v[80:83]
    v_exp_f32 v210, v2
    v_mfma_f32_16x16x32_bf16 v[84:87], a[116:119], v[192:195], v[84:87]
    buffer_load_dwordx4 v245, s[32:35], s83 offen offset:1024 sc1 lds
    v_mfma_f32_16x16x32_bf16 v[88:91], a[120:123], v[192:195], v[88:91]
    v_exp_f32 v211, v3
    v_mfma_f32_16x16x32_bf16 v[92:95], a[124:127], v[192:195], v[92:95]
    ds_read_b128 a[76:79], v234 offset:11264
    v_mfma_f32_16x16x32_bf16 a[128:131], a[144:147], v[192:195], a[128:131]
    ds_read_b128 a[80:83], v234 offset:12288
    ds_read_b128 a[84:87], v234 offset:13312
    v_mfma_f32_16x16x32_bf16 v[96:99], a[96:99], v[196:199], v[96:99]
    buffer_load_dwordx4 v245, s[32:35], s83 offen offset:2048 sc1 lds
    v_mfma_f32_16x16x32_bf16 v[100:103], a[100:103], v[196:199], v[100:103]
    ds_read_b128 a[88:91], v234 offset:14336
    ds_read_b128 a[92:95], v234 offset:15360
    v_mfma_f32_16x16x32_bf16 v[104:107], a[104:107], v[196:199], v[104:107]
    v_exp_f32 v212, v4
    v_mfma_f32_16x16x32_bf16 v[108:111], a[108:111], v[196:199], v[108:111]
    buffer_load_dwordx4 v245, s[32:35], s83 offen offset:3072 sc1 lds
    v_mfma_f32_16x16x32_bf16 v[112:115], a[112:115], v[196:199], v[112:115]
    s_add_u32 s84, s84, 16384
    s_sub_u32 s56, s84, 163840
    s_min_u32 s84, s84, s56
    v_mfma_f32_16x16x32_bf16 v[116:119], a[116:119], v[196:199], v[116:119]
    s_add_u32 s82, s82, 1
    v_exp_f32 v213, v5
    v_mfma_f32_16x16x32_bf16 v[120:123], a[120:123], v[196:199], v[120:123]
    v_exp_f32 v214, v6
    v_mfma_f32_16x16x32_bf16 v[124:127], a[124:127], v[196:199], v[124:127]
    v_exp_f32 v215, v7
    v_mfma_f32_16x16x32_bf16 a[132:135], a[144:147], v[196:199], a[132:135]
    v_add_u32 v234, s85, v245
    s_nop 6
    v_accvgpr_read_b32 v238, a132
    v_rcp_f32 v238, v238
    s_nop 0
    v_pk_mul_f32 v[96:97], v[96:97], v[238:239] op_sel_hi:[1,0]
    v_pk_mul_f32 v[98:99], v[98:99], v[238:239] op_sel_hi:[1,0]
    v_pk_mul_f32 v[100:101], v[100:101], v[238:239] op_sel_hi:[1,0]
    v_pk_mul_f32 v[102:103], v[102:103], v[238:239] op_sel_hi:[1,0]
    v_cvt_pk_bf16_f32 v216, v96, v97
    v_cvt_pk_bf16_f32 v217, v98, v99
    v_cvt_pk_bf16_f32 v218, v100, v101
    v_cvt_pk_bf16_f32 v219, v102, v103
    buffer_store_dwordx4 v[216:219], v245, s[48:51], s70 offen sc1
    v_pk_mul_f32 v[104:105], v[104:105], v[238:239] op_sel_hi:[1,0]
    v_pk_mul_f32 v[106:107], v[106:107], v[238:239] op_sel_hi:[1,0]
    v_pk_mul_f32 v[108:109], v[108:109], v[238:239] op_sel_hi:[1,0]
    v_pk_mul_f32 v[110:111], v[110:111], v[238:239] op_sel_hi:[1,0]
    v_cvt_pk_bf16_f32 v220, v104, v105
    v_cvt_pk_bf16_f32 v221, v106, v107
    v_cvt_pk_bf16_f32 v222, v108, v109
    v_cvt_pk_bf16_f32 v223, v110, v111
    buffer_store_dwordx4 v[220:223], v246, s[48:51], s70 offen sc1
    v_pk_mul_f32 v[112:113], v[112:113], v[238:239] op_sel_hi:[1,0]
    v_pk_mul_f32 v[114:115], v[114:115], v[238:239] op_sel_hi:[1,0]
    v_pk_mul_f32 v[116:117], v[116:117], v[238:239] op_sel_hi:[1,0]
    v_pk_mul_f32 v[118:119], v[118:119], v[238:239] op_sel_hi:[1,0]
    v_cvt_pk_bf16_f32 v224, v112, v113
    v_cvt_pk_bf16_f32 v225, v114, v115
    v_cvt_pk_bf16_f32 v226, v116, v117
    v_cvt_pk_bf16_f32 v227, v118, v119
    buffer_store_dwordx4 v[224:227], v247, s[48:51], s70 offen sc1
    v_pk_mul_f32 v[120:121], v[120:121], v[238:239] op_sel_hi:[1,0]
    v_pk_mul_f32 v[122:123], v[122:123], v[238:239] op_sel_hi:[1,0]
    v_pk_mul_f32 v[124:125], v[124:125], v[238:239] op_sel_hi:[1,0]
    v_pk_mul_f32 v[126:127], v[126:127], v[238:239] op_sel_hi:[1,0]
    v_cvt_pk_bf16_f32 v228, v120, v121
    v_cvt_pk_bf16_f32 v229, v122, v123
    v_cvt_pk_bf16_f32 v230, v124, v125
    v_cvt_pk_bf16_f32 v231, v126, v127
    buffer_store_dwordx4 v[228:231], v248, s[48:51], s70 offen sc1
    s_bitcmp1_b64 s[80:81], s82
    s_cbranch_scc1 L_ev1
.p2align 6
L_body1:
    v_cvt_pk_bf16_f32 v192, v208, v209
    v_cvt_pk_bf16_f32 v193, v210, v211
    v_cvt_pk_bf16_f32 v194, v212, v213
    v_cvt_pk_bf16_f32 v195, v214, v215
    v_or3_b32 v232, v192, v193, v194
    v_bitop3_b32 v232, v232, v195, s61 bitop3:0xa8
    v_cmp_ne_u32 vcc, 0, v232
    s_nop 0
    s_cbranch_vccnz L_fix_56
L_fixb_57:
    s_waitcnt lgkmcnt(4)
    v_mfma_f32_16x16x32_bf16 v[0:3], a[64:67], a[0:3], v[32:35]
    s_mov_b32 m0, s84
    ds_read_b128 a[96:99], v234 offset:0
    ds_read_b128 a[100:103], v234 offset:1024
    v_mfma_f32_16x16x32_bf16 v[0:3], a[68:71], a[16:19], v[0:3]
    s_add_u32 s83, s83, 8192
    ds_read_b128 a[104:107], v234 offset:2048
    ds_read_b128 a[108:111], v234 offset:3072
    v_mfma_f32_16x16x32_bf16 v[0:3], a[72:75], a[32:35], v[0:3]
    buffer_load_dwordx4 v245, s[32:35], s83 offen offset:0 sc1 lds
    v_mfma_f32_16x16x32_bf16 v[0:3], a[76:79], a[48:51], v[0:3]
    s_waitcnt lgkmcnt(4)
    s_add_u32 s85, s85, 16384
    ds_read_b128 a[112:115], v234 offset:4096
    v_mfma_f32_16x16x32_bf16 v[4:7], a[80:83], a[0:3], v[36:39]
    s_sub_u32 s73, s85, 163840
    ds_read_b128 a[116:119], v234 offset:5120
    v_mfma_f32_16x16x32_bf16 v[4:7], a[84:87], a[16:19], v[4:7]
    s_min_u32 s85, s85, s73
    ds_read_b128 a[120:123], v234 offset:6144
    ds_read_b128 a[124:127], v234 offset:7168
    v_mfma_f32_16x16x32_bf16 v[4:7], a[88:91], a[32:35], v[4:7]
    buffer_load_dwordx4 v245, s[32:35], s83 offen offset:1024 sc1 lds
    v_mfma_f32_16x16x32_bf16 v[4:7], a[92:95], a[48:51], v[4:7]
    s_waitcnt lgkmcnt(4)
    ds_read_b128 a[64:67], v234 offset:8192
    ds_read_b128 a[68:71], v234 offset:9216
    v_mfma_f32_16x16x32_bf16 v[64:67], a[96:99], v[192:195], v[64:67]
    ds_read_b128 a[72:75], v234 offset:10240
    ds_read_b128 a[76:79], v234 offset:11264
    v_mfma_f32_16x16x32_bf16 v[68:71], a[100:103], v[192:195], v[68:71]
    buffer_load_dwordx4 v245, s[32:35], s83 offen offset:2048 sc1 lds
    v_mfma_f32_16x16x32_bf16 v[72:75], a[104:107], v[192:195], v[72:75]
    s_add_u32 s82, s82, 1
    ds_read_b128 a[80:83], v234 offset:12288
    v_exp_f32 v208, v0
    v_mfma_f32_16x16x32_bf16 v[76:79], a[108:111], v[192:195], v[76:79]
    s_waitcnt lgkmcnt(5)
    ds_read_b128 a[84:87], v234 offset:13312
    ds_read_b128 a[88:91], v234 offset:14336
    ds_read_b128 a[92:95], v234 offset:15360
    v_mfma_f32_16x16x32_bf16 v[80:83], a[112:115], v[192:195], v[80:83]
    s_add_u32 s84, s84, 16384
    s_sub_u32 s56, s84, 163840
    s_min_u32 s84, s84, s56
    buffer_load_dwordx4 v245, s[32:35], s83 offen offset:3072 sc1 lds
    v_mfma_f32_16x16x32_bf16 v[84:87], a[116:119], v[192:195], v[84:87]
    v_exp_f32 v209, v1
    v_exp_f32 v210, v2
    v_mfma_f32_16x16x32_bf16 v[88:91], a[120:123], v[192:195], v[88:91]
    v_add_u32 v234, s85, v245
    v_exp_f32 v211, v3
    v_exp_f32 v212, v4
    v_mfma_f32_16x16x32_bf16 v[92:95], a[124:127], v[192:195], v[92:95]
    v_exp_f32 v213, v5
    v_exp_f32 v214, v6
    v_mfma_f32_16x16x32_bf16 a[128:131], a[144:147], v[192:195], a[128:131]
    v_exp_f32 v215, v7
    s_bitcmp1_b64 s[80:81], s82
    s_cbranch_scc0 L_body1
L_ev1:
    s_bitcmp1_b64 s[62:63], s82
    s_cbranch_scc1 L_sp_62
    s_waitcnt vmcnt(8) lgkmcnt(0)
    s_barrier
    s_branch L_body1
L_sp_62:
    s_and_b32 s56, s82, 3
    s_cbranch_scc1 L_nb_58
    s_waitcnt vmcnt(8) lgkmcnt(0)
    s_barrier
    s_cmp_eq_u32 s82, 8
    s_cbranch_scc0 L_nh_60
    s_and_b32 s73, s55, 0xfc
    s_add_u32 s73, s73, s52
    s_lshl_b32 s74, s73, 12
    s_lshl_b32 s73, s55, 2
    s_add_u32 s73, s73, s52
    v_and_b32 v238, 31, v255
    v_lshlrev_b32 v238, 7, v238
    v_add_u32 v238, s74, v238
    s_mul_i32 s74, s73, 1408
    v_min_u32 v239, 10, v255
    v_lshlrev_b32 v239, 7, v239
    v_add_u32 v239, s74, v239
    buffer_load_dword a200, v238, s[24:27], 0 offen
    buffer_load_dword a200, v239, s[36:39], 0 offen
    s_bfe_u32 s73, s55, 0x10002
    s_lshl_b32 s73, s73, 3
    s_bfe_u32 s74, s55, 0x30003
    s_add_u32 s74, s73, s74
    s_sub_u32 s75, 15, s74
    s_min_u32 s74, s74, s75
    s_lshl_b32 s100, s74, 7
    s_add_u32 s100, s100, 58725376
    s_mov_b32 s99, 58725376
    s_sub_u32 s73, s100, s99
    v_add_u32 v238, s73, v250
    s_bfe_u32 s73, s55, 0x10002
    s_lshl_b32 s73, s73, 4
    s_and_b32 s74, s53, 3
    s_add_u32 s73, s73, s74
    s_lshl_b32 s74, s54, 5
    s_add_u32 s73, s73, s74
    s_lshl_b32 s73, s73, 2
    v_and_b32 v239, 3, v255
    v_lshlrev_b32 v239, 4, v239
    v_cmp_gt_u32 vcc, 32, v255
    v_add_u32 v239, s73, v239
    s_nop 0
    v_cndmask_b32 v242, v239, v238, vcc
    buffer_load_dword v241, v242, s[48:51], s99 offen sc1
L_nh_60:
    s_cmp_eq_u32 s82, 12
    s_cbranch_scc0 L_nh2_61
    v_cmp_ne_u32 vcc, 1, v241
    s_nop 0
    s_cbranch_vccnz L_spin_63
L_back_64:
L_nh2_61:
L_nb_58:
    s_cmp_eq_u32 s82, s90
    s_cbranch_scc0 L_nm_59
    v_mov_b32 v238, 0xff800000
    v_cmp_gt_i32 s[76:77], 16, v236
    v_cmp_gt_i32 s[78:79], 17, v236
    s_nop 0
    v_cndmask_b32 v36, v32, v238, s[76:77]
    v_cndmask_b32 v37, v32, v238, s[78:79]
    v_cmp_gt_i32 s[76:77], 18, v236
    v_cmp_gt_i32 s[78:79], 19, v236
    s_nop 0
    v_cndmask_b32 v38, v32, v238, s[76:77]
    v_cndmask_b32 v39, v32, v238, s[78:79]
    v_cmp_gt_i32 s[76:77], 3, v236
    v_cmp_gt_i32 s[78:79], 2, v236
    s_nop 0
    v_cndmask_b32 v35, v32, v238, s[76:77]
    v_cndmask_b32 v34, v32, v238, s[78:79]
    v_cmp_gt_i32 s[76:77], 1, v236
    v_cmp_gt_i32 s[78:79], 0, v236
    s_nop 0
    v_cndmask_b32 v33, v32, v238, s[76:77]
    v_cndmask_b32 v32, v32, v238, s[78:79]
L_nm_59:
    s_cmp_eq_u32 s82, s86
    s_cbranch_scc0 L_body1
    ds_read_b128 a[96:99], v234 offset:0
    ds_read_b128 a[100:103], v234 offset:1024
    ds_read_b128 a[104:107], v234 offset:2048
    ds_read_b128 a[108:111], v234 offset:3072
    ds_read_b128 a[112:115], v234 offset:4096
    ds_read_b128 a[116:119], v234 offset:5120
    ds_read_b128 a[120:123], v234 offset:6144
    ds_read_b128 a[124:127], v234 offset:7168
    v_cvt_pk_bf16_f32 v192, v208, v209
    v_cvt_pk_bf16_f32 v193, v210, v211
    v_cvt_pk_bf16_f32 v194, v212, v213
    v_cvt_pk_bf16_f32 v195, v214, v215
    v_or3_b32 v232, v192, v193, v194
    v_bitop3_b32 v232, v232, v195, s61 bitop3:0xa8
    v_cmp_ne_u32 vcc, 0, v232
    s_nop 0
    s_cbranch_vccnz L_fix_65
L_fixb_66:
    s_waitcnt lgkmcnt(4)
    v_mfma_f32_16x16x32_bf16 v[64:67], a[96:99], v[192:195], v[64:67]
    v_mfma_f32_16x16x32_bf16 v[68:71], a[100:103], v[192:195], v[68:71]
    v_mfma_f32_16x16x32_bf16 v[72:75], a[104:107], v[192:195], v[72:75]
    v_mfma_f32_16x16x32_bf16 v[76:79], a[108:111], v[192:195], v[76:79]
    s_waitcnt lgkmcnt(0)
    s_add_u32 s82, s82, 1
    v_mfma_f32_16x16x32_bf16 v[80:83], a[112:115], v[192:195], v[80:83]
    v_mfma_f32_16x16x32_bf16 v[84:87], a[116:119], v[192:195], v[84:87]
    v_mfma_f32_16x16x32_bf16 v[88:91], a[120:123], v[192:195], v[88:91]
    v_mfma_f32_16x16x32_bf16 v[92:95], a[124:127], v[192:195], v[92:95]
    v_mfma_f32_16x16x32_bf16 a[128:131], a[144:147], v[192:195], a[128:131]
    s_nop 7
    v_accvgpr_read_b32 v238, a128
    v_rcp_f32 v238, v238
    s_nop 0
    v_pk_mul_f32 v[64:65], v[64:65], v[238:239] op_sel_hi:[1,0]
    v_pk_mul_f32 v[66:67], v[66:67], v[238:239] op_sel_hi:[1,0]
    v_pk_mul_f32 v[68:69], v[68:69], v[238:239] op_sel_hi:[1,0]
    v_pk_mul_f32 v[70:71], v[70:71], v[238:239] op_sel_hi:[1,0]
    v_cvt_pk_bf16_f32 v216, v64, v65
    v_cvt_pk_bf16_f32 v217, v66, v67
    v_cvt_pk_bf16_f32 v218, v68, v69
    v_cvt_pk_bf16_f32 v219, v70, v71
    buffer_store_dwordx4 v[216:219], v245, s[48:51], s69 offen sc1
    v_pk_mul_f32 v[72:73], v[72:73], v[238:239] op_sel_hi:[1,0]
    v_pk_mul_f32 v[74:75], v[74:75], v[238:239] op_sel_hi:[1,0]
    v_pk_mul_f32 v[76:77], v[76:77], v[238:239] op_sel_hi:[1,0]
    v_pk_mul_f32 v[78:79], v[78:79], v[238:239] op_sel_hi:[1,0]
    v_cvt_pk_bf16_f32 v220, v72, v73
    v_cvt_pk_bf16_f32 v221, v74, v75
    v_cvt_pk_bf16_f32 v222, v76, v77
    v_cvt_pk_bf16_f32 v223, v78, v79
    buffer_store_dwordx4 v[220:223], v246, s[48:51], s69 offen sc1
    v_pk_mul_f32 v[80:81], v[80:81], v[238:239] op_sel_hi:[1,0]
    v_pk_mul_f32 v[82:83], v[82:83], v[238:239] op_sel_hi:[1,0]
    v_pk_mul_f32 v[84:85], v[84:85], v[238:239] op_sel_hi:[1,0]
    v_pk_mul_f32 v[86:87], v[86:87], v[238:239] op_sel_hi:[1,0]
    v_cvt_pk_bf16_f32 v224, v80, v81
    v_cvt_pk_bf16_f32 v225, v82, v83
    v_cvt_pk_bf16_f32 v226, v84, v85
    v_cvt_pk_bf16_f32 v227, v86, v87
    buffer_store_dwordx4 v[224:227], v247, s[48:51], s69 offen sc1
    v_pk_mul_f32 v[88:89], v[88:89], v[238:239] op_sel_hi:[1,0]
    v_pk_mul_f32 v[90:91], v[90:91], v[238:239] op_sel_hi:[1,0]
    v_pk_mul_f32 v[92:93], v[92:93], v[238:239] op_sel_hi:[1,0]
    v_pk_mul_f32 v[94:95], v[94:95], v[238:239] op_sel_hi:[1,0]
    v_cvt_pk_bf16_f32 v228, v88, v89
    v_cvt_pk_bf16_f32 v229, v90, v91
    v_cvt_pk_bf16_f32 v230, v92, v93
    v_cvt_pk_bf16_f32 v231, v94, v95
    buffer_store_dwordx4 v[228:231], v248, s[48:51], s69 offen sc1
L_p4:
    s_waitcnt lgkmcnt(0)
    s_barrier
    s_add_u32 m0, s57, 0
    s_nop 0
    buffer_load_dwordx4 v243, s[36:39], s95 offen offset:0 sc1 lds
    buffer_load_dwordx4 v244, s[36:39], s95 offen offset:1024 sc1 lds
    s_add_u32 s95, s95, 32768
    s_add_u32 m0, s57, 8192
    s_nop 0
    buffer_load_dwordx4 v243, s[36:39], s95 offen offset:0 sc1 lds
    buffer_load_dwordx4 v244, s[36:39], s95 offen offset:1024 sc1 lds
    s_add_u32 s95, s95, 32768
    s_add_u32 m0, s57, 16384
    s_nop 0
    buffer_load_dwordx4 v243, s[36:39], s95 offen offset:0 sc1 lds
    buffer_load_dwordx4 v244, s[36:39], s95 offen offset:1024 sc1 lds
    s_add_u32 s95, s95, 32768
    s_add_u32 m0, s57, 24576
    s_nop 0
    buffer_load_dwordx4 v243, s[36:39], s95 offen offset:0 sc1 lds
    buffer_load_dwordx4 v244, s[36:39], s95 offen offset:1024 sc1 lds
    s_add_u32 s95, s95, 32768
    s_sub_u32 s100, s100, 58725376
    s_lshl_b32 s73, s58, 5
    s_add_u32 s100, s100, s73
    s_lshl_b32 s100, s100, 2
    s_add_u32 s100, s100, 58727424
    v_lshrrev_b32 v192, 4, v255
    v_and_b32 v193, 15, v255
    v_lshrrev_b32 v194, 2, v193
    v_lshl_add_u32 v194, v192, 2, v194
    v_and_b32 v195, 3, v193
    v_lshlrev_b32 v195, 3, v195
    v_lshl_add_u32 v195, v194, 8, v195
    v_and_b32 v194, 7, v194
    v_lshl_add_u32 v195, v194, 5, v195
    s_and_b32 s73, s58, 2
    s_lshl_b32 s73, s73, 1
    s_add_u32 s73, s73, 0
    s_and_b32 s73, s73, 7
    s_lshl_b32 s73, s73, 5
    v_xor_b32 v224, s73, v195
    s_and_b32 s73, s58, 2
    s_lshl_b32 s73, s73, 1
    s_add_u32 s73, s73, 1
    s_and_b32 s73, s73, 7
    s_lshl_b32 s73, s73, 5
    v_xor_b32 v225, s73, v195
    s_and_b32 s73, s58, 2
    s_lshl_b32 s73, s73, 1
    s_add_u32 s73, s73, 2
    s_and_b32 s73, s73, 7
    s_lshl_b32 s73, s73, 5
    v_xor_b32 v226, s73, v195
    s_and_b32 s73, s58, 2
    s_lshl_b32 s73, s73, 1
    s_add_u32 s73, s73, 3
    s_and_b32 s73, s73, 7
    s_lshl_b32 s73, s73, 5
    v_xor_b32 v227, s73, v195
    s_and_b32 s73, s58, 2
    s_lshl_b32 s73, s73, 1
    s_add_u32 s73, s73, 4
    s_and_b32 s73, s73, 7
    s_lshl_b32 s73, s73, 5
    v_xor_b32 v228, s73, v195
    s_and_b32 s73, s58, 2
    s_lshl_b32 s73, s73, 1
    s_add_u32 s73, s73, 5
    s_and_b32 s73, s73, 7
    s_lshl_b32 s73, s73, 5
    v_xor_b32 v229, s73, v195
    s_and_b32 s73, s58, 2
    s_lshl_b32 s73, s73, 1
    s_add_u32 s73, s73, 6
    s_and_b32 s73, s73, 7
    s_lshl_b32 s73, s73, 5
    v_xor_b32 v230, s73, v195
    s_and_b32 s73, s58, 2
    s_lshl_b32 s73, s73, 1
    s_add_u32 s73, s73, 7
    s_and_b32 s73, s73, 7
    s_lshl_b32 s73, s73, 5
    v_xor_b32 v231, s73, v195
    s_mov_b32 s93, 16384
    s_lshl_b32 s73, s60, 1
    s_add_u32 s73, s73, s59
    s_and_b32 s84, s73, 0
    s_mul_i32 s73, s64, 98304
    s_lshl_b32 s74, s52, 11
    s_add_u32 s73, s73, s74
    s_add_u32 s90, s73, 67108864
    s_mul_i32 s74, s58, 24576
    s_add_u32 s91, s90, s74
    s_lshl_b32 s92, s64, 2
    s_add_u32 s92, s92, s52
    s_lshl_b32 s92, s92, 4
    s_add_u32 s92, s92, 58727424
    v_mov_b32 v194, 2147483392
    v_cmp_eq_u32 vcc, 0, v255
    s_lshl_b32 s73, s58, 2
    v_mov_b32 v195, s73
    v_cndmask_b32 v235, v194, v195, vcc
    s_sub_u32 s73, s97, 58726400
    s_lshl_b32 s73, s73, 2
    s_lshl_b32 s74, s52, 2
    s_add_u32 s73, s73, s74
    s_add_u32 s73, s73, 58727424
    v_cndmask_b32 v235, v194, v253, vcc
    s_waitcnt vmcnt(8)
    buffer_store_dword v254, v235, s[48:51], s73 offen sc1
    s_waitcnt vmcnt(1)
    s_barrier
    s_add_u32 m0, s57, 32768
    s_nop 0
    buffer_load_dwordx4 v243, s[36:39], s95 offen offset:0 sc1 lds
    buffer_load_dwordx4 v244, s[36:39], s95 offen offset:1024 sc1 lds
    s_add_u32 s95, s95, 32768
    s_add_u32 m0, s57, 40960
    s_nop 0
    buffer_load_dwordx4 v243, s[36:39], s95 offen offset:0 sc1 lds
    buffer_load_dwordx4 v244, s[36:39], s95 offen offset:1024 sc1 lds
    s_add_u32 s95, s95, 32768
    s_add_u32 m0, s57, 49152
    s_nop 0
    buffer_load_dwordx4 v243, s[36:39], s95 offen offset:0 sc1 lds
    buffer_load_dwordx4 v244, s[36:39], s95 offen offset:1024 sc1 lds
    s_add_u32 s95, s95, 32768
    s_add_u32 m0, s57, 57344
    s_nop 0
    buffer_load_dwordx4 v243, s[36:39], s95 offen offset:0 sc1 lds
    buffer_load_dwordx4 v244, s[36:39], s95 offen offset:1024 sc1 lds
    s_add_u32 s95, s95, 32768
    ds_read_b64_tr_b16 v[192:193], v224 offset:0
    ds_read_b64_tr_b16 v[194:195], v224 offset:4096
    ds_read_b64_tr_b16 a[0:1], v224 offset:8192
    ds_read_b64_tr_b16 a[2:3], v224 offset:12288
    ds_read_b64_tr_b16 v[196:197], v225 offset:0
    ds_read_b64_tr_b16 v[198:199], v225 offset:4096
    ds_read_b64_tr_b16 a[4:5], v225 offset:8192
    ds_read_b64_tr_b16 a[6:7], v225 offset:12288
    ds_read_b64_tr_b16 v[200:201], v226 offset:0
    ds_read_b64_tr_b16 v[202:203], v226 offset:4096
    ds_read_b64_tr_b16 a[8:9], v226 offset:8192
    ds_read_b64_tr_b16 a[10:11], v226 offset:12288
    ds_read_b64_tr_b16 v[204:205], v227 offset:0
    ds_read_b64_tr_b16 v[206:207], v227 offset:4096
    ds_read_b64_tr_b16 a[12:13], v227 offset:8192
    ds_read_b64_tr_b16 a[14:15], v227 offset:12288
    ds_read_b64_tr_b16 v[208:209], v228 offset:0
    ds_read_b64_tr_b16 v[210:211], v228 offset:4096
    ds_read_b64_tr_b16 a[16:17], v228 offset:8192
    ds_read_b64_tr_b16 a[18:19], v228 offset:12288
    ds_read_b64_tr_b16 v[212:213], v229 offset:0
    ds_read_b64_tr_b16 v[214:215], v229 offset:4096
    ds_read_b64_tr_b16 a[20:21], v229 offset:8192
    ds_read_b64_tr_b16 a[22:23], v229 offset:12288
    ds_read_b64_tr_b16 v[216:217], v230 offset:0
    ds_read_b64_tr_b16 v[218:219], v230 offset:4096
    ds_read_b64_tr_b16 a[24:25], v230 offset:8192
    ds_read_b64_tr_b16 a[26:27], v230 offset:12288
    ds_read_b64_tr_b16 v[220:221], v231 offset:0
    ds_read_b64_tr_b16 v[222:223], v231 offset:4096
    ds_read_b64_tr_b16 a[28:29], v231 offset:8192
    ds_read_b64_tr_b16 a[30:31], v231 offset:12288
    s_add_u32 m0, s57, 65536
    s_waitcnt lgkmcnt(15)
    v_mfma_f32_16x16x32_bf16 v[0:3], v[192:195], v[128:131], 0
    buffer_load_dwordx4 v243, s[36:39], s95 offen offset:0 sc1 lds
    v_mfma_f32_16x16x32_bf16 v[0:3], a[0:3], v[136:139], v[0:3]
    v_mfma_f32_16x16x32_bf16 v[4:7], v[192:195], v[132:135], 0
    buffer_load_dwordx4 v[160:163], v241, s[8:11], s94 offen offset:0 sc1
    v_mfma_f32_16x16x32_bf16 v[4:7], a[0:3], v[140:143], v[4:7]
    ds_read_b64_tr_b16 v[192:193], v224 offset:16384
    ds_read_b64_tr_b16 v[194:195], v224 offset:20480
    v_mfma_f32_16x16x32_bf16 v[8:11], v[196:199], v[128:131], 0
    buffer_load_dwordx4 v244, s[36:39], s95 offen offset:1024 sc1 lds
    v_mfma_f32_16x16x32_bf16 v[8:11], a[4:7], v[136:139], v[8:11]
    s_add_u32 s95, s95, 32768
    s_add_u32 m0, s57, 73728
    ds_read_b64_tr_b16 a[0:1], v224 offset:24576
    v_mfma_f32_16x16x32_bf16 v[12:15], v[196:199], v[132:135], 0
    buffer_load_dwordx4 v[164:167], v242, s[8:11], s94 offen offset:0 sc1
    v_mfma_f32_16x16x32_bf16 v[12:15], a[4:7], v[140:143], v[12:15]
    ds_read_b64_tr_b16 a[2:3], v224 offset:28672
    ds_read_b64_tr_b16 v[196:197], v225 offset:16384
    v_mfma_f32_16x16x32_bf16 v[16:19], v[200:203], v[128:131], 0
    buffer_load_dwordx4 v243, s[36:39], s95 offen offset:0 sc1 lds
    v_mfma_f32_16x16x32_bf16 v[16:19], a[8:11], v[136:139], v[16:19]
    ds_read_b64_tr_b16 v[198:199], v225 offset:20480
    v_mfma_f32_16x16x32_bf16 v[20:23], v[200:203], v[132:135], 0
    s_add_u32 s94, s94, 4096
    ds_read_b64_tr_b16 a[4:5], v225 offset:24576
    ds_read_b64_tr_b16 a[6:7], v225 offset:28672
    v_mfma_f32_16x16x32_bf16 v[20:23], a[8:11], v[140:143], v[20:23]
    ds_read_b64_tr_b16 v[200:201], v226 offset:16384
    ds_read_b64_tr_b16 v[202:203], v226 offset:20480
    v_mfma_f32_16x16x32_bf16 v[24:27], v[204:207], v[128:131], 0
    buffer_load_dwordx4 v244, s[36:39], s95 offen offset:1024 sc1 lds
    v_mfma_f32_16x16x32_bf16 v[24:27], a[12:15], v[136:139], v[24:27]
    buffer_load_dwordx4 v[168:171], v241, s[8:11], s94 offen offset:0 sc1
    v_mfma_f32_16x16x32_bf16 v[28:31], v[204:207], v[132:135], 0
    s_add_u32 s95, s95, 32768
    ds_read_b64_tr_b16 a[8:9], v226 offset:24576
    ds_read_b64_tr_b16 a[10:11], v226 offset:28672
    v_mfma_f32_16x16x32_bf16 v[28:31], a[12:15], v[140:143], v[28:31]
    s_waitcnt lgkmcnt(12)
    ds_read_b64_tr_b16 v[204:205], v227 offset:16384
    ds_read_b64_tr_b16 v[206:207], v227 offset:20480
    v_mfma_f32_16x16x32_bf16 v[32:35], v[208:211], v[128:131], 0
    v_mfma_f32_16x16x32_bf16 v[32:35], a[16:19], v[136:139], v[32:35]
    buffer_load_dwordx4 v[172:175], v242, s[8:11], s94 offen offset:0 sc1
    v_mfma_f32_16x16x32_bf16 v[36:39], v[208:211], v[132:135], 0
    ds_read_b64_tr_b16 a[12:13], v227 offset:24576
    ds_read_b64_tr_b16 a[14:15], v227 offset:28672
    v_mfma_f32_16x16x32_bf16 v[36:39], a[16:19], v[140:143], v[36:39]
    ds_read_b64_tr_b16 v[208:209], v228 offset:16384
    ds_read_b64_tr_b16 v[210:211], v228 offset:20480
    v_mfma_f32_16x16x32_bf16 v[40:43], v[212:215], v[128:131], 0
    ds_read_b64_tr_b16 a[16:17], v228 offset:24576
    v_mfma_f32_16x16x32_bf16 v[40:43], a[20:23], v[136:139], v[40:43]
    s_add_u32 s94, s94, 4096
    v_mfma_f32_16x16x32_bf16 v[44:47], v[212:215], v[132:135], 0
    ds_read_b64_tr_b16 a[18:19], v228 offset:28672
    v_mfma_f32_16x16x32_bf16 v[44:47], a[20:23], v[140:143], v[44:47]
    ds_read_b64_tr_b16 v[212:213], v229 offset:16384
    ds_read_b64_tr_b16 v[214:215], v229 offset:20480
    v_mfma_f32_16x16x32_bf16 v[48:51], v[216:219], v[128:131], 0
    ds_read_b64_tr_b16 a[20:21], v229 offset:24576
    v_mfma_f32_16x16x32_bf16 v[48:51], a[24:27], v[136:139], v[48:51]
    ds_read_b64_tr_b16 a[22:23], v229 offset:28672
    v_mfma_f32_16x16x32_bf16 v[52:55], v[216:219], v[132:135], 0
    v_mfma_f32_16x16x32_bf16 v[52:55], a[24:27], v[140:143], v[52:55]
    ds_read_b64_tr_b16 v[216:217], v230 offset:16384
    ds_read_b64_tr_b16 v[218:219], v230 offset:20480
    v_mfma_f32_16x16x32_bf16 v[56:59], v[220:223], v[128:131], 0
    ds_read_b64_tr_b16 a[24:25], v230 offset:24576
    v_mfma_f32_16x16x32_bf16 v[56:59], a[28:31], v[136:139], v[56:59]
    ds_read_b64_tr_b16 a[26:27], v230 offset:28672
    v_mfma_f32_16x16x32_bf16 v[60:63], v[220:223], v[132:135], 0
    v_mfma_f32_16x16x32_bf16 v[60:63], a[28:31], v[140:143], v[60:63]
    s_waitcnt lgkmcnt(12)
    ds_read_b64_tr_b16 v[220:221], v231 offset:16384
    ds_read_b64_tr_b16 v[222:223], v231 offset:20480
    ds_read_b64_tr_b16 a[28:29], v231 offset:24576
    ds_read_b64_tr_b16 a[30:31], v231 offset:28672
    v_mfma_f32_16x16x32_bf16 v[0:3], v[192:195], v[144:147], v[0:3]
    buffer_load_dwordx4 v[176:179], v241, s[8:11], s94 offen offset:0 sc1
    v_mfma_f32_16x16x32_bf16 v[0:3], a[0:3], v[152:155], v[0:3]
    buffer_load_dwordx4 v[180:183], v242, s[8:11], s94 offen offset:0 sc1
    v_mfma_f32_16x16x32_bf16 v[4:7], v[192:195], v[148:151], v[4:7]
    v_mfma_f32_16x16x32_bf16 v[4:7], a[0:3], v[156:159], v[4:7]
    s_waitcnt vmcnt(10) lgkmcnt(0)
    s_barrier
    s_add_u32 s94, s94, 4096
    v_mfma_f32_16x16x32_bf16 v[8:11], v[196:199], v[144:147], v[8:11]
    s_add_u32 m0, s57, 81920
    ds_read_b64_tr_b16 v[192:193], v224 offset:32768
    ds_read_b64_tr_b16 v[194:195], v224 offset:36864
    v_mfma_f32_16x16x32_bf16 v[8:11], a[4:7], v[152:155], v[8:11]
    buffer_load_dwordx4 v243, s[36:39], s95 offen offset:0 sc1 lds
    v_mfma_f32_16x16x32_bf16 v[12:15], v[196:199], v[148:151], v[12:15]
    buffer_load_dwordx4 v[184:187], v241, s[8:11], s94 offen offset:0 sc1
    v_mfma_f32_16x16x32_bf16 v[12:15], a[4:7], v[156:159], v[12:15]
    ds_read_b64_tr_b16 a[0:1], v224 offset:40960
    ds_read_b64_tr_b16 a[2:3], v224 offset:45056
    v_mfma_f32_16x16x32_bf16 v[16:19], v[200:203], v[144:147], v[16:19]
    ds_read_b64_tr_b16 v[196:197], v225 offset:32768
    ds_read_b64_tr_b16 v[198:199], v225 offset:36864
    v_mfma_f32_16x16x32_bf16 v[16:19], a[8:11], v[152:155], v[16:19]
    buffer_load_dwordx4 v244, s[36:39], s95 offen offset:1024 sc1 lds
    v_mfma_f32_16x16x32_bf16 v[20:23], v[200:203], v[148:151], v[20:23]
    s_add_u32 s95, s95, 32768
    s_lshl_b32 s95, s84, 17
    s_add_u32 m0, s57, 90112
    ds_read_b64_tr_b16 a[4:5], v225 offset:40960
    v_mfma_f32_16x16x32_bf16 v[20:23], a[8:11], v[156:159], v[20:23]
    ds_read_b64_tr_b16 a[6:7], v225 offset:45056
    buffer_load_dwordx4 v[188:191], v242, s[8:11], s94 offen offset:0 sc1
    v_mfma_f32_16x16x32_bf16 v[24:27], v[204:207], v[144:147], v[24:27]
    s_add_u32 s94, s94, 4096
    ds_read_b64_tr_b16 v[200:201], v226 offset:32768
    ds_read_b64_tr_b16 v[202:203], v226 offset:36864
    v_mfma_f32_16x16x32_bf16 v[24:27], a[12:15], v[152:155], v[24:27]
    buffer_load_dwordx4 v243, s[24:27], s95 offen offset:0 sc1 lds
    v_mfma_f32_16x16x32_bf16 v[28:31], v[204:207], v[148:151], v[28:31]
    ds_read_b64_tr_b16 a[8:9], v226 offset:40960
    ds_read_b64_tr_b16 a[10:11], v226 offset:45056
    v_mfma_f32_16x16x32_bf16 v[28:31], a[12:15], v[156:159], v[28:31]
    ds_read_b64_tr_b16 v[204:205], v227 offset:32768
    ds_read_b64_tr_b16 v[206:207], v227 offset:36864
    v_mfma_f32_16x16x32_bf16 v[32:35], v[208:211], v[144:147], v[32:35]
    ds_read_b64_tr_b16 a[12:13], v227 offset:40960
    ds_read_b64_tr_b16 a[14:15], v227 offset:45056
    v_mfma_f32_16x16x32_bf16 v[32:35], a[16:19], v[152:155], v[32:35]
    buffer_load_dwordx4 v244, s[24:27], s95 offen offset:1024 sc1 lds
    v_mfma_f32_16x16x32_bf16 v[36:39], v[208:211], v[148:151], v[36:39]
    s_add_u32 s95, s95, 32768
    v_mfma_f32_16x16x32_bf16 v[36:39], a[16:19], v[156:159], v[36:39]
    ds_read_b64_tr_b16 v[208:209], v228 offset:32768
    ds_read_b64_tr_b16 v[210:211], v228 offset:36864
    v_mfma_f32_16x16x32_bf16 v[40:43], v[212:215], v[144:147], v[40:43]
    v_mfma_f32_16x16x32_bf16 v[40:43], a[20:23], v[152:155], v[40:43]
    ds_read_b64_tr_b16 a[16:17], v228 offset:40960
    v_mfma_f32_16x16x32_bf16 v[44:47], v[212:215], v[148:151], v[44:47]
    ds_read_b64_tr_b16 a[18:19], v228 offset:45056
    v_mfma_f32_16x16x32_bf16 v[44:47], a[20:23], v[156:159], v[44:47]
    ds_read_b64_tr_b16 v[212:213], v229 offset:32768
    ds_read_b64_tr_b16 v[214:215], v229 offset:36864
    v_mfma_f32_16x16x32_bf16 v[48:51], v[216:219], v[144:147], v[48:51]
    v_mfma_f32_16x16x32_bf16 v[48:51], a[24:27], v[152:155], v[48:51]
    ds_read_b64_tr_b16 a[20:21], v229 offset:40960
    ds_read_b64_tr_b16 a[22:23], v229 offset:45056
    v_mfma_f32_16x16x32_bf16 v[52:55], v[216:219], v[148:151], v[52:55]
    v_mfma_f32_16x16x32_bf16 v[52:55], a[24:27], v[156:159], v[52:55]
    ds_read_b64_tr_b16 v[216:217], v230 offset:32768
    ds_read_b64_tr_b16 v[218:219], v230 offset:36864
    v_mfma_f32_16x16x32_bf16 v[56:59], v[220:223], v[144:147], v[56:59]
    ds_read_b64_tr_b16 a[24:25], v230 offset:40960
    ds_read_b64_tr_b16 a[26:27], v230 offset:45056
    v_mfma_f32_16x16x32_bf16 v[56:59], a[28:31], v[152:155], v[56:59]
    v_mfma_f32_16x16x32_bf16 v[60:63], v[220:223], v[148:151], v[60:63]
    v_mfma_f32_16x16x32_bf16 v[60:63], a[28:31], v[156:159], v[60:63]
    s_waitcnt vmcnt(12) lgkmcnt(12)
    s_add_u32 m0, s57, 98304
    ds_read_b64_tr_b16 v[220:221], v231 offset:32768
    ds_read_b64_tr_b16 v[222:223], v231 offset:36864
    ds_read_b64_tr_b16 a[28:29], v231 offset:40960
    ds_read_b64_tr_b16 a[30:31], v231 offset:45056
    v_mfma_f32_16x16x32_bf16 v[0:3], v[192:195], v[160:163], v[0:3]
    s_waitcnt vmcnt(8)
    buffer_load_dwordx4 v243, s[24:27], s95 offen offset:0 sc1 lds
    v_mfma_f32_16x16x32_bf16 v[0:3], a[0:3], v[168:171], v[0:3]
    buffer_load_dwordx4 v[64:67], v241, s[8:11], s94 offen offset:0 sc1
    v_mfma_f32_16x16x32_bf16 v[4:7], v[192:195], v[164:167], v[4:7]
    v_mfma_f32_16x16x32_bf16 v[4:7], a[0:3], v[172:175], v[4:7]
    ds_read_b64_tr_b16 v[192:193], v224 offset:49152
    ds_read_b64_tr_b16 v[194:195], v224 offset:53248
    v_mfma_f32_16x16x32_bf16 v[8:11], v[196:199], v[160:163], v[8:11]
    buffer_load_dwordx4 v244, s[24:27], s95 offen offset:1024 sc1 lds
    v_mfma_f32_16x16x32_bf16 v[8:11], a[4:7], v[168:171], v[8:11]
    s_add_u32 s95, s95, 32768
    s_add_u32 m0, s57, 106496
    ds_read_b64_tr_b16 a[0:1], v224 offset:57344
    v_mfma_f32_16x16x32_bf16 v[12:15], v[196:199], v[164:167], v[12:15]
    buffer_load_dwordx4 v[68:71], v242, s[8:11], s94 offen offset:0 sc1
    v_mfma_f32_16x16x32_bf16 v[12:15], a[4:7], v[172:175], v[12:15]
    ds_read_b64_tr_b16 a[2:3], v224 offset:61440
    ds_read_b64_tr_b16 v[196:197], v225 offset:49152
    v_mfma_f32_16x16x32_bf16 v[16:19], v[200:203], v[160:163], v[16:19]
    buffer_load_dwordx4 v243, s[24:27], s95 offen offset:0 sc1 lds
    v_mfma_f32_16x16x32_bf16 v[16:19], a[8:11], v[168:171], v[16:19]
    s_add_u32 s94, s94, 4096
    ds_read_b64_tr_b16 v[198:199], v225 offset:53248
    v_mfma_f32_16x16x32_bf16 v[20:23], v[200:203], v[164:167], v[20:23]
    ds_read_b64_tr_b16 a[4:5], v225 offset:57344
    ds_read_b64_tr_b16 a[6:7], v225 offset:61440
    v_mfma_f32_16x16x32_bf16 v[20:23], a[8:11], v[172:175], v[20:23]
    ds_read_b64_tr_b16 v[200:201], v226 offset:49152
    ds_read_b64_tr_b16 v[202:203], v226 offset:53248
    v_mfma_f32_16x16x32_bf16 v[24:27], v[204:207], v[160:163], v[24:27]
    buffer_load_dwordx4 v244, s[24:27], s95 offen offset:1024 sc1 lds
    v_mfma_f32_16x16x32_bf16 v[24:27], a[12:15], v[168:171], v[24:27]
    s_add_u32 s95, s95, 32768
    v_mfma_f32_16x16x32_bf16 v[28:31], v[204:207], v[164:167], v[28:31]
    ds_read_b64_tr_b16 a[8:9], v226 offset:57344
    ds_read_b64_tr_b16 a[10:11], v226 offset:61440
    v_mfma_f32_16x16x32_bf16 v[28:31], a[12:15], v[172:175], v[28:31]
    s_waitcnt lgkmcnt(12)
    ds_read_b64_tr_b16 v[204:205], v227 offset:49152
    ds_read_b64_tr_b16 v[206:207], v227 offset:53248
    v_mfma_f32_16x16x32_bf16 v[32:35], v[208:211], v[160:163], v[32:35]
    buffer_load_dwordx4 v[72:75], v241, s[8:11], s94 offen offset:0 sc1
    v_mfma_f32_16x16x32_bf16 v[32:35], a[16:19], v[168:171], v[32:35]
    ds_read_b64_tr_b16 a[12:13], v227 offset:57344
    ds_read_b64_tr_b16 a[14:15], v227 offset:61440
    v_mfma_f32_16x16x32_bf16 v[36:39], v[208:211], v[164:167], v[36:39]
    v_mfma_f32_16x16x32_bf16 v[36:39], a[16:19], v[172:175], v[36:39]
    ds_read_b64_tr_b16 v[208:209], v228 offset:49152
    buffer_load_dword v234, v250, s[48:51], s100 offen sc1
    v_mfma_f32_16x16x32_bf16 v[40:43], v[212:215], v[160:163], v[40:43]
    ds_read_b64_tr_b16 v[210:211], v228 offset:53248
    ds_read_b64_tr_b16 a[16:17], v228 offset:57344
    v_mfma_f32_16x16x32_bf16 v[40:43], a[20:23], v[168:171], v[40:43]
    v_mfma_f32_16x16x32_bf16 v[44:47], v[212:215], v[164:167], v[44:47]
    ds_read_b64_tr_b16 a[18:19], v228 offset:61440
    v_mfma_f32_16x16x32_bf16 v[44:47], a[20:23], v[172:175], v[44:47]
    ds_read_b64_tr_b16 v[212:213], v229 offset:49152
    ds_read_b64_tr_b16 v[214:215], v229 offset:53248
    v_mfma_f32_16x16x32_bf16 v[48:51], v[216:219], v[160:163], v[48:51]
    ds_read_b64_tr_b16 a[20:21], v229 offset:57344
    ds_read_b64_tr_b16 a[22:23], v229 offset:61440
    v_mfma_f32_16x16x32_bf16 v[48:51], a[24:27], v[168:171], v[48:51]
    buffer_load_dwordx4 v[76:79], v242, s[8:11], s94 offen offset:0 sc1
    v_mfma_f32_16x16x32_bf16 v[52:55], v[216:219], v[164:167], v[52:55]
    s_add_u32 s94, s94, 4096
    v_mfma_f32_16x16x32_bf16 v[52:55], a[24:27], v[172:175], v[52:55]
    ds_read_b64_tr_b16 v[216:217], v230 offset:49152
    ds_read_b64_tr_b16 v[218:219], v230 offset:53248
    v_mfma_f32_16x16x32_bf16 v[56:59], v[220:223], v[160:163], v[56:59]
    ds_read_b64_tr_b16 a[24:25], v230 offset:57344
    v_mfma_f32_16x16x32_bf16 v[56:59], a[28:31], v[168:171], v[56:59]
    v_mfma_f32_16x16x32_bf16 v[60:63], v[220:223], v[164:167], v[60:63]
    ds_read_b64_tr_b16 a[26:27], v230 offset:61440
    v_mfma_f32_16x16x32_bf16 v[60:63], a[28:31], v[172:175], v[60:63]
    s_waitcnt vmcnt(15) lgkmcnt(12)
    ds_read_b64_tr_b16 v[220:221], v231 offset:49152
    ds_read_b64_tr_b16 v[222:223], v231 offset:53248
    ds_read_b64_tr_b16 a[28:29], v231 offset:57344
    ds_read_b64_tr_b16 a[30:31], v231 offset:61440
    v_mfma_f32_16x16x32_bf16 v[0:3], v[192:195], v[176:179], v[0:3]
    s_waitcnt vmcnt(11)
    buffer_load_dwordx4 v[80:83], v241, s[8:11], s94 offen offset:0 sc1
    v_mfma_f32_16x16x32_bf16 v[0:3], a[0:3], v[184:187], v[0:3]
    buffer_load_dwordx4 v[84:87], v242, s[8:11], s94 offen offset:0 sc1
    v_mfma_f32_16x16x32_bf16 v[4:7], v[192:195], v[180:183], v[4:7]
    v_mfma_f32_16x16x32_bf16 v[4:7], a[0:3], v[188:191], v[4:7]
    s_waitcnt vmcnt(11) lgkmcnt(0)
    s_barrier
    v_mfma_f32_16x16x32_bf16 v[8:11], v[196:199], v[176:179], v[8:11]
    s_add_u32 m0, s57, 114688
    v_add_u32 v224, 0x10000, v224
    v_mfma_f32_16x16x32_bf16 v[8:11], a[4:7], v[184:187], v[8:11]
    buffer_load_dwordx4 v243, s[24:27], s95 offen offset:0 sc1 lds
    v_mfma_f32_16x16x32_bf16 v[12:15], v[196:199], v[180:183], v[12:15]
    s_add_u32 s94, s94, 4096
    ds_read_b64_tr_b16 v[192:193], v224 offset:0
    v_mfma_f32_16x16x32_bf16 v[12:15], a[4:7], v[188:191], v[12:15]
    ds_read_b64_tr_b16 v[194:195], v224 offset:4096
    ds_read_b64_tr_b16 a[0:1], v224 offset:8192
    v_mfma_f32_16x16x32_bf16 v[16:19], v[200:203], v[176:179], v[16:19]
    ds_read_b64_tr_b16 a[2:3], v224 offset:12288
    v_add_u32 v225, 0x10000, v225
    v_mfma_f32_16x16x32_bf16 v[16:19], a[8:11], v[184:187], v[16:19]
    buffer_load_dwordx4 v244, s[24:27], s95 offen offset:1024 sc1 lds
    v_mfma_f32_16x16x32_bf16 v[20:23], v[200:203], v[180:183], v[20:23]
    ds_read_b64_tr_b16 v[196:197], v225 offset:0
    ds_read_b64_tr_b16 v[198:199], v225 offset:4096
    v_mfma_f32_16x16x32_bf16 v[20:23], a[8:11], v[188:191], v[20:23]
    s_add_u32 s95, s95, 32768
    s_add_u32 m0, s57, 122880
    ds_read_b64_tr_b16 a[4:5], v225 offset:8192
    v_mfma_f32_16x16x32_bf16 v[24:27], v[204:207], v[176:179], v[24:27]
    ds_read_b64_tr_b16 a[6:7], v225 offset:12288
    v_add_u32 v226, 0x10000, v226
    v_mfma_f32_16x16x32_bf16 v[24:27], a[12:15], v[184:187], v[24:27]
    buffer_load_dwordx4 v243, s[24:27], s95 offen offset:0 sc1 lds
    v_mfma_f32_16x16x32_bf16 v[28:31], v[204:207], v[180:183], v[28:31]
    ds_read_b64_tr_b16 v[200:201], v226 offset:0
    ds_read_b64_tr_b16 v[202:203], v226 offset:4096
    v_mfma_f32_16x16x32_bf16 v[28:31], a[12:15], v[188:191], v[28:31]
    ds_read_b64_tr_b16 a[8:9], v226 offset:8192
    v_mfma_f32_16x16x32_bf16 v[32:35], v[208:211], v[176:179], v[32:35]
    ds_read_b64_tr_b16 a[10:11], v226 offset:12288
    v_add_u32 v227, 0x10000, v227
    v_mfma_f32_16x16x32_bf16 v[32:35], a[16:19], v[184:187], v[32:35]
    buffer_load_dwordx4 v244, s[24:27], s95 offen offset:1024 sc1 lds
    v_mfma_f32_16x16x32_bf16 v[36:39], v[208:211], v[180:183], v[36:39]
    s_add_u32 s95, s95, 32768
    ds_read_b64_tr_b16 v[204:205], v227 offset:0
    ds_read_b64_tr_b16 v[206:207], v227 offset:4096
    v_mfma_f32_16x16x32_bf16 v[36:39], a[16:19], v[188:191], v[36:39]
    ds_read_b64_tr_b16 a[12:13], v227 offset:8192
    v_mfma_f32_16x16x32_bf16 v[40:43], v[212:215], v[176:179], v[40:43]
    ds_read_b64_tr_b16 a[14:15], v227 offset:12288
    v_add_u32 v228, 0x10000, v228
    v_mfma_f32_16x16x32_bf16 v[40:43], a[20:23], v[184:187], v[40:43]
    ds_read_b64_tr_b16 v[208:209], v228 offset:0
    ds_read_b64_tr_b16 v[210:211], v228 offset:4096
    v_mfma_f32_16x16x32_bf16 v[44:47], v[212:215], v[180:183], v[44:47]
    ds_read_b64_tr_b16 a[16:17], v228 offset:8192
    v_mfma_f32_16x16x32_bf16 v[44:47], a[20:23], v[188:191], v[44:47]
    ds_read_b64_tr_b16 a[18:19], v228 offset:12288
    v_add_u32 v229, 0x10000, v229
    v_mfma_f32_16x16x32_bf16 v[48:51], v[216:219], v[176:179], v[48:51]
    ds_read_b64_tr_b16 v[212:213], v229 offset:0
    ds_read_b64_tr_b16 v[214:215], v229 offset:4096
    v_mfma_f32_16x16x32_bf16 v[48:51], a[24:27], v[184:187], v[48:51]
    s_waitcnt vmcnt(7)
    ds_read_b64_tr_b16 a[20:21], v229 offset:8192
    v_cmp_ne_u32 vcc, 1, v234
    v_mfma_f32_16x16x32_bf16 v[52:55], v[216:219], v[180:183], v[52:55]
    v_mfma_f32_16x16x32_bf16 v[52:55], a[24:27], v[188:191], v[52:55]
    ds_read_b64_tr_b16 a[22:23], v229 offset:12288
    v_add_u32 v230, 0x10000, v230
    v_mfma_f32_16x16x32_bf16 v[56:59], v[220:223], v[176:179], v[56:59]
    s_cbranch_vccnz L_spin_67
L_back_68:
    ds_read_b64_tr_b16 v[216:217], v230 offset:0
    ds_read_b64_tr_b16 v[218:219], v230 offset:4096
    v_mfma_f32_16x16x32_bf16 v[56:59], a[28:31], v[184:187], v[56:59]
    v_mfma_f32_16x16x32_bf16 v[60:63], v[220:223], v[180:183], v[60:63]
    ds_read_b64_tr_b16 a[24:25], v230 offset:8192
    ds_read_b64_tr_b16 a[26:27], v230 offset:12288
    v_mfma_f32_16x16x32_bf16 v[60:63], a[28:31], v[188:191], v[60:63]
    s_waitcnt lgkmcnt(12)
    s_add_u32 m0, s57, 0
    v_add_u32 v231, 0x10000, v231
    ds_read_b64_tr_b16 v[220:221], v231 offset:0
    ds_read_b64_tr_b16 v[222:223], v231 offset:4096
    ds_read_b64_tr_b16 a[28:29], v231 offset:8192
    ds_read_b64_tr_b16 a[30:31], v231 offset:12288
    v_mfma_f32_16x16x32_bf16 v[0:3], v[192:195], v[64:67], v[0:3]
    buffer_load_dwordx4 v243, s[24:27], s95 offen offset:0 sc1 lds
    v_mfma_f32_16x16x32_bf16 v[0:3], a[0:3], v[72:75], v[0:3]
    s_lshl_b32 s83, s84, 14
    v_mfma_f32_16x16x32_bf16 v[4:7], v[192:195], v[68:71], v[4:7]
    s_waitcnt vmcnt(7)
    buffer_load_dwordx4 v[88:91], v241, s[12:15], s83 offen offset:0 sc1
    v_mfma_f32_16x16x32_bf16 v[4:7], a[0:3], v[76:79], v[4:7]
    ds_read_b64_tr_b16 v[192:193], v224 offset:16384
    ds_read_b64_tr_b16 v[194:195], v224 offset:20480
    v_mfma_f32_16x16x32_bf16 v[8:11], v[196:199], v[64:67], v[8:11]
    buffer_load_dwordx4 v244, s[24:27], s95 offen offset:1024 sc1 lds
    v_mfma_f32_16x16x32_bf16 v[8:11], a[4:7], v[72:75], v[8:11]
    s_add_u32 s95, s95, 32768
    s_add_u32 m0, s57, 8192
    v_mfma_f32_16x16x32_bf16 v[12:15], v[196:199], v[68:71], v[12:15]
    buffer_load_dwordx4 v[92:95], v242, s[12:15], s83 offen offset:0 sc1
    v_mfma_f32_16x16x32_bf16 v[12:15], a[4:7], v[76:79], v[12:15]
    ds_read_b64_tr_b16 a[0:1], v224 offset:24576
    ds_read_b64_tr_b16 a[2:3], v224 offset:28672
    v_mfma_f32_16x16x32_bf16 v[16:19], v[200:203], v[64:67], v[16:19]
    buffer_load_dwordx4 v243, s[24:27], s95 offen offset:0 sc1 lds
    v_mfma_f32_16x16x32_bf16 v[16:19], a[8:11], v[72:75], v[16:19]
    s_add_u32 s83, s83, 4096
    ds_read_b64_tr_b16 v[196:197], v225 offset:16384
    ds_read_b64_tr_b16 v[198:199], v225 offset:20480
    v_mfma_f32_16x16x32_bf16 v[20:23], v[200:203], v[68:71], v[20:23]
    ds_read_b64_tr_b16 a[4:5], v225 offset:24576
    ds_read_b64_tr_b16 a[6:7], v225 offset:28672
    v_mfma_f32_16x16x32_bf16 v[20:23], a[8:11], v[76:79], v[20:23]
    ds_read_b64_tr_b16 v[200:201], v226 offset:16384
    ds_read_b64_tr_b16 v[202:203], v226 offset:20480
    v_mfma_f32_16x16x32_bf16 v[24:27], v[204:207], v[64:67], v[24:27]
    buffer_load_dwordx4 v244, s[24:27], s95 offen offset:1024 sc1 lds
    v_mfma_f32_16x16x32_bf16 v[24:27], a[12:15], v[72:75], v[24:27]
    buffer_load_dwordx4 v[96:99], v241, s[12:15], s83 offen offset:0 sc1
    v_mfma_f32_16x16x32_bf16 v[28:31], v[204:207], v[68:71], v[28:31]
    s_add_u32 s95, s95, 32768
    ds_read_b64_tr_b16 a[8:9], v226 offset:24576
    ds_read_b64_tr_b16 a[10:11], v226 offset:28672
    v_mfma_f32_16x16x32_bf16 v[28:31], a[12:15], v[76:79], v[28:31]
    s_waitcnt lgkmcnt(12)
    ds_read_b64_tr_b16 v[204:205], v227 offset:16384
    ds_read_b64_tr_b16 v[206:207], v227 offset:20480
    v_mfma_f32_16x16x32_bf16 v[32:35], v[208:211], v[64:67], v[32:35]
    ds_read_b64_tr_b16 a[12:13], v227 offset:24576
    ds_read_b64_tr_b16 a[14:15], v227 offset:28672
    v_mfma_f32_16x16x32_bf16 v[32:35], a[16:19], v[72:75], v[32:35]
    buffer_load_dwordx4 v[100:103], v242, s[12:15], s83 offen offset:0 sc1
    v_mfma_f32_16x16x32_bf16 v[36:39], v[208:211], v[68:71], v[36:39]
    s_add_u32 s83, s83, 4096
    v_mfma_f32_16x16x32_bf16 v[36:39], a[16:19], v[76:79], v[36:39]
    ds_read_b64_tr_b16 v[208:209], v228 offset:16384
    v_mfma_f32_16x16x32_bf16 v[40:43], v[212:215], v[64:67], v[40:43]
    ds_read_b64_tr_b16 v[210:211], v228 offset:20480
    v_mfma_f32_16x16x32_bf16 v[40:43], a[20:23], v[72:75], v[40:43]
    buffer_load_dwordx4 v[104:107], v241, s[12:15], s83 offen offset:0 sc1
    v_mfma_f32_16x16x32_bf16 v[44:47], v[212:215], v[68:71], v[44:47]
    ds_read_b64_tr_b16 a[16:17], v228 offset:24576
    ds_read_b64_tr_b16 a[18:19], v228 offset:28672
    v_mfma_f32_16x16x32_bf16 v[44:47], a[20:23], v[76:79], v[44:47]
    ds_read_b64_tr_b16 v[212:213], v229 offset:16384
    ds_read_b64_tr_b16 v[214:215], v229 offset:20480
    v_mfma_f32_16x16x32_bf16 v[48:51], v[216:219], v[64:67], v[48:51]
    ds_read_b64_tr_b16 a[20:21], v229 offset:24576
    ds_read_b64_tr_b16 a[22:23], v229 offset:28672
    v_mfma_f32_16x16x32_bf16 v[48:51], a[24:27], v[72:75], v[48:51]
    buffer_load_dwordx4 v[108:111], v242, s[12:15], s83 offen offset:0 sc1
    v_mfma_f32_16x16x32_bf16 v[52:55], v[216:219], v[68:71], v[52:55]
    s_add_u32 s83, s83, 4096
    v_mfma_f32_16x16x32_bf16 v[52:55], a[24:27], v[76:79], v[52:55]
    ds_read_b64_tr_b16 v[216:217], v230 offset:16384
    ds_read_b64_tr_b16 v[218:219], v230 offset:20480
    v_mfma_f32_16x16x32_bf16 v[56:59], v[220:223], v[64:67], v[56:59]
    ds_read_b64_tr_b16 a[24:25], v230 offset:24576
    ds_read_b64_tr_b16 a[26:27], v230 offset:28672
    v_mfma_f32_16x16x32_bf16 v[56:59], a[28:31], v[72:75], v[56:59]
    buffer_load_dwordx4 v[112:115], v241, s[12:15], s83 offen offset:0 sc1
    v_mfma_f32_16x16x32_bf16 v[60:63], v[220:223], v[68:71], v[60:63]
    buffer_load_dwordx4 v[116:119], v242, s[12:15], s83 offen offset:0 sc1
    s_add_u32 s83, s83, 4096
    v_mfma_f32_16x16x32_bf16 v[60:63], a[28:31], v[76:79], v[60:63]
    s_waitcnt vmcnt(16) lgkmcnt(12)
    ds_read_b64_tr_b16 v[220:221], v231 offset:16384
    ds_read_b64_tr_b16 v[222:223], v231 offset:20480
    ds_read_b64_tr_b16 a[28:29], v231 offset:24576
    ds_read_b64_tr_b16 a[30:31], v231 offset:28672
    v_mfma_f32_16x16x32_bf16 v[0:3], v[192:195], v[80:83], v[0:3]
    s_waitcnt vmcnt(8)
    v_mfma_f32_16x16x32_bf16 v[0:3], a[0:3], v[88:91], v[0:3]
    buffer_load_dwordx4 v[120:123], v241, s[12:15], s83 offen offset:0 sc1
    v_mfma_f32_16x16x32_bf16 v[4:7], v[192:195], v[84:87], v[4:7]
    v_mfma_f32_16x16x32_bf16 v[4:7], a[0:3], v[92:95], v[4:7]
    s_waitcnt lgkmcnt(0)
    s_barrier
    v_mfma_f32_16x16x32_bf16 v[8:11], v[196:199], v[80:83], v[8:11]
    s_add_u32 m0, s57, 16384
    ds_read_b64_tr_b16 v[192:193], v224 offset:32768
    ds_read_b64_tr_b16 v[194:195], v224 offset:36864
    v_mfma_f32_16x16x32_bf16 v[8:11], a[4:7], v[88:91], v[8:11]
    buffer_load_dwordx4 v243, s[24:27], s95 offen offset:0 sc1 lds
    v_mfma_f32_16x16x32_bf16 v[12:15], v[196:199], v[84:87], v[12:15]
    buffer_load_dwordx4 v[124:127], v242, s[12:15], s83 offen offset:0 sc1
    v_mfma_f32_16x16x32_bf16 v[12:15], a[4:7], v[92:95], v[12:15]
    ds_read_b64_tr_b16 a[0:1], v224 offset:40960
    ds_read_b64_tr_b16 a[2:3], v224 offset:45056
    v_mfma_f32_16x16x32_bf16 v[16:19], v[200:203], v[80:83], v[16:19]
    s_add_u32 s83, s83, 4096
    ds_read_b64_tr_b16 v[196:197], v225 offset:32768
    v_mfma_f32_16x16x32_bf16 v[16:19], a[8:11], v[88:91], v[16:19]
    buffer_load_dwordx4 v244, s[24:27], s95 offen offset:1024 sc1 lds
    v_mfma_f32_16x16x32_bf16 v[20:23], v[200:203], v[84:87], v[20:23]
    s_add_u32 s95, s95, 32768
    ds_read_b64_tr_b16 v[198:199], v225 offset:36864
    ds_read_b64_tr_b16 a[4:5], v225 offset:40960
    v_mfma_f32_16x16x32_bf16 v[20:23], a[8:11], v[92:95], v[20:23]
    buffer_load_dwordx4 v[128:131], v241, s[12:15], s83 offen offset:0 sc1
    v_mfma_f32_16x16x32_bf16 v[24:27], v[204:207], v[80:83], v[24:27]
    s_add_u32 m0, s57, 24576
    ds_read_b64_tr_b16 a[6:7], v225 offset:45056
    ds_read_b64_tr_b16 v[200:201], v226 offset:32768
    v_mfma_f32_16x16x32_bf16 v[24:27], a[12:15], v[88:91], v[24:27]
    buffer_load_dwordx4 v243, s[24:27], s95 offen offset:0 sc1 lds
    v_mfma_f32_16x16x32_bf16 v[28:31], v[204:207], v[84:87], v[28:31]
    ds_read_b64_tr_b16 v[202:203], v226 offset:36864
    ds_read_b64_tr_b16 a[8:9], v226 offset:40960
    v_mfma_f32_16x16x32_bf16 v[28:31], a[12:15], v[92:95], v[28:31]
    ds_read_b64_tr_b16 a[10:11], v226 offset:45056
    ds_read_b64_tr_b16 v[204:205], v227 offset:32768
    v_mfma_f32_16x16x32_bf16 v[32:35], v[208:211], v[80:83], v[32:35]
    buffer_load_dwordx4 v[132:135], v242, s[12:15], s83 offen offset:0 sc1
    v_mfma_f32_16x16x32_bf16 v[32:35], a[16:19], v[88:91], v[32:35]
    buffer_load_dwordx4 v244, s[24:27], s95 offen offset:1024 sc1 lds
    v_mfma_f32_16x16x32_bf16 v[36:39], v[208:211], v[84:87], v[36:39]
    s_add_u32 s83, s83, 4096
    ds_read_b64_tr_b16 v[206:207], v227 offset:36864
    ds_read_b64_tr_b16 a[12:13], v227 offset:40960
    v_mfma_f32_16x16x32_bf16 v[36:39], a[16:19], v[92:95], v[36:39]
    s_add_u32 s95, s95, 32768
    ds_read_b64_tr_b16 a[14:15], v227 offset:45056
    ds_read_b64_tr_b16 v[208:209], v228 offset:32768
    v_mfma_f32_16x16x32_bf16 v[40:43], v[212:215], v[80:83], v[40:43]
    ds_read_b64_tr_b16 v[210:211], v228 offset:36864
    v_mfma_f32_16x16x32_bf16 v[40:43], a[20:23], v[88:91], v[40:43]
    buffer_load_dwordx4 v[136:139], v241, s[12:15], s83 offen offset:0 sc1
    v_mfma_f32_16x16x32_bf16 v[44:47], v[212:215], v[84:87], v[44:47]
    ds_read_b64_tr_b16 a[16:17], v228 offset:40960
    ds_read_b64_tr_b16 a[18:19], v228 offset:45056
    v_mfma_f32_16x16x32_bf16 v[44:47], a[20:23], v[92:95], v[44:47]
    ds_read_b64_tr_b16 v[212:213], v229 offset:32768
    ds_read_b64_tr_b16 v[214:215], v229 offset:36864
    v_mfma_f32_16x16x32_bf16 v[48:51], v[216:219], v[80:83], v[48:51]
    ds_read_b64_tr_b16 a[20:21], v229 offset:40960
    ds_read_b64_tr_b16 a[22:23], v229 offset:45056
    v_mfma_f32_16x16x32_bf16 v[48:51], a[24:27], v[88:91], v[48:51]
    buffer_load_dwordx4 v[140:143], v242, s[12:15], s83 offen offset:0 sc1
    v_mfma_f32_16x16x32_bf16 v[52:55], v[216:219], v[84:87], v[52:55]
    v_mfma_f32_16x16x32_bf16 v[52:55], a[24:27], v[92:95], v[52:55]
    ds_read_b64_tr_b16 v[216:217], v230 offset:32768
    ds_read_b64_tr_b16 v[218:219], v230 offset:36864
    v_mfma_f32_16x16x32_bf16 v[56:59], v[220:223], v[80:83], v[56:59]
    s_add_u32 s83, s83, 4096
    v_mfma_f32_16x16x32_bf16 v[56:59], a[28:31], v[88:91], v[56:59]
    v_mfma_f32_16x16x32_bf16 v[60:63], v[220:223], v[84:87], v[60:63]
    ds_read_b64_tr_b16 a[24:25], v230 offset:40960
    ds_read_b64_tr_b16 a[26:27], v230 offset:45056
    v_mfma_f32_16x16x32_bf16 v[60:63], a[28:31], v[92:95], v[60:63]
    s_waitcnt vmcnt(14) lgkmcnt(12)
    s_add_u32 m0, s57, 32768
    ds_read_b64_tr_b16 v[220:221], v231 offset:32768
    ds_read_b64_tr_b16 v[222:223], v231 offset:36864
    ds_read_b64_tr_b16 a[28:29], v231 offset:40960
    ds_read_b64_tr_b16 a[30:31], v231 offset:45056
    v_mfma_f32_16x16x32_bf16 v[0:3], v[192:195], v[96:99], v[0:3]
    s_waitcnt vmcnt(12)
    buffer_load_dwordx4 v243, s[24:27], s95 offen offset:0 sc1 lds
    v_mfma_f32_16x16x32_bf16 v[0:3], a[0:3], v[104:107], v[0:3]
    v_mfma_f32_16x16x32_bf16 v[4:7], v[192:195], v[100:103], v[4:7]
    buffer_load_dwordx4 v[144:147], v241, s[12:15], s83 offen offset:0 sc1
    v_mfma_f32_16x16x32_bf16 v[4:7], a[0:3], v[108:111], v[4:7]
    ds_read_b64_tr_b16 v[192:193], v224 offset:49152
    ds_read_b64_tr_b16 v[194:195], v224 offset:53248
    v_mfma_f32_16x16x32_bf16 v[8:11], v[196:199], v[96:99], v[8:11]
    buffer_load_dwordx4 v244, s[24:27], s95 offen offset:1024 sc1 lds
    v_mfma_f32_16x16x32_bf16 v[8:11], a[4:7], v[104:107], v[8:11]
    s_add_u32 s95, s95, 32768
    s_add_u32 m0, s57, 40960
    ds_read_b64_tr_b16 a[0:1], v224 offset:57344
    v_mfma_f32_16x16x32_bf16 v[12:15], v[196:199], v[100:103], v[12:15]
    buffer_load_dwordx4 v[148:151], v242, s[12:15], s83 offen offset:0 sc1
    v_mfma_f32_16x16x32_bf16 v[12:15], a[4:7], v[108:111], v[12:15]
    s_add_u32 s83, s83, 4096
    ds_read_b64_tr_b16 a[2:3], v224 offset:61440
    ds_read_b64_tr_b16 v[196:197], v225 offset:49152
    v_mfma_f32_16x16x32_bf16 v[16:19], v[200:203], v[96:99], v[16:19]
    buffer_load_dwordx4 v243, s[24:27], s95 offen offset:0 sc1 lds
    v_mfma_f32_16x16x32_bf16 v[16:19], a[8:11], v[104:107], v[16:19]
    ds_read_b64_tr_b16 v[198:199], v225 offset:53248
    v_mfma_f32_16x16x32_bf16 v[20:23], v[200:203], v[100:103], v[20:23]
    ds_read_b64_tr_b16 a[4:5], v225 offset:57344
    ds_read_b64_tr_b16 a[6:7], v225 offset:61440
    v_mfma_f32_16x16x32_bf16 v[20:23], a[8:11], v[108:111], v[20:23]
    ds_read_b64_tr_b16 v[200:201], v226 offset:49152
    v_mfma_f32_16x16x32_bf16 v[24:27], v[204:207], v[96:99], v[24:27]
    buffer_load_dwordx4 v244, s[24:27], s95 offen offset:1024 sc1 lds
    v_mfma_f32_16x16x32_bf16 v[24:27], a[12:15], v[104:107], v[24:27]
    buffer_load_dwordx4 v[152:155], v241, s[12:15], s83 offen offset:0 sc1
    v_mfma_f32_16x16x32_bf16 v[28:31], v[204:207], v[100:103], v[28:31]
    s_add_u32 s95, s95, 32768
    ds_read_b64_tr_b16 v[202:203], v226 offset:53248
    ds_read_b64_tr_b16 a[8:9], v226 offset:57344
    v_mfma_f32_16x16x32_bf16 v[28:31], a[12:15], v[108:111], v[28:31]
    s_waitcnt lgkmcnt(11)
    ds_read_b64_tr_b16 a[10:11], v226 offset:61440
    ds_read_b64_tr_b16 v[204:205], v227 offset:49152
    v_mfma_f32_16x16x32_bf16 v[32:35], v[208:211], v[96:99], v[32:35]
    ds_read_b64_tr_b16 v[206:207], v227 offset:53248
    ds_read_b64_tr_b16 a[12:13], v227 offset:57344
    v_mfma_f32_16x16x32_bf16 v[32:35], a[16:19], v[104:107], v[32:35]
    buffer_load_dwordx4 v[156:159], v242, s[12:15], s83 offen offset:0 sc1
    v_mfma_f32_16x16x32_bf16 v[36:39], v[208:211], v[100:103], v[36:39]
    ds_read_b64_tr_b16 a[14:15], v227 offset:61440
    v_mfma_f32_16x16x32_bf16 v[36:39], a[16:19], v[108:111], v[36:39]
    ds_read_b64_tr_b16 v[208:209], v228 offset:49152
    ds_read_b64_tr_b16 v[210:211], v228 offset:53248
    v_mfma_f32_16x16x32_bf16 v[40:43], v[212:215], v[96:99], v[40:43]
    ds_read_b64_tr_b16 a[16:17], v228 offset:57344
    v_mfma_f32_16x16x32_bf16 v[40:43], a[20:23], v[104:107], v[40:43]
    ds_read_b64_tr_b16 a[18:19], v228 offset:61440
    v_mfma_f32_16x16x32_bf16 v[44:47], v[212:215], v[100:103], v[44:47]
    v_mfma_f32_16x16x32_bf16 v[44:47], a[20:23], v[108:111], v[44:47]
    s_add_u32 s83, s83, 4096
    v_mfma_f32_16x16x32_bf16 v[48:51], v[216:219], v[96:99], v[48:51]
    ds_read_b64_tr_b16 v[212:213], v229 offset:49152
    v_mfma_f32_16x16x32_bf16 v[48:51], a[24:27], v[104:107], v[48:51]
    ds_read_b64_tr_b16 v[214:215], v229 offset:53248
    v_mfma_f32_16x16x32_bf16 v[52:55], v[216:219], v[100:103], v[52:55]
    ds_read_b64_tr_b16 a[20:21], v229 offset:57344
    ds_read_b64_tr_b16 a[22:23], v229 offset:61440
    v_mfma_f32_16x16x32_bf16 v[52:55], a[24:27], v[108:111], v[52:55]
    ds_read_b64_tr_b16 v[216:217], v230 offset:49152
    ds_read_b64_tr_b16 v[218:219], v230 offset:53248
    v_mfma_f32_16x16x32_bf16 v[56:59], v[220:223], v[96:99], v[56:59]
    ds_read_b64_tr_b16 a[24:25], v230 offset:57344
    v_mfma_f32_16x16x32_bf16 v[56:59], a[28:31], v[104:107], v[56:59]
    ds_read_b64_tr_b16 a[26:27], v230 offset:61440
    v_mfma_f32_16x16x32_bf16 v[60:63], v[220:223], v[100:103], v[60:63]
    v_mfma_f32_16x16x32_bf16 v[60:63], a[28:31], v[108:111], v[60:63]
    s_waitcnt vmcnt(18) lgkmcnt(12)
    ds_read_b64_tr_b16 v[220:221], v231 offset:49152
    ds_read_b64_tr_b16 v[222:223], v231 offset:53248
    ds_read_b64_tr_b16 a[28:29], v231 offset:57344
    ds_read_b64_tr_b16 a[30:31], v231 offset:61440
    v_mfma_f32_16x16x32_bf16 v[0:3], v[192:195], v[112:115], v[0:3]
    s_waitcnt vmcnt(15)
    buffer_load_dwordx4 v[160:163], v241, s[12:15], s83 offen offset:0 sc1
    v_mfma_f32_16x16x32_bf16 v[0:3], a[0:3], v[120:123], v[0:3]
    buffer_load_dwordx4 v[164:167], v242, s[12:15], s83 offen offset:0 sc1
    v_mfma_f32_16x16x32_bf16 v[4:7], v[192:195], v[116:119], v[4:7]
    s_add_u32 s83, s83, 4096
    v_mfma_f32_16x16x32_bf16 v[4:7], a[0:3], v[124:127], v[4:7]
    s_waitcnt vmcnt(12) lgkmcnt(0)
    s_barrier
    v_mfma_f32_16x16x32_bf16 v[8:11], v[196:199], v[112:115], v[8:11]
    s_add_u32 m0, s57, 49152
    v_subrev_u32 v224, 0x10000, v224
    v_mfma_f32_16x16x32_bf16 v[8:11], a[4:7], v[120:123], v[8:11]
    buffer_load_dwordx4 v243, s[24:27], s95 offen offset:0 sc1 lds
    v_mfma_f32_16x16x32_bf16 v[12:15], v[196:199], v[116:119], v[12:15]
    buffer_load_dwordx4 v[168:171], v241, s[12:15], s83 offen offset:0 sc1
    v_mfma_f32_16x16x32_bf16 v[12:15], a[4:7], v[124:127], v[12:15]
    ds_read_b64_tr_b16 v[192:193], v224 offset:0
    ds_read_b64_tr_b16 v[194:195], v224 offset:4096
    v_mfma_f32_16x16x32_bf16 v[16:19], v[200:203], v[112:115], v[16:19]
    ds_read_b64_tr_b16 a[0:1], v224 offset:8192
    ds_read_b64_tr_b16 a[2:3], v224 offset:12288
    v_mfma_f32_16x16x32_bf16 v[16:19], a[8:11], v[120:123], v[16:19]
    buffer_load_dwordx4 v244, s[24:27], s95 offen offset:1024 sc1 lds
    v_mfma_f32_16x16x32_bf16 v[20:23], v[200:203], v[116:119], v[20:23]
    s_add_u32 s95, s95, 32768
    s_add_u32 m0, s57, 57344
    v_subrev_u32 v225, 0x10000, v225
    v_mfma_f32_16x16x32_bf16 v[20:23], a[8:11], v[124:127], v[20:23]
    buffer_load_dwordx4 v[172:175], v242, s[12:15], s83 offen offset:0 sc1
    v_mfma_f32_16x16x32_bf16 v[24:27], v[204:207], v[112:115], v[24:27]
    s_add_u32 s83, s83, 4096
    ds_read_b64_tr_b16 v[196:197], v225 offset:0
    ds_read_b64_tr_b16 v[198:199], v225 offset:4096
    ds_read_b64_tr_b16 a[4:5], v225 offset:8192
    ds_read_b64_tr_b16 a[6:7], v225 offset:12288
    v_mfma_f32_16x16x32_bf16 v[24:27], a[12:15], v[120:123], v[24:27]
    buffer_load_dwordx4 v243, s[24:27], s95 offen offset:0 sc1 lds
    v_mfma_f32_16x16x32_bf16 v[28:31], v[204:207], v[116:119], v[28:31]
    v_subrev_u32 v226, 0x10000, v226
    v_mfma_f32_16x16x32_bf16 v[28:31], a[12:15], v[124:127], v[28:31]
    ds_read_b64_tr_b16 v[200:201], v226 offset:0
    ds_read_b64_tr_b16 v[202:203], v226 offset:4096
    v_mfma_f32_16x16x32_bf16 v[32:35], v[208:211], v[112:115], v[32:35]
    ds_read_b64_tr_b16 a[8:9], v226 offset:8192
    ds_read_b64_tr_b16 a[10:11], v226 offset:12288
    v_mfma_f32_16x16x32_bf16 v[32:35], a[16:19], v[120:123], v[32:35]
    buffer_load_dwordx4 v244, s[24:27], s95 offen offset:1024 sc1 lds
    v_mfma_f32_16x16x32_bf16 v[36:39], v[208:211], v[116:119], v[36:39]
    v_subrev_u32 v227, 0x10000, v227
    v_mfma_f32_16x16x32_bf16 v[36:39], a[16:19], v[124:127], v[36:39]
    ds_read_b64_tr_b16 v[204:205], v227 offset:0
    ds_read_b64_tr_b16 v[206:207], v227 offset:4096
    v_mfma_f32_16x16x32_bf16 v[40:43], v[212:215], v[112:115], v[40:43]
    s_add_u32 s95, s95, 32768
    ds_read_b64_tr_b16 a[12:13], v227 offset:8192
    ds_read_b64_tr_b16 a[14:15], v227 offset:12288
    v_mfma_f32_16x16x32_bf16 v[40:43], a[20:23], v[120:123], v[40:43]
    v_subrev_u32 v228, 0x10000, v228
    v_mfma_f32_16x16x32_bf16 v[44:47], v[212:215], v[116:119], v[44:47]
    ds_read_b64_tr_b16 v[208:209], v228 offset:0
    ds_read_b64_tr_b16 v[210:211], v228 offset:4096
    v_mfma_f32_16x16x32_bf16 v[44:47], a[20:23], v[124:127], v[44:47]
    ds_read_b64_tr_b16 a[16:17], v228 offset:8192
    v_mfma_f32_16x16x32_bf16 v[48:51], v[216:219], v[112:115], v[48:51]
    ds_read_b64_tr_b16 a[18:19], v228 offset:12288
    v_subrev_u32 v229, 0x10000, v229
    v_mfma_f32_16x16x32_bf16 v[48:51], a[24:27], v[120:123], v[48:51]
    ds_read_b64_tr_b16 v[212:213], v229 offset:0
    ds_read_b64_tr_b16 v[214:215], v229 offset:4096
    v_mfma_f32_16x16x32_bf16 v[52:55], v[216:219], v[116:119], v[52:55]
    ds_read_b64_tr_b16 a[20:21], v229 offset:8192
    v_mfma_f32_16x16x32_bf16 v[52:55], a[24:27], v[124:127], v[52:55]
    ds_read_b64_tr_b16 a[22:23], v229 offset:12288
    v_subrev_u32 v230, 0x10000, v230
    v_mfma_f32_16x16x32_bf16 v[56:59], v[220:223], v[112:115], v[56:59]
    ds_read_b64_tr_b16 v[216:217], v230 offset:0
    ds_read_b64_tr_b16 v[218:219], v230 offset:4096
    v_mfma_f32_16x16x32_bf16 v[56:59], a[28:31], v[120:123], v[56:59]
    ds_read_b64_tr_b16 a[24:25], v230 offset:8192
    ds_read_b64_tr_b16 a[26:27], v230 offset:12288
    v_mfma_f32_16x16x32_bf16 v[60:63], v[220:223], v[116:119], v[60:63]
    v_mfma_f32_16x16x32_bf16 v[60:63], a[28:31], v[124:127], v[60:63]
    s_waitcnt lgkmcnt(12)
    s_add_u32 m0, s57, 65536
    v_subrev_u32 v231, 0x10000, v231
    ds_read_b64_tr_b16 v[220:221], v231 offset:0
    ds_read_b64_tr_b16 v[222:223], v231 offset:4096
    ds_read_b64_tr_b16 a[28:29], v231 offset:8192
    ds_read_b64_tr_b16 a[30:31], v231 offset:12288
    v_mfma_f32_16x16x32_bf16 v[0:3], v[192:195], v[128:131], v[0:3]
    s_waitcnt vmcnt(16)
    buffer_load_dwordx4 v243, s[24:27], s95 offen offset:0 sc1 lds
    v_mfma_f32_16x16x32_bf16 v[0:3], a[0:3], v[136:139], v[0:3]
    v_mfma_f32_16x16x32_bf16 v[4:7], v[192:195], v[132:135], v[4:7]
    buffer_load_dwordx4 v[176:179], v241, s[12:15], s83 offen offset:0 sc1
    v_mfma_f32_16x16x32_bf16 v[4:7], a[0:3], v[140:143], v[4:7]
    ds_read_b64_tr_b16 v[192:193], v224 offset:16384
    ds_read_b64_tr_b16 v[194:195], v224 offset:20480
    v_mfma_f32_16x16x32_bf16 v[8:11], v[196:199], v[128:131], v[8:11]
    buffer_load_dwordx4 v244, s[24:27], s95 offen offset:1024 sc1 lds
    v_mfma_f32_16x16x32_bf16 v[8:11], a[4:7], v[136:139], v[8:11]
    s_add_u32 s95, s95, 32768
    s_add_u32 m0, s57, 73728
    ds_read_b64_tr_b16 a[0:1], v224 offset:24576
    v_mfma_f32_16x16x32_bf16 v[12:15], v[196:199], v[132:135], v[12:15]
    buffer_load_dwordx4 v[180:183], v242, s[12:15], s83 offen offset:0 sc1
    v_mfma_f32_16x16x32_bf16 v[12:15], a[4:7], v[140:143], v[12:15]
    ds_read_b64_tr_b16 a[2:3], v224 offset:28672
    v_mfma_f32_16x16x32_bf16 v[16:19], v[200:203], v[128:131], v[16:19]
    buffer_load_dwordx4 v243, s[24:27], s95 offen offset:0 sc1 lds
    v_mfma_f32_16x16x32_bf16 v[16:19], a[8:11], v[136:139], v[16:19]
    ds_read_b64_tr_b16 v[196:197], v225 offset:16384
    ds_read_b64_tr_b16 v[198:199], v225 offset:20480
    v_mfma_f32_16x16x32_bf16 v[20:23], v[200:203], v[132:135], v[20:23]
    ds_read_b64_tr_b16 a[4:5], v225 offset:24576
    ds_read_b64_tr_b16 a[6:7], v225 offset:28672
    v_mfma_f32_16x16x32_bf16 v[20:23], a[8:11], v[140:143], v[20:23]
    s_add_u32 s83, s83, 4096
    ds_read_b64_tr_b16 v[200:201], v226 offset:16384
    ds_read_b64_tr_b16 v[202:203], v226 offset:20480
    v_mfma_f32_16x16x32_bf16 v[24:27], v[204:207], v[128:131], v[24:27]
    buffer_load_dwordx4 v244, s[24:27], s95 offen offset:1024 sc1 lds
    v_mfma_f32_16x16x32_bf16 v[24:27], a[12:15], v[136:139], v[24:27]
    buffer_load_dwordx4 v[184:187], v241, s[12:15], s83 offen offset:0 sc1
    v_mfma_f32_16x16x32_bf16 v[28:31], v[204:207], v[132:135], v[28:31]
    s_add_u32 s95, s95, 32768
    ds_read_b64_tr_b16 a[8:9], v226 offset:24576
    ds_read_b64_tr_b16 a[10:11], v226 offset:28672
    v_mfma_f32_16x16x32_bf16 v[28:31], a[12:15], v[140:143], v[28:31]
    s_waitcnt lgkmcnt(12)
    ds_read_b64_tr_b16 v[204:205], v227 offset:16384
    ds_read_b64_tr_b16 v[206:207], v227 offset:20480
    v_mfma_f32_16x16x32_bf16 v[32:35], v[208:211], v[128:131], v[32:35]
    v_mfma_f32_16x16x32_bf16 v[32:35], a[16:19], v[136:139], v[32:35]
    buffer_load_dwordx4 v[188:191], v242, s[12:15], s83 offen offset:0 sc1
    v_mfma_f32_16x16x32_bf16 v[36:39], v[208:211], v[132:135], v[36:39]
    ds_read_b64_tr_b16 a[12:13], v227 offset:24576
    ds_read_b64_tr_b16 a[14:15], v227 offset:28672
    v_mfma_f32_16x16x32_bf16 v[36:39], a[16:19], v[140:143], v[36:39]
    ds_read_b64_tr_b16 v[208:209], v228 offset:16384
    ds_read_b64_tr_b16 v[210:211], v228 offset:20480
    v_mfma_f32_16x16x32_bf16 v[40:43], v[212:215], v[128:131], v[40:43]
    s_add_u32 s83, s83, 4096
    ds_read_b64_tr_b16 a[16:17], v228 offset:24576
    ds_read_b64_tr_b16 a[18:19], v228 offset:28672
    v_mfma_f32_16x16x32_bf16 v[40:43], a[20:23], v[136:139], v[40:43]
    v_mfma_f32_16x16x32_bf16 v[44:47], v[212:215], v[132:135], v[44:47]
    v_mfma_f32_16x16x32_bf16 v[44:47], a[20:23], v[140:143], v[44:47]
    ds_read_b64_tr_b16 v[212:213], v229 offset:16384
    ds_read_b64_tr_b16 v[214:215], v229 offset:20480
    v_mfma_f32_16x16x32_bf16 v[48:51], v[216:219], v[128:131], v[48:51]
    v_mfma_f32_16x16x32_bf16 v[48:51], a[24:27], v[136:139], v[48:51]
    ds_read_b64_tr_b16 a[20:21], v229 offset:24576
    v_mfma_f32_16x16x32_bf16 v[52:55], v[216:219], v[132:135], v[52:55]
    ds_read_b64_tr_b16 a[22:23], v229 offset:28672
    v_mfma_f32_16x16x32_bf16 v[52:55], a[24:27], v[140:143], v[52:55]
    ds_read_b64_tr_b16 v[216:217], v230 offset:16384
    ds_read_b64_tr_b16 v[218:219], v230 offset:20480
    v_mfma_f32_16x16x32_bf16 v[56:59], v[220:223], v[128:131], v[56:59]
    ds_read_b64_tr_b16 a[24:25], v230 offset:24576
    ds_read_b64_tr_b16 a[26:27], v230 offset:28672
    v_mfma_f32_16x16x32_bf16 v[56:59], a[28:31], v[136:139], v[56:59]
    v_mfma_f32_16x16x32_bf16 v[60:63], v[220:223], v[132:135], v[60:63]
    v_mfma_f32_16x16x32_bf16 v[60:63], a[28:31], v[140:143], v[60:63]
    s_waitcnt vmcnt(20) lgkmcnt(12)
    ds_read_b64_tr_b16 v[220:221], v231 offset:16384
    ds_read_b64_tr_b16 v[222:223], v231 offset:20480
    ds_read_b64_tr_b16 a[28:29], v231 offset:24576
    ds_read_b64_tr_b16 a[30:31], v231 offset:28672
    v_mfma_f32_16x16x32_bf16 v[0:3], v[192:195], v[144:147], v[0:3]
    s_waitcnt vmcnt(16)
    buffer_load_dwordx4 v[64:67], v241, s[12:15], s83 offen offset:0 sc1
    v_mfma_f32_16x16x32_bf16 v[0:3], a[0:3], v[152:155], v[0:3]
    buffer_load_dwordx4 v[68:71], v242, s[12:15], s83 offen offset:0 sc1
    v_mfma_f32_16x16x32_bf16 v[4:7], v[192:195], v[148:151], v[4:7]
    v_mfma_f32_16x16x32_bf16 v[4:7], a[0:3], v[156:159], v[4:7]
    s_waitcnt vmcnt(10) lgkmcnt(0)
    s_barrier
    s_add_u32 s83, s83, 4096
    v_mfma_f32_16x16x32_bf16 v[8:11], v[196:199], v[144:147], v[8:11]
    s_add_u32 m0, s57, 81920
    ds_read_b64_tr_b16 v[192:193], v224 offset:32768
    ds_read_b64_tr_b16 v[194:195], v224 offset:36864
    v_mfma_f32_16x16x32_bf16 v[8:11], a[4:7], v[152:155], v[8:11]
    buffer_load_dwordx4 v243, s[24:27], s95 offen offset:0 sc1 lds
    v_mfma_f32_16x16x32_bf16 v[12:15], v[196:199], v[148:151], v[12:15]
    buffer_load_dwordx4 v[72:75], v241, s[12:15], s83 offen offset:0 sc1
    v_mfma_f32_16x16x32_bf16 v[12:15], a[4:7], v[156:159], v[12:15]
    ds_read_b64_tr_b16 a[0:1], v224 offset:40960
    ds_read_b64_tr_b16 a[2:3], v224 offset:45056
    v_mfma_f32_16x16x32_bf16 v[16:19], v[200:203], v[144:147], v[16:19]
    ds_read_b64_tr_b16 v[196:197], v225 offset:32768
    ds_read_b64_tr_b16 v[198:199], v225 offset:36864
    v_mfma_f32_16x16x32_bf16 v[16:19], a[8:11], v[152:155], v[16:19]
    buffer_load_dwordx4 v244, s[24:27], s95 offen offset:1024 sc1 lds
    v_mfma_f32_16x16x32_bf16 v[20:23], v[200:203], v[148:151], v[20:23]
    s_add_u32 s95, s95, 32768
    s_add_u32 m0, s57, 90112
    ds_read_b64_tr_b16 a[4:5], v225 offset:40960
    v_mfma_f32_16x16x32_bf16 v[20:23], a[8:11], v[156:159], v[20:23]
    buffer_load_dwordx4 v[76:79], v242, s[12:15], s83 offen offset:0 sc1
    v_mfma_f32_16x16x32_bf16 v[24:27], v[204:207], v[144:147], v[24:27]
    ds_read_b64_tr_b16 a[6:7], v225 offset:45056
    ds_read_b64_tr_b16 v[200:201], v226 offset:32768
    v_mfma_f32_16x16x32_bf16 v[24:27], a[12:15], v[152:155], v[24:27]
    buffer_load_dwordx4 v243, s[24:27], s95 offen offset:0 sc1 lds
    v_mfma_f32_16x16x32_bf16 v[28:31], v[204:207], v[148:151], v[28:31]
    s_add_u32 s83, s83, 4096
    ds_read_b64_tr_b16 v[202:203], v226 offset:36864
    ds_read_b64_tr_b16 a[8:9], v226 offset:40960
    v_mfma_f32_16x16x32_bf16 v[28:31], a[12:15], v[156:159], v[28:31]
    ds_read_b64_tr_b16 a[10:11], v226 offset:45056
    ds_read_b64_tr_b16 v[204:205], v227 offset:32768
    v_mfma_f32_16x16x32_bf16 v[32:35], v[208:211], v[144:147], v[32:35]
    ds_read_b64_tr_b16 v[206:207], v227 offset:36864
    ds_read_b64_tr_b16 a[12:13], v227 offset:40960
    v_mfma_f32_16x16x32_bf16 v[32:35], a[16:19], v[152:155], v[32:35]
    buffer_load_dwordx4 v244, s[24:27], s95 offen offset:1024 sc1 lds
    v_mfma_f32_16x16x32_bf16 v[36:39], v[208:211], v[148:151], v[36:39]
    ds_read_b64_tr_b16 a[14:15], v227 offset:45056
    v_mfma_f32_16x16x32_bf16 v[36:39], a[16:19], v[156:159], v[36:39]
    ds_read_b64_tr_b16 v[208:209], v228 offset:32768
    ds_read_b64_tr_b16 v[210:211], v228 offset:36864
    v_mfma_f32_16x16x32_bf16 v[40:43], v[212:215], v[144:147], v[40:43]
    s_add_u32 s95, s95, 32768
    v_mfma_f32_16x16x32_bf16 v[40:43], a[20:23], v[152:155], v[40:43]
    v_mfma_f32_16x16x32_bf16 v[44:47], v[212:215], v[148:151], v[44:47]
    ds_read_b64_tr_b16 a[16:17], v228 offset:40960
    ds_read_b64_tr_b16 a[18:19], v228 offset:45056
    v_mfma_f32_16x16x32_bf16 v[44:47], a[20:23], v[156:159], v[44:47]
    ds_read_b64_tr_b16 v[212:213], v229 offset:32768
    ds_read_b64_tr_b16 v[214:215], v229 offset:36864
    v_mfma_f32_16x16x32_bf16 v[48:51], v[216:219], v[144:147], v[48:51]
    v_mfma_f32_16x16x32_bf16 v[48:51], a[24:27], v[152:155], v[48:51]
    v_mfma_f32_16x16x32_bf16 v[52:55], v[216:219], v[148:151], v[52:55]
    ds_read_b64_tr_b16 a[20:21], v229 offset:40960
    v_mfma_f32_16x16x32_bf16 v[52:55], a[24:27], v[156:159], v[52:55]
    ds_read_b64_tr_b16 a[22:23], v229 offset:45056
    ds_read_b64_tr_b16 v[216:217], v230 offset:32768
    v_mfma_f32_16x16x32_bf16 v[56:59], v[220:223], v[144:147], v[56:59]
    ds_read_b64_tr_b16 v[218:219], v230 offset:36864
    ds_read_b64_tr_b16 a[24:25], v230 offset:40960
    v_mfma_f32_16x16x32_bf16 v[56:59], a[28:31], v[152:155], v[56:59]
    v_mfma_f32_16x16x32_bf16 v[60:63], v[220:223], v[148:151], v[60:63]
    ds_read_b64_tr_b16 a[26:27], v230 offset:45056
    v_mfma_f32_16x16x32_bf16 v[60:63], a[28:31], v[156:159], v[60:63]
    s_waitcnt lgkmcnt(12)
    s_add_u32 m0, s57, 98304
    ds_read_b64_tr_b16 v[220:221], v231 offset:32768
    ds_read_b64_tr_b16 v[222:223], v231 offset:36864
    ds_read_b64_tr_b16 a[28:29], v231 offset:40960
    ds_read_b64_tr_b16 a[30:31], v231 offset:45056
    v_mfma_f32_16x16x32_bf16 v[0:3], v[192:195], v[160:163], v[0:3]
    buffer_load_dwordx4 v243, s[24:27], s95 offen offset:0 sc1 lds
    v_mfma_f32_16x16x32_bf16 v[0:3], a[0:3], v[168:171], v[0:3]
    buffer_load_dwordx4 v[80:83], v241, s[12:15], s83 offen offset:0 sc1
    v_mfma_f32_16x16x32_bf16 v[4:7], v[192:195], v[164:167], v[4:7]
    v_mfma_f32_16x16x32_bf16 v[4:7], a[0:3], v[172:175], v[4:7]
    ds_read_b64_tr_b16 v[192:193], v224 offset:49152
    ds_read_b64_tr_b16 v[194:195], v224 offset:53248
    v_mfma_f32_16x16x32_bf16 v[8:11], v[196:199], v[160:163], v[8:11]
    buffer_load_dwordx4 v244, s[24:27], s95 offen offset:1024 sc1 lds
    v_mfma_f32_16x16x32_bf16 v[8:11], a[4:7], v[168:171], v[8:11]
    s_add_u32 s95, s95, 32768
    ds_read_b64_tr_b16 a[0:1], v224 offset:57344
    v_mfma_f32_16x16x32_bf16 v[12:15], v[196:199], v[164:167], v[12:15]
    buffer_load_dwordx4 v[84:87], v242, s[12:15], s83 offen offset:0 sc1
    v_mfma_f32_16x16x32_bf16 v[12:15], a[4:7], v[172:175], v[12:15]
    s_add_u32 m0, s57, 106496
    ds_read_b64_tr_b16 a[2:3], v224 offset:61440
    ds_read_b64_tr_b16 v[196:197], v225 offset:49152
    v_mfma_f32_16x16x32_bf16 v[16:19], v[200:203], v[160:163], v[16:19]
    buffer_load_dwordx4 v243, s[24:27], s95 offen offset:0 sc1 lds
    v_mfma_f32_16x16x32_bf16 v[16:19], a[8:11], v[168:171], v[16:19]
    ds_read_b64_tr_b16 v[198:199], v225 offset:53248
    ds_read_b64_tr_b16 a[4:5], v225 offset:57344
    v_mfma_f32_16x16x32_bf16 v[20:23], v[200:203], v[164:167], v[20:23]
    s_add_u32 s83, s83, 4096
    ds_read_b64_tr_b16 a[6:7], v225 offset:61440
    v_mfma_f32_16x16x32_bf16 v[20:23], a[8:11], v[172:175], v[20:23]
    ds_read_b64_tr_b16 v[200:201], v226 offset:49152
    ds_read_b64_tr_b16 v[202:203], v226 offset:53248
    v_mfma_f32_16x16x32_bf16 v[24:27], v[204:207], v[160:163], v[24:27]
    buffer_load_dwordx4 v244, s[24:27], s95 offen offset:1024 sc1 lds
    v_mfma_f32_16x16x32_bf16 v[24:27], a[12:15], v[168:171], v[24:27]
    buffer_load_dwordx4 v[88:91], v241, s[12:15], s83 offen offset:0 sc1
    v_mfma_f32_16x16x32_bf16 v[28:31], v[204:207], v[164:167], v[28:31]
    s_add_u32 s95, s95, 32768
    ds_read_b64_tr_b16 a[8:9], v226 offset:57344
    v_mfma_f32_16x16x32_bf16 v[28:31], a[12:15], v[172:175], v[28:31]
    s_waitcnt lgkmcnt(11)
    ds_read_b64_tr_b16 a[10:11], v226 offset:61440
    ds_read_b64_tr_b16 v[204:205], v227 offset:49152
    v_mfma_f32_16x16x32_bf16 v[32:35], v[208:211], v[160:163], v[32:35]
    ds_read_b64_tr_b16 v[206:207], v227 offset:53248
    ds_read_b64_tr_b16 a[12:13], v227 offset:57344
    v_mfma_f32_16x16x32_bf16 v[32:35], a[16:19], v[168:171], v[32:35]
    buffer_load_dwordx4 v[92:95], v242, s[12:15], s83 offen offset:0 sc1
    v_mfma_f32_16x16x32_bf16 v[36:39], v[208:211], v[164:167], v[36:39]
    s_add_u32 s83, s83, 4096
    ds_read_b64_tr_b16 a[14:15], v227 offset:61440
    v_mfma_f32_16x16x32_bf16 v[36:39], a[16:19], v[172:175], v[36:39]
    ds_read_b64_tr_b16 v[208:209], v228 offset:49152
    ds_read_b64_tr_b16 v[210:211], v228 offset:53248
    v_mfma_f32_16x16x32_bf16 v[40:43], v[212:215], v[160:163], v[40:43]
    v_mfma_f32_16x16x32_bf16 v[40:43], a[20:23], v[168:171], v[40:43]
    ds_read_b64_tr_b16 a[16:17], v228 offset:57344
    v_mfma_f32_16x16x32_bf16 v[44:47], v[212:215], v[164:167], v[44:47]
    ds_read_b64_tr_b16 a[18:19], v228 offset:61440
    v_mfma_f32_16x16x32_bf16 v[44:47], a[20:23], v[172:175], v[44:47]
    ds_read_b64_tr_b16 v[212:213], v229 offset:49152
    ds_read_b64_tr_b16 v[214:215], v229 offset:53248
    v_mfma_f32_16x16x32_bf16 v[48:51], v[216:219], v[160:163], v[48:51]
    v_mfma_f32_16x16x32_bf16 v[48:51], a[24:27], v[168:171], v[48:51]
    ds_read_b64_tr_b16 a[20:21], v229 offset:57344
    ds_read_b64_tr_b16 a[22:23], v229 offset:61440
    v_mfma_f32_16x16x32_bf16 v[52:55], v[216:219], v[164:167], v[52:55]
    v_mfma_f32_16x16x32_bf16 v[52:55], a[24:27], v[172:175], v[52:55]
    ds_read_b64_tr_b16 v[216:217], v230 offset:49152
    v_mfma_f32_16x16x32_bf16 v[56:59], v[220:223], v[160:163], v[56:59]
    ds_read_b64_tr_b16 v[218:219], v230 offset:53248
    v_mfma_f32_16x16x32_bf16 v[56:59], a[28:31], v[168:171], v[56:59]
    ds_read_b64_tr_b16 a[24:25], v230 offset:57344
    ds_read_b64_tr_b16 a[26:27], v230 offset:61440
    v_mfma_f32_16x16x32_bf16 v[60:63], v[220:223], v[164:167], v[60:63]
    v_mfma_f32_16x16x32_bf16 v[60:63], a[28:31], v[172:175], v[60:63]
    s_waitcnt vmcnt(20) lgkmcnt(12)
    ds_read_b64_tr_b16 v[220:221], v231 offset:49152
    ds_read_b64_tr_b16 v[222:223], v231 offset:53248
    ds_read_b64_tr_b16 a[28:29], v231 offset:57344
    ds_read_b64_tr_b16 a[30:31], v231 offset:61440
    v_mfma_f32_16x16x32_bf16 v[0:3], v[192:195], v[176:179], v[0:3]
    s_waitcnt vmcnt(16)
    buffer_load_dwordx4 v[96:99], v241, s[12:15], s83 offen offset:0 sc1
    v_mfma_f32_16x16x32_bf16 v[0:3], a[0:3], v[184:187], v[0:3]
    buffer_load_dwordx4 v[100:103], v242, s[12:15], s83 offen offset:0 sc1
    v_mfma_f32_16x16x32_bf16 v[4:7], v[192:195], v[180:183], v[4:7]
    s_add_u32 s83, s83, 4096
    v_mfma_f32_16x16x32_bf16 v[4:7], a[0:3], v[188:191], v[4:7]
    s_waitcnt vmcnt(10) lgkmcnt(0)
    s_barrier
    v_mfma_f32_16x16x32_bf16 v[8:11], v[196:199], v[176:179], v[8:11]
    s_add_u32 m0, s57, 114688
    v_add_u32 v224, 0x10000, v224
    v_mfma_f32_16x16x32_bf16 v[8:11], a[4:7], v[184:187], v[8:11]
    buffer_load_dwordx4 v243, s[24:27], s95 offen offset:0 sc1 lds
    v_mfma_f32_16x16x32_bf16 v[12:15], v[196:199], v[180:183], v[12:15]
    buffer_load_dwordx4 v[104:107], v241, s[12:15], s83 offen offset:0 sc1
    v_mfma_f32_16x16x32_bf16 v[12:15], a[4:7], v[188:191], v[12:15]
    ds_read_b64_tr_b16 v[192:193], v224 offset:0
    ds_read_b64_tr_b16 v[194:195], v224 offset:4096
    v_mfma_f32_16x16x32_bf16 v[16:19], v[200:203], v[176:179], v[16:19]
    ds_read_b64_tr_b16 a[0:1], v224 offset:8192
    ds_read_b64_tr_b16 a[2:3], v224 offset:12288
    v_mfma_f32_16x16x32_bf16 v[16:19], a[8:11], v[184:187], v[16:19]
    buffer_load_dwordx4 v244, s[24:27], s95 offen offset:1024 sc1 lds
    v_mfma_f32_16x16x32_bf16 v[20:23], v[200:203], v[180:183], v[20:23]
    s_add_u32 s95, s95, 32768
    s_add_u32 m0, s57, 122880
    v_add_u32 v225, 0x10000, v225
    v_mfma_f32_16x16x32_bf16 v[20:23], a[8:11], v[188:191], v[20:23]
    ds_read_b64_tr_b16 v[196:197], v225 offset:0
    buffer_load_dwordx4 v[108:111], v242, s[12:15], s83 offen offset:0 sc1
    v_mfma_f32_16x16x32_bf16 v[24:27], v[204:207], v[176:179], v[24:27]
    s_add_u32 s83, s83, 4096
    ds_read_b64_tr_b16 v[198:199], v225 offset:4096
    ds_read_b64_tr_b16 a[4:5], v225 offset:8192
    ds_read_b64_tr_b16 a[6:7], v225 offset:12288
    v_mfma_f32_16x16x32_bf16 v[24:27], a[12:15], v[184:187], v[24:27]
    buffer_load_dwordx4 v243, s[24:27], s95 offen offset:0 sc1 lds
    v_mfma_f32_16x16x32_bf16 v[28:31], v[204:207], v[180:183], v[28:31]
    v_add_u32 v226, 0x10000, v226
    v_mfma_f32_16x16x32_bf16 v[28:31], a[12:15], v[188:191], v[28:31]
    ds_read_b64_tr_b16 v[200:201], v226 offset:0
    ds_read_b64_tr_b16 v[202:203], v226 offset:4096
    v_mfma_f32_16x16x32_bf16 v[32:35], v[208:211], v[176:179], v[32:35]
    ds_read_b64_tr_b16 a[8:9], v226 offset:8192
    ds_read_b64_tr_b16 a[10:11], v226 offset:12288
    v_mfma_f32_16x16x32_bf16 v[32:35], a[16:19], v[184:187], v[32:35]
    buffer_load_dwordx4 v244, s[24:27], s95 offen offset:1024 sc1 lds
    v_mfma_f32_16x16x32_bf16 v[36:39], v[208:211], v[180:183], v[36:39]
    v_add_u32 v227, 0x10000, v227
    v_mfma_f32_16x16x32_bf16 v[36:39], a[16:19], v[188:191], v[36:39]
    ds_read_b64_tr_b16 v[204:205], v227 offset:0
    ds_read_b64_tr_b16 v[206:207], v227 offset:4096
    v_mfma_f32_16x16x32_bf16 v[40:43], v[212:215], v[176:179], v[40:43]
    ds_read_b64_tr_b16 a[12:13], v227 offset:8192
    ds_read_b64_tr_b16 a[14:15], v227 offset:12288
    v_mfma_f32_16x16x32_bf16 v[40:43], a[20:23], v[184:187], v[40:43]
    v_add_u32 v228, 0x10000, v228
    v_mfma_f32_16x16x32_bf16 v[44:47], v[212:215], v[180:183], v[44:47]
    ds_read_b64_tr_b16 v[208:209], v228 offset:0
    ds_read_b64_tr_b16 v[210:211], v228 offset:4096
    v_mfma_f32_16x16x32_bf16 v[44:47], a[20:23], v[188:191], v[44:47]
    s_add_u32 s95, s95, 32768
    ds_read_b64_tr_b16 a[16:17], v228 offset:8192
    v_mfma_f32_16x16x32_bf16 v[48:51], v[216:219], v[176:179], v[48:51]
    ds_read_b64_tr_b16 a[18:19], v228 offset:12288
    v_add_u32 v229, 0x10000, v229
    v_mfma_f32_16x16x32_bf16 v[48:51], a[24:27], v[184:187], v[48:51]
    ds_read_b64_tr_b16 v[212:213], v229 offset:0
    ds_read_b64_tr_b16 v[214:215], v229 offset:4096
    v_mfma_f32_16x16x32_bf16 v[52:55], v[216:219], v[180:183], v[52:55]
    ds_read_b64_tr_b16 a[20:21], v229 offset:8192
    ds_read_b64_tr_b16 a[22:23], v229 offset:12288
    v_mfma_f32_16x16x32_bf16 v[52:55], a[24:27], v[188:191], v[52:55]
    v_add_u32 v230, 0x10000, v230
    v_mfma_f32_16x16x32_bf16 v[56:59], v[220:223], v[176:179], v[56:59]
    ds_read_b64_tr_b16 v[216:217], v230 offset:0
    ds_read_b64_tr_b16 v[218:219], v230 offset:4096
    v_mfma_f32_16x16x32_bf16 v[56:59], a[28:31], v[184:187], v[56:59]
    ds_read_b64_tr_b16 a[24:25], v230 offset:8192
    v_mfma_f32_16x16x32_bf16 v[60:63], v[220:223], v[180:183], v[60:63]
    ds_read_b64_tr_b16 a[26:27], v230 offset:12288
    v_mfma_f32_16x16x32_bf16 v[60:63], a[28:31], v[188:191], v[60:63]
    s_waitcnt lgkmcnt(12)
    s_add_u32 m0, s57, 0
    v_add_u32 v231, 0x10000, v231
    ds_read_b64_tr_b16 v[220:221], v231 offset:0
    ds_read_b64_tr_b16 v[222:223], v231 offset:4096
    ds_read_b64_tr_b16 a[28:29], v231 offset:8192
    ds_read_b64_tr_b16 a[30:31], v231 offset:12288
    v_mfma_f32_16x16x32_bf16 v[0:3], v[192:195], v[64:67], v[0:3]
    buffer_load_dwordx4 v243, s[24:27], s95 offen offset:0 sc1 lds
    v_mfma_f32_16x16x32_bf16 v[0:3], a[0:3], v[72:75], v[0:3]
    v_mfma_f32_16x16x32_bf16 v[4:7], v[192:195], v[68:71], v[4:7]
    buffer_load_dwordx4 v[112:115], v241, s[12:15], s83 offen offset:0 sc1
    v_mfma_f32_16x16x32_bf16 v[4:7], a[0:3], v[76:79], v[4:7]
    ds_read_b64_tr_b16 v[192:193], v224 offset:16384
    ds_read_b64_tr_b16 v[194:195], v224 offset:20480
    v_mfma_f32_16x16x32_bf16 v[8:11], v[196:199], v[64:67], v[8:11]
    buffer_load_dwordx4 v244, s[24:27], s95 offen offset:1024 sc1 lds
    v_mfma_f32_16x16x32_bf16 v[8:11], a[4:7], v[72:75], v[8:11]
    s_add_u32 s95, s95, 32768
    v_mfma_f32_16x16x32_bf16 v[12:15], v[196:199], v[68:71], v[12:15]
    buffer_load_dwordx4 v[116:119], v242, s[12:15], s83 offen offset:0 sc1
    v_mfma_f32_16x16x32_bf16 v[12:15], a[4:7], v[76:79], v[12:15]
    s_add_u32 m0, s57, 8192
    ds_read_b64_tr_b16 a[0:1], v224 offset:24576
    ds_read_b64_tr_b16 a[2:3], v224 offset:28672
    v_mfma_f32_16x16x32_bf16 v[16:19], v[200:203], v[64:67], v[16:19]
    buffer_load_dwordx4 v243, s[24:27], s95 offen offset:0 sc1 lds
    v_mfma_f32_16x16x32_bf16 v[16:19], a[8:11], v[72:75], v[16:19]
    s_add_u32 s83, s83, 4096
    ds_read_b64_tr_b16 v[196:197], v225 offset:16384
    ds_read_b64_tr_b16 v[198:199], v225 offset:20480
    v_mfma_f32_16x16x32_bf16 v[20:23], v[200:203], v[68:71], v[20:23]
    ds_read_b64_tr_b16 a[4:5], v225 offset:24576
    ds_read_b64_tr_b16 a[6:7], v225 offset:28672
    v_mfma_f32_16x16x32_bf16 v[20:23], a[8:11], v[76:79], v[20:23]
    ds_read_b64_tr_b16 v[200:201], v226 offset:16384
    ds_read_b64_tr_b16 v[202:203], v226 offset:20480
    v_mfma_f32_16x16x32_bf16 v[24:27], v[204:207], v[64:67], v[24:27]
    buffer_load_dwordx4 v244, s[24:27], s95 offen offset:1024 sc1 lds
    v_mfma_f32_16x16x32_bf16 v[24:27], a[12:15], v[72:75], v[24:27]
    buffer_load_dwordx4 v[120:123], v241, s[12:15], s83 offen offset:0 sc1
    v_mfma_f32_16x16x32_bf16 v[28:31], v[204:207], v[68:71], v[28:31]
    s_add_u32 s95, s95, 32768
    ds_read_b64_tr_b16 a[8:9], v226 offset:24576
    ds_read_b64_tr_b16 a[10:11], v226 offset:28672
    v_mfma_f32_16x16x32_bf16 v[28:31], a[12:15], v[76:79], v[28:31]
    s_waitcnt lgkmcnt(12)
    ds_read_b64_tr_b16 v[204:205], v227 offset:16384
    ds_read_b64_tr_b16 v[206:207], v227 offset:20480
    v_mfma_f32_16x16x32_bf16 v[32:35], v[208:211], v[64:67], v[32:35]
    ds_read_b64_tr_b16 a[12:13], v227 offset:24576
    ds_read_b64_tr_b16 a[14:15], v227 offset:28672
    v_mfma_f32_16x16x32_bf16 v[32:35], a[16:19], v[72:75], v[32:35]
    buffer_load_dwordx4 v[124:127], v242, s[12:15], s83 offen offset:0 sc1
    v_mfma_f32_16x16x32_bf16 v[36:39], v[208:211], v[68:71], v[36:39]
    v_mfma_f32_16x16x32_bf16 v[36:39], a[16:19], v[76:79], v[36:39]
    ds_read_b64_tr_b16 v[208:209], v228 offset:16384
    ds_read_b64_tr_b16 v[210:211], v228 offset:20480
    v_mfma_f32_16x16x32_bf16 v[40:43], v[212:215], v[64:67], v[40:43]
    v_mfma_f32_16x16x32_bf16 v[40:43], a[20:23], v[72:75], v[40:43]
    s_add_u32 s83, s83, 4096
    ds_read_b64_tr_b16 a[16:17], v228 offset:24576
    v_mfma_f32_16x16x32_bf16 v[44:47], v[212:215], v[68:71], v[44:47]
    v_mfma_f32_16x16x32_bf16 v[44:47], a[20:23], v[76:79], v[44:47]
    ds_read_b64_tr_b16 a[18:19], v228 offset:28672
    v_mfma_f32_16x16x32_bf16 v[48:51], v[216:219], v[64:67], v[48:51]
    v_mfma_f32_16x16x32_bf16 v[48:51], a[24:27], v[72:75], v[48:51]
    ds_read_b64_tr_b16 v[212:213], v229 offset:16384
    ds_read_b64_tr_b16 v[214:215], v229 offset:20480
    v_mfma_f32_16x16x32_bf16 v[52:55], v[216:219], v[68:71], v[52:55]
    ds_read_b64_tr_b16 a[20:21], v229 offset:24576
    ds_read_b64_tr_b16 a[22:23], v229 offset:28672
    v_mfma_f32_16x16x32_bf16 v[52:55], a[24:27], v[76:79], v[52:55]
    ds_read_b64_tr_b16 v[216:217], v230 offset:16384
    ds_read_b64_tr_b16 v[218:219], v230 offset:20480
    v_mfma_f32_16x16x32_bf16 v[56:59], v[220:223], v[64:67], v[56:59]
    v_mfma_f32_16x16x32_bf16 v[56:59], a[28:31], v[72:75], v[56:59]
    v_mfma_f32_16x16x32_bf16 v[60:63], v[220:223], v[68:71], v[60:63]
    ds_read_b64_tr_b16 a[24:25], v230 offset:24576
    ds_read_b64_tr_b16 a[26:27], v230 offset:28672
    v_mfma_f32_16x16x32_bf16 v[60:63], a[28:31], v[76:79], v[60:63]
    s_waitcnt vmcnt(20) lgkmcnt(12)
    ds_read_b64_tr_b16 v[220:221], v231 offset:16384
    ds_read_b64_tr_b16 v[222:223], v231 offset:20480
    ds_read_b64_tr_b16 a[28:29], v231 offset:24576
    ds_read_b64_tr_b16 a[30:31], v231 offset:28672
    v_mfma_f32_16x16x32_bf16 v[0:3], v[192:195], v[80:83], v[0:3]
    s_waitcnt vmcnt(16)
    buffer_load_dwordx4 v[128:131], v241, s[12:15], s83 offen offset:0 sc1
    v_mfma_f32_16x16x32_bf16 v[0:3], a[0:3], v[88:91], v[0:3]
    v_mfma_f32_16x16x32_bf16 v[4:7], v[192:195], v[84:87], v[4:7]
    buffer_load_dwordx4 v[132:135], v242, s[12:15], s83 offen offset:0 sc1
    v_mfma_f32_16x16x32_bf16 v[4:7], a[0:3], v[92:95], v[4:7]
    s_waitcnt vmcnt(10) lgkmcnt(0)
    s_barrier
    s_add_u32 s83, s83, 4096
    v_mfma_f32_16x16x32_bf16 v[8:11], v[196:199], v[80:83], v[8:11]
    s_add_u32 m0, s57, 16384
    ds_read_b64_tr_b16 v[192:193], v224 offset:32768
    ds_read_b64_tr_b16 v[194:195], v224 offset:36864
    v_mfma_f32_16x16x32_bf16 v[8:11], a[4:7], v[88:91], v[8:11]
    buffer_load_dwordx4 v243, s[24:27], s95 offen offset:0 sc1 lds
    v_mfma_f32_16x16x32_bf16 v[12:15], v[196:199], v[84:87], v[12:15]
    buffer_load_dwordx4 v[136:139], v241, s[12:15], s83 offen offset:0 sc1
    v_mfma_f32_16x16x32_bf16 v[12:15], a[4:7], v[92:95], v[12:15]
    ds_read_b64_tr_b16 a[0:1], v224 offset:40960
    ds_read_b64_tr_b16 a[2:3], v224 offset:45056
    v_mfma_f32_16x16x32_bf16 v[16:19], v[200:203], v[80:83], v[16:19]
    ds_read_b64_tr_b16 v[196:197], v225 offset:32768
    ds_read_b64_tr_b16 v[198:199], v225 offset:36864
    v_mfma_f32_16x16x32_bf16 v[16:19], a[8:11], v[88:91], v[16:19]
    buffer_load_dwordx4 v244, s[24:27], s95 offen offset:1024 sc1 lds
    v_mfma_f32_16x16x32_bf16 v[20:23], v[200:203], v[84:87], v[20:23]
    s_add_u32 s95, s95, 32768
    s_add_u32 m0, s57, 24576
    ds_read_b64_tr_b16 a[4:5], v225 offset:40960
    v_mfma_f32_16x16x32_bf16 v[20:23], a[8:11], v[92:95], v[20:23]
    buffer_load_dwordx4 v[140:143], v242, s[12:15], s83 offen offset:0 sc1
    v_mfma_f32_16x16x32_bf16 v[24:27], v[204:207], v[80:83], v[24:27]
    s_add_u32 s83, s83, 4096
    ds_read_b64_tr_b16 a[6:7], v225 offset:45056
    ds_read_b64_tr_b16 v[200:201], v226 offset:32768
    v_mfma_f32_16x16x32_bf16 v[24:27], a[12:15], v[88:91], v[24:27]
    buffer_load_dwordx4 v243, s[24:27], s95 offen offset:0 sc1 lds
    v_mfma_f32_16x16x32_bf16 v[28:31], v[204:207], v[84:87], v[28:31]
    ds_read_b64_tr_b16 v[202:203], v226 offset:36864
    ds_read_b64_tr_b16 a[8:9], v226 offset:40960
    v_mfma_f32_16x16x32_bf16 v[28:31], a[12:15], v[92:95], v[28:31]
    ds_read_b64_tr_b16 a[10:11], v226 offset:45056
    ds_read_b64_tr_b16 v[204:205], v227 offset:32768
    v_mfma_f32_16x16x32_bf16 v[32:35], v[208:211], v[80:83], v[32:35]
    v_mfma_f32_16x16x32_bf16 v[32:35], a[16:19], v[88:91], v[32:35]
    buffer_load_dwordx4 v244, s[24:27], s95 offen offset:1024 sc1 lds
    v_mfma_f32_16x16x32_bf16 v[36:39], v[208:211], v[84:87], v[36:39]
    ds_read_b64_tr_b16 v[206:207], v227 offset:36864
    ds_read_b64_tr_b16 a[12:13], v227 offset:40960
    v_mfma_f32_16x16x32_bf16 v[36:39], a[16:19], v[92:95], v[36:39]
    ds_read_b64_tr_b16 a[14:15], v227 offset:45056
    ds_read_b64_tr_b16 v[208:209], v228 offset:32768
    v_mfma_f32_16x16x32_bf16 v[40:43], v[212:215], v[80:83], v[40:43]
    s_add_u32 s95, s95, 32768
    ds_read_b64_tr_b16 v[210:211], v228 offset:36864
    ds_read_b64_tr_b16 a[16:17], v228 offset:40960
    v_mfma_f32_16x16x32_bf16 v[40:43], a[20:23], v[88:91], v[40:43]
    v_mfma_f32_16x16x32_bf16 v[44:47], v[212:215], v[84:87], v[44:47]
    ds_read_b64_tr_b16 a[18:19], v228 offset:45056
    v_mfma_f32_16x16x32_bf16 v[44:47], a[20:23], v[92:95], v[44:47]
    ds_read_b64_tr_b16 v[212:213], v229 offset:32768
    ds_read_b64_tr_b16 v[214:215], v229 offset:36864
    v_mfma_f32_16x16x32_bf16 v[48:51], v[216:219], v[80:83], v[48:51]
    ds_read_b64_tr_b16 a[20:21], v229 offset:40960
    ds_read_b64_tr_b16 a[22:23], v229 offset:45056
    v_mfma_f32_16x16x32_bf16 v[48:51], a[24:27], v[88:91], v[48:51]
    v_mfma_f32_16x16x32_bf16 v[52:55], v[216:219], v[84:87], v[52:55]
    v_mfma_f32_16x16x32_bf16 v[52:55], a[24:27], v[92:95], v[52:55]
    v_mfma_f32_16x16x32_bf16 v[56:59], v[220:223], v[80:83], v[56:59]
    ds_read_b64_tr_b16 v[216:217], v230 offset:32768
    ds_read_b64_tr_b16 v[218:219], v230 offset:36864
    v_mfma_f32_16x16x32_bf16 v[56:59], a[28:31], v[88:91], v[56:59]
    ds_read_b64_tr_b16 a[24:25], v230 offset:40960
    v_mfma_f32_16x16x32_bf16 v[60:63], v[220:223], v[84:87], v[60:63]
    ds_read_b64_tr_b16 a[26:27], v230 offset:45056
    v_mfma_f32_16x16x32_bf16 v[60:63], a[28:31], v[92:95], v[60:63]
    s_waitcnt lgkmcnt(12)
    s_add_u32 m0, s57, 32768
    ds_read_b64_tr_b16 v[220:221], v231 offset:32768
    ds_read_b64_tr_b16 v[222:223], v231 offset:36864
    ds_read_b64_tr_b16 a[28:29], v231 offset:40960
    ds_read_b64_tr_b16 a[30:31], v231 offset:45056
    v_mfma_f32_16x16x32_bf16 v[0:3], v[192:195], v[96:99], v[0:3]
    buffer_load_dwordx4 v243, s[24:27], s95 offen offset:0 sc1 lds
    v_mfma_f32_16x16x32_bf16 v[0:3], a[0:3], v[104:107], v[0:3]
    v_mfma_f32_16x16x32_bf16 v[4:7], v[192:195], v[100:103], v[4:7]
    buffer_load_dwordx4 v[144:147], v241, s[12:15], s83 offen offset:0 sc1
    v_mfma_f32_16x16x32_bf16 v[4:7], a[0:3], v[108:111], v[4:7]
    ds_read_b64_tr_b16 v[192:193], v224 offset:49152
    ds_read_b64_tr_b16 v[194:195], v224 offset:53248
    v_mfma_f32_16x16x32_bf16 v[8:11], v[196:199], v[96:99], v[8:11]
    buffer_load_dwordx4 v244, s[24:27], s95 offen offset:1024 sc1 lds
    v_mfma_f32_16x16x32_bf16 v[8:11], a[4:7], v[104:107], v[8:11]
    s_add_u32 s95, s95, 32768
    ds_read_b64_tr_b16 a[0:1], v224 offset:57344
    v_mfma_f32_16x16x32_bf16 v[12:15], v[196:199], v[100:103], v[12:15]
    buffer_load_dwordx4 v[148:151], v242, s[12:15], s83 offen offset:0 sc1
    v_mfma_f32_16x16x32_bf16 v[12:15], a[4:7], v[108:111], v[12:15]
    s_add_u32 m0, s57, 40960
    s_add_u32 s83, s83, 4096
    ds_read_b64_tr_b16 a[2:3], v224 offset:61440
    v_mfma_f32_16x16x32_bf16 v[16:19], v[200:203], v[96:99], v[16:19]
    buffer_load_dwordx4 v243, s[24:27], s95 offen offset:0 sc1 lds
    v_mfma_f32_16x16x32_bf16 v[16:19], a[8:11], v[104:107], v[16:19]
    ds_read_b64_tr_b16 v[196:197], v225 offset:49152
    ds_read_b64_tr_b16 v[198:199], v225 offset:53248
    v_mfma_f32_16x16x32_bf16 v[20:23], v[200:203], v[100:103], v[20:23]
    ds_read_b64_tr_b16 a[4:5], v225 offset:57344
    ds_read_b64_tr_b16 a[6:7], v225 offset:61440
    v_mfma_f32_16x16x32_bf16 v[20:23], a[8:11], v[108:111], v[20:23]
    ds_read_b64_tr_b16 v[200:201], v226 offset:49152
    ds_read_b64_tr_b16 v[202:203], v226 offset:53248
    v_mfma_f32_16x16x32_bf16 v[24:27], v[204:207], v[96:99], v[24:27]
    buffer_load_dwordx4 v244, s[24:27], s95 offen offset:1024 sc1 lds
    v_mfma_f32_16x16x32_bf16 v[24:27], a[12:15], v[104:107], v[24:27]
    buffer_load_dwordx4 v[152:155], v241, s[12:15], s83 offen offset:0 sc1
    v_mfma_f32_16x16x32_bf16 v[28:31], v[204:207], v[100:103], v[28:31]
    ds_read_b64_tr_b16 a[8:9], v226 offset:57344
    ds_read_b64_tr_b16 a[10:11], v226 offset:61440
    v_mfma_f32_16x16x32_bf16 v[28:31], a[12:15], v[108:111], v[28:31]
    s_waitcnt lgkmcnt(12)
    ds_read_b64_tr_b16 v[204:205], v227 offset:49152
    ds_read_b64_tr_b16 v[206:207], v227 offset:53248
    v_mfma_f32_16x16x32_bf16 v[32:35], v[208:211], v[96:99], v[32:35]
    ds_read_b64_tr_b16 a[12:13], v227 offset:57344
    ds_read_b64_tr_b16 a[14:15], v227 offset:61440
    v_mfma_f32_16x16x32_bf16 v[32:35], a[16:19], v[104:107], v[32:35]
    buffer_load_dwordx4 v[156:159], v242, s[12:15], s83 offen offset:0 sc1
    v_mfma_f32_16x16x32_bf16 v[36:39], v[208:211], v[100:103], v[36:39]
    v_mfma_f32_16x16x32_bf16 v[36:39], a[16:19], v[108:111], v[36:39]
    s_add_u32 s95, s95, 32768
    ds_read_b64_tr_b16 v[208:209], v228 offset:49152
    ds_read_b64_tr_b16 v[210:211], v228 offset:53248
    v_mfma_f32_16x16x32_bf16 v[40:43], v[212:215], v[96:99], v[40:43]
    s_add_u32 s83, s83, 4096
    ds_read_b64_tr_b16 a[16:17], v228 offset:57344
    ds_read_b64_tr_b16 a[18:19], v228 offset:61440
    v_mfma_f32_16x16x32_bf16 v[40:43], a[20:23], v[104:107], v[40:43]
    v_mfma_f32_16x16x32_bf16 v[44:47], v[212:215], v[100:103], v[44:47]
    v_mfma_f32_16x16x32_bf16 v[44:47], a[20:23], v[108:111], v[44:47]
    ds_read_b64_tr_b16 v[212:213], v229 offset:49152
    ds_read_b64_tr_b16 v[214:215], v229 offset:53248
    v_mfma_f32_16x16x32_bf16 v[48:51], v[216:219], v[96:99], v[48:51]
    ds_read_b64_tr_b16 a[20:21], v229 offset:57344
    ds_read_b64_tr_b16 a[22:23], v229 offset:61440
    v_mfma_f32_16x16x32_bf16 v[48:51], a[24:27], v[104:107], v[48:51]
    v_mfma_f32_16x16x32_bf16 v[52:55], v[216:219], v[100:103], v[52:55]
    v_mfma_f32_16x16x32_bf16 v[52:55], a[24:27], v[108:111], v[52:55]
    ds_read_b64_tr_b16 v[216:217], v230 offset:49152
    ds_read_b64_tr_b16 v[218:219], v230 offset:53248
    v_mfma_f32_16x16x32_bf16 v[56:59], v[220:223], v[96:99], v[56:59]
    ds_read_b64_tr_b16 a[24:25], v230 offset:57344
    ds_read_b64_tr_b16 a[26:27], v230 offset:61440
    v_mfma_f32_16x16x32_bf16 v[56:59], a[28:31], v[104:107], v[56:59]
    v_mfma_f32_16x16x32_bf16 v[60:63], v[220:223], v[100:103], v[60:63]
    v_mfma_f32_16x16x32_bf16 v[60:63], a[28:31], v[108:111], v[60:63]
    s_waitcnt vmcnt(20) lgkmcnt(12)
    ds_read_b64_tr_b16 v[220:221], v231 offset:49152
    ds_read_b64_tr_b16 v[222:223], v231 offset:53248
    ds_read_b64_tr_b16 a[28:29], v231 offset:57344
    ds_read_b64_tr_b16 a[30:31], v231 offset:61440
    v_mfma_f32_16x16x32_bf16 v[0:3], v[192:195], v[112:115], v[0:3]
    s_waitcnt vmcnt(16)
    buffer_load_dwordx4 v[160:163], v241, s[12:15], s83 offen offset:0 sc1
    v_mfma_f32_16x16x32_bf16 v[0:3], a[0:3], v[120:123], v[0:3]
    buffer_load_dwordx4 v[164:167], v242, s[12:15], s83 offen offset:0 sc1
    v_mfma_f32_16x16x32_bf16 v[4:7], v[192:195], v[116:119], v[4:7]
    v_mfma_f32_16x16x32_bf16 v[4:7], a[0:3], v[124:127], v[4:7]
    s_waitcnt vmcnt(10) lgkmcnt(0)
    s_barrier
    v_mfma_f32_16x16x32_bf16 v[8:11], v[196:199], v[112:115], v[8:11]
    s_add_u32 m0, s57, 49152
    s_add_u32 s83, s83, 4096
    v_subrev_u32 v224, 0x10000, v224
    v_mfma_f32_16x16x32_bf16 v[8:11], a[4:7], v[120:123], v[8:11]
    buffer_load_dwordx4 v243, s[24:27], s95 offen offset:0 sc1 lds
    v_mfma_f32_16x16x32_bf16 v[12:15], v[196:199], v[116:119], v[12:15]
    buffer_load_dwordx4 v[168:171], v241, s[12:15], s83 offen offset:0 sc1
    v_mfma_f32_16x16x32_bf16 v[12:15], a[4:7], v[124:127], v[12:15]
    ds_read_b64_tr_b16 v[192:193], v224 offset:0
    ds_read_b64_tr_b16 v[194:195], v224 offset:4096
    v_mfma_f32_16x16x32_bf16 v[16:19], v[200:203], v[112:115], v[16:19]
    ds_read_b64_tr_b16 a[0:1], v224 offset:8192
    ds_read_b64_tr_b16 a[2:3], v224 offset:12288
    v_mfma_f32_16x16x32_bf16 v[16:19], a[8:11], v[120:123], v[16:19]
    buffer_load_dwordx4 v244, s[24:27], s95 offen offset:1024 sc1 lds
    v_mfma_f32_16x16x32_bf16 v[20:23], v[200:203], v[116:119], v[20:23]
    s_add_u32 s95, s95, 32768
    s_add_u32 m0, s57, 57344
    v_subrev_u32 v225, 0x10000, v225
    v_mfma_f32_16x16x32_bf16 v[20:23], a[8:11], v[124:127], v[20:23]
    ds_read_b64_tr_b16 v[196:197], v225 offset:0
    buffer_load_dwordx4 v[172:175], v242, s[12:15], s83 offen offset:0 sc1
    v_mfma_f32_16x16x32_bf16 v[24:27], v[204:207], v[112:115], v[24:27]
    ds_read_b64_tr_b16 v[198:199], v225 offset:4096
    ds_read_b64_tr_b16 a[4:5], v225 offset:8192
    ds_read_b64_tr_b16 a[6:7], v225 offset:12288
    v_mfma_f32_16x16x32_bf16 v[24:27], a[12:15], v[120:123], v[24:27]
    buffer_load_dwordx4 v243, s[24:27], s95 offen offset:0 sc1 lds
    v_mfma_f32_16x16x32_bf16 v[28:31], v[204:207], v[116:119], v[28:31]
    s_add_u32 s83, s83, 4096
    v_subrev_u32 v226, 0x10000, v226
    v_mfma_f32_16x16x32_bf16 v[28:31], a[12:15], v[124:127], v[28:31]
    ds_read_b64_tr_b16 v[200:201], v226 offset:0
    ds_read_b64_tr_b16 v[202:203], v226 offset:4096
    v_mfma_f32_16x16x32_bf16 v[32:35], v[208:211], v[112:115], v[32:35]
    ds_read_b64_tr_b16 a[8:9], v226 offset:8192
    ds_read_b64_tr_b16 a[10:11], v226 offset:12288
    v_mfma_f32_16x16x32_bf16 v[32:35], a[16:19], v[120:123], v[32:35]
    buffer_load_dwordx4 v244, s[24:27], s95 offen offset:1024 sc1 lds
    v_mfma_f32_16x16x32_bf16 v[36:39], v[208:211], v[116:119], v[36:39]
    v_subrev_u32 v227, 0x10000, v227
    v_mfma_f32_16x16x32_bf16 v[36:39], a[16:19], v[124:127], v[36:39]
    ds_read_b64_tr_b16 v[204:205], v227 offset:0
    ds_read_b64_tr_b16 v[206:207], v227 offset:4096
    v_mfma_f32_16x16x32_bf16 v[40:43], v[212:215], v[112:115], v[40:43]
    ds_read_b64_tr_b16 a[12:13], v227 offset:8192
    ds_read_b64_tr_b16 a[14:15], v227 offset:12288
    v_mfma_f32_16x16x32_bf16 v[40:43], a[20:23], v[120:123], v[40:43]
    s_add_u32 s95, s95, 32768
    v_subrev_u32 v228, 0x10000, v228
    v_mfma_f32_16x16x32_bf16 v[44:47], v[212:215], v[116:119], v[44:47]
    ds_read_b64_tr_b16 v[208:209], v228 offset:0
    ds_read_b64_tr_b16 v[210:211], v228 offset:4096
    v_mfma_f32_16x16x32_bf16 v[44:47], a[20:23], v[124:127], v[44:47]
    ds_read_b64_tr_b16 a[16:17], v228 offset:8192
    v_mfma_f32_16x16x32_bf16 v[48:51], v[216:219], v[112:115], v[48:51]
    ds_read_b64_tr_b16 a[18:19], v228 offset:12288
    v_subrev_u32 v229, 0x10000, v229
    v_mfma_f32_16x16x32_bf16 v[48:51], a[24:27], v[120:123], v[48:51]
    ds_read_b64_tr_b16 v[212:213], v229 offset:0
    ds_read_b64_tr_b16 v[214:215], v229 offset:4096
    v_mfma_f32_16x16x32_bf16 v[52:55], v[216:219], v[116:119], v[52:55]
    ds_read_b64_tr_b16 a[20:21], v229 offset:8192
    ds_read_b64_tr_b16 a[22:23], v229 offset:12288
    v_mfma_f32_16x16x32_bf16 v[52:55], a[24:27], v[124:127], v[52:55]
    v_subrev_u32 v230, 0x10000, v230
    v_mfma_f32_16x16x32_bf16 v[56:59], v[220:223], v[112:115], v[56:59]
    ds_read_b64_tr_b16 v[216:217], v230 offset:0
    ds_read_b64_tr_b16 v[218:219], v230 offset:4096
    v_mfma_f32_16x16x32_bf16 v[56:59], a[28:31], v[120:123], v[56:59]
    ds_read_b64_tr_b16 a[24:25], v230 offset:8192
    ds_read_b64_tr_b16 a[26:27], v230 offset:12288
    v_mfma_f32_16x16x32_bf16 v[60:63], v[220:223], v[116:119], v[60:63]
    v_mfma_f32_16x16x32_bf16 v[60:63], a[28:31], v[124:127], v[60:63]
    s_waitcnt lgkmcnt(12)
    s_add_u32 m0, s57, 65536
    v_subrev_u32 v231, 0x10000, v231
    ds_read_b64_tr_b16 v[220:221], v231 offset:0
    ds_read_b64_tr_b16 v[222:223], v231 offset:4096
    ds_read_b64_tr_b16 a[28:29], v231 offset:8192
    ds_read_b64_tr_b16 a[30:31], v231 offset:12288
    v_mfma_f32_16x16x32_bf16 v[0:3], v[192:195], v[128:131], v[0:3]
    buffer_load_dwordx4 v243, s[24:27], s95 offen offset:0 sc1 lds
    v_mfma_f32_16x16x32_bf16 v[0:3], a[0:3], v[136:139], v[0:3]
    buffer_load_dwordx4 v[176:179], v241, s[12:15], s83 offen offset:0 sc1
    v_mfma_f32_16x16x32_bf16 v[4:7], v[192:195], v[132:135], v[4:7]
    v_mfma_f32_16x16x32_bf16 v[4:7], a[0:3], v[140:143], v[4:7]
    ds_read_b64_tr_b16 a[32:33], v224 offset:16384
    ds_read_b64_tr_b16 a[34:35], v224 offset:20480
    v_mfma_f32_16x16x32_bf16 v[8:11], v[196:199], v[128:131], v[8:11]
    buffer_load_dwordx4 v244, s[24:27], s95 offen offset:1024 sc1 lds
    v_mfma_f32_16x16x32_bf16 v[8:11], a[4:7], v[136:139], v[8:11]
    s_add_u32 s95, s95, 32768
    ds_read_b64_tr_b16 a[48:49], v224 offset:24576
    v_mfma_f32_16x16x32_bf16 v[12:15], v[196:199], v[132:135], v[12:15]
    buffer_load_dwordx4 v[180:183], v242, s[12:15], s83 offen offset:0 sc1
    v_mfma_f32_16x16x32_bf16 v[12:15], a[4:7], v[140:143], v[12:15]
    s_add_u32 m0, s57, 73728
    ds_read_b64_tr_b16 a[50:51], v224 offset:28672
    ds_read_b64_tr_b16 a[36:37], v225 offset:16384
    v_mfma_f32_16x16x32_bf16 v[16:19], v[200:203], v[128:131], v[16:19]
    buffer_load_dwordx4 v243, s[24:27], s95 offen offset:0 sc1 lds
    v_mfma_f32_16x16x32_bf16 v[16:19], a[8:11], v[136:139], v[16:19]
    ds_read_b64_tr_b16 a[38:39], v225 offset:20480
    v_mfma_f32_16x16x32_bf16 v[20:23], v[200:203], v[132:135], v[20:23]
    s_add_u32 s83, s83, 4096
    ds_read_b64_tr_b16 a[52:53], v225 offset:24576
    ds_read_b64_tr_b16 a[54:55], v225 offset:28672
    v_mfma_f32_16x16x32_bf16 v[20:23], a[8:11], v[140:143], v[20:23]
    ds_read_b64_tr_b16 a[40:41], v226 offset:16384
    ds_read_b64_tr_b16 a[42:43], v226 offset:20480
    v_mfma_f32_16x16x32_bf16 v[24:27], v[204:207], v[128:131], v[24:27]
    buffer_load_dwordx4 v244, s[24:27], s95 offen offset:1024 sc1 lds
    v_mfma_f32_16x16x32_bf16 v[24:27], a[12:15], v[136:139], v[24:27]
    buffer_load_dwordx4 v[184:187], v241, s[12:15], s83 offen offset:0 sc1
    v_mfma_f32_16x16x32_bf16 v[28:31], v[204:207], v[132:135], v[28:31]
    s_add_u32 s95, s95, 32768
    ds_read_b64_tr_b16 a[56:57], v226 offset:24576
    ds_read_b64_tr_b16 a[58:59], v226 offset:28672
    v_mfma_f32_16x16x32_bf16 v[28:31], a[12:15], v[140:143], v[28:31]
    s_waitcnt lgkmcnt(12)
    ds_read_b64_tr_b16 a[44:45], v227 offset:16384
    ds_read_b64_tr_b16 a[46:47], v227 offset:20480
    v_mfma_f32_16x16x32_bf16 v[32:35], v[208:211], v[128:131], v[32:35]
    ds_read_b64_tr_b16 a[60:61], v227 offset:24576
    ds_read_b64_tr_b16 a[62:63], v227 offset:28672
    v_mfma_f32_16x16x32_bf16 v[32:35], a[16:19], v[136:139], v[32:35]
    v_mfma_f32_16x16x32_bf16 v[36:39], v[208:211], v[132:135], v[36:39]
    buffer_load_dwordx4 v[188:191], v242, s[12:15], s83 offen offset:0 sc1
    v_mfma_f32_16x16x32_bf16 v[36:39], a[16:19], v[140:143], v[36:39]
    ds_read_b64_tr_b16 v[208:209], v228 offset:16384
    ds_read_b64_tr_b16 v[210:211], v228 offset:20480
    v_mfma_f32_16x16x32_bf16 v[40:43], v[212:215], v[128:131], v[40:43]
    ds_read_b64_tr_b16 a[16:17], v228 offset:24576
    ds_read_b64_tr_b16 a[18:19], v228 offset:28672
    v_mfma_f32_16x16x32_bf16 v[40:43], a[20:23], v[136:139], v[40:43]
    s_add_u32 s83, s83, 4096
    v_mfma_f32_16x16x32_bf16 v[44:47], v[212:215], v[132:135], v[44:47]
    v_mfma_f32_16x16x32_bf16 v[44:47], a[20:23], v[140:143], v[44:47]
    ds_read_b64_tr_b16 v[212:213], v229 offset:16384
    v_mfma_f32_16x16x32_bf16 v[48:51], v[216:219], v[128:131], v[48:51]
    ds_read_b64_tr_b16 v[214:215], v229 offset:20480
    ds_read_b64_tr_b16 a[20:21], v229 offset:24576
    v_mfma_f32_16x16x32_bf16 v[48:51], a[24:27], v[136:139], v[48:51]
    ds_read_b64_tr_b16 a[22:23], v229 offset:28672
    v_mfma_f32_16x16x32_bf16 v[52:55], v[216:219], v[132:135], v[52:55]
    v_mfma_f32_16x16x32_bf16 v[52:55], a[24:27], v[140:143], v[52:55]
    ds_read_b64_tr_b16 v[216:217], v230 offset:16384
    ds_read_b64_tr_b16 v[218:219], v230 offset:20480
    v_mfma_f32_16x16x32_bf16 v[56:59], v[220:223], v[128:131], v[56:59]
    ds_read_b64_tr_b16 a[24:25], v230 offset:24576
    ds_read_b64_tr_b16 a[26:27], v230 offset:28672
    v_mfma_f32_16x16x32_bf16 v[56:59], a[28:31], v[136:139], v[56:59]
    v_mfma_f32_16x16x32_bf16 v[60:63], v[220:223], v[132:135], v[60:63]
    v_mfma_f32_16x16x32_bf16 v[60:63], a[28:31], v[140:143], v[60:63]
    s_waitcnt vmcnt(20) lgkmcnt(12)
    ds_read_b64_tr_b16 v[220:221], v231 offset:16384
    ds_read_b64_tr_b16 v[222:223], v231 offset:20480
    ds_read_b64_tr_b16 a[28:29], v231 offset:24576
    ds_read_b64_tr_b16 a[30:31], v231 offset:28672
    v_mfma_f32_16x16x32_bf16 v[4:7], a[32:35], v[148:151], v[4:7]
    s_waitcnt vmcnt(16)
    buffer_load_dwordx4 v[64:67], v241, s[12:15], s83 offen offset:0 sc1
    v_mfma_f32_16x16x32_bf16 v[4:7], a[48:51], v[156:159], v[4:7]
    buffer_load_dwordx4 v[68:71], v242, s[12:15], s83 offen offset:0 sc1
    v_mfma_f32_16x16x32_bf16 v[12:15], a[36:39], v[148:151], v[12:15]
    s_add_u32 s83, s83, 4096
    v_mfma_f32_16x16x32_bf16 v[12:15], a[52:55], v[156:159], v[12:15]
    s_waitcnt vmcnt(10) lgkmcnt(0)
    s_barrier
    v_mfma_f32_16x16x32_bf16 v[20:23], a[40:43], v[148:151], v[20:23]
    s_add_u32 m0, s57, 81920
    ds_read_b64_tr_b16 a[64:65], v224 offset:32768
    v_mfma_f32_16x16x32_bf16 v[20:23], a[56:59], v[156:159], v[20:23]
    buffer_load_dwordx4 v243, s[24:27], s95 offen offset:0 sc1 lds
    v_mfma_f32_16x16x32_bf16 v[28:31], a[44:47], v[148:151], v[28:31]
    ds_read_b64_tr_b16 a[66:67], v224 offset:36864
    ds_read_b64_tr_b16 a[80:81], v224 offset:40960
    v_mfma_f32_16x16x32_bf16 v[28:31], a[60:63], v[156:159], v[28:31]
    ds_read_b64_tr_b16 a[82:83], v224 offset:45056
    ds_read_b64_tr_b16 a[68:69], v225 offset:32768
    v_mfma_f32_16x16x32_bf16 v[32:35], v[208:211], v[144:147], v[32:35]
    ds_read_b64_tr_b16 a[70:71], v225 offset:36864
    ds_read_b64_tr_b16 a[84:85], v225 offset:40960
    ds_read_b64_tr_b16 a[86:87], v225 offset:45056
    v_mfma_f32_16x16x32_bf16 v[32:35], a[16:19], v[152:155], v[32:35]
    ds_read_b64_tr_b16 a[72:73], v226 offset:32768
    buffer_load_dwordx4 v244, s[24:27], s95 offen offset:1024 sc1 lds
    v_mfma_f32_16x16x32_bf16 v[36:39], v[208:211], v[148:151], v[36:39]
    ds_read_b64_tr_b16 a[74:75], v226 offset:36864
    ds_read_b64_tr_b16 a[88:89], v226 offset:40960
    ds_read_b64_tr_b16 a[90:91], v226 offset:45056
    v_mfma_f32_16x16x32_bf16 v[36:39], a[16:19], v[156:159], v[36:39]
    s_add_u32 s95, s95, 32768
    ds_read_b64_tr_b16 a[76:77], v227 offset:32768
    ds_read_b64_tr_b16 a[78:79], v227 offset:36864
    v_mfma_f32_16x16x32_bf16 v[40:43], v[212:215], v[144:147], v[40:43]
    ds_read_b64_tr_b16 a[92:93], v227 offset:40960
    ds_read_b64_tr_b16 a[94:95], v227 offset:45056
    v_mfma_f32_16x16x32_bf16 v[40:43], a[20:23], v[152:155], v[40:43]
    ds_read_b64_tr_b16 v[208:209], v228 offset:32768
    buffer_load_dwordx4 v[72:75], v241, s[12:15], s83 offen offset:0 sc1
    v_mfma_f32_16x16x32_bf16 v[44:47], v[212:215], v[148:151], v[44:47]
    ds_read_b64_tr_b16 v[210:211], v228 offset:36864
    ds_read_b64_tr_b16 a[16:17], v228 offset:40960
    ds_read_b64_tr_b16 a[18:19], v228 offset:45056
    v_mfma_f32_16x16x32_bf16 v[44:47], a[20:23], v[156:159], v[44:47]
    ds_read_b64_tr_b16 v[212:213], v229 offset:32768
    ds_read_b64_tr_b16 v[214:215], v229 offset:36864
    v_mfma_f32_16x16x32_bf16 v[48:51], v[216:219], v[144:147], v[48:51]
    ds_read_b64_tr_b16 a[20:21], v229 offset:40960
    ds_read_b64_tr_b16 a[22:23], v229 offset:45056
    v_mfma_f32_16x16x32_bf16 v[48:51], a[24:27], v[152:155], v[48:51]
    buffer_load_dwordx4 v[76:79], v242, s[12:15], s83 offen offset:0 sc1
    v_mfma_f32_16x16x32_bf16 v[52:55], v[216:219], v[148:151], v[52:55]
    v_mfma_f32_16x16x32_bf16 v[52:55], a[24:27], v[156:159], v[52:55]
    s_add_u32 s83, s83, 4096
    ds_read_b64_tr_b16 v[216:217], v230 offset:32768
    ds_read_b64_tr_b16 v[218:219], v230 offset:36864
    v_mfma_f32_16x16x32_bf16 v[56:59], v[220:223], v[144:147], v[56:59]
    ds_read_b64_tr_b16 a[24:25], v230 offset:40960
    v_mfma_f32_16x16x32_bf16 v[56:59], a[28:31], v[152:155], v[56:59]
    v_mfma_f32_16x16x32_bf16 v[60:63], v[220:223], v[148:151], v[60:63]
    ds_read_b64_tr_b16 a[26:27], v230 offset:45056
    v_mfma_f32_16x16x32_bf16 v[60:63], a[28:31], v[156:159], v[60:63]
    s_waitcnt lgkmcnt(12)
    ds_read_b64_tr_b16 v[220:221], v231 offset:32768
    ds_read_b64_tr_b16 v[222:223], v231 offset:36864
    ds_read_b64_tr_b16 a[28:29], v231 offset:40960
    ds_read_b64_tr_b16 a[30:31], v231 offset:45056
    v_mfma_f32_16x16x32_bf16 v[4:7], a[64:67], v[164:167], v[4:7]
    buffer_load_dwordx4 v[80:83], v241, s[12:15], s83 offen offset:0 sc1
    v_mfma_f32_16x16x32_bf16 v[4:7], a[80:83], v[172:175], v[4:7]
    ds_read_b64_tr_b16 a[96:97], v224 offset:49152
    ds_read_b64_tr_b16 a[98:99], v224 offset:53248
    v_mfma_f32_16x16x32_bf16 v[12:15], a[68:71], v[164:167], v[12:15]
    ds_read_b64_tr_b16 a[112:113], v224 offset:57344
    ds_read_b64_tr_b16 a[114:115], v224 offset:61440
    v_mfma_f32_16x16x32_bf16 v[12:15], a[84:87], v[172:175], v[12:15]
    ds_read_b64_tr_b16 a[100:101], v225 offset:49152
    ds_read_b64_tr_b16 a[102:103], v225 offset:53248
    v_mfma_f32_16x16x32_bf16 v[20:23], a[72:75], v[164:167], v[20:23]
    buffer_load_dwordx4 v[84:87], v242, s[12:15], s83 offen offset:0 sc1
    v_mfma_f32_16x16x32_bf16 v[20:23], a[88:91], v[172:175], v[20:23]
    ds_read_b64_tr_b16 a[116:117], v225 offset:57344
    ds_read_b64_tr_b16 a[118:119], v225 offset:61440
    v_mfma_f32_16x16x32_bf16 v[28:31], a[76:79], v[164:167], v[28:31]
    s_add_u32 s83, s83, 4096
    ds_read_b64_tr_b16 a[104:105], v226 offset:49152
    ds_read_b64_tr_b16 a[106:107], v226 offset:53248
    v_mfma_f32_16x16x32_bf16 v[28:31], a[92:95], v[172:175], v[28:31]
    s_waitcnt lgkmcnt(10)
    ds_read_b64_tr_b16 a[120:121], v226 offset:57344
    ds_read_b64_tr_b16 a[122:123], v226 offset:61440
    v_mfma_f32_16x16x32_bf16 v[32:35], v[208:211], v[160:163], v[32:35]
    ds_read_b64_tr_b16 a[108:109], v227 offset:49152
    ds_read_b64_tr_b16 a[110:111], v227 offset:53248
    v_mfma_f32_16x16x32_bf16 v[32:35], a[16:19], v[168:171], v[32:35]
    ds_read_b64_tr_b16 a[124:125], v227 offset:57344
    ds_read_b64_tr_b16 a[126:127], v227 offset:61440
    v_mfma_f32_16x16x32_bf16 v[36:39], v[208:211], v[164:167], v[36:39]
    v_mfma_f32_16x16x32_bf16 v[36:39], a[16:19], v[172:175], v[36:39]
    ds_read_b64_tr_b16 v[208:209], v228 offset:49152
    ds_read_b64_tr_b16 v[210:211], v228 offset:53248
    v_mfma_f32_16x16x32_bf16 v[40:43], v[212:215], v[160:163], v[40:43]
    v_mfma_f32_16x16x32_bf16 v[40:43], a[20:23], v[168:171], v[40:43]
    ds_read_b64_tr_b16 a[16:17], v228 offset:57344
    ds_read_b64_tr_b16 a[18:19], v228 offset:61440
    v_mfma_f32_16x16x32_bf16 v[44:47], v[212:215], v[164:167], v[44:47]
    v_mfma_f32_16x16x32_bf16 v[44:47], a[20:23], v[172:175], v[44:47]
    ds_read_b64_tr_b16 v[212:213], v229 offset:49152
    v_mfma_f32_16x16x32_bf16 v[48:51], v[216:219], v[160:163], v[48:51]
    ds_read_b64_tr_b16 v[214:215], v229 offset:53248
    ds_read_b64_tr_b16 a[20:21], v229 offset:57344
    v_mfma_f32_16x16x32_bf16 v[48:51], a[24:27], v[168:171], v[48:51]
    v_mfma_f32_16x16x32_bf16 v[52:55], v[216:219], v[164:167], v[52:55]
    v_mfma_f32_16x16x32_bf16 v[52:55], a[24:27], v[172:175], v[52:55]
    ds_read_b64_tr_b16 a[22:23], v229 offset:61440
    ds_read_b64_tr_b16 v[216:217], v230 offset:49152
    v_mfma_f32_16x16x32_bf16 v[56:59], v[220:223], v[160:163], v[56:59]
    ds_read_b64_tr_b16 v[218:219], v230 offset:53248
    v_mfma_f32_16x16x32_bf16 v[56:59], a[28:31], v[168:171], v[56:59]
    ds_read_b64_tr_b16 a[24:25], v230 offset:57344
    ds_read_b64_tr_b16 a[26:27], v230 offset:61440
    v_mfma_f32_16x16x32_bf16 v[60:63], v[220:223], v[164:167], v[60:63]
    v_mfma_f32_16x16x32_bf16 v[60:63], a[28:31], v[172:175], v[60:63]
    s_waitcnt vmcnt(12) lgkmcnt(12)
    ds_read_b64_tr_b16 v[220:221], v231 offset:49152
    ds_read_b64_tr_b16 v[222:223], v231 offset:53248
    ds_read_b64_tr_b16 a[28:29], v231 offset:57344
    ds_read_b64_tr_b16 a[30:31], v231 offset:61440
    v_mfma_f32_16x16x32_bf16 v[4:7], a[96:99], v[180:183], v[4:7]
    s_waitcnt vmcnt(8)
    v_mfma_f32_16x16x32_bf16 v[4:7], a[112:115], v[188:191], v[4:7]
    v_mfma_f32_16x16x32_bf16 v[12:15], a[100:103], v[180:183], v[12:15]
    v_mfma_f32_16x16x32_bf16 v[12:15], a[116:119], v[188:191], v[12:15]
    s_waitcnt vmcnt(4) lgkmcnt(0)
    s_barrier
    v_mfma_f32_16x16x32_bf16 v[20:23], a[104:107], v[180:183], v[20:23]
    v_add_u32 v224, 0x10000, v224
    v_mfma_f32_16x16x32_bf16 v[20:23], a[120:123], v[188:191], v[20:23]
    ds_read_b64_tr_b16 a[128:129], v224 offset:0
    v_mfma_f32_16x16x32_bf16 v[28:31], a[108:111], v[180:183], v[28:31]
    ds_read_b64_tr_b16 a[130:131], v224 offset:4096
    ds_read_b64_tr_b16 a[144:145], v224 offset:8192
    v_mfma_f32_16x16x32_bf16 v[28:31], a[124:127], v[188:191], v[28:31]
    ds_read_b64_tr_b16 a[146:147], v224 offset:12288
    v_add_u32 v225, 0x10000, v225
    v_mfma_f32_16x16x32_bf16 v[32:35], v[208:211], v[176:179], v[32:35]
    ds_read_b64_tr_b16 a[132:133], v225 offset:0
    ds_read_b64_tr_b16 a[134:135], v225 offset:4096
    ds_read_b64_tr_b16 a[148:149], v225 offset:8192
    v_mfma_f32_16x16x32_bf16 v[32:35], a[16:19], v[184:187], v[32:35]
    ds_read_b64_tr_b16 a[150:151], v225 offset:12288
    v_add_u32 v226, 0x10000, v226
    v_mfma_f32_16x16x32_bf16 v[36:39], v[208:211], v[180:183], v[36:39]
    ds_read_b64_tr_b16 a[136:137], v226 offset:0
    ds_read_b64_tr_b16 a[138:139], v226 offset:4096
    ds_read_b64_tr_b16 a[152:153], v226 offset:8192
    ds_read_b64_tr_b16 a[154:155], v226 offset:12288
    v_mfma_f32_16x16x32_bf16 v[36:39], a[16:19], v[188:191], v[36:39]
    v_add_u32 v227, 0x10000, v227
    v_mfma_f32_16x16x32_bf16 v[40:43], v[212:215], v[176:179], v[40:43]
    ds_read_b64_tr_b16 a[140:141], v227 offset:0
    ds_read_b64_tr_b16 a[142:143], v227 offset:4096
    ds_read_b64_tr_b16 a[156:157], v227 offset:8192
    ds_read_b64_tr_b16 a[158:159], v227 offset:12288
    v_mfma_f32_16x16x32_bf16 v[40:43], a[20:23], v[184:187], v[40:43]
    v_add_u32 v228, 0x10000, v228
    v_mfma_f32_16x16x32_bf16 v[44:47], v[212:215], v[180:183], v[44:47]
    ds_read_b64_tr_b16 v[208:209], v228 offset:0
    ds_read_b64_tr_b16 v[210:211], v228 offset:4096
    v_mfma_f32_16x16x32_bf16 v[44:47], a[20:23], v[188:191], v[44:47]
    ds_read_b64_tr_b16 a[16:17], v228 offset:8192
    ds_read_b64_tr_b16 a[18:19], v228 offset:12288
    v_mfma_f32_16x16x32_bf16 v[48:51], v[216:219], v[176:179], v[48:51]
    v_add_u32 v229, 0x10000, v229
    v_mfma_f32_16x16x32_bf16 v[48:51], a[24:27], v[184:187], v[48:51]
    ds_read_b64_tr_b16 v[212:213], v229 offset:0
    ds_read_b64_tr_b16 v[214:215], v229 offset:4096
    v_mfma_f32_16x16x32_bf16 v[52:55], v[216:219], v[180:183], v[52:55]
    ds_read_b64_tr_b16 a[20:21], v229 offset:8192
    ds_read_b64_tr_b16 a[22:23], v229 offset:12288
    v_mfma_f32_16x16x32_bf16 v[52:55], a[24:27], v[188:191], v[52:55]
    v_add_u32 v230, 0x10000, v230
    v_mfma_f32_16x16x32_bf16 v[56:59], v[220:223], v[176:179], v[56:59]
    ds_read_b64_tr_b16 v[216:217], v230 offset:0
    ds_read_b64_tr_b16 v[218:219], v230 offset:4096
    v_mfma_f32_16x16x32_bf16 v[56:59], a[28:31], v[184:187], v[56:59]
    ds_read_b64_tr_b16 a[24:25], v230 offset:8192
    v_mfma_f32_16x16x32_bf16 v[60:63], v[220:223], v[180:183], v[60:63]
    ds_read_b64_tr_b16 a[26:27], v230 offset:12288
    v_mfma_f32_16x16x32_bf16 v[60:63], a[28:31], v[188:191], v[60:63]
    s_waitcnt lgkmcnt(12)
    v_add_u32 v231, 0x10000, v231
    ds_read_b64_tr_b16 v[220:221], v231 offset:0
    ds_read_b64_tr_b16 v[222:223], v231 offset:4096
    ds_read_b64_tr_b16 a[28:29], v231 offset:8192
    ds_read_b64_tr_b16 a[30:31], v231 offset:12288
    v_mfma_f32_16x16x32_bf16 v[4:7], a[128:131], v[68:71], v[4:7]
    s_waitcnt vmcnt(2)
    v_mfma_f32_16x16x32_bf16 v[4:7], a[144:147], v[76:79], v[4:7]
    v_mfma_f32_16x16x32_bf16 v[12:15], a[132:135], v[68:71], v[12:15]
    ds_read_b64_tr_b16 a[160:161], v224 offset:16384
    ds_read_b64_tr_b16 a[162:163], v224 offset:20480
    v_mfma_f32_16x16x32_bf16 v[12:15], a[148:151], v[76:79], v[12:15]
    v_mfma_f32_16x16x32_bf16 v[20:23], a[136:139], v[68:71], v[20:23]
    ds_read_b64_tr_b16 a[164:165], v225 offset:16384
    v_mfma_f32_16x16x32_bf16 v[20:23], a[152:155], v[76:79], v[20:23]
    ds_read_b64_tr_b16 a[166:167], v225 offset:20480
    v_mfma_f32_16x16x32_bf16 v[28:31], a[140:143], v[68:71], v[28:31]
    ds_read_b64_tr_b16 a[168:169], v226 offset:16384
    v_mfma_f32_16x16x32_bf16 v[28:31], a[156:159], v[76:79], v[28:31]
    s_waitcnt lgkmcnt(5)
    ds_read_b64_tr_b16 a[170:171], v226 offset:20480
    v_mfma_f32_16x16x32_bf16 v[32:35], v[208:211], v[64:67], v[32:35]
    ds_read_b64_tr_b16 a[172:173], v227 offset:16384
    ds_read_b64_tr_b16 a[174:175], v227 offset:20480
    v_mfma_f32_16x16x32_bf16 v[32:35], a[16:19], v[72:75], v[32:35]
    v_mfma_f32_16x16x32_bf16 v[36:39], v[208:211], v[68:71], v[36:39]
    v_mfma_f32_16x16x32_bf16 v[36:39], a[16:19], v[76:79], v[36:39]
    v_mfma_f32_16x16x32_bf16 v[40:43], v[212:215], v[64:67], v[40:43]
    ds_read_b64_tr_b16 v[208:209], v228 offset:16384
    ds_read_b64_tr_b16 v[210:211], v228 offset:20480
    v_mfma_f32_16x16x32_bf16 v[40:43], a[20:23], v[72:75], v[40:43]
    v_mfma_f32_16x16x32_bf16 v[44:47], v[212:215], v[68:71], v[44:47]
    v_mfma_f32_16x16x32_bf16 v[44:47], a[20:23], v[76:79], v[44:47]
    ds_read_b64_tr_b16 v[212:213], v229 offset:16384
    v_mfma_f32_16x16x32_bf16 v[48:51], v[216:219], v[64:67], v[48:51]
    ds_read_b64_tr_b16 v[214:215], v229 offset:20480
    v_mfma_f32_16x16x32_bf16 v[48:51], a[24:27], v[72:75], v[48:51]
    v_mfma_f32_16x16x32_bf16 v[52:55], v[216:219], v[68:71], v[52:55]
    v_mfma_f32_16x16x32_bf16 v[52:55], a[24:27], v[76:79], v[52:55]
    ds_read_b64_tr_b16 v[216:217], v230 offset:16384
    v_mfma_f32_16x16x32_bf16 v[56:59], v[220:223], v[64:67], v[56:59]
    ds_read_b64_tr_b16 v[218:219], v230 offset:20480
    v_mfma_f32_16x16x32_bf16 v[56:59], a[28:31], v[72:75], v[56:59]
    v_mfma_f32_16x16x32_bf16 v[60:63], v[220:223], v[68:71], v[60:63]
    v_mfma_f32_16x16x32_bf16 v[60:63], a[28:31], v[76:79], v[60:63]
    s_waitcnt vmcnt(0) lgkmcnt(6)
    ds_read_b64_tr_b16 v[220:221], v231 offset:16384
    ds_read_b64_tr_b16 v[222:223], v231 offset:20480
    v_mfma_f32_16x16x32_bf16 v[4:7], a[160:163], v[84:87], v[4:7]
    v_mfma_f32_16x16x32_bf16 v[12:15], a[164:167], v[84:87], v[12:15]
    v_mfma_f32_16x16x32_bf16 v[20:23], a[168:171], v[84:87], v[20:23]
    v_mfma_f32_16x16x32_bf16 v[28:31], a[172:175], v[84:87], v[28:31]
    s_waitcnt lgkmcnt(0)
    v_mfma_f32_16x16x32_bf16 v[32:35], v[208:211], v[80:83], v[32:35]
    v_mfma_f32_16x16x32_bf16 v[36:39], v[208:211], v[84:87], v[36:39]
    v_mfma_f32_16x16x32_bf16 v[40:43], v[212:215], v[80:83], v[40:43]
    v_mfma_f32_16x16x32_bf16 v[44:47], v[212:215], v[84:87], v[44:47]
    v_mfma_f32_16x16x32_bf16 v[48:51], v[216:219], v[80:83], v[48:51]
    v_mfma_f32_16x16x32_bf16 v[52:55], v[216:219], v[84:87], v[52:55]
    v_mfma_f32_16x16x32_bf16 v[56:59], v[220:223], v[80:83], v[56:59]
    v_mfma_f32_16x16x32_bf16 v[60:63], v[220:223], v[84:87], v[60:63]
    s_xor_b32 s73, s58, 1
    s_and_b32 s73, s73, 3
    s_mul_i32 s73, s73, 24576
    s_add_u32 s73, s73, s90
    s_add_u32 s73, s73, 0
    v_cvt_pk_bf16_f32 v88, v4, v5
    v_cvt_pk_bf16_f32 v89, v6, v7
    v_cvt_pk_bf16_f32 v90, v12, v13
    v_cvt_pk_bf16_f32 v91, v14, v15
    buffer_store_dwordx4 v[88:91], v245, s[48:51], s73 offen offset:0 sc1
    v_cvt_pk_bf16_f32 v92, v20, v21
    v_cvt_pk_bf16_f32 v93, v22, v23
    v_cvt_pk_bf16_f32 v94, v28, v29
    v_cvt_pk_bf16_f32 v95, v30, v31
    buffer_store_dwordx4 v[92:95], v245, s[48:51], s73 offen offset:1024 sc1
    s_xor_b32 s73, s58, 2
    s_and_b32 s73, s73, 3
    s_mul_i32 s73, s73, 24576
    s_add_u32 s73, s73, s90
    s_add_u32 s73, s73, 8192
    v_cvt_pk_bf16_f32 v96, v32, v33
    v_cvt_pk_bf16_f32 v97, v34, v35
    v_cvt_pk_bf16_f32 v98, v40, v41
    v_cvt_pk_bf16_f32 v99, v42, v43
    buffer_store_dwordx4 v[96:99], v245, s[48:51], s73 offen offset:0 sc1
    v_cvt_pk_bf16_f32 v100, v48, v49
    v_cvt_pk_bf16_f32 v101, v50, v51
    v_cvt_pk_bf16_f32 v102, v56, v57
    v_cvt_pk_bf16_f32 v103, v58, v59
    buffer_store_dwordx4 v[100:103], v245, s[48:51], s73 offen offset:1024 sc1
    s_xor_b32 s73, s58, 3
    s_and_b32 s73, s73, 3
    s_mul_i32 s73, s73, 24576
    s_add_u32 s73, s73, s90
    s_add_u32 s73, s73, 16384
    v_cvt_pk_bf16_f32 v104, v36, v37
    v_cvt_pk_bf16_f32 v105, v38, v39
    v_cvt_pk_bf16_f32 v106, v44, v45
    v_cvt_pk_bf16_f32 v107, v46, v47
    buffer_store_dwordx4 v[104:107], v245, s[48:51], s73 offen offset:0 sc1
    v_cvt_pk_bf16_f32 v108, v52, v53
    v_cvt_pk_bf16_f32 v109, v54, v55
    v_cvt_pk_bf16_f32 v110, v60, v61
    v_cvt_pk_bf16_f32 v111, v62, v63
    buffer_store_dwordx4 v[108:111], v245, s[48:51], s73 offen offset:1024 sc1
    v_mfma_f32_16x16x32_bf16 v[0:3], a[32:35], v[144:147], v[0:3]
    v_mfma_f32_16x16x32_bf16 v[0:3], a[48:51], v[152:155], v[0:3]
    v_mfma_f32_16x16x32_bf16 v[8:11], a[36:39], v[144:147], v[8:11]
    v_mfma_f32_16x16x32_bf16 v[8:11], a[52:55], v[152:155], v[8:11]
    v_mfma_f32_16x16x32_bf16 v[16:19], a[40:43], v[144:147], v[16:19]
    v_mfma_f32_16x16x32_bf16 v[16:19], a[56:59], v[152:155], v[16:19]
    v_mfma_f32_16x16x32_bf16 v[24:27], a[44:47], v[144:147], v[24:27]
    v_mfma_f32_16x16x32_bf16 v[24:27], a[60:63], v[152:155], v[24:27]
    v_mfma_f32_16x16x32_bf16 v[0:3], a[64:67], v[160:163], v[0:3]
    v_mfma_f32_16x16x32_bf16 v[0:3], a[80:83], v[168:171], v[0:3]
    v_mfma_f32_16x16x32_bf16 v[8:11], a[68:71], v[160:163], v[8:11]
    v_mfma_f32_16x16x32_bf16 v[8:11], a[84:87], v[168:171], v[8:11]
    v_mfma_f32_16x16x32_bf16 v[16:19], a[72:75], v[160:163], v[16:19]
    v_mfma_f32_16x16x32_bf16 v[16:19], a[88:91], v[168:171], v[16:19]
    v_mfma_f32_16x16x32_bf16 v[24:27], a[76:79], v[160:163], v[24:27]
    v_mfma_f32_16x16x32_bf16 v[24:27], a[92:95], v[168:171], v[24:27]
    v_mfma_f32_16x16x32_bf16 v[0:3], a[96:99], v[176:179], v[0:3]
    v_mfma_f32_16x16x32_bf16 v[0:3], a[112:115], v[184:187], v[0:3]
    v_mfma_f32_16x16x32_bf16 v[8:11], a[100:103], v[176:179], v[8:11]
    v_mfma_f32_16x16x32_bf16 v[8:11], a[116:119], v[184:187], v[8:11]
    v_mfma_f32_16x16x32_bf16 v[16:19], a[104:107], v[176:179], v[16:19]
    v_mfma_f32_16x16x32_bf16 v[16:19], a[120:123], v[184:187], v[16:19]
    v_mfma_f32_16x16x32_bf16 v[24:27], a[108:111], v[176:179], v[24:27]
    v_mfma_f32_16x16x32_bf16 v[24:27], a[124:127], v[184:187], v[24:27]
    v_mfma_f32_16x16x32_bf16 v[0:3], a[128:131], v[64:67], v[0:3]
    v_mfma_f32_16x16x32_bf16 v[0:3], a[144:147], v[72:75], v[0:3]
    v_mfma_f32_16x16x32_bf16 v[8:11], a[132:135], v[64:67], v[8:11]
    v_mfma_f32_16x16x32_bf16 v[8:11], a[148:151], v[72:75], v[8:11]
    v_mfma_f32_16x16x32_bf16 v[16:19], a[136:139], v[64:67], v[16:19]
    v_mfma_f32_16x16x32_bf16 v[16:19], a[152:155], v[72:75], v[16:19]
    v_mfma_f32_16x16x32_bf16 v[24:27], a[140:143], v[64:67], v[24:27]
    v_mfma_f32_16x16x32_bf16 v[24:27], a[156:159], v[72:75], v[24:27]
    v_mfma_f32_16x16x32_bf16 v[0:3], a[160:163], v[80:83], v[0:3]
    v_mfma_f32_16x16x32_bf16 v[8:11], a[164:167], v[80:83], v[8:11]
    v_mfma_f32_16x16x32_bf16 v[16:19], a[168:171], v[80:83], v[16:19]
    v_mfma_f32_16x16x32_bf16 v[24:27], a[172:175], v[80:83], v[24:27]
    v_accvgpr_read_b32 v196, a208
    v_accvgpr_read_b32 v197, a209
    v_lshlrev_b32 v192, 16, v196
    v_and_b32 v193, 0xffff0000, v196
    v_lshlrev_b32 v194, 16, v197
    v_and_b32 v195, 0xffff0000, v197
    v_pk_add_f32 v[0:1], v[0:1], v[192:193]
    v_pk_add_f32 v[2:3], v[2:3], v[194:195]
    v_accvgpr_read_b32 v196, a210
    v_accvgpr_read_b32 v197, a211
    v_lshlrev_b32 v192, 16, v196
    v_and_b32 v193, 0xffff0000, v196
    v_lshlrev_b32 v194, 16, v197
    v_and_b32 v195, 0xffff0000, v197
    v_pk_add_f32 v[8:9], v[8:9], v[192:193]
    v_pk_add_f32 v[10:11], v[10:11], v[194:195]
    v_accvgpr_read_b32 v196, a212
    v_accvgpr_read_b32 v197, a213
    v_lshlrev_b32 v192, 16, v196
    v_and_b32 v193, 0xffff0000, v196
    v_lshlrev_b32 v194, 16, v197
    v_and_b32 v195, 0xffff0000, v197
    v_pk_add_f32 v[16:17], v[16:17], v[192:193]
    v_pk_add_f32 v[18:19], v[18:19], v[194:195]
    v_accvgpr_read_b32 v196, a214
    v_accvgpr_read_b32 v197, a215
    v_lshlrev_b32 v192, 16, v196
    v_and_b32 v193, 0xffff0000, v196
    v_lshlrev_b32 v194, 16, v197
    v_and_b32 v195, 0xffff0000, v197
    v_pk_add_f32 v[24:25], v[24:25], v[192:193]
    v_pk_add_f32 v[26:27], v[26:27], v[194:195]
    s_add_u32 s94, s91, 0
    s_add_u32 s95, s91, 8192
    s_add_u32 s59, s91, 16384
    s_waitcnt vmcnt(0)
    buffer_load_dwordx4 v[112:115], v245, s[48:51], s94 offen offset:0 sc1
    buffer_load_dwordx4 v[116:119], v245, s[48:51], s94 offen offset:1024 sc1
    buffer_load_dwordx4 v[120:123], v245, s[48:51], s95 offen offset:0 sc1
    buffer_load_dwordx4 v[124:127], v245, s[48:51], s95 offen offset:1024 sc1
    buffer_load_dwordx4 v[128:131], v245, s[48:51], s59 offen offset:0 sc1
    buffer_load_dwordx4 v[132:135], v245, s[48:51], s59 offen offset:1024 sc1
    s_waitcnt vmcnt(5)
    v_max3_u32 v234, v112, v113, v114
    s_waitcnt vmcnt(4)
    v_max3_u32 v234, v234, v115, v116
    v_max3_u32 v234, v234, v117, v118
    s_waitcnt vmcnt(3)
    v_max3_u32 v234, v234, v119, v120
    v_max3_u32 v234, v234, v121, v122
    s_waitcnt vmcnt(2)
    v_max3_u32 v234, v234, v123, v124
    v_max3_u32 v234, v234, v125, v126
    s_waitcnt vmcnt(1)
    v_max3_u32 v234, v234, v127, v128
    v_max3_u32 v234, v234, v129, v130
    s_waitcnt vmcnt(0)
    v_max3_u32 v234, v234, v131, v132
    v_max3_u32 v234, v234, v133, v134
    v_max_u32 v234, v234, v135
    v_cmp_eq_u32 vcc, -1, v234
    s_nop 0
    s_cbranch_vccnz L_exs_69
L_exb_70:
    v_lshlrev_b32 v192, 16, v112
    v_and_b32 v193, 0xffff0000, v112
    v_pk_add_f32 v[0:1], v[0:1], v[192:193]
    v_lshlrev_b32 v194, 16, v113
    v_and_b32 v195, 0xffff0000, v113
    v_pk_add_f32 v[2:3], v[2:3], v[194:195]
    v_lshlrev_b32 v192, 16, v114
    v_and_b32 v193, 0xffff0000, v114
    v_pk_add_f32 v[8:9], v[8:9], v[192:193]
    v_lshlrev_b32 v194, 16, v115
    v_and_b32 v195, 0xffff0000, v115
    v_pk_add_f32 v[10:11], v[10:11], v[194:195]
    v_lshlrev_b32 v192, 16, v116
    v_and_b32 v193, 0xffff0000, v116
    v_pk_add_f32 v[16:17], v[16:17], v[192:193]
    v_lshlrev_b32 v194, 16, v117
    v_and_b32 v195, 0xffff0000, v117
    v_pk_add_f32 v[18:19], v[18:19], v[194:195]
    v_lshlrev_b32 v192, 16, v118
    v_and_b32 v193, 0xffff0000, v118
    v_pk_add_f32 v[24:25], v[24:25], v[192:193]
    v_lshlrev_b32 v194, 16, v119
    v_and_b32 v195, 0xffff0000, v119
    v_pk_add_f32 v[26:27], v[26:27], v[194:195]
    v_lshlrev_b32 v192, 16, v120
    v_and_b32 v193, 0xffff0000, v120
    v_pk_add_f32 v[0:1], v[0:1], v[192:193]
    v_lshlrev_b32 v194, 16, v121
    v_and_b32 v195, 0xffff0000, v121
    v_pk_add_f32 v[2:3], v[2:3], v[194:195]
    v_lshlrev_b32 v192, 16, v122
    v_and_b32 v193, 0xffff0000, v122
    v_pk_add_f32 v[8:9], v[8:9], v[192:193]
    v_lshlrev_b32 v194, 16, v123
    v_and_b32 v195, 0xffff0000, v123
    v_pk_add_f32 v[10:11], v[10:11], v[194:195]
    v_lshlrev_b32 v192, 16, v124
    v_and_b32 v193, 0xffff0000, v124
    v_pk_add_f32 v[16:17], v[16:17], v[192:193]
    v_lshlrev_b32 v194, 16, v125
    v_and_b32 v195, 0xffff0000, v125
    v_pk_add_f32 v[18:19], v[18:19], v[194:195]
    v_lshlrev_b32 v192, 16, v126
    v_and_b32 v193, 0xffff0000, v126
    v_pk_add_f32 v[24:25], v[24:25], v[192:193]
    v_lshlrev_b32 v194, 16, v127
    v_and_b32 v195, 0xffff0000, v127
    v_pk_add_f32 v[26:27], v[26:27], v[194:195]
    v_lshlrev_b32 v192, 16, v128
    v_and_b32 v193, 0xffff0000, v128
    v_pk_add_f32 v[0:1], v[0:1], v[192:193]
    v_lshlrev_b32 v194, 16, v129
    v_and_b32 v195, 0xffff0000, v129
    v_pk_add_f32 v[2:3], v[2:3], v[194:195]
    v_lshlrev_b32 v192, 16, v130
    v_and_b32 v193, 0xffff0000, v130
    v_pk_add_f32 v[8:9], v[8:9], v[192:193]
    v_lshlrev_b32 v194, 16, v131
    v_and_b32 v195, 0xffff0000, v131
    v_pk_add_f32 v[10:11], v[10:11], v[194:195]
    v_lshlrev_b32 v192, 16, v132
    v_and_b32 v193, 0xffff0000, v132
    v_pk_add_f32 v[16:17], v[16:17], v[192:193]
    v_lshlrev_b32 v194, 16, v133
    v_and_b32 v195, 0xffff0000, v133
    v_pk_add_f32 v[18:19], v[18:19], v[194:195]
    v_lshlrev_b32 v192, 16, v134
    v_and_b32 v193, 0xffff0000, v134
    v_pk_add_f32 v[24:25], v[24:25], v[192:193]
    v_lshlrev_b32 v194, 16, v135
    v_and_b32 v195, 0xffff0000, v135
    v_pk_add_f32 v[26:27], v[26:27], v[194:195]
    v_cvt_pk_bf16_f32 v196, v0, v1
    v_cvt_pk_bf16_f32 v197, v2, v3
    buffer_store_dwordx2 v[196:197], v252, s[40:43], 0 offen offset:0
    v_cvt_pk_bf16_f32 v198, v8, v9
    v_cvt_pk_bf16_f32 v199, v10, v11
    buffer_store_dwordx2 v[198:199], v252, s[40:43], 0 offen offset:32
    v_cvt_pk_bf16_f32 v200, v16, v17
    v_cvt_pk_bf16_f32 v201, v18, v19
    buffer_store_dwordx2 v[200:201], v252, s[40:43], 0 offen offset:64
    v_cvt_pk_bf16_f32 v202, v24, v25
    v_cvt_pk_bf16_f32 v203, v26, v27
    buffer_store_dwordx2 v[202:203], v252, s[40:43], 0 offen offset:96
L_exit:
    s_endpgm
L_spin_2:
    s_mov_b32 s75, 1048576
L_spin_2_l:
    buffer_load_dword v231, v253, s[44:47], 0 offen sc1
    s_waitcnt vmcnt(0)
    v_cmp_ne_u32 vcc, 1, v231
    s_nop 1
    s_cbranch_vccz L_back_3
    s_sub_u32 s75, s75, 1
    s_cmp_lg_u32 s75, 0
    s_cbranch_scc1 L_spin_2_l
    s_branch L_back_3
L_spin_4:
    s_mov_b32 s75, 1048576
L_spin_4_l:
    buffer_load_dword v231, v250, s[48:51], s100 offen sc1
    s_waitcnt vmcnt(0)
    v_cmp_ne_u32 vcc, 1, v231
    s_nop 1
    s_cbranch_vccz L_back_5
    s_sub_u32 s75, s75, 1
    s_cmp_lg_u32 s75, 0
    s_cbranch_scc1 L_spin_4_l
    s_branch L_back_5
L_spin_6:
    s_mov_b32 s75, 1048576
L_spin_6_l:
    buffer_load_dword v231, v251, s[48:51], s100 offen sc1
    s_waitcnt vmcnt(0)
    v_cmp_ne_u32 vcc, 1, v231
    s_nop 1
    s_cbranch_vccz L_back_7
    s_sub_u32 s75, s75, 1
    s_cmp_lg_u32 s75, 0
    s_cbranch_scc1 L_spin_6_l
    s_branch L_back_7
L_fix_9:
    s_nop 7
    s_nop 1
    v_max3_f32 v224, v24, v25, v26
    v_max3_f32 v225, v27, v28, v29
    v_max3_f32 v224, v224, v30, v31
    v_max_f32 v224, v224, v225
    v_mov_b32 v225, v224
    s_nop 1
    v_permlane32_swap_b32 v224, v225
    v_max_f32 v224, v224, v225
    v_mov_b32 v225, v224
    s_nop 1
    v_permlane16_swap_b32 v224, v225
    v_max_f32 v224, v224, v225
    v_add_f32 v224, 0x41000000, v224
    v_max_f32 v224, 0, v224
    v_exp_f32 v225, -v224
    v_sub_f32 v24, v24, v224
    v_sub_f32 v56, v56, v224
    v_sub_f32 v25, v25, v224
    v_sub_f32 v57, v57, v224
    v_sub_f32 v26, v26, v224
    v_sub_f32 v58, v58, v224
    v_sub_f32 v27, v27, v224
    v_sub_f32 v59, v59, v224
    v_sub_f32 v28, v28, v224
    v_sub_f32 v60, v60, v224
    v_sub_f32 v29, v29, v224
    v_sub_f32 v61, v61, v224
    v_sub_f32 v30, v30, v224
    v_sub_f32 v62, v62, v224
    v_sub_f32 v31, v31, v224
    v_sub_f32 v63, v63, v224
    v_mul_f32 v160, v160, v225
    v_mul_f32 v161, v161, v225
    v_mul_f32 v162, v162, v225
    v_mul_f32 v163, v163, v225
    v_mul_f32 v164, v164, v225
    v_mul_f32 v165, v165, v225
    v_mul_f32 v166, v166, v225
    v_mul_f32 v167, v167, v225
    v_mul_f32 v168, v168, v225
    v_mul_f32 v169, v169, v225
    v_mul_f32 v170, v170, v225
    v_mul_f32 v171, v171, v225
    v_mul_f32 v172, v172, v225
    v_mul_f32 v173, v173, v225
    v_mul_f32 v174, v174, v225
    v_mul_f32 v175, v175, v225
    v_mul_f32 v176, v176, v225
    v_mul_f32 v177, v177, v225
    v_mul_f32 v178, v178, v225
    v_mul_f32 v179, v179, v225
    v_mul_f32 v180, v180, v225
    v_mul_f32 v181, v181, v225
    v_mul_f32 v182, v182, v225
    v_mul_f32 v183, v183, v225
    v_mul_f32 v184, v184, v225
    v_mul_f32 v185, v185, v225
    v_mul_f32 v186, v186, v225
    v_mul_f32 v187, v187, v225
    v_mul_f32 v188, v188, v225
    v_mul_f32 v189, v189, v225
    v_mul_f32 v190, v190, v225
    v_mul_f32 v191, v191, v225
    v_accvgpr_read_b32 v226, a140
    v_accvgpr_read_b32 v227, a141
    v_accvgpr_read_b32 v228, a142
    v_accvgpr_read_b32 v229, a143
    v_mul_f32 v226, v226, v225
    v_mul_f32 v227, v227, v225
    v_mul_f32 v228, v228, v225
    v_mul_f32 v229, v229, v225
    v_accvgpr_write_b32 a140, v226
    v_accvgpr_write_b32 a141, v227
    v_accvgpr_write_b32 a142, v228
    v_accvgpr_write_b32 a143, v229
    v_exp_f32 v216, v24
    v_exp_f32 v217, v25
    v_exp_f32 v218, v26
    v_exp_f32 v219, v27
    v_exp_f32 v220, v28
    v_exp_f32 v221, v29
    v_exp_f32 v222, v30
    v_exp_f32 v223, v31
    v_cvt_pk_bf16_f32 v204, v216, v217
    v_cvt_pk_bf16_f32 v205, v218, v219
    v_cvt_pk_bf16_f32 v206, v220, v221
    v_cvt_pk_bf16_f32 v207, v222, v223
    s_nop 1
    s_branch L_fixb_10
L_fix_11:
    s_nop 7
    s_nop 1
    v_max3_f32 v224, v0, v1, v2
    v_max3_f32 v225, v3, v4, v5
    v_max3_f32 v224, v224, v6, v7
    v_max_f32 v224, v224, v225
    v_mov_b32 v225, v224
    s_nop 1
    v_permlane32_swap_b32 v224, v225
    v_max_f32 v224, v224, v225
    v_mov_b32 v225, v224
    s_nop 1
    v_permlane16_swap_b32 v224, v225
    v_max_f32 v224, v224, v225
    v_add_f32 v224, 0x41000000, v224
    v_max_f32 v224, 0, v224
    v_exp_f32 v225, -v224
    v_sub_f32 v0, v0, v224
    v_sub_f32 v32, v32, v224
    v_sub_f32 v1, v1, v224
    v_sub_f32 v33, v33, v224
    v_sub_f32 v2, v2, v224
    v_sub_f32 v34, v34, v224
    v_sub_f32 v3, v3, v224
    v_sub_f32 v35, v35, v224
    v_sub_f32 v4, v4, v224
    v_sub_f32 v36, v36, v224
    v_sub_f32 v5, v5, v224
    v_sub_f32 v37, v37, v224
    v_sub_f32 v6, v6, v224
    v_sub_f32 v38, v38, v224
    v_sub_f32 v7, v7, v224
    v_sub_f32 v39, v39, v224
    v_mul_f32 v64, v64, v225
    v_mul_f32 v65, v65, v225
    v_mul_f32 v66, v66, v225
    v_mul_f32 v67, v67, v225
    v_mul_f32 v68, v68, v225
    v_mul_f32 v69, v69, v225
    v_mul_f32 v70, v70, v225
    v_mul_f32 v71, v71, v225
    v_mul_f32 v72, v72, v225
    v_mul_f32 v73, v73, v225
    v_mul_f32 v74, v74, v225
    v_mul_f32 v75, v75, v225
    v_mul_f32 v76, v76, v225
    v_mul_f32 v77, v77, v225
    v_mul_f32 v78, v78, v225
    v_mul_f32 v79, v79, v225
    v_mul_f32 v80, v80, v225
    v_mul_f32 v81, v81, v225
    v_mul_f32 v82, v82, v225
    v_mul_f32 v83, v83, v225
    v_mul_f32 v84, v84, v225
    v_mul_f32 v85, v85, v225
    v_mul_f32 v86, v86, v225
    v_mul_f32 v87, v87, v225
    v_mul_f32 v88, v88, v225
    v_mul_f32 v89, v89, v225
    v_mul_f32 v90, v90, v225
    v_mul_f32 v91, v91, v225
    v_mul_f32 v92, v92, v225
    v_mul_f32 v93, v93, v225
    v_mul_f32 v94, v94, v225
    v_mul_f32 v95, v95, v225
    v_accvgpr_read_b32 v226, a128
    v_accvgpr_read_b32 v227, a129
    v_accvgpr_read_b32 v228, a130
    v_accvgpr_read_b32 v229, a131
    v_mul_f32 v226, v226, v225
    v_mul_f32 v227, v227, v225
    v_mul_f32 v228, v228, v225
    v_mul_f32 v229, v229, v225
    v_accvgpr_write_b32 a128, v226
    v_accvgpr_write_b32 a129, v227
    v_accvgpr_write_b32 a130, v228
    v_accvgpr_write_b32 a131, v229
    v_exp_f32 v216, v0
    v_exp_f32 v217, v1
    v_exp_f32 v218, v2
    v_exp_f32 v219, v3
    v_exp_f32 v220, v4
    v_exp_f32 v221, v5
    v_exp_f32 v222, v6
    v_exp_f32 v223, v7
    v_cvt_pk_bf16_f32 v192, v216, v217
    v_cvt_pk_bf16_f32 v193, v218, v219
    v_cvt_pk_bf16_f32 v194, v220, v221
    v_cvt_pk_bf16_f32 v195, v222, v223
    s_nop 7
    s_nop 1
    v_max3_f32 v224, v8, v9, v10
    v_max3_f32 v225, v11, v12, v13
    v_max3_f32 v224, v224, v14, v15
    v_max_f32 v224, v224, v225
    v_mov_b32 v225, v224
    s_nop 1
    v_permlane32_swap_b32 v224, v225
    v_max_f32 v224, v224, v225
    v_mov_b32 v225, v224
    s_nop 1
    v_permlane16_swap_b32 v224, v225
    v_max_f32 v224, v224, v225
    v_add_f32 v224, 0x41000000, v224
    v_max_f32 v224, 0, v224
    v_exp_f32 v225, -v224
    v_sub_f32 v8, v8, v224
    v_sub_f32 v40, v40, v224
    v_sub_f32 v9, v9, v224
    v_sub_f32 v41, v41, v224
    v_sub_f32 v10, v10, v224
    v_sub_f32 v42, v42, v224
    v_sub_f32 v11, v11, v224
    v_sub_f32 v43, v43, v224
    v_sub_f32 v12, v12, v224
    v_sub_f32 v44, v44, v224
    v_sub_f32 v13, v13, v224
    v_sub_f32 v45, v45, v224
    v_sub_f32 v14, v14, v224
    v_sub_f32 v46, v46, v224
    v_sub_f32 v15, v15, v224
    v_sub_f32 v47, v47, v224
    v_mul_f32 v96, v96, v225
    v_mul_f32 v97, v97, v225
    v_mul_f32 v98, v98, v225
    v_mul_f32 v99, v99, v225
    v_mul_f32 v100, v100, v225
    v_mul_f32 v101, v101, v225
    v_mul_f32 v102, v102, v225
    v_mul_f32 v103, v103, v225
    v_mul_f32 v104, v104, v225
    v_mul_f32 v105, v105, v225
    v_mul_f32 v106, v106, v225
    v_mul_f32 v107, v107, v225
    v_mul_f32 v108, v108, v225
    v_mul_f32 v109, v109, v225
    v_mul_f32 v110, v110, v225
    v_mul_f32 v111, v111, v225
    v_mul_f32 v112, v112, v225
    v_mul_f32 v113, v113, v225
    v_mul_f32 v114, v114, v225
    v_mul_f32 v115, v115, v225
    v_mul_f32 v116, v116, v225
    v_mul_f32 v117, v117, v225
    v_mul_f32 v118, v118, v225
    v_mul_f32 v119, v119, v225
    v_mul_f32 v120, v120, v225
    v_mul_f32 v121, v121, v225
    v_mul_f32 v122, v122, v225
    v_mul_f32 v123, v123, v225
    v_mul_f32 v124, v124, v225
    v_mul_f32 v125, v125, v225
    v_mul_f32 v126, v126, v225
    v_mul_f32 v127, v127, v225
    v_accvgpr_read_b32 v226, a132
    v_accvgpr_read_b32 v227, a133
    v_accvgpr_read_b32 v228, a134
    v_accvgpr_read_b32 v229, a135
    v_mul_f32 v226, v226, v225
    v_mul_f32 v227, v227, v225
    v_mul_f32 v228, v228, v225
    v_mul_f32 v229, v229, v225
    v_accvgpr_write_b32 a132, v226
    v_accvgpr_write_b32 a133, v227
    v_accvgpr_write_b32 a134, v228
    v_accvgpr_write_b32 a135, v229
    v_exp_f32 v216, v8
    v_exp_f32 v217, v9
    v_exp_f32 v218, v10
    v_exp_f32 v219, v11
    v_exp_f32 v220, v12
    v_exp_f32 v221, v13
    v_exp_f32 v222, v14
    v_exp_f32 v223, v15
    v_cvt_pk_bf16_f32 v196, v216, v217
    v_cvt_pk_bf16_f32 v197, v218, v219
    v_cvt_pk_bf16_f32 v198, v220, v221
    v_cvt_pk_bf16_f32 v199, v222, v223
    s_nop 7
    s_nop 1
    v_max3_f32 v224, v16, v17, v18
    v_max3_f32 v225, v19, v20, v21
    v_max3_f32 v224, v224, v22, v23
    v_max_f32 v224, v224, v225
    v_mov_b32 v225, v224
    s_nop 1
    v_permlane32_swap_b32 v224, v225
    v_max_f32 v224, v224, v225
    v_mov_b32 v225, v224
    s_nop 1
    v_permlane16_swap_b32 v224, v225
    v_max_f32 v224, v224, v225
    v_add_f32 v224, 0x41000000, v224
    v_max_f32 v224, 0, v224
    v_exp_f32 v225, -v224
    v_sub_f32 v16, v16, v224
    v_sub_f32 v48, v48, v224
    v_sub_f32 v17, v17, v224
    v_sub_f32 v49, v49, v224
    v_sub_f32 v18, v18, v224
    v_sub_f32 v50, v50, v224
    v_sub_f32 v19, v19, v224
    v_sub_f32 v51, v51, v224
    v_sub_f32 v20, v20, v224
    v_sub_f32 v52, v52, v224
    v_sub_f32 v21, v21, v224
    v_sub_f32 v53, v53, v224
    v_sub_f32 v22, v22, v224
    v_sub_f32 v54, v54, v224
    v_sub_f32 v23, v23, v224
    v_sub_f32 v55, v55, v224
    v_mul_f32 v128, v128, v225
    v_mul_f32 v129, v129, v225
    v_mul_f32 v130, v130, v225
    v_mul_f32 v131, v131, v225
    v_mul_f32 v132, v132, v225
    v_mul_f32 v133, v133, v225
    v_mul_f32 v134, v134, v225
    v_mul_f32 v135, v135, v225
    v_mul_f32 v136, v136, v225
    v_mul_f32 v137, v137, v225
    v_mul_f32 v138, v138, v225
    v_mul_f32 v139, v139, v225
    v_mul_f32 v140, v140, v225
    v_mul_f32 v141, v141, v225
    v_mul_f32 v142, v142, v225
    v_mul_f32 v143, v143, v225
    v_mul_f32 v144, v144, v225
    v_mul_f32 v145, v145, v225
    v_mul_f32 v146, v146, v225
    v_mul_f32 v147, v147, v225
    v_mul_f32 v148, v148, v225
    v_mul_f32 v149, v149, v225
    v_mul_f32 v150, v150, v225
    v_mul_f32 v151, v151, v225
    v_mul_f32 v152, v152, v225
    v_mul_f32 v153, v153, v225
    v_mul_f32 v154, v154, v225
    v_mul_f32 v155, v155, v225
    v_mul_f32 v156, v156, v225
    v_mul_f32 v157, v157, v225
    v_mul_f32 v158, v158, v225
    v_mul_f32 v159, v159, v225
    v_accvgpr_read_b32 v226, a136
    v_accvgpr_read_b32 v227, a137
    v_accvgpr_read_b32 v228, a138
    v_accvgpr_read_b32 v229, a139
    v_mul_f32 v226, v226, v225
    v_mul_f32 v227, v227, v225
    v_mul_f32 v228, v228, v225
    v_mul_f32 v229, v229, v225
    v_accvgpr_write_b32 a136, v226
    v_accvgpr_write_b32 a137, v227
    v_accvgpr_write_b32 a138, v228
    v_accvgpr_write_b32 a139, v229
    v_exp_f32 v216, v16
    v_exp_f32 v217, v17
    v_exp_f32 v218, v18
    v_exp_f32 v219, v19
    v_exp_f32 v220, v20
    v_exp_f32 v221, v21
    v_exp_f32 v222, v22
    v_exp_f32 v223, v23
    v_cvt_pk_bf16_f32 v200, v216, v217
    v_cvt_pk_bf16_f32 v201, v218, v219
    v_cvt_pk_bf16_f32 v202, v220, v221
    v_cvt_pk_bf16_f32 v203, v222, v223
    s_nop 1
    s_branch L_fixb_12
L_spin_18:
    s_mov_b32 s75, 1048576
L_spin_18_l:
    buffer_load_dword v241, v242, s[48:51], s99 offen sc1
    s_waitcnt vmcnt(0)
    v_cmp_ne_u32 vcc, 1, v241
    s_nop 1
    s_cbranch_vccz L_back_19
    s_sub_u32 s75, s75, 1
    s_cmp_lg_u32 s75, 0
    s_cbranch_scc1 L_spin_18_l
    s_branch L_back_19
L_fix_21:
    s_nop 7
    s_nop 1
    v_max3_f32 v224, v24, v25, v26
    v_max3_f32 v225, v27, v28, v29
    v_max3_f32 v224, v224, v30, v31
    v_max_f32 v224, v224, v225
    v_mov_b32 v225, v224
    s_nop 1
    v_permlane32_swap_b32 v224, v225
    v_max_f32 v224, v224, v225
    v_mov_b32 v225, v224
    s_nop 1
    v_permlane16_swap_b32 v224, v225
    v_max_f32 v224, v224, v225
    v_add_f32 v224, 0x41000000, v224
    v_max_f32 v224, 0, v224
    v_exp_f32 v225, -v224
    v_sub_f32 v24, v24, v224
    v_sub_f32 v56, v56, v224
    v_sub_f32 v25, v25, v224
    v_sub_f32 v57, v57, v224
    v_sub_f32 v26, v26, v224
    v_sub_f32 v58, v58, v224
    v_sub_f32 v27, v27, v224
    v_sub_f32 v59, v59, v224
    v_sub_f32 v28, v28, v224
    v_sub_f32 v60, v60, v224
    v_sub_f32 v29, v29, v224
    v_sub_f32 v61, v61, v224
    v_sub_f32 v30, v30, v224
    v_sub_f32 v62, v62, v224
    v_sub_f32 v31, v31, v224
    v_sub_f32 v63, v63, v224
    v_mul_f32 v160, v160, v225
    v_mul_f32 v161, v161, v225
    v_mul_f32 v162, v162, v225
    v_mul_f32 v163, v163, v225
    v_mul_f32 v164, v164, v225
    v_mul_f32 v165, v165, v225
    v_mul_f32 v166, v166, v225
    v_mul_f32 v167, v167, v225
    v_mul_f32 v168, v168, v225
    v_mul_f32 v169, v169, v225
    v_mul_f32 v170, v170, v225
    v_mul_f32 v171, v171, v225
    v_mul_f32 v172, v172, v225
    v_mul_f32 v173, v173, v225
    v_mul_f32 v174, v174, v225
    v_mul_f32 v175, v175, v225
    v_mul_f32 v176, v176, v225
    v_mul_f32 v177, v177, v225
    v_mul_f32 v178, v178, v225
    v_mul_f32 v179, v179, v225
    v_mul_f32 v180, v180, v225
    v_mul_f32 v181, v181, v225
    v_mul_f32 v182, v182, v225
    v_mul_f32 v183, v183, v225
    v_mul_f32 v184, v184, v225
    v_mul_f32 v185, v185, v225
    v_mul_f32 v186, v186, v225
    v_mul_f32 v187, v187, v225
    v_mul_f32 v188, v188, v225
    v_mul_f32 v189, v189, v225
    v_mul_f32 v190, v190, v225
    v_mul_f32 v191, v191, v225
    v_accvgpr_read_b32 v226, a140
    v_accvgpr_read_b32 v227, a141
    v_accvgpr_read_b32 v228, a142
    v_accvgpr_read_b32 v229, a143
    v_mul_f32 v226, v226, v225
    v_mul_f32 v227, v227, v225
    v_mul_f32 v228, v228, v225
    v_mul_f32 v229, v229, v225
    v_accvgpr_write_b32 a140, v226
    v_accvgpr_write_b32 a141, v227
    v_accvgpr_write_b32 a142, v228
    v_accvgpr_write_b32 a143, v229
    v_exp_f32 v216, v24
    v_exp_f32 v217, v25
    v_exp_f32 v218, v26
    v_exp_f32 v219, v27
    v_exp_f32 v220, v28
    v_exp_f32 v221, v29
    v_exp_f32 v222, v30
    v_exp_f32 v223, v31
    v_cvt_pk_bf16_f32 v204, v216, v217
    v_cvt_pk_bf16_f32 v205, v218, v219
    v_cvt_pk_bf16_f32 v206, v220, v221
    v_cvt_pk_bf16_f32 v207, v222, v223
    s_nop 1
    s_branch L_fixb_22
L_fix_23:
    s_nop 7
    s_nop 1
    v_max3_f32 v224, v0, v1, v2
    v_max3_f32 v225, v3, v4, v5
    v_max3_f32 v224, v224, v6, v7
    v_max_f32 v224, v224, v225
    v_mov_b32 v225, v224
    s_nop 1
    v_permlane32_swap_b32 v224, v225
    v_max_f32 v224, v224, v225
    v_mov_b32 v225, v224
    s_nop 1
    v_permlane16_swap_b32 v224, v225
    v_max_f32 v224, v224, v225
    v_add_f32 v224, 0x41000000, v224
    v_max_f32 v224, 0, v224
    v_exp_f32 v225, -v224
    v_sub_f32 v0, v0, v224
    v_sub_f32 v32, v32, v224
    v_sub_f32 v1, v1, v224
    v_sub_f32 v33, v33, v224
    v_sub_f32 v2, v2, v224
    v_sub_f32 v34, v34, v224
    v_sub_f32 v3, v3, v224
    v_sub_f32 v35, v35, v224
    v_sub_f32 v4, v4, v224
    v_sub_f32 v36, v36, v224
    v_sub_f32 v5, v5, v224
    v_sub_f32 v37, v37, v224
    v_sub_f32 v6, v6, v224
    v_sub_f32 v38, v38, v224
    v_sub_f32 v7, v7, v224
    v_sub_f32 v39, v39, v224
    v_mul_f32 v64, v64, v225
    v_mul_f32 v65, v65, v225
    v_mul_f32 v66, v66, v225
    v_mul_f32 v67, v67, v225
    v_mul_f32 v68, v68, v225
    v_mul_f32 v69, v69, v225
    v_mul_f32 v70, v70, v225
    v_mul_f32 v71, v71, v225
    v_mul_f32 v72, v72, v225
    v_mul_f32 v73, v73, v225
    v_mul_f32 v74, v74, v225
    v_mul_f32 v75, v75, v225
    v_mul_f32 v76, v76, v225
    v_mul_f32 v77, v77, v225
    v_mul_f32 v78, v78, v225
    v_mul_f32 v79, v79, v225
    v_mul_f32 v80, v80, v225
    v_mul_f32 v81, v81, v225
    v_mul_f32 v82, v82, v225
    v_mul_f32 v83, v83, v225
    v_mul_f32 v84, v84, v225
    v_mul_f32 v85, v85, v225
    v_mul_f32 v86, v86, v225
    v_mul_f32 v87, v87, v225
    v_mul_f32 v88, v88, v225
    v_mul_f32 v89, v89, v225
    v_mul_f32 v90, v90, v225
    v_mul_f32 v91, v91, v225
    v_mul_f32 v92, v92, v225
    v_mul_f32 v93, v93, v225
    v_mul_f32 v94, v94, v225
    v_mul_f32 v95, v95, v225
    v_accvgpr_read_b32 v226, a128
    v_accvgpr_read_b32 v227, a129
    v_accvgpr_read_b32 v228, a130
    v_accvgpr_read_b32 v229, a131
    v_mul_f32 v226, v226, v225
    v_mul_f32 v227, v227, v225
    v_mul_f32 v228, v228, v225
    v_mul_f32 v229, v229, v225
    v_accvgpr_write_b32 a128, v226
    v_accvgpr_write_b32 a129, v227
    v_accvgpr_write_b32 a130, v228
    v_accvgpr_write_b32 a131, v229
    v_exp_f32 v216, v0
    v_exp_f32 v217, v1
    v_exp_f32 v218, v2
    v_exp_f32 v219, v3
    v_exp_f32 v220, v4
    v_exp_f32 v221, v5
    v_exp_f32 v222, v6
    v_exp_f32 v223, v7
    v_cvt_pk_bf16_f32 v192, v216, v217
    v_cvt_pk_bf16_f32 v193, v218, v219
    v_cvt_pk_bf16_f32 v194, v220, v221
    v_cvt_pk_bf16_f32 v195, v222, v223
    s_nop 7
    s_nop 1
    v_max3_f32 v224, v8, v9, v10
    v_max3_f32 v225, v11, v12, v13
    v_max3_f32 v224, v224, v14, v15
    v_max_f32 v224, v224, v225
    v_mov_b32 v225, v224
    s_nop 1
    v_permlane32_swap_b32 v224, v225
    v_max_f32 v224, v224, v225
    v_mov_b32 v225, v224
    s_nop 1
    v_permlane16_swap_b32 v224, v225
    v_max_f32 v224, v224, v225
    v_add_f32 v224, 0x41000000, v224
    v_max_f32 v224, 0, v224
    v_exp_f32 v225, -v224
    v_sub_f32 v8, v8, v224
    v_sub_f32 v40, v40, v224
    v_sub_f32 v9, v9, v224
    v_sub_f32 v41, v41, v224
    v_sub_f32 v10, v10, v224
    v_sub_f32 v42, v42, v224
    v_sub_f32 v11, v11, v224
    v_sub_f32 v43, v43, v224
    v_sub_f32 v12, v12, v224
    v_sub_f32 v44, v44, v224
    v_sub_f32 v13, v13, v224
    v_sub_f32 v45, v45, v224
    v_sub_f32 v14, v14, v224
    v_sub_f32 v46, v46, v224
    v_sub_f32 v15, v15, v224
    v_sub_f32 v47, v47, v224
    v_mul_f32 v96, v96, v225
    v_mul_f32 v97, v97, v225
    v_mul_f32 v98, v98, v225
    v_mul_f32 v99, v99, v225
    v_mul_f32 v100, v100, v225
    v_mul_f32 v101, v101, v225
    v_mul_f32 v102, v102, v225
    v_mul_f32 v103, v103, v225
    v_mul_f32 v104, v104, v225
    v_mul_f32 v105, v105, v225
    v_mul_f32 v106, v106, v225
    v_mul_f32 v107, v107, v225
    v_mul_f32 v108, v108, v225
    v_mul_f32 v109, v109, v225
    v_mul_f32 v110, v110, v225
    v_mul_f32 v111, v111, v225
    v_mul_f32 v112, v112, v225
    v_mul_f32 v113, v113, v225
    v_mul_f32 v114, v114, v225
    v_mul_f32 v115, v115, v225
    v_mul_f32 v116, v116, v225
    v_mul_f32 v117, v117, v225
    v_mul_f32 v118, v118, v225
    v_mul_f32 v119, v119, v225
    v_mul_f32 v120, v120, v225
    v_mul_f32 v121, v121, v225
    v_mul_f32 v122, v122, v225
    v_mul_f32 v123, v123, v225
    v_mul_f32 v124, v124, v225
    v_mul_f32 v125, v125, v225
    v_mul_f32 v126, v126, v225
    v_mul_f32 v127, v127, v225
    v_accvgpr_read_b32 v226, a132
    v_accvgpr_read_b32 v227, a133
    v_accvgpr_read_b32 v228, a134
    v_accvgpr_read_b32 v229, a135
    v_mul_f32 v226, v226, v225
    v_mul_f32 v227, v227, v225
    v_mul_f32 v228, v228, v225
    v_mul_f32 v229, v229, v225
    v_accvgpr_write_b32 a132, v226
    v_accvgpr_write_b32 a133, v227
    v_accvgpr_write_b32 a134, v228
    v_accvgpr_write_b32 a135, v229
    v_exp_f32 v216, v8
    v_exp_f32 v217, v9
    v_exp_f32 v218, v10
    v_exp_f32 v219, v11
    v_exp_f32 v220, v12
    v_exp_f32 v221, v13
    v_exp_f32 v222, v14
    v_exp_f32 v223, v15
    v_cvt_pk_bf16_f32 v196, v216, v217
    v_cvt_pk_bf16_f32 v197, v218, v219
    v_cvt_pk_bf16_f32 v198, v220, v221
    v_cvt_pk_bf16_f32 v199, v222, v223
    s_nop 1
    s_branch L_fixb_24
L_fix_25:
    s_nop 7
    s_nop 1
    v_max3_f32 v224, v16, v17, v18
    v_max3_f32 v225, v19, v20, v21
    v_max3_f32 v224, v224, v22, v23
    v_max_f32 v224, v224, v225
    v_mov_b32 v225, v224
    s_nop 1
    v_permlane32_swap_b32 v224, v225
    v_max_f32 v224, v224, v225
    v_mov_b32 v225, v224
    s_nop 1
    v_permlane16_swap_b32 v224, v225
    v_max_f32 v224, v224, v225
    v_add_f32 v224, 0x41000000, v224
    v_max_f32 v224, 0, v224
    v_exp_f32 v225, -v224
    v_sub_f32 v16, v16, v224
    v_sub_f32 v48, v48, v224
    v_sub_f32 v17, v17, v224
    v_sub_f32 v49, v49, v224
    v_sub_f32 v18, v18, v224
    v_sub_f32 v50, v50, v224
    v_sub_f32 v19, v19, v224
    v_sub_f32 v51, v51, v224
    v_sub_f32 v20, v20, v224
    v_sub_f32 v52, v52, v224
    v_sub_f32 v21, v21, v224
    v_sub_f32 v53, v53, v224
    v_sub_f32 v22, v22, v224
    v_sub_f32 v54, v54, v224
    v_sub_f32 v23, v23, v224
    v_sub_f32 v55, v55, v224
    v_mul_f32 v128, v128, v225
    v_mul_f32 v129, v129, v225
    v_mul_f32 v130, v130, v225
    v_mul_f32 v131, v131, v225
    v_mul_f32 v132, v132, v225
    v_mul_f32 v133, v133, v225
    v_mul_f32 v134, v134, v225
    v_mul_f32 v135, v135, v225
    v_mul_f32 v136, v136, v225
    v_mul_f32 v137, v137, v225
    v_mul_f32 v138, v138, v225
    v_mul_f32 v139, v139, v225
    v_mul_f32 v140, v140, v225
    v_mul_f32 v141, v141, v225
    v_mul_f32 v142, v142, v225
    v_mul_f32 v143, v143, v225
    v_mul_f32 v144, v144, v225
    v_mul_f32 v145, v145, v225
    v_mul_f32 v146, v146, v225
    v_mul_f32 v147, v147, v225
    v_mul_f32 v148, v148, v225
    v_mul_f32 v149, v149, v225
    v_mul_f32 v150, v150, v225
    v_mul_f32 v151, v151, v225
    v_mul_f32 v152, v152, v225
    v_mul_f32 v153, v153, v225
    v_mul_f32 v154, v154, v225
    v_mul_f32 v155, v155, v225
    v_mul_f32 v156, v156, v225
    v_mul_f32 v157, v157, v225
    v_mul_f32 v158, v158, v225
    v_mul_f32 v159, v159, v225
    v_accvgpr_read_b32 v226, a136
    v_accvgpr_read_b32 v227, a137
    v_accvgpr_read_b32 v228, a138
    v_accvgpr_read_b32 v229, a139
    v_mul_f32 v226, v226, v225
    v_mul_f32 v227, v227, v225
    v_mul_f32 v228, v228, v225
    v_mul_f32 v229, v229, v225
    v_accvgpr_write_b32 a136, v226
    v_accvgpr_write_b32 a137, v227
    v_accvgpr_write_b32 a138, v228
    v_accvgpr_write_b32 a139, v229
    v_exp_f32 v216, v16
    v_exp_f32 v217, v17
    v_exp_f32 v218, v18
    v_exp_f32 v219, v19
    v_exp_f32 v220, v20
    v_exp_f32 v221, v21
    v_exp_f32 v222, v22
    v_exp_f32 v223, v23
    v_cvt_pk_bf16_f32 v200, v216, v217
    v_cvt_pk_bf16_f32 v201, v218, v219
    v_cvt_pk_bf16_f32 v202, v220, v221
    v_cvt_pk_bf16_f32 v203, v222, v223
    s_nop 1
    s_branch L_fixb_26
L_fix_27:
    s_nop 7
    s_nop 1
    v_max3_f32 v224, v0, v1, v2
    v_max3_f32 v225, v3, v4, v5
    v_max3_f32 v224, v224, v6, v7
    v_max_f32 v224, v224, v225
    v_mov_b32 v225, v224
    s_nop 1
    v_permlane32_swap_b32 v224, v225
    v_max_f32 v224, v224, v225
    v_mov_b32 v225, v224
    s_nop 1
    v_permlane16_swap_b32 v224, v225
    v_max_f32 v224, v224, v225
    v_add_f32 v224, 0x41000000, v224
    v_max_f32 v224, 0, v224
    v_exp_f32 v225, -v224
    v_sub_f32 v0, v0, v224
    v_sub_f32 v32, v32, v224
    v_sub_f32 v1, v1, v224
    v_sub_f32 v33, v33, v224
    v_sub_f32 v2, v2, v224
    v_sub_f32 v34, v34, v224
    v_sub_f32 v3, v3, v224
    v_sub_f32 v35, v35, v224
    v_sub_f32 v4, v4, v224
    v_sub_f32 v36, v36, v224
    v_sub_f32 v5, v5, v224
    v_sub_f32 v37, v37, v224
    v_sub_f32 v6, v6, v224
    v_sub_f32 v38, v38, v224
    v_sub_f32 v7, v7, v224
    v_sub_f32 v39, v39, v224
    v_mul_f32 v64, v64, v225
    v_mul_f32 v65, v65, v225
    v_mul_f32 v66, v66, v225
    v_mul_f32 v67, v67, v225
    v_mul_f32 v68, v68, v225
    v_mul_f32 v69, v69, v225
    v_mul_f32 v70, v70, v225
    v_mul_f32 v71, v71, v225
    v_mul_f32 v72, v72, v225
    v_mul_f32 v73, v73, v225
    v_mul_f32 v74, v74, v225
    v_mul_f32 v75, v75, v225
    v_mul_f32 v76, v76, v225
    v_mul_f32 v77, v77, v225
    v_mul_f32 v78, v78, v225
    v_mul_f32 v79, v79, v225
    v_mul_f32 v80, v80, v225
    v_mul_f32 v81, v81, v225
    v_mul_f32 v82, v82, v225
    v_mul_f32 v83, v83, v225
    v_mul_f32 v84, v84, v225
    v_mul_f32 v85, v85, v225
    v_mul_f32 v86, v86, v225
    v_mul_f32 v87, v87, v225
    v_mul_f32 v88, v88, v225
    v_mul_f32 v89, v89, v225
    v_mul_f32 v90, v90, v225
    v_mul_f32 v91, v91, v225
    v_mul_f32 v92, v92, v225
    v_mul_f32 v93, v93, v225
    v_mul_f32 v94, v94, v225
    v_mul_f32 v95, v95, v225
    v_accvgpr_read_b32 v226, a128
    v_accvgpr_read_b32 v227, a129
    v_accvgpr_read_b32 v228, a130
    v_accvgpr_read_b32 v229, a131
    v_mul_f32 v226, v226, v225
    v_mul_f32 v227, v227, v225
    v_mul_f32 v228, v228, v225
    v_mul_f32 v229, v229, v225
    v_accvgpr_write_b32 a128, v226
    v_accvgpr_write_b32 a129, v227
    v_accvgpr_write_b32 a130, v228
    v_accvgpr_write_b32 a131, v229
    v_exp_f32 v216, v0
    v_exp_f32 v217, v1
    v_exp_f32 v218, v2
    v_exp_f32 v219, v3
    v_exp_f32 v220, v4
    v_exp_f32 v221, v5
    v_exp_f32 v222, v6
    v_exp_f32 v223, v7
    v_cvt_pk_bf16_f32 v192, v216, v217
    v_cvt_pk_bf16_f32 v193, v218, v219
    v_cvt_pk_bf16_f32 v194, v220, v221
    v_cvt_pk_bf16_f32 v195, v222, v223
    s_nop 7
    s_nop 1
    v_max3_f32 v224, v8, v9, v10
    v_max3_f32 v225, v11, v12, v13
    v_max3_f32 v224, v224, v14, v15
    v_max_f32 v224, v224, v225
    v_mov_b32 v225, v224
    s_nop 1
    v_permlane32_swap_b32 v224, v225
    v_max_f32 v224, v224, v225
    v_mov_b32 v225, v224
    s_nop 1
    v_permlane16_swap_b32 v224, v225
    v_max_f32 v224, v224, v225
    v_add_f32 v224, 0x41000000, v224
    v_max_f32 v224, 0, v224
    v_exp_f32 v225, -v224
    v_sub_f32 v8, v8, v224
    v_sub_f32 v40, v40, v224
    v_sub_f32 v9, v9, v224
    v_sub_f32 v41, v41, v224
    v_sub_f32 v10, v10, v224
    v_sub_f32 v42, v42, v224
    v_sub_f32 v11, v11, v224
    v_sub_f32 v43, v43, v224
    v_sub_f32 v12, v12, v224
    v_sub_f32 v44, v44, v224
    v_sub_f32 v13, v13, v224
    v_sub_f32 v45, v45, v224
    v_sub_f32 v14, v14, v224
    v_sub_f32 v46, v46, v224
    v_sub_f32 v15, v15, v224
    v_sub_f32 v47, v47, v224
    v_mul_f32 v96, v96, v225
    v_mul_f32 v97, v97, v225
    v_mul_f32 v98, v98, v225
    v_mul_f32 v99, v99, v225
    v_mul_f32 v100, v100, v225
    v_mul_f32 v101, v101, v225
    v_mul_f32 v102, v102, v225
    v_mul_f32 v103, v103, v225
    v_mul_f32 v104, v104, v225
    v_mul_f32 v105, v105, v225
    v_mul_f32 v106, v106, v225
    v_mul_f32 v107, v107, v225
    v_mul_f32 v108, v108, v225
    v_mul_f32 v109, v109, v225
    v_mul_f32 v110, v110, v225
    v_mul_f32 v111, v111, v225
    v_mul_f32 v112, v112, v225
    v_mul_f32 v113, v113, v225
    v_mul_f32 v114, v114, v225
    v_mul_f32 v115, v115, v225
    v_mul_f32 v116, v116, v225
    v_mul_f32 v117, v117, v225
    v_mul_f32 v118, v118, v225
    v_mul_f32 v119, v119, v225
    v_mul_f32 v120, v120, v225
    v_mul_f32 v121, v121, v225
    v_mul_f32 v122, v122, v225
    v_mul_f32 v123, v123, v225
    v_mul_f32 v124, v124, v225
    v_mul_f32 v125, v125, v225
    v_mul_f32 v126, v126, v225
    v_mul_f32 v127, v127, v225
    v_accvgpr_read_b32 v226, a132
    v_accvgpr_read_b32 v227, a133
    v_accvgpr_read_b32 v228, a134
    v_accvgpr_read_b32 v229, a135
    v_mul_f32 v226, v226, v225
    v_mul_f32 v227, v227, v225
    v_mul_f32 v228, v228, v225
    v_mul_f32 v229, v229, v225
    v_accvgpr_write_b32 a132, v226
    v_accvgpr_write_b32 a133, v227
    v_accvgpr_write_b32 a134, v228
    v_accvgpr_write_b32 a135, v229
    v_exp_f32 v216, v8
    v_exp_f32 v217, v9
    v_exp_f32 v218, v10
    v_exp_f32 v219, v11
    v_exp_f32 v220, v12
    v_exp_f32 v221, v13
    v_exp_f32 v222, v14
    v_exp_f32 v223, v15
    v_cvt_pk_bf16_f32 v196, v216, v217
    v_cvt_pk_bf16_f32 v197, v218, v219
    v_cvt_pk_bf16_f32 v198, v220, v221
    v_cvt_pk_bf16_f32 v199, v222, v223
    s_nop 1
    s_branch L_fixb_28
L_spin_34:
    s_mov_b32 s75, 1048576
L_spin_34_l:
    buffer_load_dword v241, v242, s[48:51], s99 offen sc1
    s_waitcnt vmcnt(0)
    v_cmp_ne_u32 vcc, 1, v241
    s_nop 1
    s_cbranch_vccz L_back_35
    s_sub_u32 s75, s75, 1
    s_cmp_lg_u32 s75, 0
    s_cbranch_scc1 L_spin_34_l
    s_branch L_back_35
L_fix_37:
    s_nop 7
    s_nop 1
    v_max3_f32 v224, v16, v17, v18
    v_max3_f32 v225, v19, v20, v21
    v_max3_f32 v224, v224, v22, v23
    v_max_f32 v224, v224, v225
    v_mov_b32 v225, v224
    s_nop 1
    v_permlane32_swap_b32 v224, v225
    v_max_f32 v224, v224, v225
    v_mov_b32 v225, v224
    s_nop 1
    v_permlane16_swap_b32 v224, v225
    v_max_f32 v224, v224, v225
    v_add_f32 v224, 0x41000000, v224
    v_max_f32 v224, 0, v224
    v_exp_f32 v225, -v224
    v_sub_f32 v16, v16, v224
    v_sub_f32 v48, v48, v224
    v_sub_f32 v17, v17, v224
    v_sub_f32 v49, v49, v224
    v_sub_f32 v18, v18, v224
    v_sub_f32 v50, v50, v224
    v_sub_f32 v19, v19, v224
    v_sub_f32 v51, v51, v224
    v_sub_f32 v20, v20, v224
    v_sub_f32 v52, v52, v224
    v_sub_f32 v21, v21, v224
    v_sub_f32 v53, v53, v224
    v_sub_f32 v22, v22, v224
    v_sub_f32 v54, v54, v224
    v_sub_f32 v23, v23, v224
    v_sub_f32 v55, v55, v224
    v_mul_f32 v128, v128, v225
    v_mul_f32 v129, v129, v225
    v_mul_f32 v130, v130, v225
    v_mul_f32 v131, v131, v225
    v_mul_f32 v132, v132, v225
    v_mul_f32 v133, v133, v225
    v_mul_f32 v134, v134, v225
    v_mul_f32 v135, v135, v225
    v_mul_f32 v136, v136, v225
    v_mul_f32 v137, v137, v225
    v_mul_f32 v138, v138, v225
    v_mul_f32 v139, v139, v225
    v_mul_f32 v140, v140, v225
    v_mul_f32 v141, v141, v225
    v_mul_f32 v142, v142, v225
    v_mul_f32 v143, v143, v225
    v_mul_f32 v144, v144, v225
    v_mul_f32 v145, v145, v225
    v_mul_f32 v146, v146, v225
    v_mul_f32 v147, v147, v225
    v_mul_f32 v148, v148, v225
    v_mul_f32 v149, v149, v225
    v_mul_f32 v150, v150, v225
    v_mul_f32 v151, v151, v225
    v_mul_f32 v152, v152, v225
    v_mul_f32 v153, v153, v225
    v_mul_f32 v154, v154, v225
    v_mul_f32 v155, v155, v225
    v_mul_f32 v156, v156, v225
    v_mul_f32 v157, v157, v225
    v_mul_f32 v158, v158, v225
    v_mul_f32 v159, v159, v225
    v_accvgpr_read_b32 v226, a136
    v_accvgpr_read_b32 v227, a137
    v_accvgpr_read_b32 v228, a138
    v_accvgpr_read_b32 v229, a139
    v_mul_f32 v226, v226, v225
    v_mul_f32 v227, v227, v225
    v_mul_f32 v228, v228, v225
    v_mul_f32 v229, v229, v225
    v_accvgpr_write_b32 a136, v226
    v_accvgpr_write_b32 a137, v227
    v_accvgpr_write_b32 a138, v228
    v_accvgpr_write_b32 a139, v229
    v_exp_f32 v216, v16
    v_exp_f32 v217, v17
    v_exp_f32 v218, v18
    v_exp_f32 v219, v19
    v_exp_f32 v220, v20
    v_exp_f32 v221, v21
    v_exp_f32 v222, v22
    v_exp_f32 v223, v23
    v_cvt_pk_bf16_f32 v200, v216, v217
    v_cvt_pk_bf16_f32 v201, v218, v219
    v_cvt_pk_bf16_f32 v202, v220, v221
    v_cvt_pk_bf16_f32 v203, v222, v223
    s_nop 1
    s_branch L_fixb_38
L_fix_39:
    s_nop 7
    s_nop 1
    v_max3_f32 v224, v0, v1, v2
    v_max3_f32 v225, v3, v4, v5
    v_max3_f32 v224, v224, v6, v7
    v_max_f32 v224, v224, v225
    v_mov_b32 v225, v224
    s_nop 1
    v_permlane32_swap_b32 v224, v225
    v_max_f32 v224, v224, v225
    v_mov_b32 v225, v224
    s_nop 1
    v_permlane16_swap_b32 v224, v225
    v_max_f32 v224, v224, v225
    v_add_f32 v224, 0x41000000, v224
    v_max_f32 v224, 0, v224
    v_exp_f32 v225, -v224
    v_sub_f32 v0, v0, v224
    v_sub_f32 v32, v32, v224
    v_sub_f32 v1, v1, v224
    v_sub_f32 v33, v33, v224
    v_sub_f32 v2, v2, v224
    v_sub_f32 v34, v34, v224
    v_sub_f32 v3, v3, v224
    v_sub_f32 v35, v35, v224
    v_sub_f32 v4, v4, v224
    v_sub_f32 v36, v36, v224
    v_sub_f32 v5, v5, v224
    v_sub_f32 v37, v37, v224
    v_sub_f32 v6, v6, v224
    v_sub_f32 v38, v38, v224
    v_sub_f32 v7, v7, v224
    v_sub_f32 v39, v39, v224
    v_mul_f32 v64, v64, v225
    v_mul_f32 v65, v65, v225
    v_mul_f32 v66, v66, v225
    v_mul_f32 v67, v67, v225
    v_mul_f32 v68, v68, v225
    v_mul_f32 v69, v69, v225
    v_mul_f32 v70, v70, v225
    v_mul_f32 v71, v71, v225
    v_mul_f32 v72, v72, v225
    v_mul_f32 v73, v73, v225
    v_mul_f32 v74, v74, v225
    v_mul_f32 v75, v75, v225
    v_mul_f32 v76, v76, v225
    v_mul_f32 v77, v77, v225
    v_mul_f32 v78, v78, v225
    v_mul_f32 v79, v79, v225
    v_mul_f32 v80, v80, v225
    v_mul_f32 v81, v81, v225
    v_mul_f32 v82, v82, v225
    v_mul_f32 v83, v83, v225
    v_mul_f32 v84, v84, v225
    v_mul_f32 v85, v85, v225
    v_mul_f32 v86, v86, v225
    v_mul_f32 v87, v87, v225
    v_mul_f32 v88, v88, v225
    v_mul_f32 v89, v89, v225
    v_mul_f32 v90, v90, v225
    v_mul_f32 v91, v91, v225
    v_mul_f32 v92, v92, v225
    v_mul_f32 v93, v93, v225
    v_mul_f32 v94, v94, v225
    v_mul_f32 v95, v95, v225
    v_accvgpr_read_b32 v226, a128
    v_accvgpr_read_b32 v227, a129
    v_accvgpr_read_b32 v228, a130
    v_accvgpr_read_b32 v229, a131
    v_mul_f32 v226, v226, v225
    v_mul_f32 v227, v227, v225
    v_mul_f32 v228, v228, v225
    v_mul_f32 v229, v229, v225
    v_accvgpr_write_b32 a128, v226
    v_accvgpr_write_b32 a129, v227
    v_accvgpr_write_b32 a130, v228
    v_accvgpr_write_b32 a131, v229
    v_exp_f32 v216, v0
    v_exp_f32 v217, v1
    v_exp_f32 v218, v2
    v_exp_f32 v219, v3
    v_exp_f32 v220, v4
    v_exp_f32 v221, v5
    v_exp_f32 v222, v6
    v_exp_f32 v223, v7
    v_cvt_pk_bf16_f32 v192, v216, v217
    v_cvt_pk_bf16_f32 v193, v218, v219
    v_cvt_pk_bf16_f32 v194, v220, v221
    v_cvt_pk_bf16_f32 v195, v222, v223
    s_nop 1
    s_branch L_fixb_40
L_fix_41:
    s_nop 7
    s_nop 1
    v_max3_f32 v224, v8, v9, v10
    v_max3_f32 v225, v11, v12, v13
    v_max3_f32 v224, v224, v14, v15
    v_max_f32 v224, v224, v225
    v_mov_b32 v225, v224
    s_nop 1
    v_permlane32_swap_b32 v224, v225
    v_max_f32 v224, v224, v225
    v_mov_b32 v225, v224
    s_nop 1
    v_permlane16_swap_b32 v224, v225
    v_max_f32 v224, v224, v225
    v_add_f32 v224, 0x41000000, v224
    v_max_f32 v224, 0, v224
    v_exp_f32 v225, -v224
    v_sub_f32 v8, v8, v224
    v_sub_f32 v40, v40, v224
    v_sub_f32 v9, v9, v224
    v_sub_f32 v41, v41, v224
    v_sub_f32 v10, v10, v224
    v_sub_f32 v42, v42, v224
    v_sub_f32 v11, v11, v224
    v_sub_f32 v43, v43, v224
    v_sub_f32 v12, v12, v224
    v_sub_f32 v44, v44, v224
    v_sub_f32 v13, v13, v224
    v_sub_f32 v45, v45, v224
    v_sub_f32 v14, v14, v224
    v_sub_f32 v46, v46, v224
    v_sub_f32 v15, v15, v224
    v_sub_f32 v47, v47, v224
    v_mul_f32 v96, v96, v225
    v_mul_f32 v97, v97, v225
    v_mul_f32 v98, v98, v225
    v_mul_f32 v99, v99, v225
    v_mul_f32 v100, v100, v225
    v_mul_f32 v101, v101, v225
    v_mul_f32 v102, v102, v225
    v_mul_f32 v103, v103, v225
    v_mul_f32 v104, v104, v225
    v_mul_f32 v105, v105, v225
    v_mul_f32 v106, v106, v225
    v_mul_f32 v107, v107, v225
    v_mul_f32 v108, v108, v225
    v_mul_f32 v109, v109, v225
    v_mul_f32 v110, v110, v225
    v_mul_f32 v111, v111, v225
    v_mul_f32 v112, v112, v225
    v_mul_f32 v113, v113, v225
    v_mul_f32 v114, v114, v225
    v_mul_f32 v115, v115, v225
    v_mul_f32 v116, v116, v225
    v_mul_f32 v117, v117, v225
    v_mul_f32 v118, v118, v225
    v_mul_f32 v119, v119, v225
    v_mul_f32 v120, v120, v225
    v_mul_f32 v121, v121, v225
    v_mul_f32 v122, v122, v225
    v_mul_f32 v123, v123, v225
    v_mul_f32 v124, v124, v225
    v_mul_f32 v125, v125, v225
    v_mul_f32 v126, v126, v225
    v_mul_f32 v127, v127, v225
    v_accvgpr_read_b32 v226, a132
    v_accvgpr_read_b32 v227, a133
    v_accvgpr_read_b32 v228, a134
    v_accvgpr_read_b32 v229, a135
    v_mul_f32 v226, v226, v225
    v_mul_f32 v227, v227, v225
    v_mul_f32 v228, v228, v225
    v_mul_f32 v229, v229, v225
    v_accvgpr_write_b32 a132, v226
    v_accvgpr_write_b32 a133, v227
    v_accvgpr_write_b32 a134, v228
    v_accvgpr_write_b32 a135, v229
    v_exp_f32 v216, v8
    v_exp_f32 v217, v9
    v_exp_f32 v218, v10
    v_exp_f32 v219, v11
    v_exp_f32 v220, v12
    v_exp_f32 v221, v13
    v_exp_f32 v222, v14
    v_exp_f32 v223, v15
    v_cvt_pk_bf16_f32 v196, v216, v217
    v_cvt_pk_bf16_f32 v197, v218, v219
    v_cvt_pk_bf16_f32 v198, v220, v221
    v_cvt_pk_bf16_f32 v199, v222, v223
    s_nop 1
    s_branch L_fixb_42
L_fix_43:
    s_nop 7
    s_nop 1
    v_max3_f32 v224, v0, v1, v2
    v_max3_f32 v225, v3, v4, v5
    v_max3_f32 v224, v224, v6, v7
    v_max_f32 v224, v224, v225
    v_mov_b32 v225, v224
    s_nop 1
    v_permlane32_swap_b32 v224, v225
    v_max_f32 v224, v224, v225
    v_mov_b32 v225, v224
    s_nop 1
    v_permlane16_swap_b32 v224, v225
    v_max_f32 v224, v224, v225
    v_add_f32 v224, 0x41000000, v224
    v_max_f32 v224, 0, v224
    v_exp_f32 v225, -v224
    v_sub_f32 v0, v0, v224
    v_sub_f32 v32, v32, v224
    v_sub_f32 v1, v1, v224
    v_sub_f32 v33, v33, v224
    v_sub_f32 v2, v2, v224
    v_sub_f32 v34, v34, v224
    v_sub_f32 v3, v3, v224
    v_sub_f32 v35, v35, v224
    v_sub_f32 v4, v4, v224
    v_sub_f32 v36, v36, v224
    v_sub_f32 v5, v5, v224
    v_sub_f32 v37, v37, v224
    v_sub_f32 v6, v6, v224
    v_sub_f32 v38, v38, v224
    v_sub_f32 v7, v7, v224
    v_sub_f32 v39, v39, v224
    v_mul_f32 v64, v64, v225
    v_mul_f32 v65, v65, v225
    v_mul_f32 v66, v66, v225
    v_mul_f32 v67, v67, v225
    v_mul_f32 v68, v68, v225
    v_mul_f32 v69, v69, v225
    v_mul_f32 v70, v70, v225
    v_mul_f32 v71, v71, v225
    v_mul_f32 v72, v72, v225
    v_mul_f32 v73, v73, v225
    v_mul_f32 v74, v74, v225
    v_mul_f32 v75, v75, v225
    v_mul_f32 v76, v76, v225
    v_mul_f32 v77, v77, v225
    v_mul_f32 v78, v78, v225
    v_mul_f32 v79, v79, v225
    v_mul_f32 v80, v80, v225
    v_mul_f32 v81, v81, v225
    v_mul_f32 v82, v82, v225
    v_mul_f32 v83, v83, v225
    v_mul_f32 v84, v84, v225
    v_mul_f32 v85, v85, v225
    v_mul_f32 v86, v86, v225
    v_mul_f32 v87, v87, v225
    v_mul_f32 v88, v88, v225
    v_mul_f32 v89, v89, v225
    v_mul_f32 v90, v90, v225
    v_mul_f32 v91, v91, v225
    v_mul_f32 v92, v92, v225
    v_mul_f32 v93, v93, v225
    v_mul_f32 v94, v94, v225
    v_mul_f32 v95, v95, v225
    v_accvgpr_read_b32 v226, a128
    v_accvgpr_read_b32 v227, a129
    v_accvgpr_read_b32 v228, a130
    v_accvgpr_read_b32 v229, a131
    v_mul_f32 v226, v226, v225
    v_mul_f32 v227, v227, v225
    v_mul_f32 v228, v228, v225
    v_mul_f32 v229, v229, v225
    v_accvgpr_write_b32 a128, v226
    v_accvgpr_write_b32 a129, v227
    v_accvgpr_write_b32 a130, v228
    v_accvgpr_write_b32 a131, v229
    v_exp_f32 v216, v0
    v_exp_f32 v217, v1
    v_exp_f32 v218, v2
    v_exp_f32 v219, v3
    v_exp_f32 v220, v4
    v_exp_f32 v221, v5
    v_exp_f32 v222, v6
    v_exp_f32 v223, v7
    v_cvt_pk_bf16_f32 v192, v216, v217
    v_cvt_pk_bf16_f32 v193, v218, v219
    v_cvt_pk_bf16_f32 v194, v220, v221
    v_cvt_pk_bf16_f32 v195, v222, v223
    s_nop 1
    s_branch L_fixb_44
L_spin_50:
    s_mov_b32 s75, 1048576
L_spin_50_l:
    buffer_load_dword v241, v242, s[48:51], s99 offen sc1
    s_waitcnt vmcnt(0)
    v_cmp_ne_u32 vcc, 1, v241
    s_nop 1
    s_cbranch_vccz L_back_51
    s_sub_u32 s75, s75, 1
    s_cmp_lg_u32 s75, 0
    s_cbranch_scc1 L_spin_50_l
    s_branch L_back_51
L_fix_54:
    s_nop 7
    s_nop 1
    v_max3_f32 v224, v8, v9, v10
    v_max3_f32 v225, v11, v12, v13
    v_max3_f32 v224, v224, v14, v15
    v_max_f32 v224, v224, v225
    v_mov_b32 v225, v224
    s_nop 1
    v_permlane32_swap_b32 v224, v225
    v_max_f32 v224, v224, v225
    v_mov_b32 v225, v224
    s_nop 1
    v_permlane16_swap_b32 v224, v225
    v_max_f32 v224, v224, v225
    v_add_f32 v224, 0x41000000, v224
    v_max_f32 v224, 0, v224
    v_exp_f32 v225, -v224
    v_sub_f32 v8, v8, v224
    v_sub_f32 v40, v40, v224
    v_sub_f32 v9, v9, v224
    v_sub_f32 v41, v41, v224
    v_sub_f32 v10, v10, v224
    v_sub_f32 v42, v42, v224
    v_sub_f32 v11, v11, v224
    v_sub_f32 v43, v43, v224
    v_sub_f32 v12, v12, v224
    v_sub_f32 v44, v44, v224
    v_sub_f32 v13, v13, v224
    v_sub_f32 v45, v45, v224
    v_sub_f32 v14, v14, v224
    v_sub_f32 v46, v46, v224
    v_sub_f32 v15, v15, v224
    v_sub_f32 v47, v47, v224
    v_mul_f32 v96, v96, v225
    v_mul_f32 v97, v97, v225
    v_mul_f32 v98, v98, v225
    v_mul_f32 v99, v99, v225
    v_mul_f32 v100, v100, v225
    v_mul_f32 v101, v101, v225
    v_mul_f32 v102, v102, v225
    v_mul_f32 v103, v103, v225
    v_mul_f32 v104, v104, v225
    v_mul_f32 v105, v105, v225
    v_mul_f32 v106, v106, v225
    v_mul_f32 v107, v107, v225
    v_mul_f32 v108, v108, v225
    v_mul_f32 v109, v109, v225
    v_mul_f32 v110, v110, v225
    v_mul_f32 v111, v111, v225
    v_mul_f32 v112, v112, v225
    v_mul_f32 v113, v113, v225
    v_mul_f32 v114, v114, v225
    v_mul_f32 v115, v115, v225
    v_mul_f32 v116, v116, v225
    v_mul_f32 v117, v117, v225
    v_mul_f32 v118, v118, v225
    v_mul_f32 v119, v119, v225
    v_mul_f32 v120, v120, v225
    v_mul_f32 v121, v121, v225
    v_mul_f32 v122, v122, v225
    v_mul_f32 v123, v123, v225
    v_mul_f32 v124, v124, v225
    v_mul_f32 v125, v125, v225
    v_mul_f32 v126, v126, v225
    v_mul_f32 v127, v127, v225
    v_accvgpr_read_b32 v226, a132
    v_accvgpr_read_b32 v227, a133
    v_accvgpr_read_b32 v228, a134
    v_accvgpr_read_b32 v229, a135
    v_mul_f32 v226, v226, v225
    v_mul_f32 v227, v227, v225
    v_mul_f32 v228, v228, v225
    v_mul_f32 v229, v229, v225
    v_accvgpr_write_b32 a132, v226
    v_accvgpr_write_b32 a133, v227
    v_accvgpr_write_b32 a134, v228
    v_accvgpr_write_b32 a135, v229
    v_exp_f32 v216, v8
    v_exp_f32 v217, v9
    v_exp_f32 v218, v10
    v_exp_f32 v219, v11
    v_exp_f32 v220, v12
    v_exp_f32 v221, v13
    v_exp_f32 v222, v14
    v_exp_f32 v223, v15
    v_cvt_pk_bf16_f32 v196, v216, v217
    v_cvt_pk_bf16_f32 v197, v218, v219
    v_cvt_pk_bf16_f32 v198, v220, v221
    v_cvt_pk_bf16_f32 v199, v222, v223
    s_nop 1
    s_branch L_fixb_55
L_fix_56:
    s_nop 7
    s_nop 1
    v_max3_f32 v224, v0, v1, v2
    v_max3_f32 v225, v3, v4, v5
    v_max3_f32 v224, v224, v6, v7
    v_max_f32 v224, v224, v225
    v_mov_b32 v225, v224
    s_nop 1
    v_permlane32_swap_b32 v224, v225
    v_max_f32 v224, v224, v225
    v_mov_b32 v225, v224
    s_nop 1
    v_permlane16_swap_b32 v224, v225
    v_max_f32 v224, v224, v225
    v_add_f32 v224, 0x41000000, v224
    v_max_f32 v224, 0, v224
    v_exp_f32 v225, -v224
    v_sub_f32 v0, v0, v224
    v_sub_f32 v32, v32, v224
    v_sub_f32 v1, v1, v224
    v_sub_f32 v33, v33, v224
    v_sub_f32 v2, v2, v224
    v_sub_f32 v34, v34, v224
    v_sub_f32 v3, v3, v224
    v_sub_f32 v35, v35, v224
    v_sub_f32 v4, v4, v224
    v_sub_f32 v36, v36, v224
    v_sub_f32 v5, v5, v224
    v_sub_f32 v37, v37, v224
    v_sub_f32 v6, v6, v224
    v_sub_f32 v38, v38, v224
    v_sub_f32 v7, v7, v224
    v_sub_f32 v39, v39, v224
    v_mul_f32 v64, v64, v225
    v_mul_f32 v65, v65, v225
    v_mul_f32 v66, v66, v225
    v_mul_f32 v67, v67, v225
    v_mul_f32 v68, v68, v225
    v_mul_f32 v69, v69, v225
    v_mul_f32 v70, v70, v225
    v_mul_f32 v71, v71, v225
    v_mul_f32 v72, v72, v225
    v_mul_f32 v73, v73, v225
    v_mul_f32 v74, v74, v225
    v_mul_f32 v75, v75, v225
    v_mul_f32 v76, v76, v225
    v_mul_f32 v77, v77, v225
    v_mul_f32 v78, v78, v225
    v_mul_f32 v79, v79, v225
    v_mul_f32 v80, v80, v225
    v_mul_f32 v81, v81, v225
    v_mul_f32 v82, v82, v225
    v_mul_f32 v83, v83, v225
    v_mul_f32 v84, v84, v225
    v_mul_f32 v85, v85, v225
    v_mul_f32 v86, v86, v225
    v_mul_f32 v87, v87, v225
    v_mul_f32 v88, v88, v225
    v_mul_f32 v89, v89, v225
    v_mul_f32 v90, v90, v225
    v_mul_f32 v91, v91, v225
    v_mul_f32 v92, v92, v225
    v_mul_f32 v93, v93, v225
    v_mul_f32 v94, v94, v225
    v_mul_f32 v95, v95, v225
    v_accvgpr_read_b32 v226, a128
    v_accvgpr_read_b32 v227, a129
    v_accvgpr_read_b32 v228, a130
    v_accvgpr_read_b32 v229, a131
    v_mul_f32 v226, v226, v225
    v_mul_f32 v227, v227, v225
    v_mul_f32 v228, v228, v225
    v_mul_f32 v229, v229, v225
    v_accvgpr_write_b32 a128, v226
    v_accvgpr_write_b32 a129, v227
    v_accvgpr_write_b32 a130, v228
    v_accvgpr_write_b32 a131, v229
    v_exp_f32 v216, v0
    v_exp_f32 v217, v1
    v_exp_f32 v218, v2
    v_exp_f32 v219, v3
    v_exp_f32 v220, v4
    v_exp_f32 v221, v5
    v_exp_f32 v222, v6
    v_exp_f32 v223, v7
    v_cvt_pk_bf16_f32 v192, v216, v217
    v_cvt_pk_bf16_f32 v193, v218, v219
    v_cvt_pk_bf16_f32 v194, v220, v221
    v_cvt_pk_bf16_f32 v195, v222, v223
    s_nop 1
    s_branch L_fixb_57
L_spin_63:
    s_mov_b32 s75, 1048576
L_spin_63_l:
    buffer_load_dword v241, v242, s[48:51], s99 offen sc1
    s_waitcnt vmcnt(0)
    v_cmp_ne_u32 vcc, 1, v241
    s_nop 1
    s_cbranch_vccz L_back_64
    s_sub_u32 s75, s75, 1
    s_cmp_lg_u32 s75, 0
    s_cbranch_scc1 L_spin_63_l
    s_branch L_back_64
L_fix_65:
    s_nop 7
    s_nop 1
    v_max3_f32 v224, v0, v1, v2
    v_max3_f32 v225, v3, v4, v5
    v_max3_f32 v224, v224, v6, v7
    v_max_f32 v224, v224, v225
    v_mov_b32 v225, v224
    s_nop 1
    v_permlane32_swap_b32 v224, v225
    v_max_f32 v224, v224, v225
    v_mov_b32 v225, v224
    s_nop 1
    v_permlane16_swap_b32 v224, v225
    v_max_f32 v224, v224, v225
    v_add_f32 v224, 0x41000000, v224
    v_max_f32 v224, 0, v224
    v_exp_f32 v225, -v224
    v_sub_f32 v0, v0, v224
    v_sub_f32 v32, v32, v224
    v_sub_f32 v1, v1, v224
    v_sub_f32 v33, v33, v224
    v_sub_f32 v2, v2, v224
    v_sub_f32 v34, v34, v224
    v_sub_f32 v3, v3, v224
    v_sub_f32 v35, v35, v224
    v_sub_f32 v4, v4, v224
    v_sub_f32 v36, v36, v224
    v_sub_f32 v5, v5, v224
    v_sub_f32 v37, v37, v224
    v_sub_f32 v6, v6, v224
    v_sub_f32 v38, v38, v224
    v_sub_f32 v7, v7, v224
    v_sub_f32 v39, v39, v224
    v_mul_f32 v64, v64, v225
    v_mul_f32 v65, v65, v225
    v_mul_f32 v66, v66, v225
    v_mul_f32 v67, v67, v225
    v_mul_f32 v68, v68, v225
    v_mul_f32 v69, v69, v225
    v_mul_f32 v70, v70, v225
    v_mul_f32 v71, v71, v225
    v_mul_f32 v72, v72, v225
    v_mul_f32 v73, v73, v225
    v_mul_f32 v74, v74, v225
    v_mul_f32 v75, v75, v225
    v_mul_f32 v76, v76, v225
    v_mul_f32 v77, v77, v225
    v_mul_f32 v78, v78, v225
    v_mul_f32 v79, v79, v225
    v_mul_f32 v80, v80, v225
    v_mul_f32 v81, v81, v225
    v_mul_f32 v82, v82, v225
    v_mul_f32 v83, v83, v225
    v_mul_f32 v84, v84, v225
    v_mul_f32 v85, v85, v225
    v_mul_f32 v86, v86, v225
    v_mul_f32 v87, v87, v225
    v_mul_f32 v88, v88, v225
    v_mul_f32 v89, v89, v225
    v_mul_f32 v90, v90, v225
    v_mul_f32 v91, v91, v225
    v_mul_f32 v92, v92, v225
    v_mul_f32 v93, v93, v225
    v_mul_f32 v94, v94, v225
    v_mul_f32 v95, v95, v225
    v_accvgpr_read_b32 v226, a128
    v_accvgpr_read_b32 v227, a129
    v_accvgpr_read_b32 v228, a130
    v_accvgpr_read_b32 v229, a131
    v_mul_f32 v226, v226, v225
    v_mul_f32 v227, v227, v225
    v_mul_f32 v228, v228, v225
    v_mul_f32 v229, v229, v225
    v_accvgpr_write_b32 a128, v226
    v_accvgpr_write_b32 a129, v227
    v_accvgpr_write_b32 a130, v228
    v_accvgpr_write_b32 a131, v229
    v_exp_f32 v216, v0
    v_exp_f32 v217, v1
    v_exp_f32 v218, v2
    v_exp_f32 v219, v3
    v_exp_f32 v220, v4
    v_exp_f32 v221, v5
    v_exp_f32 v222, v6
    v_exp_f32 v223, v7
    v_cvt_pk_bf16_f32 v192, v216, v217
    v_cvt_pk_bf16_f32 v193, v218, v219
    v_cvt_pk_bf16_f32 v194, v220, v221
    v_cvt_pk_bf16_f32 v195, v222, v223
    s_nop 1
    s_branch L_fixb_66
L_spin_67:
    s_mov_b32 s75, 1048576
L_spin_67_l:
    buffer_load_dword v234, v250, s[48:51], s100 offen sc1
    s_waitcnt vmcnt(0)
    v_cmp_ne_u32 vcc, 1, v234
    s_nop 1
    s_cbranch_vccz L_back_68
    s_sub_u32 s75, s75, 1
    s_cmp_lg_u32 s75, 0
    s_cbranch_scc1 L_spin_67_l
    s_branch L_back_68
L_exs_69:
    s_mov_b32 s75, 1048576
L_exs_69_l:
    buffer_load_dwordx4 v[112:115], v245, s[48:51], s94 offen offset:0 sc1
    buffer_load_dwordx4 v[116:119], v245, s[48:51], s94 offen offset:1024 sc1
    buffer_load_dwordx4 v[120:123], v245, s[48:51], s95 offen offset:0 sc1
    buffer_load_dwordx4 v[124:127], v245, s[48:51], s95 offen offset:1024 sc1
    buffer_load_dwordx4 v[128:131], v245, s[48:51], s59 offen offset:0 sc1
    buffer_load_dwordx4 v[132:135], v245, s[48:51], s59 offen offset:1024 sc1
    s_waitcnt vmcnt(0)
    v_max3_u32 v234, v112, v113, v114
    v_max3_u32 v234, v234, v115, v116
    v_max3_u32 v234, v234, v117, v118
    v_max3_u32 v234, v234, v119, v120
    v_max3_u32 v234, v234, v121, v122
    v_max3_u32 v234, v234, v123, v124
    v_max3_u32 v234, v234, v125, v126
    v_max3_u32 v234, v234, v127, v128
    v_max3_u32 v234, v234, v129, v130
    v_max3_u32 v234, v234, v131, v132
    v_max3_u32 v234, v234, v133, v134
    v_max_u32 v234, v234, v135
    v_cmp_eq_u32 vcc, -1, v234
    s_nop 1
    s_cbranch_vccz L_exs_69_x
    s_sub_u32 s75, s75, 1
    s_cmp_lg_u32 s75, 0
    s_cbranch_scc1 L_exs_69_l
L_exs_69_x:
    s_branch L_exb_70
    s_endpgm
.section .rodata,"a"
.p2align 6
.amdhsa_kernel parallel_sum__compressed_kv_cla__geglu_ffn__prompt_kernel
  .amdhsa_next_free_vgpr 512
  .amdhsa_next_free_sgpr 102
  .amdhsa_accum_offset 256
  .amdhsa_group_segment_fixed_size 0
  .amdhsa_kernarg_size 104
  .amdhsa_user_sgpr_count 2
  .amdhsa_user_sgpr_kernarg_segment_ptr 1
  .amdhsa_system_sgpr_workgroup_id_x 1
  .amdhsa_float_denorm_mode_32 3
.end_amdhsa_kernel
```
